```python
import torch

def _softmax(x, axis=-1):
    return torch.softmax(x, dim=axis)

def _gelu(x):
    return torch.nn.functional.gelu(x, approximate='tanh')

def _silu(x):
    return torch.nn.functional.silu(x)

def _sigmoid(x):
    return torch.sigmoid(x)

def _layernorm(x, axis=-1, eps=1e-05):
    m = x.mean(dim=axis, keepdim=True)
    v = x.var(dim=axis, keepdim=True, unbiased=False)
    return (x - m) / torch.sqrt(v + eps)

def _scatter_add(tgt, idx, src, axis=0):
    return tgt.clone().index_add_(axis, idx, src)

def _segment_sum(src, seg, n):
    out = torch.zeros((n,) + src.shape[1:], dtype=src.dtype)
    return out.index_add_(0, seg, src)

def _pad(x, pw):
    flat = tuple((v for pair in reversed(pw) for v in pair))
    return torch.nn.functional.pad(x, flat)
kernel_name = 'parallel_sum__linear_attn_block__mixer_gmlp__prompt'

def setup_inputs():

    _w = lambda a: (lambda t: t.to(torch.bfloat16) if t.is_floating_point() else t)(torch.as_tensor(a))

    def _A_setup():
        B, S, D = (1, 2048, 576)
        return {'x': _w((lambda *s: torch.randn(*s, dtype=torch.bfloat16) * 0.05)(B, S, D)), 'wqkv': _w((lambda *s: torch.randn(*s, dtype=torch.bfloat16) * 1.6)(D, 3 * D)), 'wo': _w((lambda *s: torch.randn(*s, dtype=torch.bfloat16) * 0.2)(D, D))}
    _A_in = _A_setup()

    def _B_setup():
        B, S, D, F = (1, 2048, 576, 4608)
        Fh = F // 2
        return {'x': _w((lambda *s: torch.randn(*s, dtype=torch.bfloat16) * 0.05)(B, S, D)), 'w_in': _w((lambda *s: torch.randn(*s, dtype=torch.bfloat16) * 0.4)(D, 2 * Fh)), 'w_sp': _w(0.01 * (lambda *s: torch.randn(*s, dtype=torch.bfloat16) * 0.4)(S, S)), 'b_sp': _w(1.0 + 0.01 * (lambda *s: torch.randn(*s, dtype=torch.bfloat16) * 0.05)(S)), 'w_out': _w((lambda *s: torch.randn(*s, dtype=torch.bfloat16) * 0.05)(Fh, D))}
    _B_in = _B_setup()
    return {'A_x': _A_in['x'], 'A_wqkv': _A_in['wqkv'], 'A_wo': _A_in['wo'], 'B_x': _B_in['x'], 'B_w_in': _B_in['w_in'], 'B_w_sp': _B_in['w_sp'], 'B_b_sp': _B_in['b_sp'], 'B_w_out': _B_in['w_out']}

def reference(A_x, A_wqkv, A_wo, B_x, B_w_in, B_w_sp, B_b_sp, B_w_out):

    def _A_ref(x, wqkv, wo):
        B, S, D = x.shape
        H = 32
        Dh = D // H
        qkv = (lambda x, *d: x.permute(*d))((x @ wqkv).reshape(B, S, 3, H, Dh), 2, 0, 3, 1, 4)
        q, k, v = (qkv[0], qkv[1], qkv[2])
        phi = lambda t: torch.where(t > 0, t + 1, torch.exp(t)) + 1e-06
        pq, pk = (phi(q), phi(k))
        kv = torch.einsum('bhsd,bhse->bhde', pk, v)
        z = torch.einsum('bhsd->bhd', pk)
        num = torch.einsum('bhqd,bhde->bhqe', pq, kv)
        den = torch.einsum('bhqd,bhd->bhq', pq, z)[..., None] + 1e-06
        o = num / den
        return (lambda x, *d: x.permute(*d))(o, 0, 2, 1, 3).reshape(B, S, D) @ wo

    def _B_ref(x, w_in, w_sp, b_sp, w_out):
        B, S, D = x.shape
        F = w_in.shape[-1]
        Fh = F // 2
        z = _gelu(torch.einsum('bsd,df->bsf', x, w_in))
        z1 = z[..., :Fh].clone()
        z2 = _layernorm(z[..., Fh:], axis=-1)
        g = torch.einsum('ts,bsf->btf', w_sp, z2) + b_sp[None, :, None]
        return torch.einsum('bsf,fd->bsd', z1 * g, w_out)
    x = A_x
    xn = _layernorm(x, axis=-1)
    return x + _A_ref(xn, A_wqkv, A_wo) + _B_ref(xn, B_w_in, B_w_sp, B_b_sp, B_w_out)
```

```asm
; @launch kernel=ln_kernel grid=(256,1,1) block=(256,1,1) lds=0
; @launch kernel=gemm1_kernel grid=(256,1,1) block=(512,1,1) lds=163840
; @launch kernel=gemm2_kernel grid=(256,1,1) block=(256,1,1) lds=163840
; @launch kernel=gemm3_kernel grid=(240,1,1) block=(256,1,1) lds=81920
.amdgcn_target "amdgcn-amd-amdhsa--gfx950"
.text
.globl ln_kernel
.p2align 8
.type ln_kernel,@function
ln_kernel:
    s_cmp_ge_u32 s2, 256
    s_cbranch_scc1 L_ln_kernel_end
    s_load_dwordx4 s[4:7], s[0:1], 0
    s_load_dwordx2 s[20:21], s[0:1], 80
    s_load_dwordx2 s[22:23], s[0:1], 32
    s_load_dwordx2 s[36:37], s[0:1], 48
    s_load_dwordx2 s[40:41], s[0:1], 16
    v_readfirstlane_b32 s24, v0
    s_nop 0
    s_cmp_ge_u32 s24, 128
    s_cbranch_scc1 L_ln_kernel_aux
    v_lshrrev_b32 v1, 4, v0
    v_and_b32 v2, 15, v0
    s_lshl_b32 s3, s2, 3
    v_add_u32 v1, s3, v1
    v_mul_u32_u24 v3, 1152, v1
    v_lshl_add_u32 v3, v2, 3, v3
    s_waitcnt lgkmcnt(0)
    s_mov_b32 s8, s4
    s_mov_b32 s9, s5
    s_mov_b32 s10, 2359296
    s_mov_b32 s11, 0x20000
    buffer_load_dwordx2 v[10:11], v3, s[8:11], 0 offen offset:0
    buffer_load_dwordx2 v[12:13], v3, s[8:11], 0 offen offset:128
    buffer_load_dwordx2 v[14:15], v3, s[8:11], 0 offen offset:256
    buffer_load_dwordx2 v[16:17], v3, s[8:11], 0 offen offset:384
    buffer_load_dwordx2 v[18:19], v3, s[8:11], 0 offen offset:512
    buffer_load_dwordx2 v[20:21], v3, s[8:11], 0 offen offset:640
    buffer_load_dwordx2 v[22:23], v3, s[8:11], 0 offen offset:768
    buffer_load_dwordx2 v[24:25], v3, s[8:11], 0 offen offset:896
    buffer_load_dwordx2 v[26:27], v3, s[8:11], 0 offen offset:1024
    s_mov_b32 s12, s20
    s_mov_b32 s13, s21
    s_mov_b32 s14, 67108864
    s_mov_b32 s15, 0x20000
    v_lshrrev_b32 v4, 5, v1
    v_mul_u32_u24 v4, 36, v4
    v_lshrrev_b32 v5, 2, v2
    v_add_u32 v4, v4, v5
    v_lshlrev_b32 v4, 10, v4
    v_and_b32 v5, 31, v1
    v_lshl_add_u32 v4, v5, 4, v4
    v_bfe_u32 v5, v2, 1, 1
    v_lshl_add_u32 v4, v5, 9, v4
    v_and_b32 v5, 1, v2
    v_lshl_add_u32 v4, v5, 3, v4
    s_waitcnt vmcnt(0)
    v_lshlrev_b32 v32, 16, v10
    v_and_b32 v33, 0xffff0000, v10
    v_lshlrev_b32 v34, 16, v11
    v_and_b32 v35, 0xffff0000, v11
    v_lshlrev_b32 v36, 16, v12
    v_and_b32 v37, 0xffff0000, v12
    v_lshlrev_b32 v38, 16, v13
    v_and_b32 v39, 0xffff0000, v13
    v_lshlrev_b32 v40, 16, v14
    v_and_b32 v41, 0xffff0000, v14
    v_lshlrev_b32 v42, 16, v15
    v_and_b32 v43, 0xffff0000, v15
    v_lshlrev_b32 v44, 16, v16
    v_and_b32 v45, 0xffff0000, v16
    v_lshlrev_b32 v46, 16, v17
    v_and_b32 v47, 0xffff0000, v17
    v_lshlrev_b32 v48, 16, v18
    v_and_b32 v49, 0xffff0000, v18
    v_lshlrev_b32 v50, 16, v19
    v_and_b32 v51, 0xffff0000, v19
    v_lshlrev_b32 v52, 16, v20
    v_and_b32 v53, 0xffff0000, v20
    v_lshlrev_b32 v54, 16, v21
    v_and_b32 v55, 0xffff0000, v21
    v_lshlrev_b32 v56, 16, v22
    v_and_b32 v57, 0xffff0000, v22
    v_lshlrev_b32 v58, 16, v23
    v_and_b32 v59, 0xffff0000, v23
    v_lshlrev_b32 v60, 16, v24
    v_and_b32 v61, 0xffff0000, v24
    v_lshlrev_b32 v62, 16, v25
    v_and_b32 v63, 0xffff0000, v25
    v_lshlrev_b32 v64, 16, v26
    v_and_b32 v65, 0xffff0000, v26
    v_lshlrev_b32 v66, 16, v27
    v_and_b32 v67, 0xffff0000, v27
    v_add_f32 v6, v32, v33
    v_add_f32 v7, v34, v35
    v_add_f32 v6, v6, v36
    v_add_f32 v7, v7, v37
    v_add_f32 v6, v6, v38
    v_add_f32 v7, v7, v39
    v_add_f32 v6, v6, v40
    v_add_f32 v7, v7, v41
    v_add_f32 v6, v6, v42
    v_add_f32 v7, v7, v43
    v_add_f32 v6, v6, v44
    v_add_f32 v7, v7, v45
    v_add_f32 v6, v6, v46
    v_add_f32 v7, v7, v47
    v_add_f32 v6, v6, v48
    v_add_f32 v7, v7, v49
    v_add_f32 v6, v6, v50
    v_add_f32 v7, v7, v51
    v_add_f32 v6, v6, v52
    v_add_f32 v7, v7, v53
    v_add_f32 v6, v6, v54
    v_add_f32 v7, v7, v55
    v_add_f32 v6, v6, v56
    v_add_f32 v7, v7, v57
    v_add_f32 v6, v6, v58
    v_add_f32 v7, v7, v59
    v_add_f32 v6, v6, v60
    v_add_f32 v7, v7, v61
    v_add_f32 v6, v6, v62
    v_add_f32 v7, v7, v63
    v_add_f32 v6, v6, v64
    v_add_f32 v7, v7, v65
    v_add_f32 v6, v6, v66
    v_add_f32 v7, v7, v67
    v_add_f32 v6, v6, v7
    s_nop 1
    v_add_f32_dpp v6, v6, v6 quad_perm:[1,0,3,2] row_mask:0xf bank_mask:0xf
    s_nop 1
    v_add_f32_dpp v6, v6, v6 quad_perm:[2,3,0,1] row_mask:0xf bank_mask:0xf
    s_nop 1
    v_add_f32_dpp v6, v6, v6 row_half_mirror row_mask:0xf bank_mask:0xf
    s_nop 1
    v_add_f32_dpp v6, v6, v6 row_mirror row_mask:0xf bank_mask:0xf
    v_mul_f32 v6, 0x3ae38e39, v6
    v_mov_b32 v7, 0
    v_mov_b32 v8, 0
    v_sub_f32 v28, v32, v6
    v_sub_f32 v29, v33, v6
    v_fmac_f32 v7, v28, v28
    v_fmac_f32 v8, v29, v29
    v_sub_f32 v28, v34, v6
    v_sub_f32 v29, v35, v6
    v_fmac_f32 v7, v28, v28
    v_fmac_f32 v8, v29, v29
    v_sub_f32 v28, v36, v6
    v_sub_f32 v29, v37, v6
    v_fmac_f32 v7, v28, v28
    v_fmac_f32 v8, v29, v29
    v_sub_f32 v28, v38, v6
    v_sub_f32 v29, v39, v6
    v_fmac_f32 v7, v28, v28
    v_fmac_f32 v8, v29, v29
    v_sub_f32 v28, v40, v6
    v_sub_f32 v29, v41, v6
    v_fmac_f32 v7, v28, v28
    v_fmac_f32 v8, v29, v29
    v_sub_f32 v28, v42, v6
    v_sub_f32 v29, v43, v6
    v_fmac_f32 v7, v28, v28
    v_fmac_f32 v8, v29, v29
    v_sub_f32 v28, v44, v6
    v_sub_f32 v29, v45, v6
    v_fmac_f32 v7, v28, v28
    v_fmac_f32 v8, v29, v29
    v_sub_f32 v28, v46, v6
    v_sub_f32 v29, v47, v6
    v_fmac_f32 v7, v28, v28
    v_fmac_f32 v8, v29, v29
    v_sub_f32 v28, v48, v6
    v_sub_f32 v29, v49, v6
    v_fmac_f32 v7, v28, v28
    v_fmac_f32 v8, v29, v29
    v_sub_f32 v28, v50, v6
    v_sub_f32 v29, v51, v6
    v_fmac_f32 v7, v28, v28
    v_fmac_f32 v8, v29, v29
    v_sub_f32 v28, v52, v6
    v_sub_f32 v29, v53, v6
    v_fmac_f32 v7, v28, v28
    v_fmac_f32 v8, v29, v29
    v_sub_f32 v28, v54, v6
    v_sub_f32 v29, v55, v6
    v_fmac_f32 v7, v28, v28
    v_fmac_f32 v8, v29, v29
    v_sub_f32 v28, v56, v6
    v_sub_f32 v29, v57, v6
    v_fmac_f32 v7, v28, v28
    v_fmac_f32 v8, v29, v29
    v_sub_f32 v28, v58, v6
    v_sub_f32 v29, v59, v6
    v_fmac_f32 v7, v28, v28
    v_fmac_f32 v8, v29, v29
    v_sub_f32 v28, v60, v6
    v_sub_f32 v29, v61, v6
    v_fmac_f32 v7, v28, v28
    v_fmac_f32 v8, v29, v29
    v_sub_f32 v28, v62, v6
    v_sub_f32 v29, v63, v6
    v_fmac_f32 v7, v28, v28
    v_fmac_f32 v8, v29, v29
    v_sub_f32 v28, v64, v6
    v_sub_f32 v29, v65, v6
    v_fmac_f32 v7, v28, v28
    v_fmac_f32 v8, v29, v29
    v_sub_f32 v28, v66, v6
    v_sub_f32 v29, v67, v6
    v_fmac_f32 v7, v28, v28
    v_fmac_f32 v8, v29, v29
    v_add_f32 v7, v7, v8
    s_nop 1
    v_add_f32_dpp v7, v7, v7 quad_perm:[1,0,3,2] row_mask:0xf bank_mask:0xf
    s_nop 1
    v_add_f32_dpp v7, v7, v7 quad_perm:[2,3,0,1] row_mask:0xf bank_mask:0xf
    s_nop 1
    v_add_f32_dpp v7, v7, v7 row_half_mirror row_mask:0xf bank_mask:0xf
    s_nop 1
    v_add_f32_dpp v7, v7, v7 row_mirror row_mask:0xf bank_mask:0xf
    v_mul_f32 v7, 0x3ae38e39, v7
    v_cvt_pk_bf16_f32 v8, v6, v7
    v_lshlrev_b32 v6, 16, v8
    v_and_b32 v7, 0xffff0000, v8
    v_add_f32 v7, 0x3727c5ac, v7
    v_cvt_pk_bf16_f32 v7, v7, v7
    v_and_b32 v7, 0xffff0000, v7
    v_sqrt_f32 v7, v7
    s_nop 0
    v_cvt_pk_bf16_f32 v7, v7, v7
    v_and_b32 v7, 0xffff0000, v7
    v_rcp_f32 v7, v7
    s_mov_b32 s16, 0
    v_sub_f32 v32, v32, v6
    v_sub_f32 v33, v33, v6
    v_cvt_pk_bf16_f32 v28, v32, v33
    v_lshlrev_b32 v32, 16, v28
    v_and_b32 v33, 0xffff0000, v28
    v_mul_f32 v32, v32, v7
    v_mul_f32 v33, v33, v7
    v_cvt_pk_bf16_f32 v10, v32, v33
    v_sub_f32 v34, v34, v6
    v_sub_f32 v35, v35, v6
    v_cvt_pk_bf16_f32 v28, v34, v35
    v_lshlrev_b32 v34, 16, v28
    v_and_b32 v35, 0xffff0000, v28
    v_mul_f32 v34, v34, v7
    v_mul_f32 v35, v35, v7
    v_cvt_pk_bf16_f32 v11, v34, v35
    buffer_store_dwordx2 v[10:11], v4, s[12:15], s16 offen
    s_add_u32 s16, s16, 4096
    v_sub_f32 v36, v36, v6
    v_sub_f32 v37, v37, v6
    v_cvt_pk_bf16_f32 v28, v36, v37
    v_lshlrev_b32 v36, 16, v28
    v_and_b32 v37, 0xffff0000, v28
    v_mul_f32 v36, v36, v7
    v_mul_f32 v37, v37, v7
    v_cvt_pk_bf16_f32 v12, v36, v37
    v_sub_f32 v38, v38, v6
    v_sub_f32 v39, v39, v6
    v_cvt_pk_bf16_f32 v28, v38, v39
    v_lshlrev_b32 v38, 16, v28
    v_and_b32 v39, 0xffff0000, v28
    v_mul_f32 v38, v38, v7
    v_mul_f32 v39, v39, v7
    v_cvt_pk_bf16_f32 v13, v38, v39
    buffer_store_dwordx2 v[12:13], v4, s[12:15], s16 offen
    s_add_u32 s16, s16, 4096
    v_sub_f32 v40, v40, v6
    v_sub_f32 v41, v41, v6
    v_cvt_pk_bf16_f32 v28, v40, v41
    v_lshlrev_b32 v40, 16, v28
    v_and_b32 v41, 0xffff0000, v28
    v_mul_f32 v40, v40, v7
    v_mul_f32 v41, v41, v7
    v_cvt_pk_bf16_f32 v14, v40, v41
    v_sub_f32 v42, v42, v6
    v_sub_f32 v43, v43, v6
    v_cvt_pk_bf16_f32 v28, v42, v43
    v_lshlrev_b32 v42, 16, v28
    v_and_b32 v43, 0xffff0000, v28
    v_mul_f32 v42, v42, v7
    v_mul_f32 v43, v43, v7
    v_cvt_pk_bf16_f32 v15, v42, v43
    buffer_store_dwordx2 v[14:15], v4, s[12:15], s16 offen
    s_add_u32 s16, s16, 4096
    v_sub_f32 v44, v44, v6
    v_sub_f32 v45, v45, v6
    v_cvt_pk_bf16_f32 v28, v44, v45
    v_lshlrev_b32 v44, 16, v28
    v_and_b32 v45, 0xffff0000, v28
    v_mul_f32 v44, v44, v7
    v_mul_f32 v45, v45, v7
    v_cvt_pk_bf16_f32 v16, v44, v45
    v_sub_f32 v46, v46, v6
    v_sub_f32 v47, v47, v6
    v_cvt_pk_bf16_f32 v28, v46, v47
    v_lshlrev_b32 v46, 16, v28
    v_and_b32 v47, 0xffff0000, v28
    v_mul_f32 v46, v46, v7
    v_mul_f32 v47, v47, v7
    v_cvt_pk_bf16_f32 v17, v46, v47
    buffer_store_dwordx2 v[16:17], v4, s[12:15], s16 offen
    s_add_u32 s16, s16, 4096
    v_sub_f32 v48, v48, v6
    v_sub_f32 v49, v49, v6
    v_cvt_pk_bf16_f32 v28, v48, v49
    v_lshlrev_b32 v48, 16, v28
    v_and_b32 v49, 0xffff0000, v28
    v_mul_f32 v48, v48, v7
    v_mul_f32 v49, v49, v7
    v_cvt_pk_bf16_f32 v18, v48, v49
    v_sub_f32 v50, v50, v6
    v_sub_f32 v51, v51, v6
    v_cvt_pk_bf16_f32 v28, v50, v51
    v_lshlrev_b32 v50, 16, v28
    v_and_b32 v51, 0xffff0000, v28
    v_mul_f32 v50, v50, v7
    v_mul_f32 v51, v51, v7
    v_cvt_pk_bf16_f32 v19, v50, v51
    buffer_store_dwordx2 v[18:19], v4, s[12:15], s16 offen
    s_add_u32 s16, s16, 4096
    v_sub_f32 v52, v52, v6
    v_sub_f32 v53, v53, v6
    v_cvt_pk_bf16_f32 v28, v52, v53
    v_lshlrev_b32 v52, 16, v28
    v_and_b32 v53, 0xffff0000, v28
    v_mul_f32 v52, v52, v7
    v_mul_f32 v53, v53, v7
    v_cvt_pk_bf16_f32 v20, v52, v53
    v_sub_f32 v54, v54, v6
    v_sub_f32 v55, v55, v6
    v_cvt_pk_bf16_f32 v28, v54, v55
    v_lshlrev_b32 v54, 16, v28
    v_and_b32 v55, 0xffff0000, v28
    v_mul_f32 v54, v54, v7
    v_mul_f32 v55, v55, v7
    v_cvt_pk_bf16_f32 v21, v54, v55
    buffer_store_dwordx2 v[20:21], v4, s[12:15], s16 offen
    s_add_u32 s16, s16, 4096
    v_sub_f32 v56, v56, v6
    v_sub_f32 v57, v57, v6
    v_cvt_pk_bf16_f32 v28, v56, v57
    v_lshlrev_b32 v56, 16, v28
    v_and_b32 v57, 0xffff0000, v28
    v_mul_f32 v56, v56, v7
    v_mul_f32 v57, v57, v7
    v_cvt_pk_bf16_f32 v22, v56, v57
    v_sub_f32 v58, v58, v6
    v_sub_f32 v59, v59, v6
    v_cvt_pk_bf16_f32 v28, v58, v59
    v_lshlrev_b32 v58, 16, v28
    v_and_b32 v59, 0xffff0000, v28
    v_mul_f32 v58, v58, v7
    v_mul_f32 v59, v59, v7
    v_cvt_pk_bf16_f32 v23, v58, v59
    buffer_store_dwordx2 v[22:23], v4, s[12:15], s16 offen
    s_add_u32 s16, s16, 4096
    v_sub_f32 v60, v60, v6
    v_sub_f32 v61, v61, v6
    v_cvt_pk_bf16_f32 v28, v60, v61
    v_lshlrev_b32 v60, 16, v28
    v_and_b32 v61, 0xffff0000, v28
    v_mul_f32 v60, v60, v7
    v_mul_f32 v61, v61, v7
    v_cvt_pk_bf16_f32 v24, v60, v61
    v_sub_f32 v62, v62, v6
    v_sub_f32 v63, v63, v6
    v_cvt_pk_bf16_f32 v28, v62, v63
    v_lshlrev_b32 v62, 16, v28
    v_and_b32 v63, 0xffff0000, v28
    v_mul_f32 v62, v62, v7
    v_mul_f32 v63, v63, v7
    v_cvt_pk_bf16_f32 v25, v62, v63
    buffer_store_dwordx2 v[24:25], v4, s[12:15], s16 offen
    s_add_u32 s16, s16, 4096
    v_sub_f32 v64, v64, v6
    v_sub_f32 v65, v65, v6
    v_cvt_pk_bf16_f32 v28, v64, v65
    v_lshlrev_b32 v64, 16, v28
    v_and_b32 v65, 0xffff0000, v28
    v_mul_f32 v64, v64, v7
    v_mul_f32 v65, v65, v7
    v_cvt_pk_bf16_f32 v26, v64, v65
    v_sub_f32 v66, v66, v6
    v_sub_f32 v67, v67, v6
    v_cvt_pk_bf16_f32 v28, v66, v67
    v_lshlrev_b32 v66, 16, v28
    v_and_b32 v67, 0xffff0000, v28
    v_mul_f32 v66, v66, v7
    v_mul_f32 v67, v67, v7
    v_cvt_pk_bf16_f32 v27, v66, v67
    buffer_store_dwordx2 v[26:27], v4, s[12:15], s16 offen
    s_endpgm
L_ln_kernel_aux:
    v_subrev_u32 v0, 128, v0
    s_lshr_b32 s25, s2, 3
    s_and_b32 s26, s2, 7
    v_and_b32 v1, 7, v0
    v_lshrrev_b32 v2, 3, v0
    v_lshl_add_u32 v3, v1, 2, 0
    v_subrev_u32 v4, 19, v3
    v_cmp_gt_u32 vcc, 9, v4
    s_nop 1
    v_cndmask_b32 v4, 0, v4, vcc
    v_add_u32 v8, 567, v3
    v_cmp_gt_u32 vcc, 18, v3
    s_nop 1
    v_cndmask_b32 v4, v4, v8, vcc
    v_add_u32 v8, 288, v3
    v_cmp_gt_u32 vcc, 9, v3
    s_nop 1
    v_cndmask_b32 v4, v4, v8, vcc
    v_lshlrev_b32 v4, 2, v4
    v_lshl_add_u32 v3, v1, 2, 1
    v_subrev_u32 v5, 19, v3
    v_cmp_gt_u32 vcc, 9, v5
    s_nop 1
    v_cndmask_b32 v5, 0, v5, vcc
    v_add_u32 v8, 567, v3
    v_cmp_gt_u32 vcc, 18, v3
    s_nop 1
    v_cndmask_b32 v5, v5, v8, vcc
    v_add_u32 v8, 288, v3
    v_cmp_gt_u32 vcc, 9, v3
    s_nop 1
    v_cndmask_b32 v5, v5, v8, vcc
    v_lshlrev_b32 v5, 2, v5
    v_lshl_add_u32 v3, v1, 2, 2
    v_subrev_u32 v6, 19, v3
    v_cmp_gt_u32 vcc, 9, v6
    s_nop 1
    v_cndmask_b32 v6, 0, v6, vcc
    v_add_u32 v8, 567, v3
    v_cmp_gt_u32 vcc, 18, v3
    s_nop 1
    v_cndmask_b32 v6, v6, v8, vcc
    v_add_u32 v8, 288, v3
    v_cmp_gt_u32 vcc, 9, v3
    s_nop 1
    v_cndmask_b32 v6, v6, v8, vcc
    v_lshlrev_b32 v6, 2, v6
    v_lshl_add_u32 v3, v1, 2, 3
    v_subrev_u32 v7, 19, v3
    v_cmp_gt_u32 vcc, 9, v7
    s_nop 1
    v_cndmask_b32 v7, 0, v7, vcc
    v_add_u32 v8, 567, v3
    v_cmp_gt_u32 vcc, 18, v3
    s_nop 1
    v_cndmask_b32 v7, v7, v8, vcc
    v_add_u32 v8, 288, v3
    v_cmp_gt_u32 vcc, 9, v3
    s_nop 1
    v_cndmask_b32 v7, v7, v8, vcc
    v_lshlrev_b32 v7, 2, v7
    v_mul_u32_u24 v8, 3456, v2
    v_add_u32 v4, v4, v8
    v_add_u32 v5, v5, v8
    v_add_u32 v6, v6, v8
    v_add_u32 v7, v7, v8
    s_mul_i32 s27, s26, 248832
    s_mul_i32 s28, s25, 36
    s_add_u32 s27, s27, s28
    s_waitcnt lgkmcnt(0)
    s_mov_b32 s8, s6
    s_mov_b32 s9, s7
    s_mov_b32 s10, 1990656
    s_mov_b32 s11, 0x20000
    buffer_load_dword v16, v4, s[8:11], s27 offen
    buffer_load_dword v17, v5, s[8:11], s27 offen
    buffer_load_dword v18, v6, s[8:11], s27 offen
    buffer_load_dword v19, v7, s[8:11], s27 offen
    s_add_u32 s27, s27, 55296
    buffer_load_dword v20, v4, s[8:11], s27 offen
    buffer_load_dword v21, v5, s[8:11], s27 offen
    buffer_load_dword v22, v6, s[8:11], s27 offen
    buffer_load_dword v23, v7, s[8:11], s27 offen
    s_add_u32 s27, s27, 55296
    buffer_load_dword v24, v4, s[8:11], s27 offen
    buffer_load_dword v25, v5, s[8:11], s27 offen
    buffer_load_dword v26, v6, s[8:11], s27 offen
    buffer_load_dword v27, v7, s[8:11], s27 offen
    s_add_u32 s27, s27, 55296
    buffer_load_dword v28, v4, s[8:11], s27 offen
    buffer_load_dword v29, v5, s[8:11], s27 offen
    buffer_load_dword v30, v6, s[8:11], s27 offen
    buffer_load_dword v31, v7, s[8:11], s27 offen
    s_add_u32 s27, s27, 55296
    buffer_load_dword v32, v4, s[8:11], s27 offen
    buffer_load_dword v33, v5, s[8:11], s27 offen
    buffer_load_dword v34, v6, s[8:11], s27 offen
    buffer_load_dword v35, v7, s[8:11], s27 offen
    s_mov_b32 s12, s20
    s_mov_b32 s13, s21
    s_mov_b32 s14, 67108864
    s_mov_b32 s15, 0x20000
    s_mov_b32 s16, s22
    s_mov_b32 s17, s23
    s_mov_b32 s18, 5308416
    s_mov_b32 s19, 0x20000
    v_and_b32 v9, 63, v0
    v_lshlrev_b32 v9, 4, v9
    v_lshrrev_b32 v10, 6, v0
    v_mul_u32_u24 v10, 9216, v10
    v_add_u32 v9, v9, v10
    s_lshr_b32 s28, s26, 1
    s_lshl_b32 s28, s28, 10
    s_mul_i32 s29, s25, 165888
    s_add_u32 s28, s28, s29
    s_add_u32 s30, s28, 4608
    buffer_load_dwordx4 v[40:43], v9, s[16:19], s30 offen
    s_add_u32 s30, s30, 18432
    buffer_load_dwordx4 v[44:47], v9, s[16:19], s30 offen
    s_add_u32 s30, s30, 18432
    buffer_load_dwordx4 v[48:51], v9, s[16:19], s30 offen
    s_add_u32 s30, s30, 18432
    buffer_load_dwordx4 v[52:55], v9, s[16:19], s30 offen
    s_add_u32 s30, s30, 18432
    buffer_load_dwordx4 v[40:43], v9, s[16:19], s30 offen
    s_add_u32 s30, s30, 18432
    buffer_load_dwordx4 v[44:47], v9, s[16:19], s30 offen
    s_add_u32 s30, s30, 18432
    buffer_load_dwordx4 v[48:51], v9, s[16:19], s30 offen
    s_add_u32 s30, s30, 18432
    buffer_load_dwordx4 v[52:55], v9, s[16:19], s30 offen
    s_add_u32 s30, s30, 18432
    buffer_load_dwordx4 v[40:43], v9, s[16:19], s30 offen
    s_add_u32 s30, s30, 18432
    v_lshrrev_b32 v11, 3, v0
    v_mul_u32_u24 v11, 9216, v11
    v_and_b32 v10, 7, v0
    v_lshl_add_u32 v11, v10, 4, v11
    s_lshr_b32 s31, s26, 1
    s_lshl_b32 s31, s31, 7
    s_add_u32 s31, s31, s29
    s_add_u32 s31, s31, 8704
    buffer_load_dwordx4 v[60:63], v11, s[16:19], s31 offen
    v_mov_b32 v10, 0x40000000
    v_cmp_gt_u32 vcc, 16, v0
    s_nop 1
    v_cndmask_b32 v11, v10, v11, vcc
    s_add_u32 s31, s31, 147456
    buffer_load_dwordx4 v[64:67], v11, s[16:19], s31 offen
    s_getpc_b64 s[32:33]
    s_and_b32 s32, s32, 0xffffff00
    s_mov_b32 s34, L_text_end-ln_kernel-4096
    s_mov_b32 s35, 0x20000
    v_lshlrev_b32 v11, 4, v0
    s_mul_i32 s31, s25, 6144
    buffer_load_dwordx4 v[56:59], v11, s[32:35], s31 offen offset:0
    buffer_load_dwordx4 v[60:63], v11, s[32:35], s31 offen offset:2048
    s_add_u32 s31, s31, 4096
    buffer_load_dwordx4 v[64:67], v11, s[32:35], s31 offen offset:0
    v_mov_b32 v12, -1
    v_mov_b32 v13, -1
    v_mov_b32 v14, -1
    v_mov_b32 v15, -1
    v_lshlrev_b32 v11, 4, v0
    s_lshl_b32 s28, s2, 11
    s_add_u32 s28, s28, 55574528
    buffer_store_dwordx4 v[12:15], v11, s[12:15], s28 offen
    v_lshlrev_b32 v3, 6, v2
    v_lshrrev_b32 v8, 2, v1
    v_mul_u32_u24 v8, 36864, v8
    v_add_u32 v3, v3, v8
    v_and_b32 v8, 3, v1
    v_lshl_add_u32 v3, v8, 4, v3
    v_mov_b32 v8, 0x40000000
    v_cmp_gt_u32 vcc, 8, v2
    s_nop 1
    v_cndmask_b32 v8, v8, v3, vcc
    s_mul_i32 s27, s25, 73728
    s_mul_i32 s28, s26, 4608
    s_add_u32 s27, s27, s28
    s_add_u32 s27, s27, 58720256
    s_waitcnt vmcnt(31)
    buffer_store_dwordx4 v[16:19], v3, s[12:15], s27 offen
    s_add_u32 s27, s27, 1024
    s_waitcnt vmcnt(28)
    buffer_store_dwordx4 v[20:23], v3, s[12:15], s27 offen
    s_add_u32 s27, s27, 1024
    s_waitcnt vmcnt(25)
    buffer_store_dwordx4 v[24:27], v3, s[12:15], s27 offen
    s_add_u32 s27, s27, 1024
    s_waitcnt vmcnt(22)
    buffer_store_dwordx4 v[28:31], v3, s[12:15], s27 offen
    s_add_u32 s27, s27, 1024
    s_waitcnt vmcnt(19)
    buffer_store_dwordx4 v[32:35], v8, s[12:15], s27 offen
L_ln_kernel_end:
    s_endpgm
.globl gemm1_kernel
.p2align 8
.type gemm1_kernel,@function
gemm1_kernel:
    s_cmp_ge_u32 s2, 256
    s_cbranch_scc1 L_gemm1_kernel_end
    s_load_dwordx2 s[4:5], s[0:1], 32
    s_load_dwordx2 s[62:63], s[0:1], 80
    v_lshrrev_b32 v1, 6, v0
    v_and_b32 v0, 63, v0
    v_readfirstlane_b32 s26, v1
    s_and_b32 s28, s2, 7
    s_lshr_b32 s29, s2, 3
    s_and_b32 s24, s28, 1
    s_lshl_b32 s24, s24, 2
    s_and_b32 s30, s29, 3
    s_add_u32 s24, s24, s30
    s_lshr_b32 s25, s28, 1
    s_lshl_b32 s25, s25, 3
    s_lshr_b32 s30, s29, 2
    s_add_u32 s25, s25, s30
    s_lshl_b32 s27, s24, 3
    s_add_u32 s27, s27, s26
    s_lshl_b32 s31, s26, 10
    s_lshl_b32 s33, s25, 7
    s_add_u32 s32, s33, 4608
    s_add_u32 s3, s32, 64
    s_add_u32 s50, s31, 32768
    s_cmp_ge_u32 s26, 4
    s_cselect_b32 s51, 0x40000000, 0
    s_cselect_b32 s50, 160768, s50
    s_mul_i32 s40, s27, 36864
    s_add_u32 s40, s40, 0
    v_lshlrev_b32 v1, 4, v0
    v_lshrrev_b32 v13, 2, v0
    v_mul_u32_u24 v2, 9216, v13
    v_and_b32 v13, 3, v0
    v_lshl_add_u32 v2, v13, 4, v2
    s_mul_i32 s30, s26, 147456
    v_add_u32 v2, s30, v2
    s_waitcnt lgkmcnt(0)
    s_mov_b32 s8, s4
    s_mov_b32 s9, s5
    s_mov_b32 s10, 5308416
    s_mov_b32 s11, 0x20000
    s_mov_b32 s16, s62
    s_mov_b32 s17, s63
    s_mov_b32 s18, 67108864
    s_mov_b32 s19, 0x20000
    s_add_u32 m0, s31, 0
    s_add_u32 s30, s32, 0
    buffer_load_dwordx4 v2, s[8:11], s30 offen lds
    s_add_u32 m0, s31, 36864
    s_add_u32 s30, s3, 0
    buffer_load_dwordx4 v2, s[8:11], s30 offen lds
    s_add_u32 m0, s31, 8192
    s_add_u32 s30, s32, 1179648
    buffer_load_dwordx4 v2, s[8:11], s30 offen lds
    s_add_u32 m0, s31, 45056
    s_add_u32 s30, s3, 1179648
    buffer_load_dwordx4 v2, s[8:11], s30 offen lds
    s_add_u32 m0, s31, 16384
    s_add_u32 s30, s32, 2359296
    buffer_load_dwordx4 v2, s[8:11], s30 offen lds
    s_add_u32 m0, s31, 53248
    s_add_u32 s30, s3, 2359296
    buffer_load_dwordx4 v2, s[8:11], s30 offen lds
    s_add_u32 m0, s31, 24576
    s_add_u32 s30, s32, 3538944
    buffer_load_dwordx4 v2, s[8:11], s30 offen lds
    s_add_u32 m0, s31, 61440
    s_add_u32 s30, s3, 3538944
    buffer_load_dwordx4 v2, s[8:11], s30 offen lds
    s_add_u32 s30, s50, 0
    s_min_u32 m0, s30, 160768
    s_add_u32 s30, s32, 4718592
    s_or_b32 s30, s30, s51
    buffer_load_dwordx4 v2, s[8:11], s30 offen lds
    s_add_u32 s30, s50, 36864
    s_min_u32 m0, s30, 160768
    s_add_u32 s30, s3, 4718592
    s_or_b32 s30, s30, s51
    buffer_load_dwordx4 v2, s[8:11], s30 offen lds
    s_add_u32 s29, s40, 0
    buffer_load_dwordx4 a[0:3], v1, s[16:19], s29 offen offset:0
    buffer_load_dwordx4 a[4:7], v1, s[16:19], s29 offen offset:1024
    buffer_load_dwordx4 a[8:11], v1, s[16:19], s29 offen offset:2048
    buffer_load_dwordx4 a[12:15], v1, s[16:19], s29 offen offset:3072
    s_add_u32 s29, s40, 4096
    buffer_load_dwordx4 a[16:19], v1, s[16:19], s29 offen offset:0
    buffer_load_dwordx4 a[20:23], v1, s[16:19], s29 offen offset:1024
    buffer_load_dwordx4 a[24:27], v1, s[16:19], s29 offen offset:2048
    buffer_load_dwordx4 a[28:31], v1, s[16:19], s29 offen offset:3072
    s_add_u32 s29, s40, 8192
    buffer_load_dwordx4 a[32:35], v1, s[16:19], s29 offen offset:0
    buffer_load_dwordx4 a[36:39], v1, s[16:19], s29 offen offset:1024
    s_load_dwordx2 s[6:7], s[0:1], 40
    s_load_dwordx2 s[60:61], s[0:1], 56
    s_load_dwordx2 s[64:65], s[0:1], 16
    s_lshr_b32 s28, s25, 2
    s_lshl_b32 s30, s28, 6
    s_add_u32 s34, s30, 4096
    s_and_b32 s58, s25, 3
    s_cmp_eq_u32 s58, 0
    s_cselect_b32 s30, 4608, 0
    s_add_u32 s34, s34, s30
    s_sub_u32 s30, s33, 192
    s_cmp_eq_u32 s58, 2
    s_cselect_b32 s34, s30, s34
    s_mul_i32 s35, s25, 73728
    s_add_u32 s35, s35, s31
    s_add_u32 s35, s35, 58720256
    s_add_u32 s39, s35, 36864
    s_add_u32 s42, s33, 64
    s_mul_i32 s36, s25, 73728
    s_lshl_b32 s30, s27, 6
    s_add_u32 s36, s36, s30
    s_add_u32 s36, s36, 50331648
    s_mul_i32 s37, s26, 1520
    s_add_u32 s37, s37, 148576
    s_lshl_b32 s41, s27, 13
    s_add_u32 s41, s41, 55574528
    s_lshl_b32 s38, s25, 8
    s_add_u32 s38, s38, s41
    s_mov_b32 s44, 0x0003ffff
    s_mov_b32 s45, 0x0003ffff
    s_mov_b32 s46, 0x00ffffc0
    s_mov_b32 s47, 0x00ffffc0
    s_mov_b32 s48, 0x10
    s_mov_b32 s49, 0x10
    s_mul_i32 s54, s27, 147456
    s_add_u32 s54, s54, 4194304
    s_lshl_b32 s30, s25, 11
    s_add_u32 s52, s54, s30
    s_add_u32 s53, s52, 1024
    s_lshl_b32 s30, s34, 4
    s_add_u32 s54, s54, s30
    s_lshl_b32 s55, s24, 5
    s_add_u32 s55, s55, s25
    s_mul_i32 s55, s55, 1520
    s_add_u32 s55, s55, 54525952
    s_lshl_b32 s57, s27, 10
    s_add_u32 s57, s57, 16777216
    s_lshl_b32 s30, s25, 18
    s_add_u32 s56, s57, s30
    s_lshl_b32 s30, s28, 17
    s_add_u32 s57, s57, s30
    s_add_u32 s57, s57, 8388608
    s_lshl_b32 s97, s2, 3
    s_add_u32 s97, s97, s26
    s_lshr_b32 s99, s26, 2
    s_lshl_b32 s98, s24, 4
    s_lshl_b32 s30, s28, 1
    s_add_u32 s98, s98, s30
    s_and_b32 s30, s25, 1
    s_add_u32 s98, s98, s30
    s_lshl_b32 s98, s98, 3
    s_add_u32 s98, s98, s26
    v_lshrrev_b32 v13, 5, v0
    v_lshlrev_b32 v5, 9, v13
    v_bfe_u32 v13, v0, 2, 2
    v_lshl_add_u32 v5, v13, 6, v5
    v_bfe_u32 v13, v0, 4, 1
    v_lshl_add_u32 v5, v13, 5, v5
    v_and_b32 v13, 3, v0
    v_lshl_add_u32 v5, v13, 3, v5
    v_add_u32 v6, 49152, v5
    v_add_u32 v7, 98304, v5
    v_bfe_u32 v13, v0, 4, 1
    v_mul_u32_u24 v8, 73728, v13
    v_and_b32 v13, 15, v0
    v_lshl_add_u32 v8, v13, 4, v8
    v_lshrrev_b32 v13, 5, v0
    v_lshl_add_u32 v8, v13, 8, v8
    v_mov_b32 v9, 0x3f803f80
    v_lshlrev_b32 v3, 6, v0
    v_mov_b32 v12, 0xbdd2d3e8
    v_mov_b32 v10, 0
    v_mov_b32 v11, 0
    s_waitcnt lgkmcnt(0)
    s_mov_b32 s12, s6
    s_mov_b32 s13, s7
    s_mov_b32 s14, 8388608
    s_mov_b32 s15, 0x20000
    s_mov_b32 s20, s60
    s_mov_b32 s21, s61
    s_mov_b32 s22, 2654208
    s_mov_b32 s23, 0x20000
    s_mov_b32 s66, 663552
    s_mov_b32 s67, 0x20000
    s_cmp_eq_u32 s58, 0
    s_cbranch_scc1 L_gemm1_kernel_vA
    s_cmp_eq_u32 s58, 3
    s_cbranch_scc1 L_gemm1_kernel_vC
L_gemm1_kernel_vB:
    s_waitcnt vmcnt(10)
    s_barrier
    ds_read_b64_tr_b16 v[16:17], v5 offset:0
    ds_read_b64_tr_b16 v[18:19], v5 offset:256
    ds_read_b64_tr_b16 v[20:21], v5 offset:36864
    ds_read_b64_tr_b16 v[22:23], v5 offset:37120
    ds_read_b64_tr_b16 v[24:25], v5 offset:1024
    ds_read_b64_tr_b16 v[26:27], v5 offset:1280
    ds_read_b64_tr_b16 v[28:29], v5 offset:37888
    ds_read_b64_tr_b16 v[30:31], v5 offset:38144
    s_waitcnt vmcnt(9) lgkmcnt(6)
    v_mfma_f32_32x32x16_bf16 v[32:47], v[16:19], a[0:3], 0
    s_cmp_eq_u32 s99, 0
    s_cbranch_scc1 L_pr1
    s_setprio 1
L_pr1:
    buffer_load_dwordx4 a[40:43], v1, s[16:19], s29 offen offset:2048
    ds_read_b64_tr_b16 v[16:17], v5 offset:2048
    ds_read_b64_tr_b16 v[18:19], v5 offset:2304
    s_waitcnt lgkmcnt(6)
    v_mfma_f32_32x32x16_bf16 v[48:63], v[20:23], a[0:3], 0
    ds_read_b64_tr_b16 v[20:21], v5 offset:38912
    ds_read_b64_tr_b16 v[22:23], v5 offset:39168
    s_waitcnt vmcnt(9) lgkmcnt(6)
    v_mfma_f32_32x32x16_bf16 v[32:47], v[24:27], a[4:7], v[32:47]
    buffer_load_dwordx4 a[44:47], v1, s[16:19], s29 offen offset:3072
    ds_read_b64_tr_b16 v[24:25], v5 offset:3072
    ds_read_b64_tr_b16 v[26:27], v5 offset:3328
    s_waitcnt lgkmcnt(6)
    v_mfma_f32_32x32x16_bf16 v[48:63], v[28:31], a[4:7], v[48:63]
    ds_read_b64_tr_b16 v[28:29], v5 offset:39936
    ds_read_b64_tr_b16 v[30:31], v5 offset:40192
    s_waitcnt vmcnt(9) lgkmcnt(6)
    v_mfma_f32_32x32x16_bf16 v[32:47], v[16:19], a[8:11], v[32:47]
    s_add_u32 s29, s40, 12288
    buffer_load_dwordx4 a[48:51], v1, s[16:19], s29 offen offset:0
    ds_read_b64_tr_b16 v[16:17], v5 offset:4096
    ds_read_b64_tr_b16 v[18:19], v5 offset:4352
    s_waitcnt lgkmcnt(6)
    v_mfma_f32_32x32x16_bf16 v[48:63], v[20:23], a[8:11], v[48:63]
    ds_read_b64_tr_b16 v[20:21], v5 offset:40960
    ds_read_b64_tr_b16 v[22:23], v5 offset:41216
    s_waitcnt vmcnt(9) lgkmcnt(6)
    v_mfma_f32_32x32x16_bf16 v[32:47], v[24:27], a[12:15], v[32:47]
    buffer_load_dwordx4 a[52:55], v1, s[16:19], s29 offen offset:1024
    ds_read_b64_tr_b16 v[24:25], v5 offset:5120
    ds_read_b64_tr_b16 v[26:27], v5 offset:5376
    s_waitcnt lgkmcnt(6)
    v_mfma_f32_32x32x16_bf16 v[48:63], v[28:31], a[12:15], v[48:63]
    ds_read_b64_tr_b16 v[28:29], v5 offset:41984
    ds_read_b64_tr_b16 v[30:31], v5 offset:42240
    s_waitcnt vmcnt(9) lgkmcnt(6)
    v_mfma_f32_32x32x16_bf16 v[32:47], v[16:19], a[16:19], v[32:47]
    buffer_load_dwordx4 a[56:59], v1, s[16:19], s29 offen offset:2048
    ds_read_b64_tr_b16 v[16:17], v5 offset:6144
    ds_read_b64_tr_b16 v[18:19], v5 offset:6400
    s_waitcnt lgkmcnt(6)
    v_mfma_f32_32x32x16_bf16 v[48:63], v[20:23], a[16:19], v[48:63]
    ds_read_b64_tr_b16 v[20:21], v5 offset:43008
    ds_read_b64_tr_b16 v[22:23], v5 offset:43264
    s_waitcnt vmcnt(9) lgkmcnt(6)
    v_mfma_f32_32x32x16_bf16 v[32:47], v[24:27], a[20:23], v[32:47]
    buffer_load_dwordx4 a[60:63], v1, s[16:19], s29 offen offset:3072
    ds_read_b64_tr_b16 v[24:25], v5 offset:7168
    ds_read_b64_tr_b16 v[26:27], v5 offset:7424
    s_waitcnt lgkmcnt(6)
    v_mfma_f32_32x32x16_bf16 v[48:63], v[28:31], a[20:23], v[48:63]
    ds_read_b64_tr_b16 v[28:29], v5 offset:44032
    ds_read_b64_tr_b16 v[30:31], v5 offset:44288
    s_waitcnt vmcnt(9) lgkmcnt(6)
    v_mfma_f32_32x32x16_bf16 v[32:47], v[16:19], a[24:27], v[32:47]
    s_add_u32 s29, s40, 16384
    buffer_load_dwordx4 a[64:67], v1, s[16:19], s29 offen offset:0
    ds_read_b64_tr_b16 v[16:17], v5 offset:8192
    ds_read_b64_tr_b16 v[18:19], v5 offset:8448
    s_waitcnt lgkmcnt(6)
    v_mfma_f32_32x32x16_bf16 v[48:63], v[20:23], a[24:27], v[48:63]
    ds_read_b64_tr_b16 v[20:21], v5 offset:45056
    ds_read_b64_tr_b16 v[22:23], v5 offset:45312
    s_waitcnt vmcnt(9) lgkmcnt(6)
    v_mfma_f32_32x32x16_bf16 v[32:47], v[24:27], a[28:31], v[32:47]
    buffer_load_dwordx4 a[68:71], v1, s[16:19], s29 offen offset:1024
    ds_read_b64_tr_b16 v[24:25], v5 offset:9216
    ds_read_b64_tr_b16 v[26:27], v5 offset:9472
    s_waitcnt lgkmcnt(6)
    v_mfma_f32_32x32x16_bf16 v[48:63], v[28:31], a[28:31], v[48:63]
    ds_read_b64_tr_b16 v[28:29], v5 offset:46080
    ds_read_b64_tr_b16 v[30:31], v5 offset:46336
    s_waitcnt vmcnt(9) lgkmcnt(6)
    v_mfma_f32_32x32x16_bf16 v[32:47], v[16:19], a[32:35], v[32:47]
    buffer_load_dwordx4 a[72:75], v1, s[16:19], s29 offen offset:2048
    ds_read_b64_tr_b16 v[16:17], v5 offset:10240
    ds_read_b64_tr_b16 v[18:19], v5 offset:10496
    s_waitcnt lgkmcnt(6)
    v_mfma_f32_32x32x16_bf16 v[48:63], v[20:23], a[32:35], v[48:63]
    ds_read_b64_tr_b16 v[20:21], v5 offset:47104
    ds_read_b64_tr_b16 v[22:23], v5 offset:47360
    s_waitcnt vmcnt(9) lgkmcnt(6)
    v_mfma_f32_32x32x16_bf16 v[32:47], v[24:27], a[36:39], v[32:47]
    buffer_load_dwordx4 a[76:79], v1, s[16:19], s29 offen offset:3072
    ds_read_b64_tr_b16 v[24:25], v5 offset:11264
    ds_read_b64_tr_b16 v[26:27], v5 offset:11520
    s_waitcnt lgkmcnt(6)
    v_mfma_f32_32x32x16_bf16 v[48:63], v[28:31], a[36:39], v[48:63]
    ds_read_b64_tr_b16 v[28:29], v5 offset:48128
    ds_read_b64_tr_b16 v[30:31], v5 offset:48384
    s_waitcnt vmcnt(9) lgkmcnt(6)
    v_mfma_f32_32x32x16_bf16 v[32:47], v[16:19], a[40:43], v[32:47]
    s_add_u32 s29, s40, 20480
    buffer_load_dwordx4 a[80:83], v1, s[16:19], s29 offen offset:0
    ds_read_b64_tr_b16 v[16:17], v5 offset:12288
    ds_read_b64_tr_b16 v[18:19], v5 offset:12544
    s_waitcnt lgkmcnt(6)
    v_mfma_f32_32x32x16_bf16 v[48:63], v[20:23], a[40:43], v[48:63]
    ds_read_b64_tr_b16 v[20:21], v6 offset:0
    ds_read_b64_tr_b16 v[22:23], v6 offset:256
    s_waitcnt vmcnt(9) lgkmcnt(6)
    v_mfma_f32_32x32x16_bf16 v[32:47], v[24:27], a[44:47], v[32:47]
    buffer_load_dwordx4 a[84:87], v1, s[16:19], s29 offen offset:1024
    ds_read_b64_tr_b16 v[24:25], v5 offset:13312
    ds_read_b64_tr_b16 v[26:27], v5 offset:13568
    s_waitcnt lgkmcnt(6)
    v_mfma_f32_32x32x16_bf16 v[48:63], v[28:31], a[44:47], v[48:63]
    ds_read_b64_tr_b16 v[28:29], v6 offset:1024
    ds_read_b64_tr_b16 v[30:31], v6 offset:1280
    s_waitcnt vmcnt(9) lgkmcnt(6)
    v_mfma_f32_32x32x16_bf16 v[32:47], v[16:19], a[48:51], v[32:47]
    buffer_load_dwordx4 a[88:91], v1, s[16:19], s29 offen offset:2048
    ds_read_b64_tr_b16 v[16:17], v5 offset:14336
    ds_read_b64_tr_b16 v[18:19], v5 offset:14592
    s_waitcnt lgkmcnt(6)
    v_mfma_f32_32x32x16_bf16 v[48:63], v[20:23], a[48:51], v[48:63]
    ds_read_b64_tr_b16 v[20:21], v6 offset:2048
    ds_read_b64_tr_b16 v[22:23], v6 offset:2304
    s_waitcnt vmcnt(9) lgkmcnt(6)
    v_mfma_f32_32x32x16_bf16 v[32:47], v[24:27], a[52:55], v[32:47]
    buffer_load_dwordx4 a[92:95], v1, s[16:19], s29 offen offset:3072
    ds_read_b64_tr_b16 v[24:25], v5 offset:15360
    ds_read_b64_tr_b16 v[26:27], v5 offset:15616
    s_waitcnt lgkmcnt(6)
    v_mfma_f32_32x32x16_bf16 v[48:63], v[28:31], a[52:55], v[48:63]
    ds_read_b64_tr_b16 v[28:29], v6 offset:3072
    ds_read_b64_tr_b16 v[30:31], v6 offset:3328
    s_waitcnt vmcnt(9) lgkmcnt(6)
    v_mfma_f32_32x32x16_bf16 v[32:47], v[16:19], a[56:59], v[32:47]
    s_add_u32 s29, s40, 24576
    buffer_load_dwordx4 a[96:99], v1, s[16:19], s29 offen offset:0
    ds_read_b64_tr_b16 v[16:17], v5 offset:16384
    ds_read_b64_tr_b16 v[18:19], v5 offset:16640
    s_waitcnt lgkmcnt(6)
    v_mfma_f32_32x32x16_bf16 v[48:63], v[20:23], a[56:59], v[48:63]
    ds_read_b64_tr_b16 v[20:21], v6 offset:4096
    ds_read_b64_tr_b16 v[22:23], v6 offset:4352
    s_waitcnt vmcnt(9) lgkmcnt(6)
    v_mfma_f32_32x32x16_bf16 v[32:47], v[24:27], a[60:63], v[32:47]
    buffer_load_dwordx4 a[100:103], v1, s[16:19], s29 offen offset:1024
    ds_read_b64_tr_b16 v[24:25], v5 offset:17408
    ds_read_b64_tr_b16 v[26:27], v5 offset:17664
    s_waitcnt lgkmcnt(6)
    v_mfma_f32_32x32x16_bf16 v[48:63], v[28:31], a[60:63], v[48:63]
    ds_read_b64_tr_b16 v[28:29], v6 offset:5120
    ds_read_b64_tr_b16 v[30:31], v6 offset:5376
    s_waitcnt vmcnt(9) lgkmcnt(6)
    v_mfma_f32_32x32x16_bf16 v[32:47], v[16:19], a[64:67], v[32:47]
    buffer_load_dwordx4 a[104:107], v1, s[16:19], s29 offen offset:2048
    ds_read_b64_tr_b16 v[16:17], v5 offset:18432
    ds_read_b64_tr_b16 v[18:19], v5 offset:18688
    s_waitcnt lgkmcnt(6)
    v_mfma_f32_32x32x16_bf16 v[48:63], v[20:23], a[64:67], v[48:63]
    ds_read_b64_tr_b16 v[20:21], v6 offset:6144
    ds_read_b64_tr_b16 v[22:23], v6 offset:6400
    s_waitcnt vmcnt(9) lgkmcnt(6)
    v_mfma_f32_32x32x16_bf16 v[32:47], v[24:27], a[68:71], v[32:47]
    buffer_load_dwordx4 a[108:111], v1, s[16:19], s29 offen offset:3072
    ds_read_b64_tr_b16 v[24:25], v5 offset:19456
    ds_read_b64_tr_b16 v[26:27], v5 offset:19712
    s_waitcnt lgkmcnt(6)
    v_mfma_f32_32x32x16_bf16 v[48:63], v[28:31], a[68:71], v[48:63]
    ds_read_b64_tr_b16 v[28:29], v6 offset:7168
    ds_read_b64_tr_b16 v[30:31], v6 offset:7424
    s_waitcnt vmcnt(9) lgkmcnt(6)
    v_mfma_f32_32x32x16_bf16 v[32:47], v[16:19], a[72:75], v[32:47]
    s_cmp_eq_u32 s99, 0
    s_cbranch_scc1 L_pr2
    s_setprio 0
L_pr2:
    s_add_u32 s29, s40, 28672
    buffer_load_dwordx4 a[112:115], v1, s[16:19], s29 offen offset:0
    ds_read_b64_tr_b16 v[16:17], v5 offset:20480
    ds_read_b64_tr_b16 v[18:19], v5 offset:20736
    s_waitcnt lgkmcnt(6)
    v_mfma_f32_32x32x16_bf16 v[48:63], v[20:23], a[72:75], v[48:63]
    ds_read_b64_tr_b16 v[20:21], v6 offset:8192
    ds_read_b64_tr_b16 v[22:23], v6 offset:8448
    s_waitcnt vmcnt(9) lgkmcnt(6)
    v_mfma_f32_32x32x16_bf16 v[32:47], v[24:27], a[76:79], v[32:47]
    buffer_load_dwordx4 a[116:119], v1, s[16:19], s29 offen offset:1024
    ds_read_b64_tr_b16 v[24:25], v5 offset:21504
    ds_read_b64_tr_b16 v[26:27], v5 offset:21760
    s_waitcnt lgkmcnt(6)
    v_mfma_f32_32x32x16_bf16 v[48:63], v[28:31], a[76:79], v[48:63]
    ds_read_b64_tr_b16 v[28:29], v6 offset:9216
    ds_read_b64_tr_b16 v[30:31], v6 offset:9472
    s_waitcnt vmcnt(9) lgkmcnt(6)
    v_mfma_f32_32x32x16_bf16 v[32:47], v[16:19], a[80:83], v[32:47]
    buffer_load_dwordx4 a[120:123], v1, s[16:19], s29 offen offset:2048
    ds_read_b64_tr_b16 v[16:17], v5 offset:22528
    ds_read_b64_tr_b16 v[18:19], v5 offset:22784
    s_waitcnt lgkmcnt(6)
    v_mfma_f32_32x32x16_bf16 v[48:63], v[20:23], a[80:83], v[48:63]
    ds_read_b64_tr_b16 v[20:21], v6 offset:10240
    ds_read_b64_tr_b16 v[22:23], v6 offset:10496
    s_waitcnt vmcnt(9) lgkmcnt(6)
    v_mfma_f32_32x32x16_bf16 v[32:47], v[24:27], a[84:87], v[32:47]
    buffer_load_dwordx4 a[124:127], v1, s[16:19], s29 offen offset:3072
    ds_read_b64_tr_b16 v[24:25], v5 offset:23552
    ds_read_b64_tr_b16 v[26:27], v5 offset:23808
    s_waitcnt lgkmcnt(6)
    v_mfma_f32_32x32x16_bf16 v[48:63], v[28:31], a[84:87], v[48:63]
    ds_read_b64_tr_b16 v[28:29], v6 offset:11264
    ds_read_b64_tr_b16 v[30:31], v6 offset:11520
    s_waitcnt vmcnt(9) lgkmcnt(6)
    v_mfma_f32_32x32x16_bf16 v[32:47], v[16:19], a[88:91], v[32:47]
    s_add_u32 s29, s40, 32768
    buffer_load_dwordx4 a[128:131], v1, s[16:19], s29 offen offset:0
    ds_read_b64_tr_b16 v[16:17], v5 offset:24576
    ds_read_b64_tr_b16 v[18:19], v5 offset:24832
    s_waitcnt lgkmcnt(6)
    v_mfma_f32_32x32x16_bf16 v[48:63], v[20:23], a[88:91], v[48:63]
    ds_read_b64_tr_b16 v[20:21], v6 offset:12288
    ds_read_b64_tr_b16 v[22:23], v6 offset:12544
    s_waitcnt vmcnt(9) lgkmcnt(6)
    v_mfma_f32_32x32x16_bf16 v[32:47], v[24:27], a[92:95], v[32:47]
    buffer_load_dwordx4 a[132:135], v1, s[16:19], s29 offen offset:1024
    ds_read_b64_tr_b16 v[24:25], v5 offset:25600
    ds_read_b64_tr_b16 v[26:27], v5 offset:25856
    s_waitcnt lgkmcnt(6)
    v_mfma_f32_32x32x16_bf16 v[48:63], v[28:31], a[92:95], v[48:63]
    ds_read_b64_tr_b16 v[28:29], v6 offset:13312
    ds_read_b64_tr_b16 v[30:31], v6 offset:13568
    s_waitcnt vmcnt(9) lgkmcnt(6)
    v_mfma_f32_32x32x16_bf16 v[32:47], v[16:19], a[96:99], v[32:47]
    buffer_load_dwordx4 a[136:139], v1, s[16:19], s29 offen offset:2048
    ds_read_b64_tr_b16 v[16:17], v5 offset:26624
    ds_read_b64_tr_b16 v[18:19], v5 offset:26880
    s_waitcnt lgkmcnt(6)
    v_mfma_f32_32x32x16_bf16 v[48:63], v[20:23], a[96:99], v[48:63]
    ds_read_b64_tr_b16 v[20:21], v6 offset:14336
    ds_read_b64_tr_b16 v[22:23], v6 offset:14592
    s_waitcnt vmcnt(9) lgkmcnt(6)
    v_mfma_f32_32x32x16_bf16 v[32:47], v[24:27], a[100:103], v[32:47]
    buffer_load_dwordx4 a[140:143], v1, s[16:19], s29 offen offset:3072
    ds_read_b64_tr_b16 v[24:25], v5 offset:27648
    ds_read_b64_tr_b16 v[26:27], v5 offset:27904
    s_waitcnt lgkmcnt(6)
    v_mfma_f32_32x32x16_bf16 v[48:63], v[28:31], a[100:103], v[48:63]
    ds_read_b64_tr_b16 v[28:29], v6 offset:15360
    ds_read_b64_tr_b16 v[30:31], v6 offset:15616
    s_waitcnt vmcnt(9) lgkmcnt(6)
    v_mfma_f32_32x32x16_bf16 v[32:47], v[16:19], a[104:107], v[32:47]
    s_add_u32 m0, s31, 73728
    s_add_u32 s30, s35, 0
    buffer_load_dwordx4 v1, s[16:19], s30 offen lds
    ds_read_b64_tr_b16 v[16:17], v5 offset:28672
    ds_read_b64_tr_b16 v[18:19], v5 offset:28928
    s_waitcnt lgkmcnt(6)
    v_mfma_f32_32x32x16_bf16 v[48:63], v[20:23], a[104:107], v[48:63]
    ds_read_b64_tr_b16 v[20:21], v6 offset:16384
    ds_read_b64_tr_b16 v[22:23], v6 offset:16640
    s_waitcnt vmcnt(9) lgkmcnt(6)
    v_mfma_f32_32x32x16_bf16 v[32:47], v[24:27], a[108:111], v[32:47]
    s_add_u32 m0, s31, 110592
    s_add_u32 s30, s39, 0
    buffer_load_dwordx4 v1, s[16:19], s30 offen lds
    ds_read_b64_tr_b16 v[24:25], v5 offset:29696
    ds_read_b64_tr_b16 v[26:27], v5 offset:29952
    s_waitcnt lgkmcnt(6)
    v_mfma_f32_32x32x16_bf16 v[48:63], v[28:31], a[108:111], v[48:63]
    ds_read_b64_tr_b16 v[28:29], v6 offset:17408
    ds_read_b64_tr_b16 v[30:31], v6 offset:17664
    s_waitcnt vmcnt(9) lgkmcnt(6)
    v_mfma_f32_32x32x16_bf16 v[32:47], v[16:19], a[112:115], v[32:47]
    s_add_u32 m0, s31, 81920
    s_add_u32 s30, s35, 8192
    buffer_load_dwordx4 v1, s[16:19], s30 offen lds
    ds_read_b64_tr_b16 v[16:17], v5 offset:30720
    ds_read_b64_tr_b16 v[18:19], v5 offset:30976
    s_waitcnt lgkmcnt(6)
    v_mfma_f32_32x32x16_bf16 v[48:63], v[20:23], a[112:115], v[48:63]
    ds_read_b64_tr_b16 v[20:21], v6 offset:18432
    ds_read_b64_tr_b16 v[22:23], v6 offset:18688
    s_waitcnt vmcnt(9) lgkmcnt(6)
    v_mfma_f32_32x32x16_bf16 v[32:47], v[24:27], a[116:119], v[32:47]
    s_add_u32 m0, s31, 118784
    s_add_u32 s30, s39, 8192
    buffer_load_dwordx4 v1, s[16:19], s30 offen lds
    ds_read_b64_tr_b16 v[24:25], v5 offset:31744
    ds_read_b64_tr_b16 v[26:27], v5 offset:32000
    s_waitcnt lgkmcnt(6)
    v_mfma_f32_32x32x16_bf16 v[48:63], v[28:31], a[116:119], v[48:63]
    ds_read_b64_tr_b16 v[28:29], v6 offset:19456
    ds_read_b64_tr_b16 v[30:31], v6 offset:19712
    s_waitcnt vmcnt(9) lgkmcnt(6)
    v_mfma_f32_32x32x16_bf16 v[32:47], v[16:19], a[120:123], v[32:47]
    s_add_u32 m0, s31, 90112
    s_add_u32 s30, s35, 16384
    buffer_load_dwordx4 v1, s[16:19], s30 offen lds
    ds_read_b64_tr_b16 v[16:17], v5 offset:32768
    ds_read_b64_tr_b16 v[18:19], v5 offset:33024
    s_waitcnt lgkmcnt(6)
    v_mfma_f32_32x32x16_bf16 v[48:63], v[20:23], a[120:123], v[48:63]
    ds_read_b64_tr_b16 v[20:21], v6 offset:20480
    ds_read_b64_tr_b16 v[22:23], v6 offset:20736
    s_waitcnt vmcnt(9) lgkmcnt(6)
    v_mfma_f32_32x32x16_bf16 v[32:47], v[24:27], a[124:127], v[32:47]
    s_add_u32 m0, s31, 126976
    s_add_u32 s30, s39, 16384
    buffer_load_dwordx4 v1, s[16:19], s30 offen lds
    ds_read_b64_tr_b16 v[24:25], v5 offset:33792
    ds_read_b64_tr_b16 v[26:27], v5 offset:34048
    s_waitcnt lgkmcnt(6)
    v_mfma_f32_32x32x16_bf16 v[48:63], v[28:31], a[124:127], v[48:63]
    ds_read_b64_tr_b16 v[28:29], v6 offset:21504
    ds_read_b64_tr_b16 v[30:31], v6 offset:21760
    s_waitcnt vmcnt(9) lgkmcnt(6)
    v_mfma_f32_32x32x16_bf16 v[32:47], v[16:19], a[128:131], v[32:47]
    s_add_u32 m0, s31, 98304
    s_add_u32 s30, s35, 24576
    buffer_load_dwordx4 v1, s[16:19], s30 offen lds
    ds_read_b64_tr_b16 v[16:17], v5 offset:34816
    ds_read_b64_tr_b16 v[18:19], v5 offset:35072
    s_waitcnt lgkmcnt(6)
    v_mfma_f32_32x32x16_bf16 v[48:63], v[20:23], a[128:131], v[48:63]
    ds_read_b64_tr_b16 v[20:21], v6 offset:22528
    ds_read_b64_tr_b16 v[22:23], v6 offset:22784
    s_waitcnt vmcnt(9) lgkmcnt(6)
    v_mfma_f32_32x32x16_bf16 v[32:47], v[24:27], a[132:135], v[32:47]
    s_add_u32 m0, s31, 135168
    s_add_u32 s30, s39, 24576
    buffer_load_dwordx4 v1, s[16:19], s30 offen lds
    ds_read_b64_tr_b16 v[24:25], v5 offset:35840
    ds_read_b64_tr_b16 v[26:27], v5 offset:36096
    s_waitcnt lgkmcnt(6)
    v_mfma_f32_32x32x16_bf16 v[48:63], v[28:31], a[132:135], v[48:63]
    ds_read_b64_tr_b16 v[28:29], v6 offset:23552
    ds_read_b64_tr_b16 v[30:31], v6 offset:23808
    s_waitcnt vmcnt(9) lgkmcnt(6)
    v_mfma_f32_32x32x16_bf16 v[32:47], v[16:19], a[136:139], v[32:47]
    s_add_u32 s30, s50, 73728
    s_min_u32 m0, s30, 160768
    s_add_u32 s30, s35, 32768
    s_or_b32 s30, s30, s51
    buffer_load_dwordx4 v1, s[16:19], s30 offen lds
    s_waitcnt lgkmcnt(4)
    v_mfma_f32_32x32x16_bf16 v[48:63], v[20:23], a[136:139], v[48:63]
    s_waitcnt vmcnt(9) lgkmcnt(2)
    v_mfma_f32_32x32x16_bf16 v[32:47], v[24:27], a[140:143], v[32:47]
    s_add_u32 s30, s50, 110592
    s_min_u32 m0, s30, 160768
    s_add_u32 s30, s39, 32768
    s_or_b32 s30, s30, s51
    buffer_load_dwordx4 v1, s[16:19], s30 offen lds
    s_waitcnt lgkmcnt(0)
    v_mfma_f32_32x32x16_bf16 v[48:63], v[28:31], a[140:143], v[48:63]
    s_waitcnt vmcnt(0)
    s_barrier
    ds_read_b64_tr_b16 v[16:17], v6 offset:24576
    ds_read_b64_tr_b16 v[18:19], v6 offset:24832
    ds_read_b64_tr_b16 v[20:21], v6 offset:25600
    ds_read_b64_tr_b16 v[22:23], v6 offset:25856
    ds_read_b64_tr_b16 v[24:25], v6 offset:26624
    ds_read_b64_tr_b16 v[26:27], v6 offset:26880
    ds_read_b64_tr_b16 v[28:29], v6 offset:27648
    ds_read_b64_tr_b16 v[30:31], v6 offset:27904
    s_waitcnt lgkmcnt(6)
    v_mfma_f32_32x32x16_bf16 v[64:79], a[0:3], v[16:19], 0
    s_cmp_eq_u32 s99, 0
    s_cbranch_scc1 L_pr3
    s_setprio 1
L_pr3:
    s_add_u32 m0, s31, 0
    s_add_u32 s30, s33, 0
    buffer_load_dwordx4 v2, s[8:11], s30 offen lds
    ds_read_b64_tr_b16 v[16:17], v6 offset:28672
    ds_read_b64_tr_b16 v[18:19], v6 offset:28928
    s_waitcnt lgkmcnt(6)
    v_mfma_f32_32x32x16_bf16 v[64:79], a[4:7], v[20:23], v[64:79]
    v_mul_f32 v13, v32, v32
    v_mul_f32 v14, v33, v33
    v_fmaak_f32 v13, v12, v13, 0xc0135761
    v_fmaak_f32 v14, v12, v14, 0xc0135761
    v_mul_f32 v13, v13, v32
    v_mul_f32 v14, v14, v33
    ds_read_b64_tr_b16 v[20:21], v6 offset:29696
    ds_read_b64_tr_b16 v[22:23], v6 offset:29952
    s_waitcnt lgkmcnt(6)
    v_mfma_f32_32x32x16_bf16 v[64:79], a[8:11], v[24:27], v[64:79]
    v_exp_f32 v13, v13
    v_exp_f32 v14, v14
    v_add_f32 v13, 1.0, v13
    v_add_f32 v14, 1.0, v14
    v_rcp_f32 v13, v13
    v_rcp_f32 v14, v14
    ds_read_b64_tr_b16 v[24:25], v6 offset:30720
    ds_read_b64_tr_b16 v[26:27], v6 offset:30976
    s_waitcnt lgkmcnt(6)
    v_mfma_f32_32x32x16_bf16 v[64:79], a[12:15], v[28:31], v[64:79]
    v_mul_f32 v32, v32, v13
    v_mul_f32 v33, v33, v14
    v_add_f32 v10, v10, v32
    v_fmac_f32 v11, v32, v32
    v_add_f32 v10, v10, v33
    v_fmac_f32 v11, v33, v33
    ds_read_b64_tr_b16 v[28:29], v6 offset:31744
    ds_read_b64_tr_b16 v[30:31], v6 offset:32000
    s_waitcnt lgkmcnt(6)
    v_mfma_f32_32x32x16_bf16 v[64:79], a[16:19], v[16:19], v[64:79]
    v_cvt_pk_bf16_f32 v80, v32, v33
    v_mul_f32 v13, v34, v34
    v_mul_f32 v14, v35, v35
    v_fmaak_f32 v13, v12, v13, 0xc0135761
    v_fmaak_f32 v14, v12, v14, 0xc0135761
    s_add_u32 m0, s31, 36864
    s_add_u32 s30, s42, 0
    buffer_load_dwordx4 v2, s[8:11], s30 offen lds
    ds_read_b64_tr_b16 v[16:17], v6 offset:32768
    ds_read_b64_tr_b16 v[18:19], v6 offset:33024
    s_waitcnt lgkmcnt(6)
    v_mfma_f32_32x32x16_bf16 v[64:79], a[20:23], v[20:23], v[64:79]
    v_mul_f32 v13, v13, v34
    v_mul_f32 v14, v14, v35
    v_exp_f32 v13, v13
    v_exp_f32 v14, v14
    v_add_f32 v13, 1.0, v13
    v_add_f32 v14, 1.0, v14
    ds_read_b64_tr_b16 v[20:21], v6 offset:33792
    ds_read_b64_tr_b16 v[22:23], v6 offset:34048
    s_waitcnt lgkmcnt(6)
    v_mfma_f32_32x32x16_bf16 v[64:79], a[24:27], v[24:27], v[64:79]
    v_rcp_f32 v13, v13
    v_rcp_f32 v14, v14
    v_mul_f32 v34, v34, v13
    v_mul_f32 v35, v35, v14
    v_add_f32 v10, v10, v34
    v_fmac_f32 v11, v34, v34
    ds_read_b64_tr_b16 v[24:25], v6 offset:34816
    ds_read_b64_tr_b16 v[26:27], v6 offset:35072
    s_waitcnt lgkmcnt(6)
    v_mfma_f32_32x32x16_bf16 v[64:79], a[28:31], v[28:31], v[64:79]
    v_add_f32 v10, v10, v35
    v_fmac_f32 v11, v35, v35
    v_cvt_pk_bf16_f32 v81, v34, v35
    v_mul_f32 v13, v36, v36
    v_mul_f32 v14, v37, v37
    v_fmaak_f32 v13, v12, v13, 0xc0135761
    ds_read_b64_tr_b16 v[28:29], v6 offset:35840
    ds_read_b64_tr_b16 v[30:31], v6 offset:36096
    s_waitcnt lgkmcnt(6)
    v_mfma_f32_32x32x16_bf16 v[64:79], a[32:35], v[16:19], v[64:79]
    v_fmaak_f32 v14, v12, v14, 0xc0135761
    v_mul_f32 v13, v13, v36
    v_mul_f32 v14, v14, v37
    v_exp_f32 v13, v13
    v_exp_f32 v14, v14
    ds_read_b64_tr_b16 v[16:17], v6 offset:36864
    ds_read_b64_tr_b16 v[18:19], v6 offset:37120
    s_waitcnt lgkmcnt(6)
    v_mfma_f32_32x32x16_bf16 v[64:79], a[36:39], v[20:23], v[64:79]
    v_add_f32 v13, 1.0, v13
    v_add_f32 v14, 1.0, v14
    v_rcp_f32 v13, v13
    v_rcp_f32 v14, v14
    v_mul_f32 v36, v36, v13
    v_mul_f32 v37, v37, v14
    s_add_u32 m0, s31, 8192
    s_add_u32 s30, s33, 1179648
    buffer_load_dwordx4 v2, s[8:11], s30 offen lds
    ds_read_b64_tr_b16 v[20:21], v6 offset:37888
    ds_read_b64_tr_b16 v[22:23], v6 offset:38144
    s_waitcnt lgkmcnt(6)
    v_mfma_f32_32x32x16_bf16 v[64:79], a[40:43], v[24:27], v[64:79]
    v_add_f32 v10, v10, v36
    v_fmac_f32 v11, v36, v36
    v_add_f32 v10, v10, v37
    v_fmac_f32 v11, v37, v37
    v_cvt_pk_bf16_f32 v82, v36, v37
    v_mul_f32 v13, v38, v38
    ds_read_b64_tr_b16 v[24:25], v6 offset:38912
    ds_read_b64_tr_b16 v[26:27], v6 offset:39168
    s_waitcnt lgkmcnt(6)
    v_mfma_f32_32x32x16_bf16 v[64:79], a[44:47], v[28:31], v[64:79]
    v_mul_f32 v14, v39, v39
    v_fmaak_f32 v13, v12, v13, 0xc0135761
    v_fmaak_f32 v14, v12, v14, 0xc0135761
    v_mul_f32 v13, v13, v38
    v_mul_f32 v14, v14, v39
    v_exp_f32 v13, v13
    ds_read_b64_tr_b16 v[28:29], v6 offset:39936
    ds_read_b64_tr_b16 v[30:31], v6 offset:40192
    s_waitcnt lgkmcnt(6)
    v_mfma_f32_32x32x16_bf16 v[64:79], a[48:51], v[16:19], v[64:79]
    v_exp_f32 v14, v14
    v_add_f32 v13, 1.0, v13
    v_add_f32 v14, 1.0, v14
    v_rcp_f32 v13, v13
    v_rcp_f32 v14, v14
    ds_read_b64_tr_b16 v[16:17], v6 offset:40960
    ds_read_b64_tr_b16 v[18:19], v6 offset:41216
    s_waitcnt lgkmcnt(6)
    v_mfma_f32_32x32x16_bf16 v[64:79], a[52:55], v[20:23], v[64:79]
    v_mul_f32 v38, v38, v13
    v_mul_f32 v39, v39, v14
    v_add_f32 v10, v10, v38
    v_fmac_f32 v11, v38, v38
    v_add_f32 v10, v10, v39
    v_fmac_f32 v11, v39, v39
    ds_read_b64_tr_b16 v[20:21], v6 offset:41984
    ds_read_b64_tr_b16 v[22:23], v6 offset:42240
    s_waitcnt lgkmcnt(6)
    v_mfma_f32_32x32x16_bf16 v[64:79], a[56:59], v[24:27], v[64:79]
    v_cvt_pk_bf16_f32 v83, v38, v39
    v_mul_f32 v13, v40, v40
    v_mul_f32 v14, v41, v41
    v_fmaak_f32 v13, v12, v13, 0xc0135761
    v_fmaak_f32 v14, v12, v14, 0xc0135761
    v_mul_f32 v13, v13, v40
    s_add_u32 m0, s31, 45056
    s_add_u32 s30, s42, 1179648
    buffer_load_dwordx4 v2, s[8:11], s30 offen lds
    ds_read_b64_tr_b16 v[24:25], v6 offset:43008
    ds_read_b64_tr_b16 v[26:27], v6 offset:43264
    s_waitcnt lgkmcnt(6)
    v_mfma_f32_32x32x16_bf16 v[64:79], a[60:63], v[28:31], v[64:79]
    v_mul_f32 v14, v14, v41
    v_exp_f32 v13, v13
    v_exp_f32 v14, v14
    v_add_f32 v13, 1.0, v13
    v_add_f32 v14, 1.0, v14
    v_rcp_f32 v13, v13
    ds_read_b64_tr_b16 v[28:29], v6 offset:44032
    ds_read_b64_tr_b16 v[30:31], v6 offset:44288
    s_waitcnt lgkmcnt(6)
    v_mfma_f32_32x32x16_bf16 v[64:79], a[64:67], v[16:19], v[64:79]
    v_rcp_f32 v14, v14
    v_mul_f32 v40, v40, v13
    v_mul_f32 v41, v41, v14
    v_add_f32 v10, v10, v40
    v_fmac_f32 v11, v40, v40
    ds_read_b64_tr_b16 v[16:17], v6 offset:45056
    ds_read_b64_tr_b16 v[18:19], v6 offset:45312
    s_waitcnt lgkmcnt(6)
    v_mfma_f32_32x32x16_bf16 v[64:79], a[68:71], v[20:23], v[64:79]
    v_add_f32 v10, v10, v41
    v_fmac_f32 v11, v41, v41
    v_cvt_pk_bf16_f32 v84, v40, v41
    v_mul_f32 v13, v42, v42
    v_mul_f32 v14, v43, v43
    v_fmaak_f32 v13, v12, v13, 0xc0135761
    ds_read_b64_tr_b16 v[20:21], v6 offset:46080
    ds_read_b64_tr_b16 v[22:23], v6 offset:46336
    s_waitcnt lgkmcnt(6)
    v_mfma_f32_32x32x16_bf16 v[64:79], a[72:75], v[24:27], v[64:79]
    v_fmaak_f32 v14, v12, v14, 0xc0135761
    v_mul_f32 v13, v13, v42
    v_mul_f32 v14, v14, v43
    v_exp_f32 v13, v13
    v_exp_f32 v14, v14
    v_add_f32 v13, 1.0, v13
    s_add_u32 m0, s31, 16384
    s_add_u32 s30, s33, 2359296
    buffer_load_dwordx4 v2, s[8:11], s30 offen lds
    ds_read_b64_tr_b16 v[24:25], v6 offset:47104
    ds_read_b64_tr_b16 v[26:27], v6 offset:47360
    s_waitcnt lgkmcnt(6)
    v_mfma_f32_32x32x16_bf16 v[64:79], a[76:79], v[28:31], v[64:79]
    v_add_f32 v14, 1.0, v14
    v_rcp_f32 v13, v13
    v_rcp_f32 v14, v14
    v_mul_f32 v42, v42, v13
    v_mul_f32 v43, v43, v14
    ds_read_b64_tr_b16 v[28:29], v6 offset:48128
    ds_read_b64_tr_b16 v[30:31], v6 offset:48384
    s_waitcnt lgkmcnt(6)
    v_mfma_f32_32x32x16_bf16 v[64:79], a[80:83], v[16:19], v[64:79]
    v_add_f32 v10, v10, v42
    v_fmac_f32 v11, v42, v42
    v_add_f32 v10, v10, v43
    v_fmac_f32 v11, v43, v43
    v_cvt_pk_bf16_f32 v85, v42, v43
    v_mul_f32 v13, v44, v44
    ds_read_b64_tr_b16 v[16:17], v7 offset:0
    ds_read_b64_tr_b16 v[18:19], v7 offset:256
    s_waitcnt lgkmcnt(6)
    v_mfma_f32_32x32x16_bf16 v[64:79], a[84:87], v[20:23], v[64:79]
    v_mul_f32 v14, v45, v45
    v_fmaak_f32 v13, v12, v13, 0xc0135761
    v_fmaak_f32 v14, v12, v14, 0xc0135761
    v_mul_f32 v13, v13, v44
    v_mul_f32 v14, v14, v45
    v_exp_f32 v13, v13
    ds_read_b64_tr_b16 v[20:21], v7 offset:1024
    ds_read_b64_tr_b16 v[22:23], v7 offset:1280
    s_waitcnt lgkmcnt(6)
    v_mfma_f32_32x32x16_bf16 v[64:79], a[88:91], v[24:27], v[64:79]
    v_exp_f32 v14, v14
    v_add_f32 v13, 1.0, v13
    v_add_f32 v14, 1.0, v14
    v_rcp_f32 v13, v13
    v_rcp_f32 v14, v14
    v_mul_f32 v44, v44, v13
    ds_read_b64_tr_b16 v[24:25], v7 offset:2048
    ds_read_b64_tr_b16 v[26:27], v7 offset:2304
    s_waitcnt lgkmcnt(6)
    v_mfma_f32_32x32x16_bf16 v[64:79], a[92:95], v[28:31], v[64:79]
    v_mul_f32 v45, v45, v14
    v_add_f32 v10, v10, v44
    v_fmac_f32 v11, v44, v44
    v_add_f32 v10, v10, v45
    v_fmac_f32 v11, v45, v45
    s_add_u32 m0, s31, 53248
    s_add_u32 s30, s42, 2359296
    buffer_load_dwordx4 v2, s[8:11], s30 offen lds
    ds_read_b64_tr_b16 v[28:29], v7 offset:3072
    ds_read_b64_tr_b16 v[30:31], v7 offset:3328
    s_waitcnt lgkmcnt(6)
    v_mfma_f32_32x32x16_bf16 v[64:79], a[96:99], v[16:19], v[64:79]
    v_cvt_pk_bf16_f32 v86, v44, v45
    v_mul_f32 v13, v46, v46
    v_mul_f32 v14, v47, v47
    v_fmaak_f32 v13, v12, v13, 0xc0135761
    v_fmaak_f32 v14, v12, v14, 0xc0135761
    v_mul_f32 v13, v13, v46
    ds_read_b64_tr_b16 v[16:17], v7 offset:4096
    ds_read_b64_tr_b16 v[18:19], v7 offset:4352
    s_waitcnt lgkmcnt(6)
    v_mfma_f32_32x32x16_bf16 v[64:79], a[100:103], v[20:23], v[64:79]
    v_mul_f32 v14, v14, v47
    v_exp_f32 v13, v13
    v_exp_f32 v14, v14
    v_add_f32 v13, 1.0, v13
    v_add_f32 v14, 1.0, v14
    v_rcp_f32 v13, v13
    ds_read_b64_tr_b16 v[20:21], v7 offset:5120
    ds_read_b64_tr_b16 v[22:23], v7 offset:5376
    s_waitcnt lgkmcnt(6)
    v_mfma_f32_32x32x16_bf16 v[64:79], a[104:107], v[24:27], v[64:79]
    v_rcp_f32 v14, v14
    v_mul_f32 v46, v46, v13
    v_mul_f32 v47, v47, v14
    v_add_f32 v10, v10, v46
    v_fmac_f32 v11, v46, v46
    v_add_f32 v10, v10, v47
    ds_read_b64_tr_b16 v[24:25], v7 offset:6144
    ds_read_b64_tr_b16 v[26:27], v7 offset:6400
    s_waitcnt lgkmcnt(6)
    v_mfma_f32_32x32x16_bf16 v[64:79], a[108:111], v[28:31], v[64:79]
    v_fmac_f32 v11, v47, v47
    v_cvt_pk_bf16_f32 v87, v46, v47
    v_mul_f32 v13, v48, v48
    v_mul_f32 v14, v49, v49
    v_fmaak_f32 v13, v12, v13, 0xc0135761
    ds_read_b64_tr_b16 v[28:29], v7 offset:7168
    ds_read_b64_tr_b16 v[30:31], v7 offset:7424
    s_waitcnt lgkmcnt(6)
    v_mfma_f32_32x32x16_bf16 v[64:79], a[112:115], v[16:19], v[64:79]
    v_fmaak_f32 v14, v12, v14, 0xc0135761
    v_mul_f32 v13, v13, v48
    v_mul_f32 v14, v14, v49
    v_exp_f32 v13, v13
    v_exp_f32 v14, v14
    v_add_f32 v13, 1.0, v13
    s_add_u32 m0, s31, 24576
    s_add_u32 s30, s33, 3538944
    buffer_load_dwordx4 v2, s[8:11], s30 offen lds
    ds_read_b64_tr_b16 v[16:17], v7 offset:8192
    ds_read_b64_tr_b16 v[18:19], v7 offset:8448
    s_waitcnt lgkmcnt(6)
    v_mfma_f32_32x32x16_bf16 v[64:79], a[116:119], v[20:23], v[64:79]
    v_add_f32 v14, 1.0, v14
    v_rcp_f32 v13, v13
    v_rcp_f32 v14, v14
    v_mul_f32 v48, v48, v13
    v_mul_f32 v49, v49, v14
    v_add_f32 v10, v10, v48
    ds_read_b64_tr_b16 v[20:21], v7 offset:9216
    ds_read_b64_tr_b16 v[22:23], v7 offset:9472
    s_waitcnt lgkmcnt(6)
    v_mfma_f32_32x32x16_bf16 v[64:79], a[120:123], v[24:27], v[64:79]
    v_fmac_f32 v11, v48, v48
    v_add_f32 v10, v10, v49
    v_fmac_f32 v11, v49, v49
    v_cvt_pk_bf16_f32 v88, v48, v49
    v_mul_f32 v13, v50, v50
    v_mul_f32 v14, v51, v51
    ds_read_b64_tr_b16 v[24:25], v7 offset:10240
    ds_read_b64_tr_b16 v[26:27], v7 offset:10496
    s_waitcnt lgkmcnt(6)
    v_mfma_f32_32x32x16_bf16 v[64:79], a[124:127], v[28:31], v[64:79]
    v_fmaak_f32 v13, v12, v13, 0xc0135761
    v_fmaak_f32 v14, v12, v14, 0xc0135761
    v_mul_f32 v13, v13, v50
    v_mul_f32 v14, v14, v51
    v_exp_f32 v13, v13
    ds_read_b64_tr_b16 v[28:29], v7 offset:11264
    ds_read_b64_tr_b16 v[30:31], v7 offset:11520
    s_waitcnt lgkmcnt(6)
    v_mfma_f32_32x32x16_bf16 v[64:79], a[128:131], v[16:19], v[64:79]
    v_exp_f32 v14, v14
    v_add_f32 v13, 1.0, v13
    v_add_f32 v14, 1.0, v14
    v_rcp_f32 v13, v13
    v_rcp_f32 v14, v14
    v_mul_f32 v50, v50, v13
    s_add_u32 m0, s31, 61440
    s_add_u32 s30, s42, 3538944
    buffer_load_dwordx4 v2, s[8:11], s30 offen lds
    ds_read_b64_tr_b16 v[16:17], v7 offset:12288
    ds_read_b64_tr_b16 v[18:19], v7 offset:12544
    s_waitcnt lgkmcnt(6)
    v_mfma_f32_32x32x16_bf16 v[64:79], a[132:135], v[20:23], v[64:79]
    v_mul_f32 v51, v51, v14
    v_add_f32 v10, v10, v50
    v_fmac_f32 v11, v50, v50
    v_add_f32 v10, v10, v51
    v_fmac_f32 v11, v51, v51
    v_cvt_pk_bf16_f32 v89, v50, v51
    ds_read_b64_tr_b16 v[20:21], v7 offset:13312
    ds_read_b64_tr_b16 v[22:23], v7 offset:13568
    s_waitcnt lgkmcnt(6)
    v_mfma_f32_32x32x16_bf16 v[64:79], a[136:139], v[24:27], v[64:79]
    v_mul_f32 v13, v52, v52
    v_mul_f32 v14, v53, v53
    v_fmaak_f32 v13, v12, v13, 0xc0135761
    v_fmaak_f32 v14, v12, v14, 0xc0135761
    v_mul_f32 v13, v13, v52
    ds_read_b64_tr_b16 v[24:25], v7 offset:14336
    ds_read_b64_tr_b16 v[26:27], v7 offset:14592
    s_waitcnt lgkmcnt(6)
    v_mfma_f32_32x32x16_bf16 v[64:79], a[140:143], v[28:31], v[64:79]
    ds_read_b64_tr_b16 v[28:29], v7 offset:15360
    ds_read_b64_tr_b16 v[30:31], v7 offset:15616
    s_waitcnt lgkmcnt(6)
    v_mfma_f32_32x32x16_bf16 v[32:47], a[0:3], v[16:19], 0
    s_cmp_eq_u32 s99, 0
    s_cbranch_scc1 L_pr4
    s_setprio 0
L_pr4:
    ds_read_b64_tr_b16 v[16:17], v7 offset:16384
    ds_read_b64_tr_b16 v[18:19], v7 offset:16640
    s_waitcnt lgkmcnt(6)
    v_mfma_f32_32x32x16_bf16 v[32:47], a[4:7], v[20:23], v[32:47]
    v_mul_f32 v14, v14, v53
    v_exp_f32 v13, v13
    v_exp_f32 v14, v14
    v_add_f32 v13, 1.0, v13
    v_add_f32 v14, 1.0, v14
    v_rcp_f32 v13, v13
    s_add_u32 s30, s50, 0
    s_min_u32 m0, s30, 160768
    s_add_u32 s30, s33, 4718592
    s_or_b32 s30, s30, s51
    buffer_load_dwordx4 v2, s[8:11], s30 offen lds
    ds_read_b64_tr_b16 v[20:21], v7 offset:17408
    ds_read_b64_tr_b16 v[22:23], v7 offset:17664
    s_waitcnt lgkmcnt(6)
    v_mfma_f32_32x32x16_bf16 v[32:47], a[8:11], v[24:27], v[32:47]
    v_rcp_f32 v14, v14
    v_mul_f32 v52, v52, v13
    v_mul_f32 v53, v53, v14
    v_add_f32 v10, v10, v52
    v_fmac_f32 v11, v52, v52
    v_add_f32 v10, v10, v53
    ds_read_b64_tr_b16 v[24:25], v7 offset:18432
    ds_read_b64_tr_b16 v[26:27], v7 offset:18688
    s_waitcnt lgkmcnt(6)
    v_mfma_f32_32x32x16_bf16 v[32:47], a[12:15], v[28:31], v[32:47]
    v_fmac_f32 v11, v53, v53
    v_cvt_pk_bf16_f32 v90, v52, v53
    v_mul_f32 v13, v54, v54
    v_mul_f32 v14, v55, v55
    v_fmaak_f32 v13, v12, v13, 0xc0135761
    v_fmaak_f32 v14, v12, v14, 0xc0135761
    ds_read_b64_tr_b16 v[28:29], v7 offset:19456
    ds_read_b64_tr_b16 v[30:31], v7 offset:19712
    s_waitcnt lgkmcnt(6)
    v_mfma_f32_32x32x16_bf16 v[32:47], a[16:19], v[16:19], v[32:47]
    v_mul_f32 v13, v13, v54
    v_mul_f32 v14, v14, v55
    v_exp_f32 v13, v13
    v_exp_f32 v14, v14
    v_add_f32 v13, 1.0, v13
    v_add_f32 v14, 1.0, v14
    ds_read_b64_tr_b16 v[16:17], v7 offset:20480
    ds_read_b64_tr_b16 v[18:19], v7 offset:20736
    s_waitcnt lgkmcnt(6)
    v_mfma_f32_32x32x16_bf16 v[32:47], a[20:23], v[20:23], v[32:47]
    v_rcp_f32 v13, v13
    v_rcp_f32 v14, v14
    v_mul_f32 v54, v54, v13
    v_mul_f32 v55, v55, v14
    v_add_f32 v10, v10, v54
    v_fmac_f32 v11, v54, v54
    ds_read_b64_tr_b16 v[20:21], v7 offset:21504
    ds_read_b64_tr_b16 v[22:23], v7 offset:21760
    s_waitcnt lgkmcnt(6)
    v_mfma_f32_32x32x16_bf16 v[32:47], a[24:27], v[24:27], v[32:47]
    v_add_f32 v10, v10, v55
    v_fmac_f32 v11, v55, v55
    v_cvt_pk_bf16_f32 v91, v54, v55
    v_mul_f32 v13, v56, v56
    v_mul_f32 v14, v57, v57
    v_fmaak_f32 v13, v12, v13, 0xc0135761
    s_add_u32 s30, s50, 36864
    s_min_u32 m0, s30, 160768
    s_add_u32 s30, s42, 4718592
    s_or_b32 s30, s30, s51
    buffer_load_dwordx4 v2, s[8:11], s30 offen lds
    ds_read_b64_tr_b16 v[24:25], v7 offset:22528
    ds_read_b64_tr_b16 v[26:27], v7 offset:22784
    s_waitcnt lgkmcnt(6)
    v_mfma_f32_32x32x16_bf16 v[32:47], a[28:31], v[28:31], v[32:47]
    v_fmaak_f32 v14, v12, v14, 0xc0135761
    v_mul_f32 v13, v13, v56
    v_mul_f32 v14, v14, v57
    v_exp_f32 v13, v13
    v_exp_f32 v14, v14
    ds_read_b64_tr_b16 v[28:29], v7 offset:23552
    ds_read_b64_tr_b16 v[30:31], v7 offset:23808
    s_waitcnt lgkmcnt(6)
    v_mfma_f32_32x32x16_bf16 v[32:47], a[32:35], v[16:19], v[32:47]
    v_add_f32 v13, 1.0, v13
    v_add_f32 v14, 1.0, v14
    v_rcp_f32 v13, v13
    v_rcp_f32 v14, v14
    v_mul_f32 v56, v56, v13
    v_mul_f32 v57, v57, v14
    ds_read_b64_tr_b16 v[16:17], v7 offset:24576
    ds_read_b64_tr_b16 v[18:19], v7 offset:24832
    s_waitcnt lgkmcnt(6)
    v_mfma_f32_32x32x16_bf16 v[32:47], a[36:39], v[20:23], v[32:47]
    v_add_f32 v10, v10, v56
    v_fmac_f32 v11, v56, v56
    v_add_f32 v10, v10, v57
    v_fmac_f32 v11, v57, v57
    v_cvt_pk_bf16_f32 v92, v56, v57
    v_mul_f32 v13, v58, v58
    ds_read_b64_tr_b16 v[20:21], v7 offset:25600
    ds_read_b64_tr_b16 v[22:23], v7 offset:25856
    s_waitcnt lgkmcnt(6)
    v_mfma_f32_32x32x16_bf16 v[32:47], a[40:43], v[24:27], v[32:47]
    v_mul_f32 v14, v59, v59
    v_fmaak_f32 v13, v12, v13, 0xc0135761
    v_fmaak_f32 v14, v12, v14, 0xc0135761
    v_mul_f32 v13, v13, v58
    v_mul_f32 v14, v14, v59
    v_exp_f32 v13, v13
    ds_read_b64_tr_b16 v[24:25], v7 offset:26624
    ds_read_b64_tr_b16 v[26:27], v7 offset:26880
    s_waitcnt lgkmcnt(6)
    v_mfma_f32_32x32x16_bf16 v[32:47], a[44:47], v[28:31], v[32:47]
    v_exp_f32 v14, v14
    v_add_f32 v13, 1.0, v13
    v_add_f32 v14, 1.0, v14
    v_rcp_f32 v13, v13
    v_rcp_f32 v14, v14
    v_mul_f32 v58, v58, v13
    ds_read_b64_tr_b16 v[28:29], v7 offset:27648
    ds_read_b64_tr_b16 v[30:31], v7 offset:27904
    s_waitcnt lgkmcnt(6)
    v_mfma_f32_32x32x16_bf16 v[32:47], a[48:51], v[16:19], v[32:47]
    v_mul_f32 v59, v59, v14
    v_add_f32 v10, v10, v58
    v_fmac_f32 v11, v58, v58
    v_add_f32 v10, v10, v59
    v_fmac_f32 v11, v59, v59
    v_cvt_pk_bf16_f32 v93, v58, v59
    ds_read_b64_tr_b16 v[16:17], v7 offset:28672
    ds_read_b64_tr_b16 v[18:19], v7 offset:28928
    s_waitcnt lgkmcnt(6)
    v_mfma_f32_32x32x16_bf16 v[32:47], a[52:55], v[20:23], v[32:47]
    v_mul_f32 v13, v60, v60
    v_mul_f32 v14, v61, v61
    v_fmaak_f32 v13, v12, v13, 0xc0135761
    v_fmaak_f32 v14, v12, v14, 0xc0135761
    v_mul_f32 v13, v13, v60
    v_mul_f32 v14, v14, v61
    ds_read_b64_tr_b16 v[20:21], v7 offset:29696
    ds_read_b64_tr_b16 v[22:23], v7 offset:29952
    s_waitcnt lgkmcnt(6)
    v_mfma_f32_32x32x16_bf16 v[32:47], a[56:59], v[24:27], v[32:47]
    v_exp_f32 v13, v13
    v_exp_f32 v14, v14
    v_add_f32 v13, 1.0, v13
    v_add_f32 v14, 1.0, v14
    v_rcp_f32 v13, v13
    ds_read_b64_tr_b16 v[24:25], v7 offset:30720
    ds_read_b64_tr_b16 v[26:27], v7 offset:30976
    s_waitcnt lgkmcnt(6)
    v_mfma_f32_32x32x16_bf16 v[32:47], a[60:63], v[28:31], v[32:47]
    v_rcp_f32 v14, v14
    v_mul_f32 v60, v60, v13
    v_mul_f32 v61, v61, v14
    v_add_f32 v10, v10, v60
    v_fmac_f32 v11, v60, v60
    v_add_f32 v10, v10, v61
    ds_read_b64_tr_b16 v[28:29], v7 offset:31744
    ds_read_b64_tr_b16 v[30:31], v7 offset:32000
    s_waitcnt lgkmcnt(6)
    v_mfma_f32_32x32x16_bf16 v[32:47], a[64:67], v[16:19], v[32:47]
    v_fmac_f32 v11, v61, v61
    v_cvt_pk_bf16_f32 v94, v60, v61
    v_mul_f32 v13, v62, v62
    v_mul_f32 v14, v63, v63
    v_fmaak_f32 v13, v12, v13, 0xc0135761
    v_fmaak_f32 v14, v12, v14, 0xc0135761
    ds_read_b64_tr_b16 v[16:17], v7 offset:32768
    ds_read_b64_tr_b16 v[18:19], v7 offset:33024
    s_waitcnt lgkmcnt(6)
    v_mfma_f32_32x32x16_bf16 v[32:47], a[68:71], v[20:23], v[32:47]
    v_mul_f32 v13, v13, v62
    v_mul_f32 v14, v14, v63
    v_exp_f32 v13, v13
    v_exp_f32 v14, v14
    v_add_f32 v13, 1.0, v13
    v_add_f32 v14, 1.0, v14
    ds_read_b64_tr_b16 v[20:21], v7 offset:33792
    ds_read_b64_tr_b16 v[22:23], v7 offset:34048
    s_waitcnt lgkmcnt(6)
    v_mfma_f32_32x32x16_bf16 v[32:47], a[72:75], v[24:27], v[32:47]
    v_rcp_f32 v13, v13
    v_rcp_f32 v14, v14
    v_mul_f32 v62, v62, v13
    v_mul_f32 v63, v63, v14
    v_add_f32 v10, v10, v62
    v_fmac_f32 v11, v62, v62
    ds_read_b64_tr_b16 v[24:25], v7 offset:34816
    ds_read_b64_tr_b16 v[26:27], v7 offset:35072
    s_waitcnt lgkmcnt(6)
    v_mfma_f32_32x32x16_bf16 v[32:47], a[76:79], v[28:31], v[32:47]
    v_add_f32 v10, v10, v63
    v_fmac_f32 v11, v63, v63
    v_cvt_pk_bf16_f32 v95, v62, v63
    s_nop 0
    v_permlane32_swap_b32 v10, v11
    v_add_f32 v10, v10, v11
    v_and_b32 v13, 15, v0
    ds_read_b64_tr_b16 v[28:29], v7 offset:35840
    ds_read_b64_tr_b16 v[30:31], v7 offset:36096
    s_waitcnt lgkmcnt(6)
    v_mfma_f32_32x32x16_bf16 v[32:47], a[80:83], v[16:19], v[32:47]
    v_lshlrev_b32 v13, 4, v13
    v_bfe_u32 v14, v0, 4, 1
    v_lshl_add_u32 v13, v14, 3, v13
    v_bfe_u32 v14, v0, 5, 1
    v_lshl_add_u32 v13, v14, 2, v13
    buffer_store_dword v10, v13, s[16:19], s38 offen sc0 sc1
    ds_read_b64_tr_b16 v[16:17], v7 offset:36864
    ds_read_b64_tr_b16 v[18:19], v7 offset:37120
    s_waitcnt lgkmcnt(6)
    v_mfma_f32_32x32x16_bf16 v[32:47], a[84:87], v[20:23], v[32:47]
    v_cndmask_b32 v3, 0, 1.0, s[44:45]
    v_mul_f32 v4, 0x358637bd, v3
    v_mov_b32 v15, 0xff800000
    v_cndmask_b32 v9, v15, 0, s[44:45]
    v_mov_b32 v15, 0x7f800000
    ds_read_b64_tr_b16 v[20:21], v7 offset:37888
    ds_read_b64_tr_b16 v[22:23], v7 offset:38144
    s_waitcnt lgkmcnt(6)
    v_mfma_f32_32x32x16_bf16 v[32:47], a[88:91], v[24:27], v[32:47]
    v_mul_f32 v13, 0x3fb8aa3b, v64
    v_mul_f32 v14, 0x3fb8aa3b, v65
    v_min_f32 v13, 0, v13
    v_min_f32 v14, 0, v14
    v_exp_f32 v13, v13
    v_exp_f32 v14, v14
    ds_read_b64_tr_b16 v[24:25], v7 offset:38912
    ds_read_b64_tr_b16 v[26:27], v7 offset:39168
    s_waitcnt lgkmcnt(6)
    v_mfma_f32_32x32x16_bf16 v[32:47], a[92:95], v[28:31], v[32:47]
    v_med3_f32 v64, v64, v9, v15
    v_med3_f32 v65, v65, v9, v15
    v_fma_f32 v13, v13, v3, v4
    v_fma_f32 v14, v14, v3, v4
    v_add_f32 v64, v64, v13
    v_add_f32 v65, v65, v14
    ds_read_b64_tr_b16 v[28:29], v7 offset:39936
    ds_read_b64_tr_b16 v[30:31], v7 offset:40192
    s_waitcnt lgkmcnt(6)
    v_mfma_f32_32x32x16_bf16 v[32:47], a[96:99], v[16:19], v[32:47]
    v_cvt_pk_bf16_f32 v64, v64, v65
    v_mul_f32 v13, 0x3fb8aa3b, v66
    v_mul_f32 v14, 0x3fb8aa3b, v67
    v_min_f32 v13, 0, v13
    v_min_f32 v14, 0, v14
    v_exp_f32 v13, v13
    ds_read_b64_tr_b16 v[16:17], v7 offset:40960
    ds_read_b64_tr_b16 v[18:19], v7 offset:41216
    s_waitcnt lgkmcnt(6)
    v_mfma_f32_32x32x16_bf16 v[32:47], a[100:103], v[20:23], v[32:47]
    v_exp_f32 v14, v14
    v_med3_f32 v66, v66, v9, v15
    v_med3_f32 v67, v67, v9, v15
    v_fma_f32 v13, v13, v3, v4
    v_fma_f32 v14, v14, v3, v4
    v_add_f32 v66, v66, v13
    ds_read_b64_tr_b16 v[20:21], v7 offset:41984
    ds_read_b64_tr_b16 v[22:23], v7 offset:42240
    s_waitcnt lgkmcnt(6)
    v_mfma_f32_32x32x16_bf16 v[32:47], a[104:107], v[24:27], v[32:47]
    v_add_f32 v67, v67, v14
    v_cvt_pk_bf16_f32 v65, v66, v67
    v_mul_f32 v13, 0x3fb8aa3b, v68
    v_mul_f32 v14, 0x3fb8aa3b, v69
    v_min_f32 v13, 0, v13
    v_min_f32 v14, 0, v14
    ds_read_b64_tr_b16 v[24:25], v7 offset:43008
    ds_read_b64_tr_b16 v[26:27], v7 offset:43264
    s_waitcnt lgkmcnt(6)
    v_mfma_f32_32x32x16_bf16 v[32:47], a[108:111], v[28:31], v[32:47]
    v_exp_f32 v13, v13
    v_exp_f32 v14, v14
    v_med3_f32 v68, v68, v9, v15
    v_med3_f32 v69, v69, v9, v15
    v_fma_f32 v13, v13, v3, v4
    v_fma_f32 v14, v14, v3, v4
    ds_read_b64_tr_b16 v[28:29], v7 offset:44032
    ds_read_b64_tr_b16 v[30:31], v7 offset:44288
    s_waitcnt lgkmcnt(6)
    v_mfma_f32_32x32x16_bf16 v[32:47], a[112:115], v[16:19], v[32:47]
    v_add_f32 v68, v68, v13
    v_add_f32 v69, v69, v14
    v_cvt_pk_bf16_f32 v66, v68, v69
    v_mul_f32 v13, 0x3fb8aa3b, v70
    v_mul_f32 v14, 0x3fb8aa3b, v71
    ds_read_b64_tr_b16 v[16:17], v7 offset:45056
    ds_read_b64_tr_b16 v[18:19], v7 offset:45312
    s_waitcnt lgkmcnt(6)
    v_mfma_f32_32x32x16_bf16 v[32:47], a[116:119], v[20:23], v[32:47]
    v_min_f32 v13, 0, v13
    v_min_f32 v14, 0, v14
    v_exp_f32 v13, v13
    v_exp_f32 v14, v14
    v_med3_f32 v70, v70, v9, v15
    v_med3_f32 v71, v71, v9, v15
    ds_read_b64_tr_b16 v[20:21], v7 offset:46080
    ds_read_b64_tr_b16 v[22:23], v7 offset:46336
    s_waitcnt lgkmcnt(6)
    v_mfma_f32_32x32x16_bf16 v[32:47], a[120:123], v[24:27], v[32:47]
    v_fma_f32 v13, v13, v3, v4
    v_fma_f32 v14, v14, v3, v4
    v_add_f32 v70, v70, v13
    v_add_f32 v71, v71, v14
    v_cvt_pk_bf16_f32 v67, v70, v71
    v_mul_f32 v13, 0x3fb8aa3b, v72
    ds_read_b64_tr_b16 v[24:25], v7 offset:47104
    ds_read_b64_tr_b16 v[26:27], v7 offset:47360
    s_waitcnt lgkmcnt(6)
    v_mfma_f32_32x32x16_bf16 v[32:47], a[124:127], v[28:31], v[32:47]
    v_mul_f32 v14, 0x3fb8aa3b, v73
    v_min_f32 v13, 0, v13
    v_min_f32 v14, 0, v14
    v_exp_f32 v13, v13
    v_exp_f32 v14, v14
    v_med3_f32 v72, v72, v9, v15
    ds_read_b64_tr_b16 v[28:29], v7 offset:48128
    ds_read_b64_tr_b16 v[30:31], v7 offset:48384
    s_waitcnt lgkmcnt(6)
    v_mfma_f32_32x32x16_bf16 v[32:47], a[128:131], v[16:19], v[32:47]
    v_med3_f32 v73, v73, v9, v15
    v_fma_f32 v13, v13, v3, v4
    v_fma_f32 v14, v14, v3, v4
    v_add_f32 v72, v72, v13
    v_add_f32 v73, v73, v14
    v_cvt_pk_bf16_f32 v68, v72, v73
    s_waitcnt lgkmcnt(4)
    v_mfma_f32_32x32x16_bf16 v[32:47], a[132:135], v[20:23], v[32:47]
    v_mul_f32 v13, 0x3fb8aa3b, v74
    v_mul_f32 v14, 0x3fb8aa3b, v75
    v_min_f32 v13, 0, v13
    v_min_f32 v14, 0, v14
    v_exp_f32 v13, v13
    v_exp_f32 v14, v14
    s_waitcnt lgkmcnt(2)
    v_mfma_f32_32x32x16_bf16 v[32:47], a[136:139], v[24:27], v[32:47]
    v_med3_f32 v74, v74, v9, v15
    v_med3_f32 v75, v75, v9, v15
    v_fma_f32 v13, v13, v3, v4
    v_fma_f32 v14, v14, v3, v4
    v_add_f32 v74, v74, v13
    s_waitcnt lgkmcnt(0)
    v_mfma_f32_32x32x16_bf16 v[32:47], a[140:143], v[28:31], v[32:47]
    s_waitcnt vmcnt(1)
    s_barrier
    ds_read_b64_tr_b16 v[16:17], v5 offset:0
    ds_read_b64_tr_b16 v[18:19], v5 offset:256
    ds_read_b64_tr_b16 v[20:21], v5 offset:1024
    ds_read_b64_tr_b16 v[22:23], v5 offset:1280
    ds_read_b64_tr_b16 v[24:25], v5 offset:2048
    ds_read_b64_tr_b16 v[26:27], v5 offset:2304
    ds_read_b64_tr_b16 v[28:29], v5 offset:3072
    ds_read_b64_tr_b16 v[30:31], v5 offset:3328
    s_waitcnt lgkmcnt(6)
    v_mfma_f32_32x32x16_bf16 v[48:63], v[16:19], a[0:3], 0
    s_cmp_eq_u32 s99, 0
    s_cbranch_scc1 L_pr5
    s_setprio 1
L_pr5:
    s_add_u32 m0, s31, 73728
    s_add_u32 s30, s34, 0
    buffer_load_dwordx4 v2, s[8:11], s30 offen lds
    ds_read_b64_tr_b16 v[16:17], v5 offset:4096
    ds_read_b64_tr_b16 v[18:19], v5 offset:4352
    s_waitcnt lgkmcnt(6)
    v_mfma_f32_32x32x16_bf16 v[48:63], v[20:23], a[4:7], v[48:63]
    v_add_f32 v75, v75, v14
    v_cvt_pk_bf16_f32 v69, v74, v75
    v_mul_f32 v13, 0x3fb8aa3b, v76
    v_mul_f32 v14, 0x3fb8aa3b, v77
    v_min_f32 v13, 0, v13
    ds_read_b64_tr_b16 v[20:21], v5 offset:5120
    ds_read_b64_tr_b16 v[22:23], v5 offset:5376
    s_waitcnt lgkmcnt(6)
    v_mfma_f32_32x32x16_bf16 v[48:63], v[24:27], a[8:11], v[48:63]
    v_min_f32 v14, 0, v14
    v_exp_f32 v13, v13
    v_exp_f32 v14, v14
    v_med3_f32 v76, v76, v9, v15
    v_med3_f32 v77, v77, v9, v15
    s_add_u32 m0, s31, 81920
    s_add_u32 s30, s34, 1179648
    buffer_load_dwordx4 v2, s[8:11], s30 offen lds
    ds_read_b64_tr_b16 v[24:25], v5 offset:6144
    ds_read_b64_tr_b16 v[26:27], v5 offset:6400
    s_waitcnt lgkmcnt(6)
    v_mfma_f32_32x32x16_bf16 v[48:63], v[28:31], a[12:15], v[48:63]
    v_fma_f32 v13, v13, v3, v4
    v_fma_f32 v14, v14, v3, v4
    v_add_f32 v76, v76, v13
    v_add_f32 v77, v77, v14
    v_cvt_pk_bf16_f32 v70, v76, v77
    ds_read_b64_tr_b16 v[28:29], v5 offset:7168
    ds_read_b64_tr_b16 v[30:31], v5 offset:7424
    s_waitcnt lgkmcnt(6)
    v_mfma_f32_32x32x16_bf16 v[48:63], v[16:19], a[16:19], v[48:63]
    v_mul_f32 v13, 0x3fb8aa3b, v78
    v_mul_f32 v14, 0x3fb8aa3b, v79
    v_min_f32 v13, 0, v13
    v_min_f32 v14, 0, v14
    ds_read_b64_tr_b16 v[16:17], v5 offset:8192
    ds_read_b64_tr_b16 v[18:19], v5 offset:8448
    s_waitcnt lgkmcnt(6)
    v_mfma_f32_32x32x16_bf16 v[48:63], v[20:23], a[20:23], v[48:63]
    v_exp_f32 v13, v13
    v_exp_f32 v14, v14
    v_med3_f32 v78, v78, v9, v15
    v_med3_f32 v79, v79, v9, v15
    v_fma_f32 v13, v13, v3, v4
    s_add_u32 m0, s31, 90112
    s_add_u32 s30, s34, 2359296
    buffer_load_dwordx4 v2, s[8:11], s30 offen lds
    ds_read_b64_tr_b16 v[20:21], v5 offset:9216
    ds_read_b64_tr_b16 v[22:23], v5 offset:9472
    s_waitcnt lgkmcnt(6)
    v_mfma_f32_32x32x16_bf16 v[48:63], v[24:27], a[24:27], v[48:63]
    v_fma_f32 v14, v14, v3, v4
    v_add_f32 v78, v78, v13
    v_add_f32 v79, v79, v14
    v_cvt_pk_bf16_f32 v71, v78, v79
    v_and_b32 v13, 31, v0
    ds_read_b64_tr_b16 v[24:25], v5 offset:10240
    ds_read_b64_tr_b16 v[26:27], v5 offset:10496
    s_waitcnt lgkmcnt(6)
    v_mfma_f32_32x32x16_bf16 v[48:63], v[28:31], a[28:31], v[48:63]
    v_lshrrev_b32 v14, 5, v0
    v_mul_u32_u24 v105, 80, v13
    v_lshl_add_u32 v105, v14, 4, v105
    v_add_u32 v105, s37, v105
    s_add_u32 m0, s31, 98304
    s_add_u32 s30, s34, 3538944
    buffer_load_dwordx4 v2, s[8:11], s30 offen lds
    ds_read_b64_tr_b16 v[28:29], v5 offset:11264
    ds_read_b64_tr_b16 v[30:31], v5 offset:11520
    s_waitcnt lgkmcnt(6)
    v_mfma_f32_32x32x16_bf16 v[48:63], v[16:19], a[32:35], v[48:63]
    v_subrev_u32 v104, 2560, v105
    v_subrev_u32 v13, 6, v13
    v_lshlrev_b32 v106, 12, v13
    v_lshl_add_u32 v106, v14, 4, v106
    v_cndmask_b32 v3, 0, 1.0, s[46:47]
    ds_read_b64_tr_b16 v[16:17], v5 offset:12288
    ds_read_b64_tr_b16 v[18:19], v5 offset:12544
    s_waitcnt lgkmcnt(6)
    v_mfma_f32_32x32x16_bf16 v[48:63], v[20:23], a[36:39], v[48:63]
    v_mul_f32 v4, 0x358637bd, v3
    v_mov_b32 v15, 0xff800000
    v_cndmask_b32 v9, v15, 0, s[46:47]
    v_mov_b32 v15, 0x7f800000
    v_cndmask_b32 v9, v9, 1.0, s[48:49]
    ds_read_b64_tr_b16 v[20:21], v5 offset:13312
    ds_read_b64_tr_b16 v[22:23], v5 offset:13568
    s_waitcnt lgkmcnt(6)
    v_mfma_f32_32x32x16_bf16 v[48:63], v[24:27], a[40:43], v[48:63]
    v_cndmask_b32 v15, v15, 1.0, s[48:49]
    v_mul_f32 v13, 0x3fb8aa3b, v32
    v_mul_f32 v14, 0x3fb8aa3b, v33
    v_min_f32 v13, 0, v13
    v_min_f32 v14, 0, v14
    s_add_u32 s30, s50, 73728
    s_min_u32 m0, s30, 160768
    s_add_u32 s30, s34, 4718592
    s_or_b32 s30, s30, s51
    buffer_load_dwordx4 v2, s[8:11], s30 offen lds
    ds_read_b64_tr_b16 v[24:25], v5 offset:14336
    ds_read_b64_tr_b16 v[26:27], v5 offset:14592
    s_waitcnt lgkmcnt(6)
    v_mfma_f32_32x32x16_bf16 v[48:63], v[28:31], a[44:47], v[48:63]
    v_exp_f32 v13, v13
    v_exp_f32 v14, v14
    v_med3_f32 v32, v32, v9, v15
    v_med3_f32 v33, v33, v9, v15
    ds_read_b64_tr_b16 v[28:29], v5 offset:15360
    ds_read_b64_tr_b16 v[30:31], v5 offset:15616
    s_waitcnt lgkmcnt(6)
    v_mfma_f32_32x32x16_bf16 v[48:63], v[16:19], a[48:51], v[48:63]
    v_fma_f32 v13, v13, v3, v4
    v_fma_f32 v14, v14, v3, v4
    v_add_f32 v32, v32, v13
    v_add_f32 v33, v33, v14
    v_cvt_pk_bf16_f32 v72, v32, v33
    ds_read_b64_tr_b16 v[16:17], v5 offset:16384
    ds_read_b64_tr_b16 v[18:19], v5 offset:16640
    s_waitcnt lgkmcnt(6)
    v_mfma_f32_32x32x16_bf16 v[48:63], v[20:23], a[52:55], v[48:63]
    v_mul_f32 v13, 0x3fb8aa3b, v34
    v_mul_f32 v14, 0x3fb8aa3b, v35
    v_min_f32 v13, 0, v13
    v_min_f32 v14, 0, v14
    v_exp_f32 v13, v13
    ds_read_b64_tr_b16 v[20:21], v5 offset:17408
    ds_read_b64_tr_b16 v[22:23], v5 offset:17664
    s_waitcnt lgkmcnt(6)
    v_mfma_f32_32x32x16_bf16 v[48:63], v[24:27], a[56:59], v[48:63]
    v_exp_f32 v14, v14
    v_med3_f32 v34, v34, v9, v15
    v_med3_f32 v35, v35, v9, v15
    v_fma_f32 v13, v13, v3, v4
    ds_read_b64_tr_b16 v[24:25], v5 offset:18432
    ds_read_b64_tr_b16 v[26:27], v5 offset:18688
    s_waitcnt lgkmcnt(6)
    v_mfma_f32_32x32x16_bf16 v[48:63], v[28:31], a[60:63], v[48:63]
    v_fma_f32 v14, v14, v3, v4
    v_add_f32 v34, v34, v13
    v_add_f32 v35, v35, v14
    v_cvt_pk_bf16_f32 v73, v34, v35
    v_mul_f32 v13, 0x3fb8aa3b, v36
    ds_read_b64_tr_b16 v[28:29], v5 offset:19456
    ds_read_b64_tr_b16 v[30:31], v5 offset:19712
    s_waitcnt lgkmcnt(6)
    v_mfma_f32_32x32x16_bf16 v[48:63], v[16:19], a[64:67], v[48:63]
    v_mul_f32 v14, 0x3fb8aa3b, v37
    v_min_f32 v13, 0, v13
    v_min_f32 v14, 0, v14
    v_exp_f32 v13, v13
    v_exp_f32 v14, v14
    ds_read_b64_tr_b16 v[16:17], v5 offset:20480
    ds_read_b64_tr_b16 v[18:19], v5 offset:20736
    s_waitcnt lgkmcnt(6)
    v_mfma_f32_32x32x16_bf16 v[48:63], v[20:23], a[68:71], v[48:63]
    v_med3_f32 v36, v36, v9, v15
    v_med3_f32 v37, v37, v9, v15
    v_fma_f32 v13, v13, v3, v4
    v_fma_f32 v14, v14, v3, v4
    ds_read_b64_tr_b16 v[20:21], v5 offset:21504
    ds_read_b64_tr_b16 v[22:23], v5 offset:21760
    s_waitcnt lgkmcnt(6)
    v_mfma_f32_32x32x16_bf16 v[48:63], v[24:27], a[72:75], v[48:63]
    v_add_f32 v36, v36, v13
    v_add_f32 v37, v37, v14
    v_cvt_pk_bf16_f32 v74, v36, v37
    v_mul_f32 v13, 0x3fb8aa3b, v38
    v_mul_f32 v14, 0x3fb8aa3b, v39
    ds_read_b64_tr_b16 v[24:25], v5 offset:22528
    ds_read_b64_tr_b16 v[26:27], v5 offset:22784
    s_waitcnt lgkmcnt(6)
    v_mfma_f32_32x32x16_bf16 v[48:63], v[28:31], a[76:79], v[48:63]
    v_min_f32 v13, 0, v13
    v_min_f32 v14, 0, v14
    v_exp_f32 v13, v13
    v_exp_f32 v14, v14
    v_med3_f32 v38, v38, v9, v15
    ds_read_b64_tr_b16 v[28:29], v5 offset:23552
    ds_read_b64_tr_b16 v[30:31], v5 offset:23808
    s_waitcnt lgkmcnt(6)
    v_mfma_f32_32x32x16_bf16 v[48:63], v[16:19], a[80:83], v[48:63]
    v_med3_f32 v39, v39, v9, v15
    v_fma_f32 v13, v13, v3, v4
    v_fma_f32 v14, v14, v3, v4
    v_add_f32 v38, v38, v13
    v_add_f32 v39, v39, v14
    ds_read_b64_tr_b16 v[16:17], v5 offset:24576
    ds_read_b64_tr_b16 v[18:19], v5 offset:24832
    s_waitcnt lgkmcnt(6)
    v_mfma_f32_32x32x16_bf16 v[48:63], v[20:23], a[84:87], v[48:63]
    v_cvt_pk_bf16_f32 v75, v38, v39
    v_mul_f32 v13, 0x3fb8aa3b, v40
    v_mul_f32 v14, 0x3fb8aa3b, v41
    v_min_f32 v13, 0, v13
    ds_read_b64_tr_b16 v[20:21], v5 offset:25600
    ds_read_b64_tr_b16 v[22:23], v5 offset:25856
    s_waitcnt lgkmcnt(6)
    v_mfma_f32_32x32x16_bf16 v[48:63], v[24:27], a[88:91], v[48:63]
    v_min_f32 v14, 0, v14
    v_exp_f32 v13, v13
    v_exp_f32 v14, v14
    v_med3_f32 v40, v40, v9, v15
    v_med3_f32 v41, v41, v9, v15
    ds_read_b64_tr_b16 v[24:25], v5 offset:26624
    ds_read_b64_tr_b16 v[26:27], v5 offset:26880
    s_waitcnt lgkmcnt(6)
    v_mfma_f32_32x32x16_bf16 v[48:63], v[28:31], a[92:95], v[48:63]
    v_fma_f32 v13, v13, v3, v4
    v_fma_f32 v14, v14, v3, v4
    v_add_f32 v40, v40, v13
    v_add_f32 v41, v41, v14
    v_cvt_pk_bf16_f32 v76, v40, v41
    ds_read_b64_tr_b16 v[28:29], v5 offset:27648
    ds_read_b64_tr_b16 v[30:31], v5 offset:27904
    s_waitcnt lgkmcnt(6)
    v_mfma_f32_32x32x16_bf16 v[48:63], v[16:19], a[96:99], v[48:63]
    v_mul_f32 v13, 0x3fb8aa3b, v42
    v_mul_f32 v14, 0x3fb8aa3b, v43
    v_min_f32 v13, 0, v13
    v_min_f32 v14, 0, v14
    ds_read_b64_tr_b16 v[16:17], v5 offset:28672
    ds_read_b64_tr_b16 v[18:19], v5 offset:28928
    s_waitcnt lgkmcnt(6)
    v_mfma_f32_32x32x16_bf16 v[48:63], v[20:23], a[100:103], v[48:63]
    v_exp_f32 v13, v13
    v_exp_f32 v14, v14
    v_med3_f32 v42, v42, v9, v15
    v_med3_f32 v43, v43, v9, v15
    v_fma_f32 v13, v13, v3, v4
    ds_read_b64_tr_b16 v[20:21], v5 offset:29696
    ds_read_b64_tr_b16 v[22:23], v5 offset:29952
    s_waitcnt lgkmcnt(6)
    v_mfma_f32_32x32x16_bf16 v[48:63], v[24:27], a[104:107], v[48:63]
    v_fma_f32 v14, v14, v3, v4
    v_add_f32 v42, v42, v13
    v_add_f32 v43, v43, v14
    v_cvt_pk_bf16_f32 v77, v42, v43
    v_mul_f32 v13, 0x3fb8aa3b, v44
    ds_read_b64_tr_b16 v[24:25], v5 offset:30720
    ds_read_b64_tr_b16 v[26:27], v5 offset:30976
    s_waitcnt lgkmcnt(6)
    v_mfma_f32_32x32x16_bf16 v[48:63], v[28:31], a[108:111], v[48:63]
    v_mul_f32 v14, 0x3fb8aa3b, v45
    v_min_f32 v13, 0, v13
    v_min_f32 v14, 0, v14
    v_exp_f32 v13, v13
    v_exp_f32 v14, v14
    ds_read_b64_tr_b16 v[28:29], v5 offset:31744
    ds_read_b64_tr_b16 v[30:31], v5 offset:32000
    s_waitcnt lgkmcnt(6)
    v_mfma_f32_32x32x16_bf16 v[48:63], v[16:19], a[112:115], v[48:63]
    v_med3_f32 v44, v44, v9, v15
    v_med3_f32 v45, v45, v9, v15
    v_fma_f32 v13, v13, v3, v4
    v_fma_f32 v14, v14, v3, v4
    ds_read_b64_tr_b16 v[16:17], v5 offset:32768
    ds_read_b64_tr_b16 v[18:19], v5 offset:33024
    s_waitcnt lgkmcnt(6)
    v_mfma_f32_32x32x16_bf16 v[48:63], v[20:23], a[116:119], v[48:63]
    v_add_f32 v44, v44, v13
    v_add_f32 v45, v45, v14
    v_cvt_pk_bf16_f32 v78, v44, v45
    v_mul_f32 v13, 0x3fb8aa3b, v46
    v_mul_f32 v14, 0x3fb8aa3b, v47
    ds_read_b64_tr_b16 v[20:21], v5 offset:33792
    ds_read_b64_tr_b16 v[22:23], v5 offset:34048
    s_waitcnt lgkmcnt(6)
    v_mfma_f32_32x32x16_bf16 v[48:63], v[24:27], a[120:123], v[48:63]
    v_min_f32 v13, 0, v13
    v_min_f32 v14, 0, v14
    v_exp_f32 v13, v13
    v_exp_f32 v14, v14
    v_med3_f32 v46, v46, v9, v15
    ds_read_b64_tr_b16 v[24:25], v5 offset:34816
    ds_read_b64_tr_b16 v[26:27], v5 offset:35072
    s_waitcnt lgkmcnt(6)
    v_mfma_f32_32x32x16_bf16 v[48:63], v[28:31], a[124:127], v[48:63]
    v_med3_f32 v47, v47, v9, v15
    v_fma_f32 v13, v13, v3, v4
    v_fma_f32 v14, v14, v3, v4
    v_add_f32 v46, v46, v13
    ds_read_b64_tr_b16 v[28:29], v5 offset:35840
    ds_read_b64_tr_b16 v[30:31], v5 offset:36096
    s_waitcnt lgkmcnt(6)
    v_mfma_f32_32x32x16_bf16 v[48:63], v[16:19], a[128:131], v[48:63]
    v_add_f32 v47, v47, v14
    v_cvt_pk_bf16_f32 v79, v46, v47
    v_mfma_f32_32x32x16_bf16 v[32:47], v[64:67], v[64:67], 0
    v_mfma_f32_32x32x16_bf16 v[32:47], v[68:71], v[68:71], v[32:47]
    s_mov_b32 exec_lo, 0xfffc0000
    s_mov_b32 exec_hi, 0xfffc0000
    s_nop 7
    s_nop 1
    ds_write_b128 v104, v[32:35]
    ds_write_b128 v104, v[36:39] offset:32
    s_mov_b32 exec_hi, 0
    ds_write_b128 v104, v[40:43] offset:64
    s_mov_b64 exec, -1
    ds_read_b64_tr_b16 v[16:17], v5 offset:36864
    ds_read_b64_tr_b16 v[18:19], v5 offset:37120
    s_waitcnt lgkmcnt(9)
    v_mfma_f32_32x32x16_bf16 v[48:63], v[20:23], a[132:135], v[48:63]
    s_waitcnt lgkmcnt(2)
    v_mfma_f32_32x32x16_bf16 v[32:47], v[64:67], v[72:75], 0
    v_mfma_f32_32x32x16_bf16 v[32:47], v[68:71], v[76:79], v[32:47]
    v_permlane32_swap_b32 v72, v74
    v_permlane32_swap_b32 v73, v75
    ds_read_b64_tr_b16 v[20:21], v5 offset:37888
    ds_read_b64_tr_b16 v[22:23], v5 offset:38144
    v_mfma_f32_32x32x16_bf16 v[48:63], v[24:27], a[136:139], v[48:63]
    v_permlane32_swap_b32 v76, v78
    v_permlane32_swap_b32 v77, v79
    s_mov_b32 exec_lo, 0x00ffffc0
    s_mov_b32 exec_hi, 0x00ffffc0
    buffer_store_dwordx4 v[72:75], v106, s[16:19], s36 offen
    buffer_store_dwordx4 v[76:79], v106, s[16:19], s36 offen offset:32
    s_mov_b64 exec, -1
    s_mov_b32 exec_lo, 0x0000001f
    s_mov_b32 exec_hi, 0x0000001f
    ds_write_b128 v105, v[32:35]
    ds_write_b128 v105, v[36:39] offset:32
    s_mov_b32 exec_hi, 0
    ds_write_b128 v105, v[40:43] offset:64
    s_mov_b64 exec, -1
    ds_read_b64_tr_b16 v[24:25], v5 offset:38912
    ds_read_b64_tr_b16 v[26:27], v5 offset:39168
    v_mfma_f32_32x32x16_bf16 v[48:63], v[28:31], a[140:143], v[48:63]
    ds_read_b64_tr_b16 v[28:29], v5 offset:39936
    ds_read_b64_tr_b16 v[30:31], v5 offset:40192
    s_waitcnt lgkmcnt(9)
    v_mfma_f32_32x32x16_bf16 v[64:79], v[16:19], a[0:3], 0
    s_cmp_eq_u32 s99, 0
    s_cbranch_scc1 L_pr6
    s_setprio 0
L_pr6:
    ds_read_b64_tr_b16 v[16:17], v5 offset:40960
    ds_read_b64_tr_b16 v[18:19], v5 offset:41216
    s_waitcnt lgkmcnt(9)
    v_mfma_f32_32x32x16_bf16 v[64:79], v[20:23], a[4:7], v[64:79]
    s_add_u32 s29, s41, 4096
    buffer_load_dwordx4 v[32:35], v1, s[16:19], s41 offen offset:0 sc1
    buffer_load_dwordx4 v[36:39], v1, s[16:19], s41 offen offset:1024 sc1
    buffer_load_dwordx4 v[40:43], v1, s[16:19], s41 offen offset:2048 sc1
    buffer_load_dwordx4 v[44:47], v1, s[16:19], s41 offen offset:3072 sc1
    v_mul_f32 v13, v48, v48
    ds_read_b64_tr_b16 v[20:21], v5 offset:41984
    ds_read_b64_tr_b16 v[22:23], v5 offset:42240
    s_waitcnt lgkmcnt(6)
    v_mfma_f32_32x32x16_bf16 v[64:79], v[24:27], a[8:11], v[64:79]
    v_mul_f32 v14, v49, v49
    v_fmaak_f32 v13, v12, v13, 0xc0135761
    v_fmaak_f32 v14, v12, v14, 0xc0135761
    v_mul_f32 v13, v13, v48
    v_mul_f32 v14, v14, v49
    ds_read_b64_tr_b16 v[24:25], v5 offset:43008
    ds_read_b64_tr_b16 v[26:27], v5 offset:43264
    s_waitcnt lgkmcnt(6)
    v_mfma_f32_32x32x16_bf16 v[64:79], v[28:31], a[12:15], v[64:79]
    v_exp_f32 v13, v13
    v_exp_f32 v14, v14
    v_add_f32 v13, 1.0, v13
    v_add_f32 v14, 1.0, v14
    v_rcp_f32 v13, v13
    v_rcp_f32 v14, v14
    ds_read_b64_tr_b16 v[28:29], v5 offset:44032
    ds_read_b64_tr_b16 v[30:31], v5 offset:44288
    s_waitcnt lgkmcnt(6)
    v_mfma_f32_32x32x16_bf16 v[64:79], v[16:19], a[16:19], v[64:79]
    v_mul_f32 v48, v48, v13
    v_mul_f32 v49, v49, v14
    v_cvt_pk_bf16_f32 v48, v48, v49
    v_mul_f32 v13, v50, v50
    v_mul_f32 v14, v51, v51
    ds_read_b64_tr_b16 v[16:17], v5 offset:45056
    ds_read_b64_tr_b16 v[18:19], v5 offset:45312
    s_waitcnt lgkmcnt(6)
    v_mfma_f32_32x32x16_bf16 v[64:79], v[20:23], a[20:23], v[64:79]
    v_fmaak_f32 v13, v12, v13, 0xc0135761
    v_fmaak_f32 v14, v12, v14, 0xc0135761
    v_mul_f32 v13, v13, v50
    v_mul_f32 v14, v14, v51
    v_exp_f32 v13, v13
    v_exp_f32 v14, v14
    ds_read_b64_tr_b16 v[20:21], v5 offset:46080
    ds_read_b64_tr_b16 v[22:23], v5 offset:46336
    s_waitcnt lgkmcnt(6)
    v_mfma_f32_32x32x16_bf16 v[64:79], v[24:27], a[24:27], v[64:79]
    v_add_f32 v13, 1.0, v13
    v_add_f32 v14, 1.0, v14
    v_rcp_f32 v13, v13
    v_rcp_f32 v14, v14
    v_mul_f32 v50, v50, v13
    ds_read_b64_tr_b16 v[24:25], v5 offset:47104
    ds_read_b64_tr_b16 v[26:27], v5 offset:47360
    s_waitcnt lgkmcnt(6)
    v_mfma_f32_32x32x16_bf16 v[64:79], v[28:31], a[28:31], v[64:79]
    v_mul_f32 v51, v51, v14
    v_cvt_pk_bf16_f32 v49, v50, v51
    v_mul_f32 v13, v56, v56
    v_mul_f32 v14, v57, v57
    v_fmaak_f32 v13, v12, v13, 0xc0135761
    v_fmaak_f32 v14, v12, v14, 0xc0135761
    ds_read_b64_tr_b16 v[28:29], v5 offset:48128
    ds_read_b64_tr_b16 v[30:31], v5 offset:48384
    s_waitcnt lgkmcnt(6)
    v_mfma_f32_32x32x16_bf16 v[64:79], v[16:19], a[32:35], v[64:79]
    v_mul_f32 v13, v13, v56
    v_mul_f32 v14, v14, v57
    v_exp_f32 v13, v13
    v_exp_f32 v14, v14
    v_add_f32 v13, 1.0, v13
    ds_read_b64_tr_b16 v[16:17], v6 offset:0
    ds_read_b64_tr_b16 v[18:19], v6 offset:256
    s_waitcnt lgkmcnt(6)
    v_mfma_f32_32x32x16_bf16 v[64:79], v[20:23], a[36:39], v[64:79]
    v_add_f32 v14, 1.0, v14
    v_rcp_f32 v13, v13
    v_rcp_f32 v14, v14
    v_mul_f32 v56, v56, v13
    v_mul_f32 v57, v57, v14
    ds_read_b64_tr_b16 v[20:21], v6 offset:1024
    ds_read_b64_tr_b16 v[22:23], v6 offset:1280
    s_waitcnt lgkmcnt(6)
    v_mfma_f32_32x32x16_bf16 v[64:79], v[24:27], a[40:43], v[64:79]
    v_cvt_pk_bf16_f32 v50, v56, v57
    v_mul_f32 v13, v58, v58
    v_mul_f32 v14, v59, v59
    v_fmaak_f32 v13, v12, v13, 0xc0135761
    v_fmaak_f32 v14, v12, v14, 0xc0135761
    v_mul_f32 v13, v13, v58
    ds_read_b64_tr_b16 v[24:25], v6 offset:2048
    ds_read_b64_tr_b16 v[26:27], v6 offset:2304
    s_waitcnt lgkmcnt(6)
    v_mfma_f32_32x32x16_bf16 v[64:79], v[28:31], a[44:47], v[64:79]
    v_mul_f32 v14, v14, v59
    v_exp_f32 v13, v13
    v_exp_f32 v14, v14
    v_add_f32 v13, 1.0, v13
    v_add_f32 v14, 1.0, v14
    ds_read_b64_tr_b16 v[28:29], v6 offset:3072
    ds_read_b64_tr_b16 v[30:31], v6 offset:3328
    s_waitcnt lgkmcnt(6)
    v_mfma_f32_32x32x16_bf16 v[64:79], v[16:19], a[48:51], v[64:79]
    v_rcp_f32 v13, v13
    v_rcp_f32 v14, v14
    v_mul_f32 v58, v58, v13
    v_mul_f32 v59, v59, v14
    v_cvt_pk_bf16_f32 v51, v58, v59
    buffer_store_dwordx4 v[48:51], v8, s[16:19], s52 offen offset:0 sc0 sc1
    ds_read_b64_tr_b16 v[16:17], v6 offset:4096
    ds_read_b64_tr_b16 v[18:19], v6 offset:4352
    s_waitcnt lgkmcnt(6)
    v_mfma_f32_32x32x16_bf16 v[64:79], v[20:23], a[52:55], v[64:79]
    s_waitcnt vmcnt(1)
    v_add_f32 v108, v32, v36
    v_add_f32 v108, v108, v40
    v_add_f32 v108, v108, v44
    v_add_f32 v109, v33, v37
    ds_read_b64_tr_b16 v[20:21], v6 offset:5120
    ds_read_b64_tr_b16 v[22:23], v6 offset:5376
    s_waitcnt lgkmcnt(6)
    v_mfma_f32_32x32x16_bf16 v[64:79], v[24:27], a[56:59], v[64:79]
    v_add_f32 v109, v109, v41
    v_add_f32 v109, v109, v45
    v_add_f32 v110, v34, v38
    v_add_f32 v110, v110, v42
    v_add_f32 v110, v110, v46
    v_add_f32 v111, v35, v39
    ds_read_b64_tr_b16 v[24:25], v6 offset:6144
    ds_read_b64_tr_b16 v[26:27], v6 offset:6400
    s_waitcnt lgkmcnt(6)
    v_mfma_f32_32x32x16_bf16 v[64:79], v[28:31], a[60:63], v[64:79]
    v_add_f32 v111, v111, v43
    v_add_f32 v111, v111, v47
    buffer_load_dwordx4 v[32:35], v1, s[16:19], s29 offen offset:0 sc1
    buffer_load_dwordx4 v[36:39], v1, s[16:19], s29 offen offset:1024 sc1
    buffer_load_dwordx4 v[40:43], v1, s[16:19], s29 offen offset:2048 sc1
    ds_read_b64_tr_b16 v[28:29], v6 offset:7168
    ds_read_b64_tr_b16 v[30:31], v6 offset:7424
    s_waitcnt lgkmcnt(6)
    v_mfma_f32_32x32x16_bf16 v[64:79], v[16:19], a[64:67], v[64:79]
    buffer_load_dwordx4 v[44:47], v1, s[16:19], s29 offen offset:3072 sc1
    v_mul_f32 v13, v52, v52
    v_mul_f32 v14, v53, v53
    v_fmaak_f32 v13, v12, v13, 0xc0135761
    v_fmaak_f32 v14, v12, v14, 0xc0135761
    v_mul_f32 v13, v13, v52
    ds_read_b64_tr_b16 v[16:17], v6 offset:8192
    ds_read_b64_tr_b16 v[18:19], v6 offset:8448
    s_waitcnt lgkmcnt(6)
    v_mfma_f32_32x32x16_bf16 v[64:79], v[20:23], a[68:71], v[64:79]
    v_mul_f32 v14, v14, v53
    v_exp_f32 v13, v13
    v_exp_f32 v14, v14
    v_add_f32 v13, 1.0, v13
    v_add_f32 v14, 1.0, v14
    ds_read_b64_tr_b16 v[20:21], v6 offset:9216
    ds_read_b64_tr_b16 v[22:23], v6 offset:9472
    s_waitcnt lgkmcnt(6)
    v_mfma_f32_32x32x16_bf16 v[64:79], v[24:27], a[72:75], v[64:79]
    v_rcp_f32 v13, v13
    v_rcp_f32 v14, v14
    v_mul_f32 v52, v52, v13
    v_mul_f32 v53, v53, v14
    v_cvt_pk_bf16_f32 v52, v52, v53
    ds_read_b64_tr_b16 v[24:25], v6 offset:10240
    ds_read_b64_tr_b16 v[26:27], v6 offset:10496
    s_waitcnt lgkmcnt(6)
    v_mfma_f32_32x32x16_bf16 v[64:79], v[28:31], a[76:79], v[64:79]
    v_mul_f32 v13, v54, v54
    v_mul_f32 v14, v55, v55
    v_fmaak_f32 v13, v12, v13, 0xc0135761
    v_fmaak_f32 v14, v12, v14, 0xc0135761
    v_mul_f32 v13, v13, v54
    v_mul_f32 v14, v14, v55
    ds_read_b64_tr_b16 v[28:29], v6 offset:11264
    ds_read_b64_tr_b16 v[30:31], v6 offset:11520
    s_waitcnt lgkmcnt(6)
    v_mfma_f32_32x32x16_bf16 v[64:79], v[16:19], a[80:83], v[64:79]
    v_exp_f32 v13, v13
    v_exp_f32 v14, v14
    v_add_f32 v13, 1.0, v13
    v_add_f32 v14, 1.0, v14
    v_rcp_f32 v13, v13
    ds_read_b64_tr_b16 v[16:17], v6 offset:12288
    ds_read_b64_tr_b16 v[18:19], v6 offset:12544
    s_waitcnt lgkmcnt(6)
    v_mfma_f32_32x32x16_bf16 v[64:79], v[20:23], a[84:87], v[64:79]
    v_rcp_f32 v14, v14
    v_mul_f32 v54, v54, v13
    v_mul_f32 v55, v55, v14
    v_cvt_pk_bf16_f32 v53, v54, v55
    v_mul_f32 v13, v60, v60
    v_mul_f32 v14, v61, v61
    ds_read_b64_tr_b16 v[20:21], v6 offset:13312
    ds_read_b64_tr_b16 v[22:23], v6 offset:13568
    s_waitcnt lgkmcnt(6)
    v_mfma_f32_32x32x16_bf16 v[64:79], v[24:27], a[88:91], v[64:79]
    v_fmaak_f32 v13, v12, v13, 0xc0135761
    v_fmaak_f32 v14, v12, v14, 0xc0135761
    v_mul_f32 v13, v13, v60
    v_mul_f32 v14, v14, v61
    v_exp_f32 v13, v13
    ds_read_b64_tr_b16 v[24:25], v6 offset:14336
    ds_read_b64_tr_b16 v[26:27], v6 offset:14592
    s_waitcnt lgkmcnt(6)
    v_mfma_f32_32x32x16_bf16 v[64:79], v[28:31], a[92:95], v[64:79]
    v_exp_f32 v14, v14
    v_add_f32 v13, 1.0, v13
    v_add_f32 v14, 1.0, v14
    v_rcp_f32 v13, v13
    v_rcp_f32 v14, v14
    v_mul_f32 v60, v60, v13
    ds_read_b64_tr_b16 v[28:29], v6 offset:15360
    ds_read_b64_tr_b16 v[30:31], v6 offset:15616
    s_waitcnt lgkmcnt(6)
    v_mfma_f32_32x32x16_bf16 v[64:79], v[16:19], a[96:99], v[64:79]
    v_mul_f32 v61, v61, v14
    v_cvt_pk_bf16_f32 v54, v60, v61
    v_mul_f32 v13, v62, v62
    v_mul_f32 v14, v63, v63
    v_fmaak_f32 v13, v12, v13, 0xc0135761
    ds_read_b64_tr_b16 v[16:17], v6 offset:16384
    ds_read_b64_tr_b16 v[18:19], v6 offset:16640
    s_waitcnt lgkmcnt(6)
    v_mfma_f32_32x32x16_bf16 v[64:79], v[20:23], a[100:103], v[64:79]
    v_fmaak_f32 v14, v12, v14, 0xc0135761
    v_mul_f32 v13, v13, v62
    v_mul_f32 v14, v14, v63
    v_exp_f32 v13, v13
    v_exp_f32 v14, v14
    v_add_f32 v13, 1.0, v13
    ds_read_b64_tr_b16 v[20:21], v6 offset:17408
    ds_read_b64_tr_b16 v[22:23], v6 offset:17664
    s_waitcnt lgkmcnt(6)
    v_mfma_f32_32x32x16_bf16 v[64:79], v[24:27], a[104:107], v[64:79]
    v_add_f32 v14, 1.0, v14
    v_rcp_f32 v13, v13
    v_rcp_f32 v14, v14
    v_mul_f32 v62, v62, v13
    v_mul_f32 v63, v63, v14
    ds_read_b64_tr_b16 v[24:25], v6 offset:18432
    ds_read_b64_tr_b16 v[26:27], v6 offset:18688
    s_waitcnt lgkmcnt(6)
    v_mfma_f32_32x32x16_bf16 v[64:79], v[28:31], a[108:111], v[64:79]
    v_cvt_pk_bf16_f32 v55, v62, v63
    buffer_store_dwordx4 v[52:55], v8, s[16:19], s52 offen offset:512 sc0 sc1
    s_waitcnt vmcnt(1)
    v_add_f32 v108, v108, v32
    v_add_f32 v108, v108, v36
    ds_read_b64_tr_b16 v[28:29], v6 offset:19456
    ds_read_b64_tr_b16 v[30:31], v6 offset:19712
    s_waitcnt lgkmcnt(6)
    v_mfma_f32_32x32x16_bf16 v[64:79], v[16:19], a[112:115], v[64:79]
    v_add_f32 v108, v108, v40
    v_add_f32 v108, v108, v44
    v_add_f32 v109, v109, v33
    v_add_f32 v109, v109, v37
    v_add_f32 v109, v109, v41
    v_add_f32 v109, v109, v45
    ds_read_b64_tr_b16 v[16:17], v6 offset:20480
    ds_read_b64_tr_b16 v[18:19], v6 offset:20736
    s_waitcnt lgkmcnt(6)
    v_mfma_f32_32x32x16_bf16 v[64:79], v[20:23], a[116:119], v[64:79]
    v_add_f32 v110, v110, v34
    v_add_f32 v110, v110, v38
    v_add_f32 v110, v110, v42
    v_add_f32 v110, v110, v46
    v_add_f32 v111, v111, v35
    ds_read_b64_tr_b16 v[20:21], v6 offset:21504
    ds_read_b64_tr_b16 v[22:23], v6 offset:21760
    s_waitcnt lgkmcnt(6)
    v_mfma_f32_32x32x16_bf16 v[64:79], v[24:27], a[120:123], v[64:79]
    v_add_f32 v111, v111, v39
    v_add_f32 v111, v111, v43
    v_add_f32 v111, v111, v47
    v_permlane32_swap_b32 v108, v109
    s_nop 0
    v_permlane32_swap_b32 v110, v111
    v_add_f32 v108, v108, v109
    ds_read_b64_tr_b16 v[24:25], v6 offset:22528
    ds_read_b64_tr_b16 v[26:27], v6 offset:22784
    s_waitcnt lgkmcnt(6)
    v_mfma_f32_32x32x16_bf16 v[64:79], v[28:31], a[124:127], v[64:79]
    v_add_f32 v110, v110, v111
    s_nop 1
    v_permlane16_swap_b32 v108, v110
    v_add_f32 v10, v108, v110
    v_cmp_u_f32 vcc, v10, v10
    s_cbranch_vccz L_gemm1_kernel_B_go
    s_mov_b32 s59, 0
L_gemm1_kernel_B_poll:
    buffer_load_dwordx4 v[32:35], v1, s[16:19], s41 offen offset:0 sc1
    buffer_load_dwordx4 v[36:39], v1, s[16:19], s41 offen offset:1024 sc1
    buffer_load_dwordx4 v[40:43], v1, s[16:19], s41 offen offset:2048 sc1
    buffer_load_dwordx4 v[44:47], v1, s[16:19], s41 offen offset:3072 sc1
    s_waitcnt vmcnt(0)
    v_add_f32 v108, v32, v36
    v_add_f32 v108, v108, v40
    v_add_f32 v108, v108, v44
    v_add_f32 v109, v33, v37
    v_add_f32 v109, v109, v41
    v_add_f32 v109, v109, v45
    v_add_f32 v110, v34, v38
    v_add_f32 v110, v110, v42
    v_add_f32 v110, v110, v46
    v_add_f32 v111, v35, v39
    v_add_f32 v111, v111, v43
    v_add_f32 v111, v111, v47
    buffer_load_dwordx4 v[32:35], v1, s[16:19], s29 offen offset:0 sc1
    buffer_load_dwordx4 v[36:39], v1, s[16:19], s29 offen offset:1024 sc1
    buffer_load_dwordx4 v[40:43], v1, s[16:19], s29 offen offset:2048 sc1
    buffer_load_dwordx4 v[44:47], v1, s[16:19], s29 offen offset:3072 sc1
    s_waitcnt vmcnt(0)
    v_add_f32 v108, v108, v32
    v_add_f32 v108, v108, v36
    v_add_f32 v108, v108, v40
    v_add_f32 v108, v108, v44
    v_add_f32 v109, v109, v33
    v_add_f32 v109, v109, v37
    v_add_f32 v109, v109, v41
    v_add_f32 v109, v109, v45
    v_add_f32 v110, v110, v34
    v_add_f32 v110, v110, v38
    v_add_f32 v110, v110, v42
    v_add_f32 v110, v110, v46
    v_add_f32 v111, v111, v35
    v_add_f32 v111, v111, v39
    v_add_f32 v111, v111, v43
    v_add_f32 v111, v111, v47
    v_permlane32_swap_b32 v108, v109
    s_nop 0
    v_permlane32_swap_b32 v110, v111
    v_add_f32 v108, v108, v109
    v_add_f32 v110, v110, v111
    s_nop 1
    v_permlane16_swap_b32 v108, v110
    v_add_f32 v10, v108, v110
    v_cmp_u_f32 vcc, v10, v10
    s_cbranch_vccz L_gemm1_kernel_B_go
    s_sleep 4
    s_add_u32 s59, s59, 1
    s_cmp_lt_u32 s59, 0x40000
    s_cbranch_scc1 L_gemm1_kernel_B_poll
L_gemm1_kernel_B_go:
    v_mov_b32 v11, v10
    ds_read_b64_tr_b16 v[28:29], v6 offset:23552
    ds_read_b64_tr_b16 v[30:31], v6 offset:23808
    s_waitcnt lgkmcnt(6)
    v_mfma_f32_32x32x16_bf16 v[64:79], v[16:19], a[128:131], v[64:79]
    v_permlane32_swap_b32 v10, v11
    v_mul_f32 v10, 0x39e38e39, v10
    v_mul_f32 v11, 0x39e38e39, v11
    v_fma_f32 v11, -v10, v10, v11
    v_max_f32 v11, 0, v11
    v_cvt_pk_bf16_f32 v13, v10, v11
    s_waitcnt lgkmcnt(4)
    v_mfma_f32_32x32x16_bf16 v[64:79], v[20:23], a[132:135], v[64:79]
    v_lshlrev_b32 v10, 16, v13
    v_and_b32 v11, 0xffff0000, v13
    v_add_f32 v11, 0x3727c5ac, v11
    v_cvt_pk_bf16_f32 v11, v11, v11
    v_and_b32 v11, 0xffff0000, v11
    s_waitcnt lgkmcnt(2)
    v_mfma_f32_32x32x16_bf16 v[64:79], v[24:27], a[136:139], v[64:79]
    v_sqrt_f32 v11, v11
    s_nop 0
    v_cvt_pk_bf16_f32 v11, v11, v11
    v_and_b32 v11, 0xffff0000, v11
    v_rcp_f32 v11, v11
    s_nop 0
    v_mul_f32 v10, v10, v11
    s_waitcnt lgkmcnt(0)
    v_mfma_f32_32x32x16_bf16 v[64:79], v[28:31], a[140:143], v[64:79]
    s_barrier
    ds_read_b64_tr_b16 v[16:17], v6 offset:24576
    ds_read_b64_tr_b16 v[18:19], v6 offset:24832
    ds_read_b64_tr_b16 v[20:21], v6 offset:25600
    ds_read_b64_tr_b16 v[22:23], v6 offset:25856
    ds_read_b64_tr_b16 v[24:25], v6 offset:26624
    ds_read_b64_tr_b16 v[26:27], v6 offset:26880
    ds_read_b64_tr_b16 v[28:29], v6 offset:27648
    ds_read_b64_tr_b16 v[30:31], v6 offset:27904
    s_waitcnt lgkmcnt(6)
    v_mfma_f32_32x32x16_bf16 v[32:47], v[16:19], a[0:3], 0
    s_cmp_eq_u32 s99, 0
    s_cbranch_scc1 L_pr7
    s_setprio 1
L_pr7:
    ds_read_b64_tr_b16 v[16:17], v6 offset:28672
    ds_read_b64_tr_b16 v[18:19], v6 offset:28928
    s_waitcnt lgkmcnt(6)
    v_mfma_f32_32x32x16_bf16 v[32:47], v[20:23], a[4:7], v[32:47]
    s_lshl_b32 s30, s26, 8
    v_lshl_add_u32 v4, v0, 2, s30
    v_add_u32 v13, 147456, v4
    ds_read_b32 v48, v13 offset:0
    ds_read_b32 v49, v13 offset:1520
    ds_read_b32 v50, v13 offset:3040
    ds_read_b32 v51, v13 offset:4560
    v_mov_b32 v14, 0x40000000
    ds_read_b64_tr_b16 v[20:21], v6 offset:29696
    ds_read_b64_tr_b16 v[22:23], v6 offset:29952
    s_waitcnt lgkmcnt(10)
    v_mfma_f32_32x32x16_bf16 v[32:47], v[24:27], a[8:11], v[32:47]
    v_cmp_gt_u32 vcc, 1520, v4
    s_nop 1
    v_cndmask_b32 v4, v14, v4, vcc
    s_waitcnt lgkmcnt(2)
    v_add_f32 v14, v48, v49
    v_add_f32 v15, v50, v51
    ds_read_b32 v48, v13 offset:6080
    ds_read_b32 v49, v13 offset:7600
    ds_read_b32 v50, v13 offset:9120
    ds_read_b32 v51, v13 offset:10640
    ds_read_b64_tr_b16 v[24:25], v6 offset:30720
    ds_read_b64_tr_b16 v[26:27], v6 offset:30976
    v_mfma_f32_32x32x16_bf16 v[32:47], v[28:31], a[12:15], v[32:47]
    v_add_f32 v14, v14, v15
    s_waitcnt lgkmcnt(2)
    v_add_f32 v15, v48, v49
    v_add_f32 v14, v14, v50
    v_add_f32 v15, v15, v51
    v_add_f32 v14, v14, v15
    buffer_store_dword v14, v4, s[16:19], s55 offen
    s_mul_i32 s28, s26, 6912
    ds_read_b64_tr_b16 v[28:29], v6 offset:31744
    ds_read_b64_tr_b16 v[30:31], v6 offset:32000
    v_mfma_f32_32x32x16_bf16 v[32:47], v[16:19], a[16:19], v[32:47]
    s_add_u32 s28, s28, 0
    v_and_b32 v13, 31, v0
    v_mul_u32_u24 v107, 72, v13
    v_lshrrev_b32 v13, 5, v0
    v_lshl_add_u32 v107, v13, 3, v107
    v_add_u32 v107, s28, v107
    v_lshrrev_b32 v13, 4, v0
    ds_read_b64_tr_b16 v[16:17], v6 offset:32768
    ds_read_b64_tr_b16 v[18:19], v6 offset:33024
    v_mfma_f32_32x32x16_bf16 v[32:47], v[20:23], a[20:23], v[32:47]
    v_lshlrev_b32 v13, 3, v13
    v_bfe_u32 v14, v0, 2, 2
    v_add_u32 v13, v13, v14
    v_mul_u32_u24 v106, 72, v13
    v_and_b32 v13, 3, v0
    v_lshl_add_u32 v106, v13, 3, v106
    v_add_u32 v106, s28, v106
    v_lshlrev_b32 v13, 16, v80
    ds_read_b64_tr_b16 v[20:21], v6 offset:33792
    ds_read_b64_tr_b16 v[22:23], v6 offset:34048
    s_waitcnt lgkmcnt(6)
    v_mfma_f32_32x32x16_bf16 v[32:47], v[24:27], a[24:27], v[32:47]
    v_and_b32 v14, 0xffff0000, v80
    v_fma_f32 v13, v13, v11, -v10
    v_fma_f32 v14, v14, v11, -v10
    v_cvt_pk_bf16_f32 v80, v13, v14
    v_lshlrev_b32 v13, 16, v81
    v_and_b32 v14, 0xffff0000, v81
    v_fma_f32 v13, v13, v11, -v10
    v_fma_f32 v14, v14, v11, -v10
    ds_read_b64_tr_b16 v[24:25], v6 offset:34816
    ds_read_b64_tr_b16 v[26:27], v6 offset:35072
    s_waitcnt lgkmcnt(6)
    v_mfma_f32_32x32x16_bf16 v[32:47], v[28:31], a[28:31], v[32:47]
    v_cvt_pk_bf16_f32 v81, v13, v14
    ds_write_b64 v107, v[80:81] offset:0
    v_lshlrev_b32 v13, 16, v82
    v_and_b32 v14, 0xffff0000, v82
    v_fma_f32 v13, v13, v11, -v10
    v_fma_f32 v14, v14, v11, -v10
    v_cvt_pk_bf16_f32 v82, v13, v14
    ds_read_b64_tr_b16 v[28:29], v6 offset:35840
    ds_read_b64_tr_b16 v[30:31], v6 offset:36096
    s_waitcnt lgkmcnt(7)
    v_mfma_f32_32x32x16_bf16 v[32:47], v[16:19], a[32:35], v[32:47]
    v_lshlrev_b32 v13, 16, v83
    v_and_b32 v14, 0xffff0000, v83
    v_fma_f32 v13, v13, v11, -v10
    v_fma_f32 v14, v14, v11, -v10
    v_cvt_pk_bf16_f32 v83, v13, v14
    ds_write_b64 v107, v[82:83] offset:16
    v_lshlrev_b32 v13, 16, v84
    v_and_b32 v14, 0xffff0000, v84
    ds_read_b64_tr_b16 v[16:17], v6 offset:36864
    ds_read_b64_tr_b16 v[18:19], v6 offset:37120
    s_waitcnt lgkmcnt(8)
    v_mfma_f32_32x32x16_bf16 v[32:47], v[20:23], a[36:39], v[32:47]
    v_fma_f32 v13, v13, v11, -v10
    v_fma_f32 v14, v14, v11, -v10
    v_cvt_pk_bf16_f32 v84, v13, v14
    v_lshlrev_b32 v13, 16, v85
    v_and_b32 v14, 0xffff0000, v85
    v_fma_f32 v13, v13, v11, -v10
    v_fma_f32 v14, v14, v11, -v10
    v_cvt_pk_bf16_f32 v85, v13, v14
    ds_read_b64_tr_b16 v[20:21], v6 offset:37888
    ds_read_b64_tr_b16 v[22:23], v6 offset:38144
    s_waitcnt lgkmcnt(8)
    v_mfma_f32_32x32x16_bf16 v[32:47], v[24:27], a[40:43], v[32:47]
    ds_write_b64 v107, v[84:85] offset:32
    v_lshlrev_b32 v13, 16, v86
    v_and_b32 v14, 0xffff0000, v86
    v_fma_f32 v13, v13, v11, -v10
    v_fma_f32 v14, v14, v11, -v10
    v_cvt_pk_bf16_f32 v86, v13, v14
    v_lshlrev_b32 v13, 16, v87
    v_and_b32 v14, 0xffff0000, v87
    ds_read_b64_tr_b16 v[24:25], v6 offset:38912
    ds_read_b64_tr_b16 v[26:27], v6 offset:39168
    s_waitcnt lgkmcnt(8)
    v_mfma_f32_32x32x16_bf16 v[32:47], v[28:31], a[44:47], v[32:47]
    v_fma_f32 v13, v13, v11, -v10
    v_fma_f32 v14, v14, v11, -v10
    v_cvt_pk_bf16_f32 v87, v13, v14
    ds_write_b64 v107, v[86:87] offset:48
    s_waitcnt lgkmcnt(0)
    ds_read_b64_tr_b16 v[48:49], v106 offset:0
    ds_read_b64_tr_b16 v[50:51], v106 offset:288
    ds_read_b64_tr_b16 v[28:29], v6 offset:39936
    ds_read_b64_tr_b16 v[30:31], v6 offset:40192
    v_mfma_f32_32x32x16_bf16 v[32:47], v[16:19], a[48:51], v[32:47]
    ds_read_b64_tr_b16 v[52:53], v106 offset:32
    ds_read_b64_tr_b16 v[54:55], v106 offset:320
    v_lshlrev_b32 v13, 16, v88
    v_and_b32 v14, 0xffff0000, v88
    v_fma_f32 v13, v13, v11, -v10
    v_fma_f32 v14, v14, v11, -v10
    v_cvt_pk_bf16_f32 v88, v13, v14
    v_lshlrev_b32 v13, 16, v89
    ds_read_b64_tr_b16 v[16:17], v6 offset:40960
    ds_read_b64_tr_b16 v[18:19], v6 offset:41216
    v_mfma_f32_32x32x16_bf16 v[32:47], v[20:23], a[52:55], v[32:47]
    v_and_b32 v14, 0xffff0000, v89
    v_fma_f32 v13, v13, v11, -v10
    v_fma_f32 v14, v14, v11, -v10
    v_cvt_pk_bf16_f32 v89, v13, v14
    ds_write_b64 v107, v[88:89] offset:2304
    v_lshlrev_b32 v13, 16, v90
    v_and_b32 v14, 0xffff0000, v90
    v_fma_f32 v13, v13, v11, -v10
    ds_read_b64_tr_b16 v[20:21], v6 offset:41984
    ds_read_b64_tr_b16 v[22:23], v6 offset:42240
    v_mfma_f32_32x32x16_bf16 v[32:47], v[24:27], a[56:59], v[32:47]
    v_fma_f32 v14, v14, v11, -v10
    v_cvt_pk_bf16_f32 v90, v13, v14
    v_lshlrev_b32 v13, 16, v91
    v_and_b32 v14, 0xffff0000, v91
    v_fma_f32 v13, v13, v11, -v10
    v_fma_f32 v14, v14, v11, -v10
    v_cvt_pk_bf16_f32 v91, v13, v14
    ds_read_b64_tr_b16 v[24:25], v6 offset:43008
    ds_read_b64_tr_b16 v[26:27], v6 offset:43264
    s_waitcnt lgkmcnt(9)
    v_mfma_f32_32x32x16_bf16 v[32:47], v[28:31], a[60:63], v[32:47]
    ds_write_b64 v107, v[90:91] offset:2320
    v_lshlrev_b32 v13, 16, v92
    v_and_b32 v14, 0xffff0000, v92
    v_fma_f32 v13, v13, v11, -v10
    v_fma_f32 v14, v14, v11, -v10
    v_cvt_pk_bf16_f32 v92, v13, v14
    v_lshlrev_b32 v13, 16, v93
    v_and_b32 v14, 0xffff0000, v93
    ds_read_b64_tr_b16 v[28:29], v6 offset:44032
    ds_read_b64_tr_b16 v[30:31], v6 offset:44288
    s_waitcnt lgkmcnt(8)
    v_mfma_f32_32x32x16_bf16 v[32:47], v[16:19], a[64:67], v[32:47]
    v_fma_f32 v13, v13, v11, -v10
    v_fma_f32 v14, v14, v11, -v10
    v_cvt_pk_bf16_f32 v93, v13, v14
    ds_write_b64 v107, v[92:93] offset:2336
    v_lshlrev_b32 v13, 16, v94
    v_and_b32 v14, 0xffff0000, v94
    v_fma_f32 v13, v13, v11, -v10
    v_fma_f32 v14, v14, v11, -v10
    ds_read_b64_tr_b16 v[16:17], v6 offset:45056
    ds_read_b64_tr_b16 v[18:19], v6 offset:45312
    s_waitcnt lgkmcnt(8)
    v_mfma_f32_32x32x16_bf16 v[32:47], v[20:23], a[68:71], v[32:47]
    v_cvt_pk_bf16_f32 v94, v13, v14
    v_lshlrev_b32 v13, 16, v95
    v_and_b32 v14, 0xffff0000, v95
    v_fma_f32 v13, v13, v11, -v10
    v_fma_f32 v14, v14, v11, -v10
    v_cvt_pk_bf16_f32 v95, v13, v14
    ds_write_b64 v107, v[94:95] offset:2352
    ds_read_b64_tr_b16 v[20:21], v6 offset:46080
    ds_read_b64_tr_b16 v[22:23], v6 offset:46336
    s_waitcnt lgkmcnt(9)
    v_mfma_f32_32x32x16_bf16 v[32:47], v[24:27], a[72:75], v[32:47]
    s_cmp_eq_u32 s99, 0
    s_cbranch_scc1 L_pr8
    s_setprio 0
L_pr8:
    s_add_u32 s30, s56, 0
    buffer_store_dwordx4 v[48:51], v1, s[16:19], s30 offen sc0 sc1
    s_add_u32 s30, s56, 65536
    buffer_store_dwordx4 v[52:55], v1, s[16:19], s30 offen sc0 sc1
    s_waitcnt lgkmcnt(2)
    ds_read_b64_tr_b16 v[56:57], v106 offset:2304
    ds_read_b64_tr_b16 v[58:59], v106 offset:2592
    ds_read_b64_tr_b16 v[60:61], v106 offset:2336
    ds_read_b64_tr_b16 v[62:63], v106 offset:2624
    s_waitcnt lgkmcnt(2)
    s_add_u32 s30, s56, 131072
    buffer_store_dwordx4 v[56:59], v1, s[16:19], s30 offen sc0 sc1
    ds_read_b64_tr_b16 v[24:25], v6 offset:47104
    ds_read_b64_tr_b16 v[26:27], v6 offset:47360
    v_mfma_f32_32x32x16_bf16 v[32:47], v[28:31], a[76:79], v[32:47]
    s_waitcnt lgkmcnt(2)
    s_add_u32 s30, s56, 196608
    buffer_store_dwordx4 v[60:63], v1, s[16:19], s30 offen sc0 sc1
    v_mul_f32 v13, v64, v64
    v_mul_f32 v14, v65, v65
    v_fmaak_f32 v13, v12, v13, 0xc0135761
    v_fmaak_f32 v14, v12, v14, 0xc0135761
    v_mul_f32 v13, v13, v64
    v_mul_f32 v14, v14, v65
    v_exp_f32 v13, v13
    ds_read_b64_tr_b16 v[28:29], v6 offset:48128
    ds_read_b64_tr_b16 v[30:31], v6 offset:48384
    v_mfma_f32_32x32x16_bf16 v[32:47], v[16:19], a[80:83], v[32:47]
    v_exp_f32 v14, v14
    v_add_f32 v13, 1.0, v13
    v_add_f32 v14, 1.0, v14
    v_rcp_f32 v13, v13
    v_rcp_f32 v14, v14
    v_mul_f32 v64, v64, v13
    v_mul_f32 v65, v65, v14
    v_cvt_pk_bf16_f32 v64, v64, v65
    ds_read_b64_tr_b16 v[16:17], v7 offset:0
    ds_read_b64_tr_b16 v[18:19], v7 offset:256
    v_mfma_f32_32x32x16_bf16 v[32:47], v[20:23], a[84:87], v[32:47]
    v_mul_f32 v13, v66, v66
    v_mul_f32 v14, v67, v67
    v_fmaak_f32 v13, v12, v13, 0xc0135761
    v_fmaak_f32 v14, v12, v14, 0xc0135761
    v_mul_f32 v13, v13, v66
    v_mul_f32 v14, v14, v67
    v_exp_f32 v13, v13
    ds_read_b64_tr_b16 v[20:21], v7 offset:1024
    ds_read_b64_tr_b16 v[22:23], v7 offset:1280
    s_waitcnt lgkmcnt(6)
    v_mfma_f32_32x32x16_bf16 v[32:47], v[24:27], a[88:91], v[32:47]
    v_exp_f32 v14, v14
    v_add_f32 v13, 1.0, v13
    v_add_f32 v14, 1.0, v14
    v_rcp_f32 v13, v13
    v_rcp_f32 v14, v14
    v_mul_f32 v66, v66, v13
    v_mul_f32 v67, v67, v14
    v_cvt_pk_bf16_f32 v65, v66, v67
    ds_read_b64_tr_b16 v[24:25], v7 offset:2048
    ds_read_b64_tr_b16 v[26:27], v7 offset:2304
    s_waitcnt lgkmcnt(6)
    v_mfma_f32_32x32x16_bf16 v[32:47], v[28:31], a[92:95], v[32:47]
    v_mul_f32 v13, v72, v72
    v_mul_f32 v14, v73, v73
    v_fmaak_f32 v13, v12, v13, 0xc0135761
    v_fmaak_f32 v14, v12, v14, 0xc0135761
    v_mul_f32 v13, v13, v72
    v_mul_f32 v14, v14, v73
    v_exp_f32 v13, v13
    v_exp_f32 v14, v14
    ds_read_b64_tr_b16 v[28:29], v7 offset:3072
    ds_read_b64_tr_b16 v[30:31], v7 offset:3328
    s_waitcnt lgkmcnt(6)
    v_mfma_f32_32x32x16_bf16 v[32:47], v[16:19], a[96:99], v[32:47]
    v_add_f32 v13, 1.0, v13
    v_add_f32 v14, 1.0, v14
    v_rcp_f32 v13, v13
    v_rcp_f32 v14, v14
    v_mul_f32 v72, v72, v13
    v_mul_f32 v73, v73, v14
    v_cvt_pk_bf16_f32 v66, v72, v73
    ds_read_b64_tr_b16 v[16:17], v7 offset:4096
    ds_read_b64_tr_b16 v[18:19], v7 offset:4352
    s_waitcnt lgkmcnt(6)
    v_mfma_f32_32x32x16_bf16 v[32:47], v[20:23], a[100:103], v[32:47]
    v_mul_f32 v13, v74, v74
    v_mul_f32 v14, v75, v75
    v_fmaak_f32 v13, v12, v13, 0xc0135761
    v_fmaak_f32 v14, v12, v14, 0xc0135761
    v_mul_f32 v13, v13, v74
    v_mul_f32 v14, v14, v75
    v_exp_f32 v13, v13
    v_exp_f32 v14, v14
    ds_read_b64_tr_b16 v[20:21], v7 offset:5120
    ds_read_b64_tr_b16 v[22:23], v7 offset:5376
    s_waitcnt lgkmcnt(6)
    v_mfma_f32_32x32x16_bf16 v[32:47], v[24:27], a[104:107], v[32:47]
    v_add_f32 v13, 1.0, v13
    v_add_f32 v14, 1.0, v14
    v_rcp_f32 v13, v13
    v_rcp_f32 v14, v14
    v_mul_f32 v74, v74, v13
    v_mul_f32 v75, v75, v14
    v_cvt_pk_bf16_f32 v67, v74, v75
    buffer_store_dwordx4 v[64:67], v8, s[16:19], s53 offen offset:0 sc0 sc1
    ds_read_b64_tr_b16 v[24:25], v7 offset:6144
    ds_read_b64_tr_b16 v[26:27], v7 offset:6400
    s_waitcnt lgkmcnt(6)
    v_mfma_f32_32x32x16_bf16 v[32:47], v[28:31], a[108:111], v[32:47]
    v_mul_f32 v13, v68, v68
    v_mul_f32 v14, v69, v69
    v_fmaak_f32 v13, v12, v13, 0xc0135761
    v_fmaak_f32 v14, v12, v14, 0xc0135761
    v_mul_f32 v13, v13, v68
    v_mul_f32 v14, v14, v69
    v_exp_f32 v13, v13
    v_exp_f32 v14, v14
    ds_read_b64_tr_b16 v[28:29], v7 offset:7168
    ds_read_b64_tr_b16 v[30:31], v7 offset:7424
    s_waitcnt lgkmcnt(6)
    v_mfma_f32_32x32x16_bf16 v[32:47], v[16:19], a[112:115], v[32:47]
    v_add_f32 v13, 1.0, v13
    v_add_f32 v14, 1.0, v14
    v_rcp_f32 v13, v13
    v_rcp_f32 v14, v14
    v_mul_f32 v68, v68, v13
    v_mul_f32 v69, v69, v14
    v_cvt_pk_bf16_f32 v68, v68, v69
    ds_read_b64_tr_b16 v[16:17], v7 offset:8192
    ds_read_b64_tr_b16 v[18:19], v7 offset:8448
    s_waitcnt lgkmcnt(6)
    v_mfma_f32_32x32x16_bf16 v[32:47], v[20:23], a[116:119], v[32:47]
    v_mul_f32 v13, v70, v70
    v_mul_f32 v14, v71, v71
    v_fmaak_f32 v13, v12, v13, 0xc0135761
    v_fmaak_f32 v14, v12, v14, 0xc0135761
    v_mul_f32 v13, v13, v70
    v_mul_f32 v14, v14, v71
    v_exp_f32 v13, v13
    v_exp_f32 v14, v14
    ds_read_b64_tr_b16 v[20:21], v7 offset:9216
    ds_read_b64_tr_b16 v[22:23], v7 offset:9472
    s_waitcnt lgkmcnt(6)
    v_mfma_f32_32x32x16_bf16 v[32:47], v[24:27], a[120:123], v[32:47]
    v_add_f32 v13, 1.0, v13
    v_add_f32 v14, 1.0, v14
    v_rcp_f32 v13, v13
    v_rcp_f32 v14, v14
    v_mul_f32 v70, v70, v13
    v_mul_f32 v71, v71, v14
    v_cvt_pk_bf16_f32 v69, v70, v71
    v_mul_f32 v13, v76, v76
    ds_read_b64_tr_b16 v[24:25], v7 offset:10240
    ds_read_b64_tr_b16 v[26:27], v7 offset:10496
    s_waitcnt lgkmcnt(6)
    v_mfma_f32_32x32x16_bf16 v[32:47], v[28:31], a[124:127], v[32:47]
    v_mul_f32 v14, v77, v77
    v_fmaak_f32 v13, v12, v13, 0xc0135761
    v_fmaak_f32 v14, v12, v14, 0xc0135761
    v_mul_f32 v13, v13, v76
    v_mul_f32 v14, v14, v77
    v_exp_f32 v13, v13
    v_exp_f32 v14, v14
    ds_read_b64_tr_b16 v[28:29], v7 offset:11264
    ds_read_b64_tr_b16 v[30:31], v7 offset:11520
    s_waitcnt lgkmcnt(6)
    v_mfma_f32_32x32x16_bf16 v[32:47], v[16:19], a[128:131], v[32:47]
    v_add_f32 v13, 1.0, v13
    v_add_f32 v14, 1.0, v14
    v_rcp_f32 v13, v13
    v_rcp_f32 v14, v14
    v_mul_f32 v76, v76, v13
    v_mul_f32 v77, v77, v14
    v_cvt_pk_bf16_f32 v70, v76, v77
    v_mul_f32 v13, v78, v78
    s_waitcnt lgkmcnt(4)
    v_mfma_f32_32x32x16_bf16 v[32:47], v[20:23], a[132:135], v[32:47]
    v_mul_f32 v14, v79, v79
    v_fmaak_f32 v13, v12, v13, 0xc0135761
    v_fmaak_f32 v14, v12, v14, 0xc0135761
    v_mul_f32 v13, v13, v78
    v_mul_f32 v14, v14, v79
    v_exp_f32 v13, v13
    v_exp_f32 v14, v14
    v_add_f32 v13, 1.0, v13
    s_waitcnt lgkmcnt(2)
    v_mfma_f32_32x32x16_bf16 v[32:47], v[24:27], a[136:139], v[32:47]
    v_add_f32 v14, 1.0, v14
    v_rcp_f32 v13, v13
    v_rcp_f32 v14, v14
    v_mul_f32 v78, v78, v13
    v_mul_f32 v79, v79, v14
    v_cvt_pk_bf16_f32 v71, v78, v79
    buffer_store_dwordx4 v[68:71], v8, s[16:19], s53 offen offset:512 sc0 sc1
    s_waitcnt lgkmcnt(0)
    v_mfma_f32_32x32x16_bf16 v[32:47], v[28:31], a[140:143], v[32:47]
    s_nop 7
    s_nop 3
    v_mul_f32 v13, v32, v32
    v_mul_f32 v14, v33, v33
    v_fmaak_f32 v13, v12, v13, 0xc0135761
    v_fmaak_f32 v14, v12, v14, 0xc0135761
    v_mul_f32 v13, v13, v32
    v_mul_f32 v14, v14, v33
    v_exp_f32 v13, v13
    v_exp_f32 v14, v14
    v_add_f32 v13, 1.0, v13
    v_add_f32 v14, 1.0, v14
    v_rcp_f32 v13, v13
    v_rcp_f32 v14, v14
    v_mul_f32 v32, v32, v13
    v_mul_f32 v33, v33, v14
    v_cvt_pk_bf16_f32 v32, v32, v33
    v_mul_f32 v13, v34, v34
    v_mul_f32 v14, v35, v35
    v_fmaak_f32 v13, v12, v13, 0xc0135761
    v_fmaak_f32 v14, v12, v14, 0xc0135761
    v_mul_f32 v13, v13, v34
    v_mul_f32 v14, v14, v35
    v_exp_f32 v13, v13
    v_exp_f32 v14, v14
    v_add_f32 v13, 1.0, v13
    v_add_f32 v14, 1.0, v14
    v_rcp_f32 v13, v13
    v_rcp_f32 v14, v14
    v_mul_f32 v34, v34, v13
    v_mul_f32 v35, v35, v14
    v_cvt_pk_bf16_f32 v33, v34, v35
    v_mul_f32 v13, v40, v40
    v_mul_f32 v14, v41, v41
    v_fmaak_f32 v13, v12, v13, 0xc0135761
    v_fmaak_f32 v14, v12, v14, 0xc0135761
    v_mul_f32 v13, v13, v40
    v_mul_f32 v14, v14, v41
    v_exp_f32 v13, v13
    v_exp_f32 v14, v14
    v_add_f32 v13, 1.0, v13
    v_add_f32 v14, 1.0, v14
    v_rcp_f32 v13, v13
    v_rcp_f32 v14, v14
    v_mul_f32 v40, v40, v13
    v_mul_f32 v41, v41, v14
    v_cvt_pk_bf16_f32 v34, v40, v41
    v_mul_f32 v13, v42, v42
    v_mul_f32 v14, v43, v43
    v_fmaak_f32 v13, v12, v13, 0xc0135761
    v_fmaak_f32 v14, v12, v14, 0xc0135761
    v_mul_f32 v13, v13, v42
    v_mul_f32 v14, v14, v43
    v_exp_f32 v13, v13
    v_exp_f32 v14, v14
    v_add_f32 v13, 1.0, v13
    v_add_f32 v14, 1.0, v14
    v_rcp_f32 v13, v13
    v_rcp_f32 v14, v14
    v_mul_f32 v42, v42, v13
    v_mul_f32 v43, v43, v14
    v_cvt_pk_bf16_f32 v35, v42, v43
    buffer_store_dwordx4 v[32:35], v8, s[16:19], s54 offen offset:0 sc0 sc1
    v_mul_f32 v13, v36, v36
    v_mul_f32 v14, v37, v37
    v_fmaak_f32 v13, v12, v13, 0xc0135761
    v_fmaak_f32 v14, v12, v14, 0xc0135761
    v_mul_f32 v13, v13, v36
    v_mul_f32 v14, v14, v37
    v_exp_f32 v13, v13
    v_exp_f32 v14, v14
    v_add_f32 v13, 1.0, v13
    v_add_f32 v14, 1.0, v14
    v_rcp_f32 v13, v13
    v_rcp_f32 v14, v14
    v_mul_f32 v36, v36, v13
    v_mul_f32 v37, v37, v14
    v_cvt_pk_bf16_f32 v36, v36, v37
    v_mul_f32 v13, v38, v38
    v_mul_f32 v14, v39, v39
    v_fmaak_f32 v13, v12, v13, 0xc0135761
    v_fmaak_f32 v14, v12, v14, 0xc0135761
    v_mul_f32 v13, v13, v38
    v_mul_f32 v14, v14, v39
    v_exp_f32 v13, v13
    v_exp_f32 v14, v14
    v_add_f32 v13, 1.0, v13
    v_add_f32 v14, 1.0, v14
    v_rcp_f32 v13, v13
    v_rcp_f32 v14, v14
    v_mul_f32 v38, v38, v13
    v_mul_f32 v39, v39, v14
    v_cvt_pk_bf16_f32 v37, v38, v39
    v_mul_f32 v13, v44, v44
    v_mul_f32 v14, v45, v45
    v_fmaak_f32 v13, v12, v13, 0xc0135761
    v_fmaak_f32 v14, v12, v14, 0xc0135761
    v_mul_f32 v13, v13, v44
    v_mul_f32 v14, v14, v45
    v_exp_f32 v13, v13
    v_exp_f32 v14, v14
    v_add_f32 v13, 1.0, v13
    v_add_f32 v14, 1.0, v14
    v_rcp_f32 v13, v13
    v_rcp_f32 v14, v14
    v_mul_f32 v44, v44, v13
    v_mul_f32 v45, v45, v14
    v_cvt_pk_bf16_f32 v38, v44, v45
    v_mul_f32 v13, v46, v46
    v_mul_f32 v14, v47, v47
    v_fmaak_f32 v13, v12, v13, 0xc0135761
    v_fmaak_f32 v14, v12, v14, 0xc0135761
    v_mul_f32 v13, v13, v46
    v_mul_f32 v14, v14, v47
    v_exp_f32 v13, v13
    v_exp_f32 v14, v14
    v_add_f32 v13, 1.0, v13
    v_add_f32 v14, 1.0, v14
    v_rcp_f32 v13, v13
    v_rcp_f32 v14, v14
    v_mul_f32 v46, v46, v13
    v_mul_f32 v47, v47, v14
    v_cvt_pk_bf16_f32 v39, v46, v47
    buffer_store_dwordx4 v[36:39], v8, s[16:19], s54 offen offset:512 sc0 sc1
    s_endpgm
L_gemm1_kernel_vA:
    s_waitcnt vmcnt(10)
    s_barrier
    ds_read_b64_tr_b16 v[16:17], v5 offset:0
    ds_read_b64_tr_b16 v[18:19], v5 offset:256
    ds_read_b64_tr_b16 v[20:21], v5 offset:36864
    ds_read_b64_tr_b16 v[22:23], v5 offset:37120
    ds_read_b64_tr_b16 v[24:25], v5 offset:1024
    ds_read_b64_tr_b16 v[26:27], v5 offset:1280
    ds_read_b64_tr_b16 v[28:29], v5 offset:37888
    ds_read_b64_tr_b16 v[30:31], v5 offset:38144
    s_waitcnt vmcnt(9) lgkmcnt(6)
    v_mfma_f32_32x32x16_bf16 v[32:47], v[16:19], a[0:3], 0
    s_cmp_eq_u32 s99, 0
    s_cbranch_scc1 L_pr9
    s_setprio 1
L_pr9:
    buffer_load_dwordx4 a[40:43], v1, s[16:19], s29 offen offset:2048
    ds_read_b64_tr_b16 v[16:17], v5 offset:2048
    ds_read_b64_tr_b16 v[18:19], v5 offset:2304
    s_waitcnt lgkmcnt(6)
    v_mfma_f32_32x32x16_bf16 v[48:63], v[20:23], a[0:3], 0
    ds_read_b64_tr_b16 v[20:21], v5 offset:38912
    ds_read_b64_tr_b16 v[22:23], v5 offset:39168
    s_waitcnt vmcnt(9) lgkmcnt(6)
    v_mfma_f32_32x32x16_bf16 v[32:47], v[24:27], a[4:7], v[32:47]
    buffer_load_dwordx4 a[44:47], v1, s[16:19], s29 offen offset:3072
    ds_read_b64_tr_b16 v[24:25], v5 offset:3072
    ds_read_b64_tr_b16 v[26:27], v5 offset:3328
    s_waitcnt lgkmcnt(6)
    v_mfma_f32_32x32x16_bf16 v[48:63], v[28:31], a[4:7], v[48:63]
    ds_read_b64_tr_b16 v[28:29], v5 offset:39936
    ds_read_b64_tr_b16 v[30:31], v5 offset:40192
    s_waitcnt vmcnt(9) lgkmcnt(6)
    v_mfma_f32_32x32x16_bf16 v[32:47], v[16:19], a[8:11], v[32:47]
    s_add_u32 s29, s40, 12288
    buffer_load_dwordx4 a[48:51], v1, s[16:19], s29 offen offset:0
    ds_read_b64_tr_b16 v[16:17], v5 offset:4096
    ds_read_b64_tr_b16 v[18:19], v5 offset:4352
    s_waitcnt lgkmcnt(6)
    v_mfma_f32_32x32x16_bf16 v[48:63], v[20:23], a[8:11], v[48:63]
    ds_read_b64_tr_b16 v[20:21], v5 offset:40960
    ds_read_b64_tr_b16 v[22:23], v5 offset:41216
    s_waitcnt vmcnt(9) lgkmcnt(6)
    v_mfma_f32_32x32x16_bf16 v[32:47], v[24:27], a[12:15], v[32:47]
    buffer_load_dwordx4 a[52:55], v1, s[16:19], s29 offen offset:1024
    ds_read_b64_tr_b16 v[24:25], v5 offset:5120
    ds_read_b64_tr_b16 v[26:27], v5 offset:5376
    s_waitcnt lgkmcnt(6)
    v_mfma_f32_32x32x16_bf16 v[48:63], v[28:31], a[12:15], v[48:63]
    ds_read_b64_tr_b16 v[28:29], v5 offset:41984
    ds_read_b64_tr_b16 v[30:31], v5 offset:42240
    s_waitcnt vmcnt(9) lgkmcnt(6)
    v_mfma_f32_32x32x16_bf16 v[32:47], v[16:19], a[16:19], v[32:47]
    buffer_load_dwordx4 a[56:59], v1, s[16:19], s29 offen offset:2048
    ds_read_b64_tr_b16 v[16:17], v5 offset:6144
    ds_read_b64_tr_b16 v[18:19], v5 offset:6400
    s_waitcnt lgkmcnt(6)
    v_mfma_f32_32x32x16_bf16 v[48:63], v[20:23], a[16:19], v[48:63]
    ds_read_b64_tr_b16 v[20:21], v5 offset:43008
    ds_read_b64_tr_b16 v[22:23], v5 offset:43264
    s_waitcnt vmcnt(9) lgkmcnt(6)
    v_mfma_f32_32x32x16_bf16 v[32:47], v[24:27], a[20:23], v[32:47]
    buffer_load_dwordx4 a[60:63], v1, s[16:19], s29 offen offset:3072
    ds_read_b64_tr_b16 v[24:25], v5 offset:7168
    ds_read_b64_tr_b16 v[26:27], v5 offset:7424
    s_waitcnt lgkmcnt(6)
    v_mfma_f32_32x32x16_bf16 v[48:63], v[28:31], a[20:23], v[48:63]
    ds_read_b64_tr_b16 v[28:29], v5 offset:44032
    ds_read_b64_tr_b16 v[30:31], v5 offset:44288
    s_waitcnt vmcnt(9) lgkmcnt(6)
    v_mfma_f32_32x32x16_bf16 v[32:47], v[16:19], a[24:27], v[32:47]
    s_add_u32 s29, s40, 16384
    buffer_load_dwordx4 a[64:67], v1, s[16:19], s29 offen offset:0
    ds_read_b64_tr_b16 v[16:17], v5 offset:8192
    ds_read_b64_tr_b16 v[18:19], v5 offset:8448
    s_waitcnt lgkmcnt(6)
    v_mfma_f32_32x32x16_bf16 v[48:63], v[20:23], a[24:27], v[48:63]
    ds_read_b64_tr_b16 v[20:21], v5 offset:45056
    ds_read_b64_tr_b16 v[22:23], v5 offset:45312
    s_waitcnt vmcnt(9) lgkmcnt(6)
    v_mfma_f32_32x32x16_bf16 v[32:47], v[24:27], a[28:31], v[32:47]
    buffer_load_dwordx4 a[68:71], v1, s[16:19], s29 offen offset:1024
    ds_read_b64_tr_b16 v[24:25], v5 offset:9216
    ds_read_b64_tr_b16 v[26:27], v5 offset:9472
    s_waitcnt lgkmcnt(6)
    v_mfma_f32_32x32x16_bf16 v[48:63], v[28:31], a[28:31], v[48:63]
    ds_read_b64_tr_b16 v[28:29], v5 offset:46080
    ds_read_b64_tr_b16 v[30:31], v5 offset:46336
    s_waitcnt vmcnt(9) lgkmcnt(6)
    v_mfma_f32_32x32x16_bf16 v[32:47], v[16:19], a[32:35], v[32:47]
    buffer_load_dwordx4 a[72:75], v1, s[16:19], s29 offen offset:2048
    ds_read_b64_tr_b16 v[16:17], v5 offset:10240
    ds_read_b64_tr_b16 v[18:19], v5 offset:10496
    s_waitcnt lgkmcnt(6)
    v_mfma_f32_32x32x16_bf16 v[48:63], v[20:23], a[32:35], v[48:63]
    ds_read_b64_tr_b16 v[20:21], v5 offset:47104
    ds_read_b64_tr_b16 v[22:23], v5 offset:47360
    s_waitcnt vmcnt(9) lgkmcnt(6)
    v_mfma_f32_32x32x16_bf16 v[32:47], v[24:27], a[36:39], v[32:47]
    buffer_load_dwordx4 a[76:79], v1, s[16:19], s29 offen offset:3072
    ds_read_b64_tr_b16 v[24:25], v5 offset:11264
    ds_read_b64_tr_b16 v[26:27], v5 offset:11520
    s_waitcnt lgkmcnt(6)
    v_mfma_f32_32x32x16_bf16 v[48:63], v[28:31], a[36:39], v[48:63]
    ds_read_b64_tr_b16 v[28:29], v5 offset:48128
    ds_read_b64_tr_b16 v[30:31], v5 offset:48384
    s_waitcnt vmcnt(9) lgkmcnt(6)
    v_mfma_f32_32x32x16_bf16 v[32:47], v[16:19], a[40:43], v[32:47]
    s_add_u32 s29, s40, 20480
    buffer_load_dwordx4 a[80:83], v1, s[16:19], s29 offen offset:0
    ds_read_b64_tr_b16 v[16:17], v5 offset:12288
    ds_read_b64_tr_b16 v[18:19], v5 offset:12544
    s_waitcnt lgkmcnt(6)
    v_mfma_f32_32x32x16_bf16 v[48:63], v[20:23], a[40:43], v[48:63]
    ds_read_b64_tr_b16 v[20:21], v6 offset:0
    ds_read_b64_tr_b16 v[22:23], v6 offset:256
    s_waitcnt vmcnt(9) lgkmcnt(6)
    v_mfma_f32_32x32x16_bf16 v[32:47], v[24:27], a[44:47], v[32:47]
    buffer_load_dwordx4 a[84:87], v1, s[16:19], s29 offen offset:1024
    ds_read_b64_tr_b16 v[24:25], v5 offset:13312
    ds_read_b64_tr_b16 v[26:27], v5 offset:13568
    s_waitcnt lgkmcnt(6)
    v_mfma_f32_32x32x16_bf16 v[48:63], v[28:31], a[44:47], v[48:63]
    ds_read_b64_tr_b16 v[28:29], v6 offset:1024
    ds_read_b64_tr_b16 v[30:31], v6 offset:1280
    s_waitcnt vmcnt(9) lgkmcnt(6)
    v_mfma_f32_32x32x16_bf16 v[32:47], v[16:19], a[48:51], v[32:47]
    buffer_load_dwordx4 a[88:91], v1, s[16:19], s29 offen offset:2048
    ds_read_b64_tr_b16 v[16:17], v5 offset:14336
    ds_read_b64_tr_b16 v[18:19], v5 offset:14592
    s_waitcnt lgkmcnt(6)
    v_mfma_f32_32x32x16_bf16 v[48:63], v[20:23], a[48:51], v[48:63]
    ds_read_b64_tr_b16 v[20:21], v6 offset:2048
    ds_read_b64_tr_b16 v[22:23], v6 offset:2304
    s_waitcnt vmcnt(9) lgkmcnt(6)
    v_mfma_f32_32x32x16_bf16 v[32:47], v[24:27], a[52:55], v[32:47]
    buffer_load_dwordx4 a[92:95], v1, s[16:19], s29 offen offset:3072
    ds_read_b64_tr_b16 v[24:25], v5 offset:15360
    ds_read_b64_tr_b16 v[26:27], v5 offset:15616
    s_waitcnt lgkmcnt(6)
    v_mfma_f32_32x32x16_bf16 v[48:63], v[28:31], a[52:55], v[48:63]
    ds_read_b64_tr_b16 v[28:29], v6 offset:3072
    ds_read_b64_tr_b16 v[30:31], v6 offset:3328
    s_waitcnt vmcnt(9) lgkmcnt(6)
    v_mfma_f32_32x32x16_bf16 v[32:47], v[16:19], a[56:59], v[32:47]
    s_add_u32 s29, s40, 24576
    buffer_load_dwordx4 a[96:99], v1, s[16:19], s29 offen offset:0
    ds_read_b64_tr_b16 v[16:17], v5 offset:16384
    ds_read_b64_tr_b16 v[18:19], v5 offset:16640
    s_waitcnt lgkmcnt(6)
    v_mfma_f32_32x32x16_bf16 v[48:63], v[20:23], a[56:59], v[48:63]
    ds_read_b64_tr_b16 v[20:21], v6 offset:4096
    ds_read_b64_tr_b16 v[22:23], v6 offset:4352
    s_waitcnt vmcnt(9) lgkmcnt(6)
    v_mfma_f32_32x32x16_bf16 v[32:47], v[24:27], a[60:63], v[32:47]
    buffer_load_dwordx4 a[100:103], v1, s[16:19], s29 offen offset:1024
    ds_read_b64_tr_b16 v[24:25], v5 offset:17408
    ds_read_b64_tr_b16 v[26:27], v5 offset:17664
    s_waitcnt lgkmcnt(6)
    v_mfma_f32_32x32x16_bf16 v[48:63], v[28:31], a[60:63], v[48:63]
    ds_read_b64_tr_b16 v[28:29], v6 offset:5120
    ds_read_b64_tr_b16 v[30:31], v6 offset:5376
    s_waitcnt vmcnt(9) lgkmcnt(6)
    v_mfma_f32_32x32x16_bf16 v[32:47], v[16:19], a[64:67], v[32:47]
    buffer_load_dwordx4 a[104:107], v1, s[16:19], s29 offen offset:2048
    ds_read_b64_tr_b16 v[16:17], v5 offset:18432
    ds_read_b64_tr_b16 v[18:19], v5 offset:18688
    s_waitcnt lgkmcnt(6)
    v_mfma_f32_32x32x16_bf16 v[48:63], v[20:23], a[64:67], v[48:63]
    ds_read_b64_tr_b16 v[20:21], v6 offset:6144
    ds_read_b64_tr_b16 v[22:23], v6 offset:6400
    s_waitcnt vmcnt(9) lgkmcnt(6)
    v_mfma_f32_32x32x16_bf16 v[32:47], v[24:27], a[68:71], v[32:47]
    buffer_load_dwordx4 a[108:111], v1, s[16:19], s29 offen offset:3072
    ds_read_b64_tr_b16 v[24:25], v5 offset:19456
    ds_read_b64_tr_b16 v[26:27], v5 offset:19712
    s_waitcnt lgkmcnt(6)
    v_mfma_f32_32x32x16_bf16 v[48:63], v[28:31], a[68:71], v[48:63]
    ds_read_b64_tr_b16 v[28:29], v6 offset:7168
    ds_read_b64_tr_b16 v[30:31], v6 offset:7424
    s_waitcnt vmcnt(9) lgkmcnt(6)
    v_mfma_f32_32x32x16_bf16 v[32:47], v[16:19], a[72:75], v[32:47]
    s_cmp_eq_u32 s99, 0
    s_cbranch_scc1 L_pr10
    s_setprio 0
L_pr10:
    s_add_u32 s29, s40, 28672
    buffer_load_dwordx4 a[112:115], v1, s[16:19], s29 offen offset:0
    ds_read_b64_tr_b16 v[16:17], v5 offset:20480
    ds_read_b64_tr_b16 v[18:19], v5 offset:20736
    s_waitcnt lgkmcnt(6)
    v_mfma_f32_32x32x16_bf16 v[48:63], v[20:23], a[72:75], v[48:63]
    ds_read_b64_tr_b16 v[20:21], v6 offset:8192
    ds_read_b64_tr_b16 v[22:23], v6 offset:8448
    s_waitcnt vmcnt(9) lgkmcnt(6)
    v_mfma_f32_32x32x16_bf16 v[32:47], v[24:27], a[76:79], v[32:47]
    buffer_load_dwordx4 a[116:119], v1, s[16:19], s29 offen offset:1024
    ds_read_b64_tr_b16 v[24:25], v5 offset:21504
    ds_read_b64_tr_b16 v[26:27], v5 offset:21760
    s_waitcnt lgkmcnt(6)
    v_mfma_f32_32x32x16_bf16 v[48:63], v[28:31], a[76:79], v[48:63]
    ds_read_b64_tr_b16 v[28:29], v6 offset:9216
    ds_read_b64_tr_b16 v[30:31], v6 offset:9472
    s_waitcnt vmcnt(9) lgkmcnt(6)
    v_mfma_f32_32x32x16_bf16 v[32:47], v[16:19], a[80:83], v[32:47]
    buffer_load_dwordx4 a[120:123], v1, s[16:19], s29 offen offset:2048
    ds_read_b64_tr_b16 v[16:17], v5 offset:22528
    ds_read_b64_tr_b16 v[18:19], v5 offset:22784
    s_waitcnt lgkmcnt(6)
    v_mfma_f32_32x32x16_bf16 v[48:63], v[20:23], a[80:83], v[48:63]
    ds_read_b64_tr_b16 v[20:21], v6 offset:10240
    ds_read_b64_tr_b16 v[22:23], v6 offset:10496
    s_waitcnt vmcnt(9) lgkmcnt(6)
    v_mfma_f32_32x32x16_bf16 v[32:47], v[24:27], a[84:87], v[32:47]
    buffer_load_dwordx4 a[124:127], v1, s[16:19], s29 offen offset:3072
    ds_read_b64_tr_b16 v[24:25], v5 offset:23552
    ds_read_b64_tr_b16 v[26:27], v5 offset:23808
    s_waitcnt lgkmcnt(6)
    v_mfma_f32_32x32x16_bf16 v[48:63], v[28:31], a[84:87], v[48:63]
    ds_read_b64_tr_b16 v[28:29], v6 offset:11264
    ds_read_b64_tr_b16 v[30:31], v6 offset:11520
    s_waitcnt vmcnt(9) lgkmcnt(6)
    v_mfma_f32_32x32x16_bf16 v[32:47], v[16:19], a[88:91], v[32:47]
    s_add_u32 s29, s40, 32768
    buffer_load_dwordx4 a[128:131], v1, s[16:19], s29 offen offset:0
    ds_read_b64_tr_b16 v[16:17], v5 offset:24576
    ds_read_b64_tr_b16 v[18:19], v5 offset:24832
    s_waitcnt lgkmcnt(6)
    v_mfma_f32_32x32x16_bf16 v[48:63], v[20:23], a[88:91], v[48:63]
    ds_read_b64_tr_b16 v[20:21], v6 offset:12288
    ds_read_b64_tr_b16 v[22:23], v6 offset:12544
    s_waitcnt vmcnt(9) lgkmcnt(6)
    v_mfma_f32_32x32x16_bf16 v[32:47], v[24:27], a[92:95], v[32:47]
    buffer_load_dwordx4 a[132:135], v1, s[16:19], s29 offen offset:1024
    ds_read_b64_tr_b16 v[24:25], v5 offset:25600
    ds_read_b64_tr_b16 v[26:27], v5 offset:25856
    s_waitcnt lgkmcnt(6)
    v_mfma_f32_32x32x16_bf16 v[48:63], v[28:31], a[92:95], v[48:63]
    ds_read_b64_tr_b16 v[28:29], v6 offset:13312
    ds_read_b64_tr_b16 v[30:31], v6 offset:13568
    s_waitcnt vmcnt(9) lgkmcnt(6)
    v_mfma_f32_32x32x16_bf16 v[32:47], v[16:19], a[96:99], v[32:47]
    buffer_load_dwordx4 a[136:139], v1, s[16:19], s29 offen offset:2048
    ds_read_b64_tr_b16 v[16:17], v5 offset:26624
    ds_read_b64_tr_b16 v[18:19], v5 offset:26880
    s_waitcnt lgkmcnt(6)
    v_mfma_f32_32x32x16_bf16 v[48:63], v[20:23], a[96:99], v[48:63]
    ds_read_b64_tr_b16 v[20:21], v6 offset:14336
    ds_read_b64_tr_b16 v[22:23], v6 offset:14592
    s_waitcnt vmcnt(9) lgkmcnt(6)
    v_mfma_f32_32x32x16_bf16 v[32:47], v[24:27], a[100:103], v[32:47]
    buffer_load_dwordx4 a[140:143], v1, s[16:19], s29 offen offset:3072
    ds_read_b64_tr_b16 v[24:25], v5 offset:27648
    ds_read_b64_tr_b16 v[26:27], v5 offset:27904
    s_waitcnt lgkmcnt(6)
    v_mfma_f32_32x32x16_bf16 v[48:63], v[28:31], a[100:103], v[48:63]
    ds_read_b64_tr_b16 v[28:29], v6 offset:15360
    ds_read_b64_tr_b16 v[30:31], v6 offset:15616
    s_waitcnt vmcnt(9) lgkmcnt(6)
    v_mfma_f32_32x32x16_bf16 v[32:47], v[16:19], a[104:107], v[32:47]
    s_add_u32 m0, s31, 73728
    s_add_u32 s30, s34, 0
    buffer_load_dwordx4 v2, s[8:11], s30 offen lds
    ds_read_b64_tr_b16 v[16:17], v5 offset:28672
    ds_read_b64_tr_b16 v[18:19], v5 offset:28928
    s_waitcnt lgkmcnt(6)
    v_mfma_f32_32x32x16_bf16 v[48:63], v[20:23], a[104:107], v[48:63]
    ds_read_b64_tr_b16 v[20:21], v6 offset:16384
    ds_read_b64_tr_b16 v[22:23], v6 offset:16640
    s_waitcnt vmcnt(9) lgkmcnt(6)
    v_mfma_f32_32x32x16_bf16 v[32:47], v[24:27], a[108:111], v[32:47]
    s_add_u32 m0, s31, 110592
    s_add_u32 s30, s35, 0
    buffer_load_dwordx4 v1, s[16:19], s30 offen lds
    ds_read_b64_tr_b16 v[24:25], v5 offset:29696
    ds_read_b64_tr_b16 v[26:27], v5 offset:29952
    s_waitcnt lgkmcnt(6)
    v_mfma_f32_32x32x16_bf16 v[48:63], v[28:31], a[108:111], v[48:63]
    ds_read_b64_tr_b16 v[28:29], v6 offset:17408
    ds_read_b64_tr_b16 v[30:31], v6 offset:17664
    s_waitcnt vmcnt(9) lgkmcnt(6)
    v_mfma_f32_32x32x16_bf16 v[32:47], v[16:19], a[112:115], v[32:47]
    s_add_u32 m0, s31, 81920
    s_add_u32 s30, s34, 1179648
    buffer_load_dwordx4 v2, s[8:11], s30 offen lds
    ds_read_b64_tr_b16 v[16:17], v5 offset:30720
    ds_read_b64_tr_b16 v[18:19], v5 offset:30976
    s_waitcnt lgkmcnt(6)
    v_mfma_f32_32x32x16_bf16 v[48:63], v[20:23], a[112:115], v[48:63]
    ds_read_b64_tr_b16 v[20:21], v6 offset:18432
    ds_read_b64_tr_b16 v[22:23], v6 offset:18688
    s_waitcnt vmcnt(9) lgkmcnt(6)
    v_mfma_f32_32x32x16_bf16 v[32:47], v[24:27], a[116:119], v[32:47]
    s_add_u32 m0, s31, 118784
    s_add_u32 s30, s35, 8192
    buffer_load_dwordx4 v1, s[16:19], s30 offen lds
    ds_read_b64_tr_b16 v[24:25], v5 offset:31744
    ds_read_b64_tr_b16 v[26:27], v5 offset:32000
    s_waitcnt lgkmcnt(6)
    v_mfma_f32_32x32x16_bf16 v[48:63], v[28:31], a[116:119], v[48:63]
    ds_read_b64_tr_b16 v[28:29], v6 offset:19456
    ds_read_b64_tr_b16 v[30:31], v6 offset:19712
    s_waitcnt vmcnt(9) lgkmcnt(6)
    v_mfma_f32_32x32x16_bf16 v[32:47], v[16:19], a[120:123], v[32:47]
    s_add_u32 m0, s31, 90112
    s_add_u32 s30, s34, 2359296
    buffer_load_dwordx4 v2, s[8:11], s30 offen lds
    ds_read_b64_tr_b16 v[16:17], v5 offset:32768
    ds_read_b64_tr_b16 v[18:19], v5 offset:33024
    s_waitcnt lgkmcnt(6)
    v_mfma_f32_32x32x16_bf16 v[48:63], v[20:23], a[120:123], v[48:63]
    ds_read_b64_tr_b16 v[20:21], v6 offset:20480
    ds_read_b64_tr_b16 v[22:23], v6 offset:20736
    s_waitcnt vmcnt(9) lgkmcnt(6)
    v_mfma_f32_32x32x16_bf16 v[32:47], v[24:27], a[124:127], v[32:47]
    s_add_u32 m0, s31, 126976
    s_add_u32 s30, s35, 16384
    buffer_load_dwordx4 v1, s[16:19], s30 offen lds
    ds_read_b64_tr_b16 v[24:25], v5 offset:33792
    ds_read_b64_tr_b16 v[26:27], v5 offset:34048
    s_waitcnt lgkmcnt(6)
    v_mfma_f32_32x32x16_bf16 v[48:63], v[28:31], a[124:127], v[48:63]
    ds_read_b64_tr_b16 v[28:29], v6 offset:21504
    ds_read_b64_tr_b16 v[30:31], v6 offset:21760
    s_waitcnt vmcnt(9) lgkmcnt(6)
    v_mfma_f32_32x32x16_bf16 v[32:47], v[16:19], a[128:131], v[32:47]
    s_add_u32 m0, s31, 98304
    s_add_u32 s30, s34, 3538944
    buffer_load_dwordx4 v2, s[8:11], s30 offen lds
    ds_read_b64_tr_b16 v[16:17], v5 offset:34816
    ds_read_b64_tr_b16 v[18:19], v5 offset:35072
    s_waitcnt lgkmcnt(6)
    v_mfma_f32_32x32x16_bf16 v[48:63], v[20:23], a[128:131], v[48:63]
    ds_read_b64_tr_b16 v[20:21], v6 offset:22528
    ds_read_b64_tr_b16 v[22:23], v6 offset:22784
    s_waitcnt vmcnt(9) lgkmcnt(6)
    v_mfma_f32_32x32x16_bf16 v[32:47], v[24:27], a[132:135], v[32:47]
    s_add_u32 m0, s31, 135168
    s_add_u32 s30, s35, 24576
    buffer_load_dwordx4 v1, s[16:19], s30 offen lds
    ds_read_b64_tr_b16 v[24:25], v5 offset:35840
    ds_read_b64_tr_b16 v[26:27], v5 offset:36096
    s_waitcnt lgkmcnt(6)
    v_mfma_f32_32x32x16_bf16 v[48:63], v[28:31], a[132:135], v[48:63]
    ds_read_b64_tr_b16 v[28:29], v6 offset:23552
    ds_read_b64_tr_b16 v[30:31], v6 offset:23808
    s_waitcnt vmcnt(9) lgkmcnt(6)
    v_mfma_f32_32x32x16_bf16 v[32:47], v[16:19], a[136:139], v[32:47]
    s_add_u32 s30, s50, 73728
    s_min_u32 m0, s30, 160768
    s_add_u32 s30, s34, 4718592
    s_or_b32 s30, s30, s51
    buffer_load_dwordx4 v2, s[8:11], s30 offen lds
    s_waitcnt lgkmcnt(4)
    v_mfma_f32_32x32x16_bf16 v[48:63], v[20:23], a[136:139], v[48:63]
    s_waitcnt vmcnt(9) lgkmcnt(2)
    v_mfma_f32_32x32x16_bf16 v[32:47], v[24:27], a[140:143], v[32:47]
    s_add_u32 s30, s50, 110592
    s_min_u32 m0, s30, 160768
    s_add_u32 s30, s35, 32768
    s_or_b32 s30, s30, s51
    buffer_load_dwordx4 v1, s[16:19], s30 offen lds
    s_waitcnt lgkmcnt(0)
    v_mfma_f32_32x32x16_bf16 v[48:63], v[28:31], a[140:143], v[48:63]
    s_waitcnt vmcnt(0)
    s_barrier
    ds_read_b64_tr_b16 v[16:17], v6 offset:24576
    ds_read_b64_tr_b16 v[18:19], v6 offset:24832
    ds_read_b64_tr_b16 v[20:21], v6 offset:25600
    ds_read_b64_tr_b16 v[22:23], v6 offset:25856
    ds_read_b64_tr_b16 v[24:25], v6 offset:26624
    ds_read_b64_tr_b16 v[26:27], v6 offset:26880
    ds_read_b64_tr_b16 v[28:29], v6 offset:27648
    ds_read_b64_tr_b16 v[30:31], v6 offset:27904
    s_waitcnt lgkmcnt(6)
    v_mfma_f32_32x32x16_bf16 v[64:79], v[16:19], a[0:3], 0
    s_cmp_eq_u32 s99, 0
    s_cbranch_scc1 L_pr11
    s_setprio 1
L_pr11:
    s_add_u32 m0, s31, 0
    s_add_u32 s30, s39, 0
    buffer_load_dwordx4 v1, s[16:19], s30 offen lds
    ds_read_b64_tr_b16 v[16:17], v6 offset:28672
    ds_read_b64_tr_b16 v[18:19], v6 offset:28928
    s_waitcnt lgkmcnt(6)
    v_mfma_f32_32x32x16_bf16 v[64:79], v[20:23], a[4:7], v[64:79]
    v_mul_f32 v13, v32, v32
    v_mul_f32 v14, v33, v33
    v_fmaak_f32 v13, v12, v13, 0xc0135761
    v_fmaak_f32 v14, v12, v14, 0xc0135761
    v_mul_f32 v13, v13, v32
    v_mul_f32 v14, v14, v33
    v_exp_f32 v13, v13
    v_exp_f32 v14, v14
    v_add_f32 v13, 1.0, v13
    ds_read_b64_tr_b16 v[20:21], v6 offset:29696
    ds_read_b64_tr_b16 v[22:23], v6 offset:29952
    s_waitcnt lgkmcnt(6)
    v_mfma_f32_32x32x16_bf16 v[64:79], v[24:27], a[8:11], v[64:79]
    v_add_f32 v14, 1.0, v14
    v_rcp_f32 v13, v13
    v_rcp_f32 v14, v14
    v_mul_f32 v32, v32, v13
    v_mul_f32 v33, v33, v14
    v_add_f32 v10, v10, v32
    v_fmac_f32 v11, v32, v32
    v_add_f32 v10, v10, v33
    v_fmac_f32 v11, v33, v33
    ds_read_b64_tr_b16 v[24:25], v6 offset:30720
    ds_read_b64_tr_b16 v[26:27], v6 offset:30976
    s_waitcnt lgkmcnt(6)
    v_mfma_f32_32x32x16_bf16 v[64:79], v[28:31], a[12:15], v[64:79]
    v_cvt_pk_bf16_f32 v80, v32, v33
    v_mul_f32 v13, v34, v34
    v_mul_f32 v14, v35, v35
    v_fmaak_f32 v13, v12, v13, 0xc0135761
    v_fmaak_f32 v14, v12, v14, 0xc0135761
    v_mul_f32 v13, v13, v34
    v_mul_f32 v14, v14, v35
    v_exp_f32 v13, v13
    v_exp_f32 v14, v14
    ds_read_b64_tr_b16 v[28:29], v6 offset:31744
    ds_read_b64_tr_b16 v[30:31], v6 offset:32000
    s_waitcnt lgkmcnt(6)
    v_mfma_f32_32x32x16_bf16 v[64:79], v[16:19], a[16:19], v[64:79]
    v_add_f32 v13, 1.0, v13
    v_add_f32 v14, 1.0, v14
    v_rcp_f32 v13, v13
    v_rcp_f32 v14, v14
    v_mul_f32 v34, v34, v13
    v_mul_f32 v35, v35, v14
    v_add_f32 v10, v10, v34
    v_fmac_f32 v11, v34, v34
    v_add_f32 v10, v10, v35
    s_add_u32 m0, s31, 36864
    s_add_u32 s30, s33, 0
    buffer_load_dwordx4 v2, s[8:11], s30 offen lds
    ds_read_b64_tr_b16 v[16:17], v6 offset:32768
    ds_read_b64_tr_b16 v[18:19], v6 offset:33024
    s_waitcnt lgkmcnt(6)
    v_mfma_f32_32x32x16_bf16 v[64:79], v[20:23], a[20:23], v[64:79]
    v_fmac_f32 v11, v35, v35
    v_cvt_pk_bf16_f32 v81, v34, v35
    v_mul_f32 v13, v36, v36
    v_mul_f32 v14, v37, v37
    v_fmaak_f32 v13, v12, v13, 0xc0135761
    v_fmaak_f32 v14, v12, v14, 0xc0135761
    v_mul_f32 v13, v13, v36
    v_mul_f32 v14, v14, v37
    v_exp_f32 v13, v13
    ds_read_b64_tr_b16 v[20:21], v6 offset:33792
    ds_read_b64_tr_b16 v[22:23], v6 offset:34048
    s_waitcnt lgkmcnt(6)
    v_mfma_f32_32x32x16_bf16 v[64:79], v[24:27], a[24:27], v[64:79]
    v_exp_f32 v14, v14
    v_add_f32 v13, 1.0, v13
    v_add_f32 v14, 1.0, v14
    v_rcp_f32 v13, v13
    v_rcp_f32 v14, v14
    v_mul_f32 v36, v36, v13
    v_mul_f32 v37, v37, v14
    v_add_f32 v10, v10, v36
    v_fmac_f32 v11, v36, v36
    ds_read_b64_tr_b16 v[24:25], v6 offset:34816
    ds_read_b64_tr_b16 v[26:27], v6 offset:35072
    s_waitcnt lgkmcnt(6)
    v_mfma_f32_32x32x16_bf16 v[64:79], v[28:31], a[28:31], v[64:79]
    v_add_f32 v10, v10, v37
    v_fmac_f32 v11, v37, v37
    v_cvt_pk_bf16_f32 v82, v36, v37
    v_mul_f32 v13, v38, v38
    v_mul_f32 v14, v39, v39
    v_fmaak_f32 v13, v12, v13, 0xc0135761
    v_fmaak_f32 v14, v12, v14, 0xc0135761
    v_mul_f32 v13, v13, v38
    v_mul_f32 v14, v14, v39
    ds_read_b64_tr_b16 v[28:29], v6 offset:35840
    ds_read_b64_tr_b16 v[30:31], v6 offset:36096
    s_waitcnt lgkmcnt(6)
    v_mfma_f32_32x32x16_bf16 v[64:79], v[16:19], a[32:35], v[64:79]
    v_exp_f32 v13, v13
    v_exp_f32 v14, v14
    v_add_f32 v13, 1.0, v13
    v_add_f32 v14, 1.0, v14
    v_rcp_f32 v13, v13
    v_rcp_f32 v14, v14
    v_mul_f32 v38, v38, v13
    v_mul_f32 v39, v39, v14
    v_add_f32 v10, v10, v38
    ds_read_b64_tr_b16 v[16:17], v6 offset:36864
    ds_read_b64_tr_b16 v[18:19], v6 offset:37120
    s_waitcnt lgkmcnt(6)
    v_mfma_f32_32x32x16_bf16 v[64:79], v[20:23], a[36:39], v[64:79]
    v_fmac_f32 v11, v38, v38
    v_add_f32 v10, v10, v39
    v_fmac_f32 v11, v39, v39
    v_cvt_pk_bf16_f32 v83, v38, v39
    v_mul_f32 v13, v40, v40
    v_mul_f32 v14, v41, v41
    v_fmaak_f32 v13, v12, v13, 0xc0135761
    v_fmaak_f32 v14, v12, v14, 0xc0135761
    v_mul_f32 v13, v13, v40
    s_add_u32 m0, s31, 8192
    s_add_u32 s30, s39, 8192
    buffer_load_dwordx4 v1, s[16:19], s30 offen lds
    ds_read_b64_tr_b16 v[20:21], v6 offset:37888
    ds_read_b64_tr_b16 v[22:23], v6 offset:38144
    s_waitcnt lgkmcnt(6)
    v_mfma_f32_32x32x16_bf16 v[64:79], v[24:27], a[40:43], v[64:79]
    v_mul_f32 v14, v14, v41
    v_exp_f32 v13, v13
    v_exp_f32 v14, v14
    v_add_f32 v13, 1.0, v13
    v_add_f32 v14, 1.0, v14
    v_rcp_f32 v13, v13
    v_rcp_f32 v14, v14
    v_mul_f32 v40, v40, v13
    v_mul_f32 v41, v41, v14
    ds_read_b64_tr_b16 v[24:25], v6 offset:38912
    ds_read_b64_tr_b16 v[26:27], v6 offset:39168
    s_waitcnt lgkmcnt(6)
    v_mfma_f32_32x32x16_bf16 v[64:79], v[28:31], a[44:47], v[64:79]
    v_add_f32 v10, v10, v40
    v_fmac_f32 v11, v40, v40
    v_add_f32 v10, v10, v41
    v_fmac_f32 v11, v41, v41
    v_cvt_pk_bf16_f32 v84, v40, v41
    v_mul_f32 v13, v42, v42
    v_mul_f32 v14, v43, v43
    v_fmaak_f32 v13, v12, v13, 0xc0135761
    v_fmaak_f32 v14, v12, v14, 0xc0135761
    ds_read_b64_tr_b16 v[28:29], v6 offset:39936
    ds_read_b64_tr_b16 v[30:31], v6 offset:40192
    s_waitcnt lgkmcnt(6)
    v_mfma_f32_32x32x16_bf16 v[64:79], v[16:19], a[48:51], v[64:79]
    v_mul_f32 v13, v13, v42
    v_mul_f32 v14, v14, v43
    v_exp_f32 v13, v13
    v_exp_f32 v14, v14
    v_add_f32 v13, 1.0, v13
    v_add_f32 v14, 1.0, v14
    v_rcp_f32 v13, v13
    v_rcp_f32 v14, v14
    v_mul_f32 v42, v42, v13
    ds_read_b64_tr_b16 v[16:17], v6 offset:40960
    ds_read_b64_tr_b16 v[18:19], v6 offset:41216
    s_waitcnt lgkmcnt(6)
    v_mfma_f32_32x32x16_bf16 v[64:79], v[20:23], a[52:55], v[64:79]
    v_mul_f32 v43, v43, v14
    v_add_f32 v10, v10, v42
    v_fmac_f32 v11, v42, v42
    v_add_f32 v10, v10, v43
    v_fmac_f32 v11, v43, v43
    v_cvt_pk_bf16_f32 v85, v42, v43
    v_mul_f32 v13, v44, v44
    v_mul_f32 v14, v45, v45
    v_fmaak_f32 v13, v12, v13, 0xc0135761
    ds_read_b64_tr_b16 v[20:21], v6 offset:41984
    ds_read_b64_tr_b16 v[22:23], v6 offset:42240
    s_waitcnt lgkmcnt(6)
    v_mfma_f32_32x32x16_bf16 v[64:79], v[24:27], a[56:59], v[64:79]
    v_fmaak_f32 v14, v12, v14, 0xc0135761
    v_mul_f32 v13, v13, v44
    v_mul_f32 v14, v14, v45
    v_exp_f32 v13, v13
    v_exp_f32 v14, v14
    v_add_f32 v13, 1.0, v13
    v_add_f32 v14, 1.0, v14
    v_rcp_f32 v13, v13
    v_rcp_f32 v14, v14
    s_add_u32 m0, s31, 45056
    s_add_u32 s30, s33, 1179648
    buffer_load_dwordx4 v2, s[8:11], s30 offen lds
    ds_read_b64_tr_b16 v[24:25], v6 offset:43008
    ds_read_b64_tr_b16 v[26:27], v6 offset:43264
    s_waitcnt lgkmcnt(6)
    v_mfma_f32_32x32x16_bf16 v[64:79], v[28:31], a[60:63], v[64:79]
    v_mul_f32 v44, v44, v13
    v_mul_f32 v45, v45, v14
    v_add_f32 v10, v10, v44
    v_fmac_f32 v11, v44, v44
    v_add_f32 v10, v10, v45
    v_fmac_f32 v11, v45, v45
    v_cvt_pk_bf16_f32 v86, v44, v45
    v_mul_f32 v13, v46, v46
    v_mul_f32 v14, v47, v47
    ds_read_b64_tr_b16 v[28:29], v6 offset:44032
    ds_read_b64_tr_b16 v[30:31], v6 offset:44288
    s_waitcnt lgkmcnt(6)
    v_mfma_f32_32x32x16_bf16 v[64:79], v[16:19], a[64:67], v[64:79]
    v_fmaak_f32 v13, v12, v13, 0xc0135761
    v_fmaak_f32 v14, v12, v14, 0xc0135761
    v_mul_f32 v13, v13, v46
    v_mul_f32 v14, v14, v47
    v_exp_f32 v13, v13
    v_exp_f32 v14, v14
    v_add_f32 v13, 1.0, v13
    v_add_f32 v14, 1.0, v14
    v_rcp_f32 v13, v13
    ds_read_b64_tr_b16 v[16:17], v6 offset:45056
    ds_read_b64_tr_b16 v[18:19], v6 offset:45312
    s_waitcnt lgkmcnt(6)
    v_mfma_f32_32x32x16_bf16 v[64:79], v[20:23], a[68:71], v[64:79]
    v_rcp_f32 v14, v14
    v_mul_f32 v46, v46, v13
    v_mul_f32 v47, v47, v14
    v_add_f32 v10, v10, v46
    v_fmac_f32 v11, v46, v46
    v_add_f32 v10, v10, v47
    v_fmac_f32 v11, v47, v47
    v_cvt_pk_bf16_f32 v87, v46, v47
    ds_read_b64_tr_b16 v[20:21], v6 offset:46080
    ds_read_b64_tr_b16 v[22:23], v6 offset:46336
    s_waitcnt lgkmcnt(6)
    v_mfma_f32_32x32x16_bf16 v[64:79], v[24:27], a[72:75], v[64:79]
    v_mul_f32 v13, v48, v48
    v_mul_f32 v14, v49, v49
    v_fmaak_f32 v13, v12, v13, 0xc0135761
    v_fmaak_f32 v14, v12, v14, 0xc0135761
    v_mul_f32 v13, v13, v48
    v_mul_f32 v14, v14, v49
    v_exp_f32 v13, v13
    v_exp_f32 v14, v14
    v_add_f32 v13, 1.0, v13
    s_add_u32 m0, s31, 16384
    s_add_u32 s30, s39, 16384
    buffer_load_dwordx4 v1, s[16:19], s30 offen lds
    ds_read_b64_tr_b16 v[24:25], v6 offset:47104
    ds_read_b64_tr_b16 v[26:27], v6 offset:47360
    s_waitcnt lgkmcnt(6)
    v_mfma_f32_32x32x16_bf16 v[64:79], v[28:31], a[76:79], v[64:79]
    v_add_f32 v14, 1.0, v14
    v_rcp_f32 v13, v13
    v_rcp_f32 v14, v14
    v_mul_f32 v48, v48, v13
    v_mul_f32 v49, v49, v14
    v_add_f32 v10, v10, v48
    v_fmac_f32 v11, v48, v48
    v_add_f32 v10, v10, v49
    v_fmac_f32 v11, v49, v49
    ds_read_b64_tr_b16 v[28:29], v6 offset:48128
    ds_read_b64_tr_b16 v[30:31], v6 offset:48384
    s_waitcnt lgkmcnt(6)
    v_mfma_f32_32x32x16_bf16 v[64:79], v[16:19], a[80:83], v[64:79]
    v_cvt_pk_bf16_f32 v88, v48, v49
    v_mul_f32 v13, v50, v50
    v_mul_f32 v14, v51, v51
    v_fmaak_f32 v13, v12, v13, 0xc0135761
    v_fmaak_f32 v14, v12, v14, 0xc0135761
    v_mul_f32 v13, v13, v50
    v_mul_f32 v14, v14, v51
    v_exp_f32 v13, v13
    v_exp_f32 v14, v14
    ds_read_b64_tr_b16 v[16:17], v7 offset:0
    ds_read_b64_tr_b16 v[18:19], v7 offset:256
    s_waitcnt lgkmcnt(6)
    v_mfma_f32_32x32x16_bf16 v[64:79], v[20:23], a[84:87], v[64:79]
    v_add_f32 v13, 1.0, v13
    v_add_f32 v14, 1.0, v14
    v_rcp_f32 v13, v13
    v_rcp_f32 v14, v14
    v_mul_f32 v50, v50, v13
    v_mul_f32 v51, v51, v14
    v_add_f32 v10, v10, v50
    v_fmac_f32 v11, v50, v50
    v_add_f32 v10, v10, v51
    ds_read_b64_tr_b16 v[20:21], v7 offset:1024
    ds_read_b64_tr_b16 v[22:23], v7 offset:1280
    s_waitcnt lgkmcnt(6)
    v_mfma_f32_32x32x16_bf16 v[64:79], v[24:27], a[88:91], v[64:79]
    v_fmac_f32 v11, v51, v51
    v_cvt_pk_bf16_f32 v89, v50, v51
    v_mul_f32 v13, v52, v52
    v_mul_f32 v14, v53, v53
    v_fmaak_f32 v13, v12, v13, 0xc0135761
    v_fmaak_f32 v14, v12, v14, 0xc0135761
    v_mul_f32 v13, v13, v52
    v_mul_f32 v14, v14, v53
    v_exp_f32 v13, v13
    ds_read_b64_tr_b16 v[24:25], v7 offset:2048
    ds_read_b64_tr_b16 v[26:27], v7 offset:2304
    s_waitcnt lgkmcnt(6)
    v_mfma_f32_32x32x16_bf16 v[64:79], v[28:31], a[92:95], v[64:79]
    v_exp_f32 v14, v14
    v_add_f32 v13, 1.0, v13
    v_add_f32 v14, 1.0, v14
    v_rcp_f32 v13, v13
    v_rcp_f32 v14, v14
    v_mul_f32 v52, v52, v13
    v_mul_f32 v53, v53, v14
    v_add_f32 v10, v10, v52
    v_fmac_f32 v11, v52, v52
    s_add_u32 m0, s31, 53248
    s_add_u32 s30, s33, 2359296
    buffer_load_dwordx4 v2, s[8:11], s30 offen lds
    ds_read_b64_tr_b16 v[28:29], v7 offset:3072
    ds_read_b64_tr_b16 v[30:31], v7 offset:3328
    s_waitcnt lgkmcnt(6)
    v_mfma_f32_32x32x16_bf16 v[64:79], v[16:19], a[96:99], v[64:79]
    v_add_f32 v10, v10, v53
    v_fmac_f32 v11, v53, v53
    v_cvt_pk_bf16_f32 v90, v52, v53
    v_mul_f32 v13, v54, v54
    v_mul_f32 v14, v55, v55
    v_fmaak_f32 v13, v12, v13, 0xc0135761
    v_fmaak_f32 v14, v12, v14, 0xc0135761
    v_mul_f32 v13, v13, v54
    v_mul_f32 v14, v14, v55
    ds_read_b64_tr_b16 v[16:17], v7 offset:4096
    ds_read_b64_tr_b16 v[18:19], v7 offset:4352
    s_waitcnt lgkmcnt(6)
    v_mfma_f32_32x32x16_bf16 v[64:79], v[20:23], a[100:103], v[64:79]
    v_exp_f32 v13, v13
    v_exp_f32 v14, v14
    v_add_f32 v13, 1.0, v13
    v_add_f32 v14, 1.0, v14
    v_rcp_f32 v13, v13
    v_rcp_f32 v14, v14
    v_mul_f32 v54, v54, v13
    v_mul_f32 v55, v55, v14
    v_add_f32 v10, v10, v54
    ds_read_b64_tr_b16 v[20:21], v7 offset:5120
    ds_read_b64_tr_b16 v[22:23], v7 offset:5376
    s_waitcnt lgkmcnt(6)
    v_mfma_f32_32x32x16_bf16 v[64:79], v[24:27], a[104:107], v[64:79]
    v_fmac_f32 v11, v54, v54
    v_add_f32 v10, v10, v55
    v_fmac_f32 v11, v55, v55
    v_cvt_pk_bf16_f32 v91, v54, v55
    v_mul_f32 v13, v56, v56
    v_mul_f32 v14, v57, v57
    v_fmaak_f32 v13, v12, v13, 0xc0135761
    v_fmaak_f32 v14, v12, v14, 0xc0135761
    v_mul_f32 v13, v13, v56
    ds_read_b64_tr_b16 v[24:25], v7 offset:6144
    ds_read_b64_tr_b16 v[26:27], v7 offset:6400
    s_waitcnt lgkmcnt(6)
    v_mfma_f32_32x32x16_bf16 v[64:79], v[28:31], a[108:111], v[64:79]
    v_mul_f32 v14, v14, v57
    v_exp_f32 v13, v13
    v_exp_f32 v14, v14
    v_add_f32 v13, 1.0, v13
    v_add_f32 v14, 1.0, v14
    v_rcp_f32 v13, v13
    v_rcp_f32 v14, v14
    v_mul_f32 v56, v56, v13
    v_mul_f32 v57, v57, v14
    ds_read_b64_tr_b16 v[28:29], v7 offset:7168
    ds_read_b64_tr_b16 v[30:31], v7 offset:7424
    s_waitcnt lgkmcnt(6)
    v_mfma_f32_32x32x16_bf16 v[64:79], v[16:19], a[112:115], v[64:79]
    v_add_f32 v10, v10, v56
    v_fmac_f32 v11, v56, v56
    v_add_f32 v10, v10, v57
    v_fmac_f32 v11, v57, v57
    v_cvt_pk_bf16_f32 v92, v56, v57
    v_mul_f32 v13, v58, v58
    v_mul_f32 v14, v59, v59
    v_fmaak_f32 v13, v12, v13, 0xc0135761
    v_fmaak_f32 v14, v12, v14, 0xc0135761
    s_add_u32 m0, s31, 24576
    s_add_u32 s30, s39, 24576
    buffer_load_dwordx4 v1, s[16:19], s30 offen lds
    ds_read_b64_tr_b16 v[16:17], v7 offset:8192
    ds_read_b64_tr_b16 v[18:19], v7 offset:8448
    s_waitcnt lgkmcnt(6)
    v_mfma_f32_32x32x16_bf16 v[64:79], v[20:23], a[116:119], v[64:79]
    v_mul_f32 v13, v13, v58
    v_mul_f32 v14, v14, v59
    v_exp_f32 v13, v13
    v_exp_f32 v14, v14
    v_add_f32 v13, 1.0, v13
    v_add_f32 v14, 1.0, v14
    v_rcp_f32 v13, v13
    v_rcp_f32 v14, v14
    v_mul_f32 v58, v58, v13
    ds_read_b64_tr_b16 v[20:21], v7 offset:9216
    ds_read_b64_tr_b16 v[22:23], v7 offset:9472
    s_waitcnt lgkmcnt(6)
    v_mfma_f32_32x32x16_bf16 v[64:79], v[24:27], a[120:123], v[64:79]
    v_mul_f32 v59, v59, v14
    v_add_f32 v10, v10, v58
    v_fmac_f32 v11, v58, v58
    v_add_f32 v10, v10, v59
    v_fmac_f32 v11, v59, v59
    v_cvt_pk_bf16_f32 v93, v58, v59
    v_mul_f32 v13, v60, v60
    v_mul_f32 v14, v61, v61
    v_fmaak_f32 v13, v12, v13, 0xc0135761
    ds_read_b64_tr_b16 v[24:25], v7 offset:10240
    ds_read_b64_tr_b16 v[26:27], v7 offset:10496
    s_waitcnt lgkmcnt(6)
    v_mfma_f32_32x32x16_bf16 v[64:79], v[28:31], a[124:127], v[64:79]
    v_fmaak_f32 v14, v12, v14, 0xc0135761
    v_mul_f32 v13, v13, v60
    v_mul_f32 v14, v14, v61
    v_exp_f32 v13, v13
    v_exp_f32 v14, v14
    v_add_f32 v13, 1.0, v13
    v_add_f32 v14, 1.0, v14
    v_rcp_f32 v13, v13
    v_rcp_f32 v14, v14
    ds_read_b64_tr_b16 v[28:29], v7 offset:11264
    ds_read_b64_tr_b16 v[30:31], v7 offset:11520
    s_waitcnt lgkmcnt(6)
    v_mfma_f32_32x32x16_bf16 v[64:79], v[16:19], a[128:131], v[64:79]
    v_mul_f32 v60, v60, v13
    v_mul_f32 v61, v61, v14
    v_add_f32 v10, v10, v60
    v_fmac_f32 v11, v60, v60
    v_add_f32 v10, v10, v61
    v_fmac_f32 v11, v61, v61
    v_cvt_pk_bf16_f32 v94, v60, v61
    v_mul_f32 v13, v62, v62
    v_mul_f32 v14, v63, v63
    s_add_u32 m0, s31, 61440
    s_add_u32 s30, s33, 3538944
    buffer_load_dwordx4 v2, s[8:11], s30 offen lds
    ds_read_b64_tr_b16 v[16:17], v7 offset:12288
    ds_read_b64_tr_b16 v[18:19], v7 offset:12544
    s_waitcnt lgkmcnt(6)
    v_mfma_f32_32x32x16_bf16 v[64:79], v[20:23], a[132:135], v[64:79]
    v_fmaak_f32 v13, v12, v13, 0xc0135761
    v_fmaak_f32 v14, v12, v14, 0xc0135761
    v_mul_f32 v13, v13, v62
    v_mul_f32 v14, v14, v63
    v_exp_f32 v13, v13
    v_exp_f32 v14, v14
    v_add_f32 v13, 1.0, v13
    v_add_f32 v14, 1.0, v14
    v_rcp_f32 v13, v13
    ds_read_b64_tr_b16 v[20:21], v7 offset:13312
    ds_read_b64_tr_b16 v[22:23], v7 offset:13568
    s_waitcnt lgkmcnt(6)
    v_mfma_f32_32x32x16_bf16 v[64:79], v[24:27], a[136:139], v[64:79]
    v_rcp_f32 v14, v14
    v_mul_f32 v62, v62, v13
    v_mul_f32 v63, v63, v14
    v_add_f32 v10, v10, v62
    v_fmac_f32 v11, v62, v62
    v_add_f32 v10, v10, v63
    v_fmac_f32 v11, v63, v63
    v_cvt_pk_bf16_f32 v95, v62, v63
    ds_read_b64_tr_b16 v[24:25], v7 offset:14336
    ds_read_b64_tr_b16 v[26:27], v7 offset:14592
    s_waitcnt lgkmcnt(6)
    v_mfma_f32_32x32x16_bf16 v[64:79], v[28:31], a[140:143], v[64:79]
    ds_read_b64_tr_b16 v[28:29], v7 offset:15360
    ds_read_b64_tr_b16 v[30:31], v7 offset:15616
    s_waitcnt lgkmcnt(6)
    v_mfma_f32_32x32x16_bf16 v[32:47], a[0:3], v[16:19], 0
    s_cmp_eq_u32 s99, 0
    s_cbranch_scc1 L_pr12
    s_setprio 0
L_pr12:
    s_nop 0
    ds_read_b64_tr_b16 v[16:17], v7 offset:16384
    ds_read_b64_tr_b16 v[18:19], v7 offset:16640
    s_waitcnt lgkmcnt(6)
    v_mfma_f32_32x32x16_bf16 v[32:47], a[4:7], v[20:23], v[32:47]
    s_nop 0
    v_mul_f32 v13, v64, v64
    v_mul_f32 v14, v65, v65
    v_fmaak_f32 v13, v12, v13, 0xc0135761
    v_fmaak_f32 v14, v12, v14, 0xc0135761
    v_mul_f32 v13, v13, v64
    s_add_u32 s30, s50, 0
    s_min_u32 m0, s30, 160768
    s_add_u32 s30, s39, 32768
    s_or_b32 s30, s30, s51
    buffer_load_dwordx4 v1, s[16:19], s30 offen lds
    ds_read_b64_tr_b16 v[20:21], v7 offset:17408
    ds_read_b64_tr_b16 v[22:23], v7 offset:17664
    s_waitcnt lgkmcnt(6)
    v_mfma_f32_32x32x16_bf16 v[32:47], a[8:11], v[24:27], v[32:47]
    v_mul_f32 v14, v14, v65
    v_exp_f32 v13, v13
    v_exp_f32 v14, v14
    v_add_f32 v13, 1.0, v13
    v_add_f32 v14, 1.0, v14
    ds_read_b64_tr_b16 v[24:25], v7 offset:18432
    ds_read_b64_tr_b16 v[26:27], v7 offset:18688
    s_waitcnt lgkmcnt(6)
    v_mfma_f32_32x32x16_bf16 v[32:47], a[12:15], v[28:31], v[32:47]
    v_rcp_f32 v13, v13
    v_rcp_f32 v14, v14
    v_mul_f32 v64, v64, v13
    v_mul_f32 v65, v65, v14
    v_add_f32 v10, v10, v64
    ds_read_b64_tr_b16 v[28:29], v7 offset:19456
    ds_read_b64_tr_b16 v[30:31], v7 offset:19712
    s_waitcnt lgkmcnt(6)
    v_mfma_f32_32x32x16_bf16 v[32:47], a[16:19], v[16:19], v[32:47]
    s_mov_b32 m0, 160768
    s_lshl_b32 s30, s98, 13
    s_add_u32 s30, s30, 0
    buffer_load_dwordx4 v1, s[12:15], s30 offen lds
    v_fmac_f32 v11, v64, v64
    v_add_f32 v10, v10, v65
    v_fmac_f32 v11, v65, v65
    v_cvt_pk_bf16_f32 v96, v64, v65
    ds_read_b64_tr_b16 v[16:17], v7 offset:20480
    ds_read_b64_tr_b16 v[18:19], v7 offset:20736
    s_waitcnt lgkmcnt(6)
    v_mfma_f32_32x32x16_bf16 v[32:47], a[20:23], v[20:23], v[32:47]
    v_mul_f32 v13, v66, v66
    v_mul_f32 v14, v67, v67
    v_fmaak_f32 v13, v12, v13, 0xc0135761
    v_fmaak_f32 v14, v12, v14, 0xc0135761
    v_mul_f32 v13, v13, v66
    ds_read_b64_tr_b16 v[20:21], v7 offset:21504
    ds_read_b64_tr_b16 v[22:23], v7 offset:21760
    s_waitcnt lgkmcnt(6)
    v_mfma_f32_32x32x16_bf16 v[32:47], a[24:27], v[24:27], v[32:47]
    v_mul_f32 v14, v14, v67
    v_exp_f32 v13, v13
    v_exp_f32 v14, v14
    v_add_f32 v13, 1.0, v13
    v_add_f32 v14, 1.0, v14
    s_add_u32 s30, s50, 36864
    s_min_u32 m0, s30, 160768
    s_add_u32 s30, s33, 4718592
    s_or_b32 s30, s30, s51
    buffer_load_dwordx4 v2, s[8:11], s30 offen lds
    ds_read_b64_tr_b16 v[24:25], v7 offset:22528
    ds_read_b64_tr_b16 v[26:27], v7 offset:22784
    s_waitcnt lgkmcnt(6)
    v_mfma_f32_32x32x16_bf16 v[32:47], a[28:31], v[28:31], v[32:47]
    v_rcp_f32 v13, v13
    v_rcp_f32 v14, v14
    v_mul_f32 v66, v66, v13
    v_mul_f32 v67, v67, v14
    v_add_f32 v10, v10, v66
    ds_read_b64_tr_b16 v[28:29], v7 offset:23552
    ds_read_b64_tr_b16 v[30:31], v7 offset:23808
    s_waitcnt lgkmcnt(6)
    v_mfma_f32_32x32x16_bf16 v[32:47], a[32:35], v[16:19], v[32:47]
    s_mov_b32 m0, 160768
    s_lshl_b32 s30, s98, 13
    s_add_u32 s30, s30, 1024
    buffer_load_dwordx4 v1, s[12:15], s30 offen lds
    v_fmac_f32 v11, v66, v66
    v_add_f32 v10, v10, v67
    v_fmac_f32 v11, v67, v67
    v_cvt_pk_bf16_f32 v97, v66, v67
    ds_read_b64_tr_b16 v[16:17], v7 offset:24576
    ds_read_b64_tr_b16 v[18:19], v7 offset:24832
    s_waitcnt lgkmcnt(6)
    v_mfma_f32_32x32x16_bf16 v[32:47], a[36:39], v[20:23], v[32:47]
    v_mul_f32 v13, v68, v68
    v_mul_f32 v14, v69, v69
    v_fmaak_f32 v13, v12, v13, 0xc0135761
    v_fmaak_f32 v14, v12, v14, 0xc0135761
    v_mul_f32 v13, v13, v68
    ds_read_b64_tr_b16 v[20:21], v7 offset:25600
    ds_read_b64_tr_b16 v[22:23], v7 offset:25856
    s_waitcnt lgkmcnt(6)
    v_mfma_f32_32x32x16_bf16 v[32:47], a[40:43], v[24:27], v[32:47]
    v_mul_f32 v14, v14, v69
    v_exp_f32 v13, v13
    v_exp_f32 v14, v14
    v_add_f32 v13, 1.0, v13
    v_add_f32 v14, 1.0, v14
    ds_read_b64_tr_b16 v[24:25], v7 offset:26624
    ds_read_b64_tr_b16 v[26:27], v7 offset:26880
    s_waitcnt lgkmcnt(6)
    v_mfma_f32_32x32x16_bf16 v[32:47], a[44:47], v[28:31], v[32:47]
    v_rcp_f32 v13, v13
    v_rcp_f32 v14, v14
    v_mul_f32 v68, v68, v13
    v_mul_f32 v69, v69, v14
    v_add_f32 v10, v10, v68
    ds_read_b64_tr_b16 v[28:29], v7 offset:27648
    ds_read_b64_tr_b16 v[30:31], v7 offset:27904
    s_waitcnt lgkmcnt(6)
    v_mfma_f32_32x32x16_bf16 v[32:47], a[48:51], v[16:19], v[32:47]
    v_fmac_f32 v11, v68, v68
    v_add_f32 v10, v10, v69
    v_fmac_f32 v11, v69, v69
    v_cvt_pk_bf16_f32 v98, v68, v69
    ds_read_b64_tr_b16 v[16:17], v7 offset:28672
    ds_read_b64_tr_b16 v[18:19], v7 offset:28928
    s_waitcnt lgkmcnt(6)
    v_mfma_f32_32x32x16_bf16 v[32:47], a[52:55], v[20:23], v[32:47]
    s_mov_b32 m0, 160768
    s_lshl_b32 s30, s98, 13
    s_add_u32 s30, s30, 2048
    buffer_load_dwordx4 v1, s[12:15], s30 offen lds
    v_mul_f32 v13, v70, v70
    v_mul_f32 v14, v71, v71
    v_fmaak_f32 v13, v12, v13, 0xc0135761
    v_fmaak_f32 v14, v12, v14, 0xc0135761
    v_mul_f32 v13, v13, v70
    ds_read_b64_tr_b16 v[20:21], v7 offset:29696
    ds_read_b64_tr_b16 v[22:23], v7 offset:29952
    s_waitcnt lgkmcnt(6)
    v_mfma_f32_32x32x16_bf16 v[32:47], a[56:59], v[24:27], v[32:47]
    v_mul_f32 v14, v14, v71
    v_exp_f32 v13, v13
    v_exp_f32 v14, v14
    v_add_f32 v13, 1.0, v13
    v_add_f32 v14, 1.0, v14
    ds_read_b64_tr_b16 v[24:25], v7 offset:30720
    ds_read_b64_tr_b16 v[26:27], v7 offset:30976
    s_waitcnt lgkmcnt(6)
    v_mfma_f32_32x32x16_bf16 v[32:47], a[60:63], v[28:31], v[32:47]
    v_rcp_f32 v13, v13
    v_rcp_f32 v14, v14
    v_mul_f32 v70, v70, v13
    v_mul_f32 v71, v71, v14
    v_add_f32 v10, v10, v70
    ds_read_b64_tr_b16 v[28:29], v7 offset:31744
    ds_read_b64_tr_b16 v[30:31], v7 offset:32000
    s_waitcnt lgkmcnt(6)
    v_mfma_f32_32x32x16_bf16 v[32:47], a[64:67], v[16:19], v[32:47]
    v_fmac_f32 v11, v70, v70
    v_add_f32 v10, v10, v71
    v_fmac_f32 v11, v71, v71
    v_cvt_pk_bf16_f32 v99, v70, v71
    ds_read_b64_tr_b16 v[16:17], v7 offset:32768
    ds_read_b64_tr_b16 v[18:19], v7 offset:33024
    s_waitcnt lgkmcnt(6)
    v_mfma_f32_32x32x16_bf16 v[32:47], a[68:71], v[20:23], v[32:47]
    s_mov_b32 m0, 160768
    s_lshl_b32 s30, s98, 13
    s_add_u32 s30, s30, 3072
    buffer_load_dwordx4 v1, s[12:15], s30 offen lds
    v_mul_f32 v13, v72, v72
    v_mul_f32 v14, v73, v73
    v_fmaak_f32 v13, v12, v13, 0xc0135761
    v_fmaak_f32 v14, v12, v14, 0xc0135761
    v_mul_f32 v13, v13, v72
    ds_read_b64_tr_b16 v[20:21], v7 offset:33792
    ds_read_b64_tr_b16 v[22:23], v7 offset:34048
    s_waitcnt lgkmcnt(6)
    v_mfma_f32_32x32x16_bf16 v[32:47], a[72:75], v[24:27], v[32:47]
    v_mul_f32 v14, v14, v73
    v_exp_f32 v13, v13
    v_exp_f32 v14, v14
    v_add_f32 v13, 1.0, v13
    v_add_f32 v14, 1.0, v14
    ds_read_b64_tr_b16 v[24:25], v7 offset:34816
    ds_read_b64_tr_b16 v[26:27], v7 offset:35072
    s_waitcnt lgkmcnt(6)
    v_mfma_f32_32x32x16_bf16 v[32:47], a[76:79], v[28:31], v[32:47]
    v_rcp_f32 v13, v13
    v_rcp_f32 v14, v14
    v_mul_f32 v72, v72, v13
    v_mul_f32 v73, v73, v14
    ds_read_b64_tr_b16 v[28:29], v7 offset:35840
    ds_read_b64_tr_b16 v[30:31], v7 offset:36096
    s_waitcnt lgkmcnt(6)
    v_mfma_f32_32x32x16_bf16 v[32:47], a[80:83], v[16:19], v[32:47]
    v_add_f32 v10, v10, v72
    v_fmac_f32 v11, v72, v72
    v_add_f32 v10, v10, v73
    v_fmac_f32 v11, v73, v73
    v_cvt_pk_bf16_f32 v100, v72, v73
    ds_read_b64_tr_b16 v[16:17], v7 offset:36864
    ds_read_b64_tr_b16 v[18:19], v7 offset:37120
    s_waitcnt lgkmcnt(6)
    v_mfma_f32_32x32x16_bf16 v[32:47], a[84:87], v[20:23], v[32:47]
    v_mul_f32 v13, v74, v74
    v_mul_f32 v14, v75, v75
    v_fmaak_f32 v13, v12, v13, 0xc0135761
    v_fmaak_f32 v14, v12, v14, 0xc0135761
    v_mul_f32 v13, v13, v74
    ds_read_b64_tr_b16 v[20:21], v7 offset:37888
    ds_read_b64_tr_b16 v[22:23], v7 offset:38144
    s_waitcnt lgkmcnt(6)
    v_mfma_f32_32x32x16_bf16 v[32:47], a[88:91], v[24:27], v[32:47]
    s_mov_b32 m0, 160768
    s_lshl_b32 s30, s98, 13
    s_add_u32 s30, s30, 4096
    buffer_load_dwordx4 v1, s[12:15], s30 offen lds
    v_mul_f32 v14, v14, v75
    v_exp_f32 v13, v13
    v_exp_f32 v14, v14
    v_add_f32 v13, 1.0, v13
    v_add_f32 v14, 1.0, v14
    ds_read_b64_tr_b16 v[24:25], v7 offset:38912
    ds_read_b64_tr_b16 v[26:27], v7 offset:39168
    s_waitcnt lgkmcnt(6)
    v_mfma_f32_32x32x16_bf16 v[32:47], a[92:95], v[28:31], v[32:47]
    v_rcp_f32 v13, v13
    v_rcp_f32 v14, v14
    v_mul_f32 v74, v74, v13
    v_mul_f32 v75, v75, v14
    ds_read_b64_tr_b16 v[28:29], v7 offset:39936
    ds_read_b64_tr_b16 v[30:31], v7 offset:40192
    s_waitcnt lgkmcnt(6)
    v_mfma_f32_32x32x16_bf16 v[32:47], a[96:99], v[16:19], v[32:47]
    v_add_f32 v10, v10, v74
    v_fmac_f32 v11, v74, v74
    v_add_f32 v10, v10, v75
    v_fmac_f32 v11, v75, v75
    v_cvt_pk_bf16_f32 v101, v74, v75
    ds_read_b64_tr_b16 v[16:17], v7 offset:40960
    ds_read_b64_tr_b16 v[18:19], v7 offset:41216
    s_waitcnt lgkmcnt(6)
    v_mfma_f32_32x32x16_bf16 v[32:47], a[100:103], v[20:23], v[32:47]
    v_mul_f32 v13, v76, v76
    v_mul_f32 v14, v77, v77
    v_fmaak_f32 v13, v12, v13, 0xc0135761
    v_fmaak_f32 v14, v12, v14, 0xc0135761
    v_mul_f32 v13, v13, v76
    ds_read_b64_tr_b16 v[20:21], v7 offset:41984
    ds_read_b64_tr_b16 v[22:23], v7 offset:42240
    s_waitcnt lgkmcnt(6)
    v_mfma_f32_32x32x16_bf16 v[32:47], a[104:107], v[24:27], v[32:47]
    s_mov_b32 m0, 160768
    s_lshl_b32 s30, s98, 13
    s_add_u32 s30, s30, 5120
    buffer_load_dwordx4 v1, s[12:15], s30 offen lds
    v_mul_f32 v14, v14, v77
    v_exp_f32 v13, v13
    v_exp_f32 v14, v14
    v_add_f32 v13, 1.0, v13
    v_add_f32 v14, 1.0, v14
    ds_read_b64_tr_b16 v[24:25], v7 offset:43008
    ds_read_b64_tr_b16 v[26:27], v7 offset:43264
    s_waitcnt lgkmcnt(6)
    v_mfma_f32_32x32x16_bf16 v[32:47], a[108:111], v[28:31], v[32:47]
    v_rcp_f32 v13, v13
    v_rcp_f32 v14, v14
    v_mul_f32 v76, v76, v13
    v_mul_f32 v77, v77, v14
    ds_read_b64_tr_b16 v[28:29], v7 offset:44032
    ds_read_b64_tr_b16 v[30:31], v7 offset:44288
    s_waitcnt lgkmcnt(6)
    v_mfma_f32_32x32x16_bf16 v[32:47], a[112:115], v[16:19], v[32:47]
    v_add_f32 v10, v10, v76
    v_fmac_f32 v11, v76, v76
    v_add_f32 v10, v10, v77
    v_fmac_f32 v11, v77, v77
    v_cvt_pk_bf16_f32 v102, v76, v77
    ds_read_b64_tr_b16 v[16:17], v7 offset:45056
    ds_read_b64_tr_b16 v[18:19], v7 offset:45312
    s_waitcnt lgkmcnt(6)
    v_mfma_f32_32x32x16_bf16 v[32:47], a[116:119], v[20:23], v[32:47]
    v_mul_f32 v13, v78, v78
    v_mul_f32 v14, v79, v79
    v_fmaak_f32 v13, v12, v13, 0xc0135761
    v_fmaak_f32 v14, v12, v14, 0xc0135761
    v_mul_f32 v13, v13, v78
    ds_read_b64_tr_b16 v[20:21], v7 offset:46080
    ds_read_b64_tr_b16 v[22:23], v7 offset:46336
    s_waitcnt lgkmcnt(6)
    v_mfma_f32_32x32x16_bf16 v[32:47], a[120:123], v[24:27], v[32:47]
    v_mul_f32 v14, v14, v79
    v_exp_f32 v13, v13
    v_exp_f32 v14, v14
    v_add_f32 v13, 1.0, v13
    v_add_f32 v14, 1.0, v14
    ds_read_b64_tr_b16 v[24:25], v7 offset:47104
    ds_read_b64_tr_b16 v[26:27], v7 offset:47360
    s_waitcnt lgkmcnt(6)
    v_mfma_f32_32x32x16_bf16 v[32:47], a[124:127], v[28:31], v[32:47]
    v_rcp_f32 v13, v13
    v_rcp_f32 v14, v14
    v_mul_f32 v78, v78, v13
    v_mul_f32 v79, v79, v14
    ds_read_b64_tr_b16 v[28:29], v7 offset:48128
    ds_read_b64_tr_b16 v[30:31], v7 offset:48384
    s_waitcnt lgkmcnt(6)
    v_mfma_f32_32x32x16_bf16 v[32:47], a[128:131], v[16:19], v[32:47]
    v_add_f32 v10, v10, v78
    v_fmac_f32 v11, v78, v78
    v_add_f32 v10, v10, v79
    v_fmac_f32 v11, v79, v79
    v_cvt_pk_bf16_f32 v103, v78, v79
    s_waitcnt lgkmcnt(4)
    v_mfma_f32_32x32x16_bf16 v[32:47], a[132:135], v[20:23], v[32:47]
    v_permlane32_swap_b32 v10, v11
    v_add_f32 v10, v10, v11
    v_and_b32 v13, 15, v0
    v_lshlrev_b32 v13, 4, v13
    v_bfe_u32 v14, v0, 4, 1
    s_waitcnt lgkmcnt(2)
    v_mfma_f32_32x32x16_bf16 v[32:47], a[136:139], v[24:27], v[32:47]
    v_lshl_add_u32 v13, v14, 3, v13
    v_bfe_u32 v14, v0, 5, 1
    v_lshl_add_u32 v13, v14, 2, v13
    buffer_store_dword v10, v13, s[16:19], s38 offen sc0 sc1
    s_waitcnt lgkmcnt(0)
    v_mfma_f32_32x32x16_bf16 v[32:47], a[140:143], v[28:31], v[32:47]
    s_waitcnt vmcnt(6)
    s_barrier
    ds_read_b64_tr_b16 v[16:17], v5 offset:0
    ds_read_b64_tr_b16 v[18:19], v5 offset:256
    ds_read_b64_tr_b16 v[20:21], v5 offset:1024
    ds_read_b64_tr_b16 v[22:23], v5 offset:1280
    ds_read_b64_tr_b16 v[24:25], v5 offset:2048
    ds_read_b64_tr_b16 v[26:27], v5 offset:2304
    ds_read_b64_tr_b16 v[28:29], v5 offset:3072
    ds_read_b64_tr_b16 v[30:31], v5 offset:3328
    s_waitcnt lgkmcnt(6)
    v_mfma_f32_32x32x16_bf16 v[48:63], a[0:3], v[16:19], 0
    s_cmp_eq_u32 s99, 0
    s_cbranch_scc1 L_pr13
    s_setprio 1
L_pr13:
    ds_read_b64_tr_b16 v[16:17], v5 offset:4096
    ds_read_b64_tr_b16 v[18:19], v5 offset:4352
    s_waitcnt lgkmcnt(6)
    v_mfma_f32_32x32x16_bf16 v[48:63], a[4:7], v[20:23], v[48:63]
    v_cndmask_b32 v3, 0, 1.0, s[44:45]
    v_mul_f32 v4, 0x358637bd, v3
    v_mov_b32 v15, 0xff800000
    v_cndmask_b32 v9, v15, 0, s[44:45]
    ds_read_b64_tr_b16 v[20:21], v5 offset:5120
    ds_read_b64_tr_b16 v[22:23], v5 offset:5376
    s_waitcnt lgkmcnt(6)
    v_mfma_f32_32x32x16_bf16 v[48:63], a[8:11], v[24:27], v[48:63]
    v_mov_b32 v15, 0x7f800000
    v_mul_f32 v13, 0x3fb8aa3b, v32
    v_mul_f32 v14, 0x3fb8aa3b, v33
    ds_read_b64_tr_b16 v[24:25], v5 offset:6144
    ds_read_b64_tr_b16 v[26:27], v5 offset:6400
    s_waitcnt lgkmcnt(6)
    v_mfma_f32_32x32x16_bf16 v[48:63], a[12:15], v[28:31], v[48:63]
    v_min_f32 v13, 0, v13
    v_min_f32 v14, 0, v14
    v_exp_f32 v13, v13
    ds_read_b64_tr_b16 v[28:29], v5 offset:7168
    ds_read_b64_tr_b16 v[30:31], v5 offset:7424
    s_waitcnt lgkmcnt(6)
    v_mfma_f32_32x32x16_bf16 v[48:63], a[16:19], v[16:19], v[48:63]
    s_mov_b32 m0, 160768
    s_lshl_b32 s30, s98, 13
    s_add_u32 s30, s30, 6144
    buffer_load_dwordx4 v1, s[12:15], s30 offen lds
    v_exp_f32 v14, v14
    v_med3_f32 v32, v32, v9, v15
    v_med3_f32 v33, v33, v9, v15
    ds_read_b64_tr_b16 v[16:17], v5 offset:8192
    ds_read_b64_tr_b16 v[18:19], v5 offset:8448
    s_waitcnt lgkmcnt(6)
    v_mfma_f32_32x32x16_bf16 v[48:63], a[20:23], v[20:23], v[48:63]
    v_fma_f32 v13, v13, v3, v4
    v_fma_f32 v14, v14, v3, v4
    v_add_f32 v32, v32, v13
    v_add_f32 v33, v33, v14
    ds_read_b64_tr_b16 v[20:21], v5 offset:9216
    ds_read_b64_tr_b16 v[22:23], v5 offset:9472
    s_waitcnt lgkmcnt(6)
    v_mfma_f32_32x32x16_bf16 v[48:63], a[24:27], v[24:27], v[48:63]
    v_cvt_pk_bf16_f32 v32, v32, v33
    v_mul_f32 v13, 0x3fb8aa3b, v34
    v_mul_f32 v14, 0x3fb8aa3b, v35
    ds_read_b64_tr_b16 v[24:25], v5 offset:10240
    ds_read_b64_tr_b16 v[26:27], v5 offset:10496
    s_waitcnt lgkmcnt(6)
    v_mfma_f32_32x32x16_bf16 v[48:63], a[28:31], v[28:31], v[48:63]
    v_min_f32 v13, 0, v13
    v_min_f32 v14, 0, v14
    v_exp_f32 v13, v13
    ds_read_b64_tr_b16 v[28:29], v5 offset:11264
    ds_read_b64_tr_b16 v[30:31], v5 offset:11520
    s_waitcnt lgkmcnt(6)
    v_mfma_f32_32x32x16_bf16 v[48:63], a[32:35], v[16:19], v[48:63]
    v_exp_f32 v14, v14
    v_med3_f32 v34, v34, v9, v15
    v_med3_f32 v35, v35, v9, v15
    ds_read_b64_tr_b16 v[16:17], v5 offset:12288
    ds_read_b64_tr_b16 v[18:19], v5 offset:12544
    s_waitcnt lgkmcnt(6)
    v_mfma_f32_32x32x16_bf16 v[48:63], a[36:39], v[20:23], v[48:63]
    s_mov_b32 m0, 160768
    s_lshl_b32 s30, s98, 13
    s_add_u32 s30, s30, 7168
    buffer_load_dwordx4 v1, s[12:15], s30 offen lds
    v_fma_f32 v13, v13, v3, v4
    v_fma_f32 v14, v14, v3, v4
    v_add_f32 v34, v34, v13
    ds_read_b64_tr_b16 v[20:21], v5 offset:13312
    ds_read_b64_tr_b16 v[22:23], v5 offset:13568
    s_waitcnt lgkmcnt(6)
    v_mfma_f32_32x32x16_bf16 v[48:63], a[40:43], v[24:27], v[48:63]
    v_add_f32 v35, v35, v14
    v_cvt_pk_bf16_f32 v33, v34, v35
    v_mul_f32 v13, 0x3fb8aa3b, v36
    v_mul_f32 v14, 0x3fb8aa3b, v37
    ds_read_b64_tr_b16 v[24:25], v5 offset:14336
    ds_read_b64_tr_b16 v[26:27], v5 offset:14592
    s_waitcnt lgkmcnt(6)
    v_mfma_f32_32x32x16_bf16 v[48:63], a[44:47], v[28:31], v[48:63]
    v_min_f32 v13, 0, v13
    v_min_f32 v14, 0, v14
    v_exp_f32 v13, v13
    ds_read_b64_tr_b16 v[28:29], v5 offset:15360
    ds_read_b64_tr_b16 v[30:31], v5 offset:15616
    s_waitcnt lgkmcnt(6)
    v_mfma_f32_32x32x16_bf16 v[48:63], a[48:51], v[16:19], v[48:63]
    v_exp_f32 v14, v14
    v_med3_f32 v36, v36, v9, v15
    v_med3_f32 v37, v37, v9, v15
    ds_read_b64_tr_b16 v[16:17], v5 offset:16384
    ds_read_b64_tr_b16 v[18:19], v5 offset:16640
    s_waitcnt lgkmcnt(6)
    v_mfma_f32_32x32x16_bf16 v[48:63], a[52:55], v[20:23], v[48:63]
    v_fma_f32 v13, v13, v3, v4
    v_fma_f32 v14, v14, v3, v4
    v_add_f32 v36, v36, v13
    ds_read_b64_tr_b16 v[20:21], v5 offset:17408
    ds_read_b64_tr_b16 v[22:23], v5 offset:17664
    s_waitcnt lgkmcnt(6)
    v_mfma_f32_32x32x16_bf16 v[48:63], a[56:59], v[24:27], v[48:63]
    s_mov_b32 m0, 160768
    s_mul_i32 s30, s98, 3072
    s_add_u32 s30, s30, 0
    buffer_load_dwordx4 v1, s[20:23], s30 offen lds
    v_add_f32 v37, v37, v14
    v_cvt_pk_bf16_f32 v34, v36, v37
    v_mul_f32 v13, 0x3fb8aa3b, v38
    ds_read_b64_tr_b16 v[24:25], v5 offset:18432
    ds_read_b64_tr_b16 v[26:27], v5 offset:18688
    s_waitcnt lgkmcnt(6)
    v_mfma_f32_32x32x16_bf16 v[48:63], a[60:63], v[28:31], v[48:63]
    v_mul_f32 v14, 0x3fb8aa3b, v39
    v_min_f32 v13, 0, v13
    v_min_f32 v14, 0, v14
    v_exp_f32 v13, v13
    ds_read_b64_tr_b16 v[28:29], v5 offset:19456
    ds_read_b64_tr_b16 v[30:31], v5 offset:19712
    s_waitcnt lgkmcnt(6)
    v_mfma_f32_32x32x16_bf16 v[48:63], a[64:67], v[16:19], v[48:63]
    v_exp_f32 v14, v14
    v_med3_f32 v38, v38, v9, v15
    v_med3_f32 v39, v39, v9, v15
    ds_read_b64_tr_b16 v[16:17], v5 offset:20480
    ds_read_b64_tr_b16 v[18:19], v5 offset:20736
    s_waitcnt lgkmcnt(6)
    v_mfma_f32_32x32x16_bf16 v[48:63], a[68:71], v[20:23], v[48:63]
    v_fma_f32 v13, v13, v3, v4
    v_fma_f32 v14, v14, v3, v4
    v_add_f32 v38, v38, v13
    ds_read_b64_tr_b16 v[20:21], v5 offset:21504
    ds_read_b64_tr_b16 v[22:23], v5 offset:21760
    s_waitcnt lgkmcnt(6)
    v_mfma_f32_32x32x16_bf16 v[48:63], a[72:75], v[24:27], v[48:63]
    v_add_f32 v39, v39, v14
    v_cvt_pk_bf16_f32 v35, v38, v39
    v_mul_f32 v13, 0x3fb8aa3b, v40
    ds_read_b64_tr_b16 v[24:25], v5 offset:22528
    ds_read_b64_tr_b16 v[26:27], v5 offset:22784
    s_waitcnt lgkmcnt(6)
    v_mfma_f32_32x32x16_bf16 v[48:63], a[76:79], v[28:31], v[48:63]
    v_mul_f32 v14, 0x3fb8aa3b, v41
    v_min_f32 v13, 0, v13
    v_min_f32 v14, 0, v14
    ds_read_b64_tr_b16 v[28:29], v5 offset:23552
    ds_read_b64_tr_b16 v[30:31], v5 offset:23808
    s_waitcnt lgkmcnt(6)
    v_mfma_f32_32x32x16_bf16 v[48:63], a[80:83], v[16:19], v[48:63]
    s_mov_b32 m0, 160768
    s_mul_i32 s30, s98, 3072
    s_add_u32 s30, s30, 1024
    buffer_load_dwordx4 v1, s[20:23], s30 offen lds
    v_exp_f32 v13, v13
    v_exp_f32 v14, v14
    v_med3_f32 v40, v40, v9, v15
    v_med3_f32 v41, v41, v9, v15
    ds_read_b64_tr_b16 v[16:17], v5 offset:24576
    ds_read_b64_tr_b16 v[18:19], v5 offset:24832
    s_waitcnt lgkmcnt(6)
    v_mfma_f32_32x32x16_bf16 v[48:63], a[84:87], v[20:23], v[48:63]
    v_fma_f32 v13, v13, v3, v4
    v_fma_f32 v14, v14, v3, v4
    v_add_f32 v40, v40, v13
    ds_read_b64_tr_b16 v[20:21], v5 offset:25600
    ds_read_b64_tr_b16 v[22:23], v5 offset:25856
    s_waitcnt lgkmcnt(6)
    v_mfma_f32_32x32x16_bf16 v[48:63], a[88:91], v[24:27], v[48:63]
    v_add_f32 v41, v41, v14
    v_cvt_pk_bf16_f32 v36, v40, v41
    v_mul_f32 v13, 0x3fb8aa3b, v42
    ds_read_b64_tr_b16 v[24:25], v5 offset:26624
    ds_read_b64_tr_b16 v[26:27], v5 offset:26880
    s_waitcnt lgkmcnt(6)
    v_mfma_f32_32x32x16_bf16 v[48:63], a[92:95], v[28:31], v[48:63]
    v_mul_f32 v14, 0x3fb8aa3b, v43
    v_min_f32 v13, 0, v13
    v_min_f32 v14, 0, v14
    ds_read_b64_tr_b16 v[28:29], v5 offset:27648
    ds_read_b64_tr_b16 v[30:31], v5 offset:27904
    s_waitcnt lgkmcnt(6)
    v_mfma_f32_32x32x16_bf16 v[48:63], a[96:99], v[16:19], v[48:63]
    v_exp_f32 v13, v13
    v_exp_f32 v14, v14
    v_med3_f32 v42, v42, v9, v15
    ds_read_b64_tr_b16 v[16:17], v5 offset:28672
    ds_read_b64_tr_b16 v[18:19], v5 offset:28928
    s_waitcnt lgkmcnt(6)
    v_mfma_f32_32x32x16_bf16 v[48:63], a[100:103], v[20:23], v[48:63]
    s_mov_b32 m0, 160768
    s_mul_i32 s30, s98, 3072
    s_add_u32 s30, s30, 2048
    buffer_load_dwordx4 v1, s[20:23], s30 offen lds
    v_med3_f32 v43, v43, v9, v15
    v_fma_f32 v13, v13, v3, v4
    v_fma_f32 v14, v14, v3, v4
    v_add_f32 v42, v42, v13
    ds_read_b64_tr_b16 v[20:21], v5 offset:29696
    ds_read_b64_tr_b16 v[22:23], v5 offset:29952
    s_waitcnt lgkmcnt(6)
    v_mfma_f32_32x32x16_bf16 v[48:63], a[104:107], v[24:27], v[48:63]
    v_add_f32 v43, v43, v14
    v_cvt_pk_bf16_f32 v37, v42, v43
    v_mul_f32 v13, 0x3fb8aa3b, v44
    ds_read_b64_tr_b16 v[24:25], v5 offset:30720
    ds_read_b64_tr_b16 v[26:27], v5 offset:30976
    s_waitcnt lgkmcnt(6)
    v_mfma_f32_32x32x16_bf16 v[48:63], a[108:111], v[28:31], v[48:63]
    v_mul_f32 v14, 0x3fb8aa3b, v45
    v_min_f32 v13, 0, v13
    v_min_f32 v14, 0, v14
    ds_read_b64_tr_b16 v[28:29], v5 offset:31744
    ds_read_b64_tr_b16 v[30:31], v5 offset:32000
    s_waitcnt lgkmcnt(6)
    v_mfma_f32_32x32x16_bf16 v[48:63], a[112:115], v[16:19], v[48:63]
    v_exp_f32 v13, v13
    v_exp_f32 v14, v14
    v_med3_f32 v44, v44, v9, v15
    ds_read_b64_tr_b16 v[16:17], v5 offset:32768
    ds_read_b64_tr_b16 v[18:19], v5 offset:33024
    s_waitcnt lgkmcnt(6)
    v_mfma_f32_32x32x16_bf16 v[48:63], a[116:119], v[20:23], v[48:63]
    v_med3_f32 v45, v45, v9, v15
    v_fma_f32 v13, v13, v3, v4
    v_fma_f32 v14, v14, v3, v4
    ds_read_b64_tr_b16 v[20:21], v5 offset:33792
    ds_read_b64_tr_b16 v[22:23], v5 offset:34048
    s_waitcnt lgkmcnt(6)
    v_mfma_f32_32x32x16_bf16 v[48:63], a[120:123], v[24:27], v[48:63]
    v_add_f32 v44, v44, v13
    v_add_f32 v45, v45, v14
    v_cvt_pk_bf16_f32 v38, v44, v45
    v_mul_f32 v13, 0x3fb8aa3b, v46
    ds_read_b64_tr_b16 v[24:25], v5 offset:34816
    ds_read_b64_tr_b16 v[26:27], v5 offset:35072
    s_waitcnt lgkmcnt(6)
    v_mfma_f32_32x32x16_bf16 v[48:63], a[124:127], v[28:31], v[48:63]
    v_mul_f32 v14, 0x3fb8aa3b, v47
    v_min_f32 v13, 0, v13
    v_min_f32 v14, 0, v14
    ds_read_b64_tr_b16 v[28:29], v5 offset:35840
    ds_read_b64_tr_b16 v[30:31], v5 offset:36096
    s_waitcnt lgkmcnt(6)
    v_mfma_f32_32x32x16_bf16 v[48:63], a[128:131], v[16:19], v[48:63]
    v_exp_f32 v13, v13
    v_exp_f32 v14, v14
    v_med3_f32 v46, v46, v9, v15
    ds_read_b64_tr_b16 v[16:17], v5 offset:36864
    ds_read_b64_tr_b16 v[18:19], v5 offset:37120
    s_waitcnt lgkmcnt(6)
    v_mfma_f32_32x32x16_bf16 v[48:63], a[132:135], v[20:23], v[48:63]
    v_med3_f32 v47, v47, v9, v15
    v_fma_f32 v13, v13, v3, v4
    v_fma_f32 v14, v14, v3, v4
    ds_read_b64_tr_b16 v[20:21], v5 offset:37888
    ds_read_b64_tr_b16 v[22:23], v5 offset:38144
    s_waitcnt lgkmcnt(6)
    v_mfma_f32_32x32x16_bf16 v[48:63], a[136:139], v[24:27], v[48:63]
    v_add_f32 v46, v46, v13
    v_add_f32 v47, v47, v14
    v_cvt_pk_bf16_f32 v39, v46, v47
    ds_read_b64_tr_b16 v[24:25], v5 offset:38912
    ds_read_b64_tr_b16 v[26:27], v5 offset:39168
    s_waitcnt lgkmcnt(6)
    v_mfma_f32_32x32x16_bf16 v[48:63], a[140:143], v[28:31], v[48:63]
    ds_read_b64_tr_b16 v[28:29], v5 offset:39936
    ds_read_b64_tr_b16 v[30:31], v5 offset:40192
    s_waitcnt lgkmcnt(6)
    v_mfma_f32_32x32x16_bf16 v[64:79], v[16:19], a[0:3], 0
    s_cmp_eq_u32 s99, 0
    s_cbranch_scc1 L_pr14
    s_setprio 0
L_pr14:
    ds_read_b64_tr_b16 v[16:17], v5 offset:40960
    ds_read_b64_tr_b16 v[18:19], v5 offset:41216
    s_waitcnt lgkmcnt(6)
    v_mfma_f32_32x32x16_bf16 v[64:79], v[20:23], a[4:7], v[64:79]
    v_and_b32 v13, 31, v0
    v_lshrrev_b32 v14, 5, v0
    v_mul_u32_u24 v105, 80, v13
    v_lshl_add_u32 v105, v14, 4, v105
    v_add_u32 v105, s37, v105
    ds_read_b64_tr_b16 v[20:21], v5 offset:41984
    ds_read_b64_tr_b16 v[22:23], v5 offset:42240
    s_waitcnt lgkmcnt(6)
    v_mfma_f32_32x32x16_bf16 v[64:79], v[24:27], a[8:11], v[64:79]
    v_subrev_u32 v104, 2560, v105
    v_subrev_u32 v13, 6, v13
    v_lshlrev_b32 v106, 12, v13
    v_lshl_add_u32 v106, v14, 4, v106
    ds_read_b64_tr_b16 v[24:25], v5 offset:43008
    ds_read_b64_tr_b16 v[26:27], v5 offset:43264
    s_waitcnt lgkmcnt(6)
    v_mfma_f32_32x32x16_bf16 v[64:79], v[28:31], a[12:15], v[64:79]
    v_cndmask_b32 v3, 0, 1.0, s[46:47]
    v_mul_f32 v4, 0x358637bd, v3
    v_mov_b32 v15, 0xff800000
    v_cndmask_b32 v9, v15, 0, s[46:47]
    ds_read_b64_tr_b16 v[28:29], v5 offset:44032
    ds_read_b64_tr_b16 v[30:31], v5 offset:44288
    s_waitcnt lgkmcnt(6)
    v_mfma_f32_32x32x16_bf16 v[64:79], v[16:19], a[16:19], v[64:79]
    v_mov_b32 v15, 0x7f800000
    v_cndmask_b32 v9, v9, 1.0, s[48:49]
    v_cndmask_b32 v15, v15, 1.0, s[48:49]
    v_mul_f32 v13, 0x3fb8aa3b, v48
    ds_read_b64_tr_b16 v[16:17], v5 offset:45056
    ds_read_b64_tr_b16 v[18:19], v5 offset:45312
    s_waitcnt lgkmcnt(6)
    v_mfma_f32_32x32x16_bf16 v[64:79], v[20:23], a[20:23], v[64:79]
    v_mul_f32 v14, 0x3fb8aa3b, v49
    v_min_f32 v13, 0, v13
    v_min_f32 v14, 0, v14
    v_exp_f32 v13, v13
    ds_read_b64_tr_b16 v[20:21], v5 offset:46080
    ds_read_b64_tr_b16 v[22:23], v5 offset:46336
    s_waitcnt lgkmcnt(6)
    v_mfma_f32_32x32x16_bf16 v[64:79], v[24:27], a[24:27], v[64:79]
    v_exp_f32 v14, v14
    v_med3_f32 v48, v48, v9, v15
    v_med3_f32 v49, v49, v9, v15
    v_fma_f32 v13, v13, v3, v4
    v_fma_f32 v14, v14, v3, v4
    ds_read_b64_tr_b16 v[24:25], v5 offset:47104
    ds_read_b64_tr_b16 v[26:27], v5 offset:47360
    s_waitcnt lgkmcnt(6)
    v_mfma_f32_32x32x16_bf16 v[64:79], v[28:31], a[28:31], v[64:79]
    v_add_f32 v48, v48, v13
    v_add_f32 v49, v49, v14
    v_cvt_pk_bf16_f32 v40, v48, v49
    v_mul_f32 v13, 0x3fb8aa3b, v50
    ds_read_b64_tr_b16 v[28:29], v5 offset:48128
    ds_read_b64_tr_b16 v[30:31], v5 offset:48384
    s_waitcnt lgkmcnt(6)
    v_mfma_f32_32x32x16_bf16 v[64:79], v[16:19], a[32:35], v[64:79]
    v_mul_f32 v14, 0x3fb8aa3b, v51
    v_min_f32 v13, 0, v13
    v_min_f32 v14, 0, v14
    v_exp_f32 v13, v13
    ds_read_b64_tr_b16 v[16:17], v6 offset:0
    ds_read_b64_tr_b16 v[18:19], v6 offset:256
    s_waitcnt lgkmcnt(6)
    v_mfma_f32_32x32x16_bf16 v[64:79], v[20:23], a[36:39], v[64:79]
    v_exp_f32 v14, v14
    v_med3_f32 v50, v50, v9, v15
    v_med3_f32 v51, v51, v9, v15
    v_fma_f32 v13, v13, v3, v4
    ds_read_b64_tr_b16 v[20:21], v6 offset:1024
    ds_read_b64_tr_b16 v[22:23], v6 offset:1280
    s_waitcnt lgkmcnt(6)
    v_mfma_f32_32x32x16_bf16 v[64:79], v[24:27], a[40:43], v[64:79]
    v_fma_f32 v14, v14, v3, v4
    v_add_f32 v50, v50, v13
    v_add_f32 v51, v51, v14
    v_cvt_pk_bf16_f32 v41, v50, v51
    ds_read_b64_tr_b16 v[24:25], v6 offset:2048
    ds_read_b64_tr_b16 v[26:27], v6 offset:2304
    s_waitcnt lgkmcnt(6)
    v_mfma_f32_32x32x16_bf16 v[64:79], v[28:31], a[44:47], v[64:79]
    v_mul_f32 v13, 0x3fb8aa3b, v52
    v_mul_f32 v14, 0x3fb8aa3b, v53
    v_min_f32 v13, 0, v13
    v_min_f32 v14, 0, v14
    ds_read_b64_tr_b16 v[28:29], v6 offset:3072
    ds_read_b64_tr_b16 v[30:31], v6 offset:3328
    s_waitcnt lgkmcnt(6)
    v_mfma_f32_32x32x16_bf16 v[64:79], v[16:19], a[48:51], v[64:79]
    v_exp_f32 v13, v13
    v_exp_f32 v14, v14
    v_med3_f32 v52, v52, v9, v15
    v_med3_f32 v53, v53, v9, v15
    v_fma_f32 v13, v13, v3, v4
    ds_read_b64_tr_b16 v[16:17], v6 offset:4096
    ds_read_b64_tr_b16 v[18:19], v6 offset:4352
    s_waitcnt lgkmcnt(6)
    v_mfma_f32_32x32x16_bf16 v[64:79], v[20:23], a[52:55], v[64:79]
    v_fma_f32 v14, v14, v3, v4
    v_add_f32 v52, v52, v13
    v_add_f32 v53, v53, v14
    v_cvt_pk_bf16_f32 v42, v52, v53
    ds_read_b64_tr_b16 v[20:21], v6 offset:5120
    ds_read_b64_tr_b16 v[22:23], v6 offset:5376
    s_waitcnt lgkmcnt(6)
    v_mfma_f32_32x32x16_bf16 v[64:79], v[24:27], a[56:59], v[64:79]
    v_mul_f32 v13, 0x3fb8aa3b, v54
    v_mul_f32 v14, 0x3fb8aa3b, v55
    v_min_f32 v13, 0, v13
    v_min_f32 v14, 0, v14
    ds_read_b64_tr_b16 v[24:25], v6 offset:6144
    ds_read_b64_tr_b16 v[26:27], v6 offset:6400
    s_waitcnt lgkmcnt(6)
    v_mfma_f32_32x32x16_bf16 v[64:79], v[28:31], a[60:63], v[64:79]
    v_exp_f32 v13, v13
    v_exp_f32 v14, v14
    v_med3_f32 v54, v54, v9, v15
    v_med3_f32 v55, v55, v9, v15
    ds_read_b64_tr_b16 v[28:29], v6 offset:7168
    ds_read_b64_tr_b16 v[30:31], v6 offset:7424
    s_waitcnt lgkmcnt(6)
    v_mfma_f32_32x32x16_bf16 v[64:79], v[16:19], a[64:67], v[64:79]
    v_fma_f32 v13, v13, v3, v4
    v_fma_f32 v14, v14, v3, v4
    v_add_f32 v54, v54, v13
    v_add_f32 v55, v55, v14
    ds_read_b64_tr_b16 v[16:17], v6 offset:8192
    ds_read_b64_tr_b16 v[18:19], v6 offset:8448
    s_waitcnt lgkmcnt(6)
    v_mfma_f32_32x32x16_bf16 v[64:79], v[20:23], a[68:71], v[64:79]
    v_cvt_pk_bf16_f32 v43, v54, v55
    v_mul_f32 v13, 0x3fb8aa3b, v56
    v_mul_f32 v14, 0x3fb8aa3b, v57
    v_min_f32 v13, 0, v13
    ds_read_b64_tr_b16 v[20:21], v6 offset:9216
    ds_read_b64_tr_b16 v[22:23], v6 offset:9472
    s_waitcnt lgkmcnt(6)
    v_mfma_f32_32x32x16_bf16 v[64:79], v[24:27], a[72:75], v[64:79]
    v_min_f32 v14, 0, v14
    v_exp_f32 v13, v13
    v_exp_f32 v14, v14
    v_med3_f32 v56, v56, v9, v15
    v_med3_f32 v57, v57, v9, v15
    ds_read_b64_tr_b16 v[24:25], v6 offset:10240
    ds_read_b64_tr_b16 v[26:27], v6 offset:10496
    s_waitcnt lgkmcnt(6)
    v_mfma_f32_32x32x16_bf16 v[64:79], v[28:31], a[76:79], v[64:79]
    v_fma_f32 v13, v13, v3, v4
    v_fma_f32 v14, v14, v3, v4
    v_add_f32 v56, v56, v13
    v_add_f32 v57, v57, v14
    ds_read_b64_tr_b16 v[28:29], v6 offset:11264
    ds_read_b64_tr_b16 v[30:31], v6 offset:11520
    s_waitcnt lgkmcnt(6)
    v_mfma_f32_32x32x16_bf16 v[64:79], v[16:19], a[80:83], v[64:79]
    v_cvt_pk_bf16_f32 v44, v56, v57
    v_mul_f32 v13, 0x3fb8aa3b, v58
    v_mul_f32 v14, 0x3fb8aa3b, v59
    v_min_f32 v13, 0, v13
    ds_read_b64_tr_b16 v[16:17], v6 offset:12288
    ds_read_b64_tr_b16 v[18:19], v6 offset:12544
    s_waitcnt lgkmcnt(6)
    v_mfma_f32_32x32x16_bf16 v[64:79], v[20:23], a[84:87], v[64:79]
    v_min_f32 v14, 0, v14
    v_exp_f32 v13, v13
    v_exp_f32 v14, v14
    v_med3_f32 v58, v58, v9, v15
    ds_read_b64_tr_b16 v[20:21], v6 offset:13312
    ds_read_b64_tr_b16 v[22:23], v6 offset:13568
    s_waitcnt lgkmcnt(6)
    v_mfma_f32_32x32x16_bf16 v[64:79], v[24:27], a[88:91], v[64:79]
    v_med3_f32 v59, v59, v9, v15
    v_fma_f32 v13, v13, v3, v4
    v_fma_f32 v14, v14, v3, v4
    v_add_f32 v58, v58, v13
    ds_read_b64_tr_b16 v[24:25], v6 offset:14336
    ds_read_b64_tr_b16 v[26:27], v6 offset:14592
    s_waitcnt lgkmcnt(6)
    v_mfma_f32_32x32x16_bf16 v[64:79], v[28:31], a[92:95], v[64:79]
    v_add_f32 v59, v59, v14
    v_cvt_pk_bf16_f32 v45, v58, v59
    v_mul_f32 v13, 0x3fb8aa3b, v60
    v_mul_f32 v14, 0x3fb8aa3b, v61
    v_min_f32 v13, 0, v13
    ds_read_b64_tr_b16 v[28:29], v6 offset:15360
    ds_read_b64_tr_b16 v[30:31], v6 offset:15616
    s_waitcnt lgkmcnt(6)
    v_mfma_f32_32x32x16_bf16 v[64:79], v[16:19], a[96:99], v[64:79]
    v_min_f32 v14, 0, v14
    v_exp_f32 v13, v13
    v_exp_f32 v14, v14
    v_med3_f32 v60, v60, v9, v15
    ds_read_b64_tr_b16 v[16:17], v6 offset:16384
    ds_read_b64_tr_b16 v[18:19], v6 offset:16640
    s_waitcnt lgkmcnt(6)
    v_mfma_f32_32x32x16_bf16 v[64:79], v[20:23], a[100:103], v[64:79]
    v_med3_f32 v61, v61, v9, v15
    v_fma_f32 v13, v13, v3, v4
    v_fma_f32 v14, v14, v3, v4
    v_add_f32 v60, v60, v13
    ds_read_b64_tr_b16 v[20:21], v6 offset:17408
    ds_read_b64_tr_b16 v[22:23], v6 offset:17664
    s_waitcnt lgkmcnt(6)
    v_mfma_f32_32x32x16_bf16 v[64:79], v[24:27], a[104:107], v[64:79]
    v_add_f32 v61, v61, v14
    v_cvt_pk_bf16_f32 v46, v60, v61
    v_mul_f32 v13, 0x3fb8aa3b, v62
    v_mul_f32 v14, 0x3fb8aa3b, v63
    ds_read_b64_tr_b16 v[24:25], v6 offset:18432
    ds_read_b64_tr_b16 v[26:27], v6 offset:18688
    s_waitcnt lgkmcnt(6)
    v_mfma_f32_32x32x16_bf16 v[64:79], v[28:31], a[108:111], v[64:79]
    v_min_f32 v13, 0, v13
    v_min_f32 v14, 0, v14
    v_exp_f32 v13, v13
    v_exp_f32 v14, v14
    ds_read_b64_tr_b16 v[28:29], v6 offset:19456
    ds_read_b64_tr_b16 v[30:31], v6 offset:19712
    s_waitcnt lgkmcnt(6)
    v_mfma_f32_32x32x16_bf16 v[64:79], v[16:19], a[112:115], v[64:79]
    v_med3_f32 v62, v62, v9, v15
    v_med3_f32 v63, v63, v9, v15
    v_fma_f32 v13, v13, v3, v4
    v_fma_f32 v14, v14, v3, v4
    ds_read_b64_tr_b16 v[16:17], v6 offset:20480
    ds_read_b64_tr_b16 v[18:19], v6 offset:20736
    s_waitcnt lgkmcnt(6)
    v_mfma_f32_32x32x16_bf16 v[64:79], v[20:23], a[116:119], v[64:79]
    v_add_f32 v62, v62, v13
    v_add_f32 v63, v63, v14
    v_cvt_pk_bf16_f32 v47, v62, v63
    v_mfma_f32_32x32x16_bf16 v[48:63], v[32:35], v[32:35], 0
    v_mfma_f32_32x32x16_bf16 v[48:63], v[36:39], v[36:39], v[48:63]
    ds_read_b64_tr_b16 v[20:21], v6 offset:21504
    ds_read_b64_tr_b16 v[22:23], v6 offset:21760
    s_waitcnt lgkmcnt(6)
    v_mfma_f32_32x32x16_bf16 v[64:79], v[24:27], a[120:123], v[64:79]
    s_mov_b32 exec_lo, 0xfffc0000
    s_mov_b32 exec_hi, 0xfffc0000
    s_nop 5
    ds_write_b128 v104, v[48:51]
    ds_write_b128 v104, v[52:55] offset:32
    s_mov_b32 exec_hi, 0
    ds_write_b128 v104, v[56:59] offset:64
    s_mov_b64 exec, -1
    s_waitcnt lgkmcnt(0)
    v_mfma_f32_32x32x16_bf16 v[48:63], v[32:35], v[40:43], 0
    v_mfma_f32_32x32x16_bf16 v[48:63], v[36:39], v[44:47], v[48:63]
    ds_read_b64_tr_b16 v[24:25], v6 offset:22528
    ds_read_b64_tr_b16 v[26:27], v6 offset:22784
    v_mfma_f32_32x32x16_bf16 v[64:79], v[28:31], a[124:127], v[64:79]
    v_permlane32_swap_b32 v40, v42
    v_permlane32_swap_b32 v41, v43
    v_permlane32_swap_b32 v44, v46
    v_permlane32_swap_b32 v45, v47
    ds_read_b64_tr_b16 v[28:29], v6 offset:23552
    ds_read_b64_tr_b16 v[30:31], v6 offset:23808
    v_mfma_f32_32x32x16_bf16 v[64:79], v[16:19], a[128:131], v[64:79]
    s_mov_b32 exec_lo, 0x00ffffc0
    s_mov_b32 exec_hi, 0x00ffffc0
    buffer_store_dwordx4 v[40:43], v106, s[16:19], s36 offen
    buffer_store_dwordx4 v[44:47], v106, s[16:19], s36 offen offset:32
    s_mov_b64 exec, -1
    s_mov_b32 exec_lo, 0x0000001f
    s_mov_b32 exec_hi, 0x0000001f
    ds_write_b128 v105, v[48:51]
    ds_write_b128 v105, v[52:55] offset:32
    s_mov_b32 exec_hi, 0
    ds_write_b128 v105, v[56:59] offset:64
    s_mov_b64 exec, -1
    s_waitcnt lgkmcnt(0)
    s_add_u32 s29, s41, 4096
    v_mfma_f32_32x32x16_bf16 v[64:79], v[20:23], a[132:135], v[64:79]
    buffer_load_dwordx4 v[32:35], v1, s[16:19], s41 offen offset:0 sc1
    buffer_load_dwordx4 v[36:39], v1, s[16:19], s41 offen offset:1024 sc1
    buffer_load_dwordx4 v[40:43], v1, s[16:19], s41 offen offset:2048 sc1
    buffer_load_dwordx4 v[44:47], v1, s[16:19], s41 offen offset:3072 sc1
    v_mfma_f32_32x32x16_bf16 v[64:79], v[24:27], a[136:139], v[64:79]
    buffer_load_dwordx4 v[48:51], v1, s[16:19], s29 offen offset:0 sc1
    buffer_load_dwordx4 v[52:55], v1, s[16:19], s29 offen offset:1024 sc1
    buffer_load_dwordx4 v[56:59], v1, s[16:19], s29 offen offset:2048 sc1
    buffer_load_dwordx4 v[60:63], v1, s[16:19], s29 offen offset:3072 sc1
    v_mfma_f32_32x32x16_bf16 v[64:79], v[28:31], a[140:143], v[64:79]
    s_nop 7
    s_nop 3
    v_mul_f32 v13, v64, v64
    v_mul_f32 v14, v65, v65
    v_fmaak_f32 v13, v12, v13, 0xc0135761
    v_fmaak_f32 v14, v12, v14, 0xc0135761
    v_mul_f32 v13, v13, v64
    v_mul_f32 v14, v14, v65
    v_exp_f32 v13, v13
    v_exp_f32 v14, v14
    v_add_f32 v13, 1.0, v13
    v_add_f32 v14, 1.0, v14
    v_rcp_f32 v13, v13
    v_rcp_f32 v14, v14
    v_mul_f32 v64, v64, v13
    v_mul_f32 v65, v65, v14
    v_cvt_pk_bf16_f32 v64, v64, v65
    v_mul_f32 v13, v66, v66
    v_mul_f32 v14, v67, v67
    v_fmaak_f32 v13, v12, v13, 0xc0135761
    v_fmaak_f32 v14, v12, v14, 0xc0135761
    v_mul_f32 v13, v13, v66
    v_mul_f32 v14, v14, v67
    v_exp_f32 v13, v13
    v_exp_f32 v14, v14
    v_add_f32 v13, 1.0, v13
    v_add_f32 v14, 1.0, v14
    v_rcp_f32 v13, v13
    v_rcp_f32 v14, v14
    v_mul_f32 v66, v66, v13
    v_mul_f32 v67, v67, v14
    v_cvt_pk_bf16_f32 v65, v66, v67
    v_mul_f32 v13, v72, v72
    v_mul_f32 v14, v73, v73
    v_fmaak_f32 v13, v12, v13, 0xc0135761
    v_fmaak_f32 v14, v12, v14, 0xc0135761
    v_mul_f32 v13, v13, v72
    v_mul_f32 v14, v14, v73
    v_exp_f32 v13, v13
    v_exp_f32 v14, v14
    v_add_f32 v13, 1.0, v13
    v_add_f32 v14, 1.0, v14
    v_rcp_f32 v13, v13
    v_rcp_f32 v14, v14
    v_mul_f32 v72, v72, v13
    v_mul_f32 v73, v73, v14
    v_cvt_pk_bf16_f32 v66, v72, v73
    v_mul_f32 v13, v74, v74
    v_mul_f32 v14, v75, v75
    v_fmaak_f32 v13, v12, v13, 0xc0135761
    v_fmaak_f32 v14, v12, v14, 0xc0135761
    v_mul_f32 v13, v13, v74
    v_mul_f32 v14, v14, v75
    v_exp_f32 v13, v13
    v_exp_f32 v14, v14
    v_add_f32 v13, 1.0, v13
    v_add_f32 v14, 1.0, v14
    v_rcp_f32 v13, v13
    v_rcp_f32 v14, v14
    v_mul_f32 v74, v74, v13
    v_mul_f32 v75, v75, v14
    v_cvt_pk_bf16_f32 v67, v74, v75
    buffer_store_dwordx4 v[64:67], v8, s[16:19], s52 offen offset:0 sc0 sc1
    v_mul_f32 v13, v68, v68
    v_mul_f32 v14, v69, v69
    v_fmaak_f32 v13, v12, v13, 0xc0135761
    v_fmaak_f32 v14, v12, v14, 0xc0135761
    v_mul_f32 v13, v13, v68
    v_mul_f32 v14, v14, v69
    v_exp_f32 v13, v13
    v_exp_f32 v14, v14
    v_add_f32 v13, 1.0, v13
    v_add_f32 v14, 1.0, v14
    v_rcp_f32 v13, v13
    v_rcp_f32 v14, v14
    v_mul_f32 v68, v68, v13
    v_mul_f32 v69, v69, v14
    v_cvt_pk_bf16_f32 v68, v68, v69
    v_mul_f32 v13, v70, v70
    v_mul_f32 v14, v71, v71
    v_fmaak_f32 v13, v12, v13, 0xc0135761
    v_fmaak_f32 v14, v12, v14, 0xc0135761
    v_mul_f32 v13, v13, v70
    v_mul_f32 v14, v14, v71
    v_exp_f32 v13, v13
    v_exp_f32 v14, v14
    v_add_f32 v13, 1.0, v13
    v_add_f32 v14, 1.0, v14
    v_rcp_f32 v13, v13
    v_rcp_f32 v14, v14
    v_mul_f32 v70, v70, v13
    v_mul_f32 v71, v71, v14
    v_cvt_pk_bf16_f32 v69, v70, v71
    v_mul_f32 v13, v76, v76
    v_mul_f32 v14, v77, v77
    v_fmaak_f32 v13, v12, v13, 0xc0135761
    v_fmaak_f32 v14, v12, v14, 0xc0135761
    v_mul_f32 v13, v13, v76
    v_mul_f32 v14, v14, v77
    v_exp_f32 v13, v13
    v_exp_f32 v14, v14
    v_add_f32 v13, 1.0, v13
    v_add_f32 v14, 1.0, v14
    v_rcp_f32 v13, v13
    v_rcp_f32 v14, v14
    v_mul_f32 v76, v76, v13
    v_mul_f32 v77, v77, v14
    v_cvt_pk_bf16_f32 v70, v76, v77
    v_mul_f32 v13, v78, v78
    v_mul_f32 v14, v79, v79
    v_fmaak_f32 v13, v12, v13, 0xc0135761
    v_fmaak_f32 v14, v12, v14, 0xc0135761
    v_mul_f32 v13, v13, v78
    v_mul_f32 v14, v14, v79
    v_exp_f32 v13, v13
    v_exp_f32 v14, v14
    v_add_f32 v13, 1.0, v13
    v_add_f32 v14, 1.0, v14
    v_rcp_f32 v13, v13
    v_rcp_f32 v14, v14
    v_mul_f32 v78, v78, v13
    v_mul_f32 v79, v79, v14
    v_cvt_pk_bf16_f32 v71, v78, v79
    buffer_store_dwordx4 v[68:71], v8, s[16:19], s52 offen offset:512 sc0 sc1
    s_waitcnt vmcnt(6)
    v_add_f32 v108, v32, v36
    v_add_f32 v108, v108, v40
    v_add_f32 v108, v108, v44
    v_add_f32 v109, v33, v37
    v_add_f32 v109, v109, v41
    v_add_f32 v109, v109, v45
    v_add_f32 v110, v34, v38
    v_add_f32 v110, v110, v42
    v_add_f32 v110, v110, v46
    v_add_f32 v111, v35, v39
    v_add_f32 v111, v111, v43
    v_add_f32 v111, v111, v47
    s_waitcnt vmcnt(2)
    v_add_f32 v108, v108, v48
    v_add_f32 v108, v108, v52
    v_add_f32 v108, v108, v56
    v_add_f32 v108, v108, v60
    v_add_f32 v109, v109, v49
    v_add_f32 v109, v109, v53
    v_add_f32 v109, v109, v57
    v_add_f32 v109, v109, v61
    v_add_f32 v110, v110, v50
    v_add_f32 v110, v110, v54
    v_add_f32 v110, v110, v58
    v_add_f32 v110, v110, v62
    v_add_f32 v111, v111, v51
    v_add_f32 v111, v111, v55
    v_add_f32 v111, v111, v59
    v_add_f32 v111, v111, v63
    v_permlane32_swap_b32 v108, v109
    s_nop 0
    v_permlane32_swap_b32 v110, v111
    v_add_f32 v108, v108, v109
    v_add_f32 v110, v110, v111
    s_nop 1
    v_permlane16_swap_b32 v108, v110
    v_add_f32 v10, v108, v110
    v_cmp_u_f32 vcc, v10, v10
    s_cbranch_vccz L_gemm1_kernel_A_go
    s_mov_b32 s59, 0
L_gemm1_kernel_A_poll:
    buffer_load_dwordx4 v[32:35], v1, s[16:19], s41 offen offset:0 sc1
    buffer_load_dwordx4 v[36:39], v1, s[16:19], s41 offen offset:1024 sc1
    buffer_load_dwordx4 v[40:43], v1, s[16:19], s41 offen offset:2048 sc1
    buffer_load_dwordx4 v[44:47], v1, s[16:19], s41 offen offset:3072 sc1
    s_waitcnt vmcnt(0)
    v_add_f32 v108, v32, v36
    v_add_f32 v108, v108, v40
    v_add_f32 v108, v108, v44
    v_add_f32 v109, v33, v37
    v_add_f32 v109, v109, v41
    v_add_f32 v109, v109, v45
    v_add_f32 v110, v34, v38
    v_add_f32 v110, v110, v42
    v_add_f32 v110, v110, v46
    v_add_f32 v111, v35, v39
    v_add_f32 v111, v111, v43
    v_add_f32 v111, v111, v47
    buffer_load_dwordx4 v[32:35], v1, s[16:19], s29 offen offset:0 sc1
    buffer_load_dwordx4 v[36:39], v1, s[16:19], s29 offen offset:1024 sc1
    buffer_load_dwordx4 v[40:43], v1, s[16:19], s29 offen offset:2048 sc1
    buffer_load_dwordx4 v[44:47], v1, s[16:19], s29 offen offset:3072 sc1
    s_waitcnt vmcnt(0)
    v_add_f32 v108, v108, v32
    v_add_f32 v108, v108, v36
    v_add_f32 v108, v108, v40
    v_add_f32 v108, v108, v44
    v_add_f32 v109, v109, v33
    v_add_f32 v109, v109, v37
    v_add_f32 v109, v109, v41
    v_add_f32 v109, v109, v45
    v_add_f32 v110, v110, v34
    v_add_f32 v110, v110, v38
    v_add_f32 v110, v110, v42
    v_add_f32 v110, v110, v46
    v_add_f32 v111, v111, v35
    v_add_f32 v111, v111, v39
    v_add_f32 v111, v111, v43
    v_add_f32 v111, v111, v47
    v_permlane32_swap_b32 v108, v109
    s_nop 0
    v_permlane32_swap_b32 v110, v111
    v_add_f32 v108, v108, v109
    v_add_f32 v110, v110, v111
    s_nop 1
    v_permlane16_swap_b32 v108, v110
    v_add_f32 v10, v108, v110
    v_cmp_u_f32 vcc, v10, v10
    s_cbranch_vccz L_gemm1_kernel_A_go
    s_sleep 4
    s_add_u32 s59, s59, 1
    s_cmp_lt_u32 s59, 0x40000
    s_cbranch_scc1 L_gemm1_kernel_A_poll
L_gemm1_kernel_A_go:
    v_mov_b32 v11, v10
    s_nop 1
    v_permlane32_swap_b32 v10, v11
    v_mul_f32 v10, 0x39e38e39, v10
    v_mul_f32 v11, 0x39e38e39, v11
    v_fma_f32 v11, -v10, v10, v11
    v_max_f32 v11, 0, v11
    v_cvt_pk_bf16_f32 v13, v10, v11
    v_lshlrev_b32 v10, 16, v13
    v_and_b32 v11, 0xffff0000, v13
    v_add_f32 v11, 0x3727c5ac, v11
    v_cvt_pk_bf16_f32 v11, v11, v11
    v_and_b32 v11, 0xffff0000, v11
    v_sqrt_f32 v11, v11
    s_nop 0
    v_cvt_pk_bf16_f32 v11, v11, v11
    v_and_b32 v11, 0xffff0000, v11
    v_rcp_f32 v11, v11
    s_nop 0
    v_mul_f32 v10, v10, v11
    s_mul_i32 s28, s26, 6912
    s_add_u32 s28, s28, 73728
    v_and_b32 v13, 31, v0
    v_mul_u32_u24 v107, 72, v13
    v_lshrrev_b32 v13, 5, v0
    v_lshl_add_u32 v107, v13, 3, v107
    v_add_u32 v107, s28, v107
    v_lshrrev_b32 v13, 4, v0
    v_lshlrev_b32 v13, 3, v13
    v_bfe_u32 v14, v0, 2, 2
    v_add_u32 v13, v13, v14
    v_mul_u32_u24 v106, 72, v13
    v_and_b32 v13, 3, v0
    v_lshl_add_u32 v106, v13, 3, v106
    v_add_u32 v106, s28, v106
    v_lshlrev_b32 v13, 16, v80
    v_and_b32 v14, 0xffff0000, v80
    v_fma_f32 v13, v13, v11, -v10
    v_fma_f32 v14, v14, v11, -v10
    v_cvt_pk_bf16_f32 v80, v13, v14
    v_lshlrev_b32 v13, 16, v81
    v_and_b32 v14, 0xffff0000, v81
    v_fma_f32 v13, v13, v11, -v10
    v_fma_f32 v14, v14, v11, -v10
    v_cvt_pk_bf16_f32 v81, v13, v14
    ds_write_b64 v107, v[80:81] offset:0
    v_lshlrev_b32 v13, 16, v82
    v_and_b32 v14, 0xffff0000, v82
    v_fma_f32 v13, v13, v11, -v10
    v_fma_f32 v14, v14, v11, -v10
    v_cvt_pk_bf16_f32 v82, v13, v14
    v_lshlrev_b32 v13, 16, v83
    v_and_b32 v14, 0xffff0000, v83
    v_fma_f32 v13, v13, v11, -v10
    v_fma_f32 v14, v14, v11, -v10
    v_cvt_pk_bf16_f32 v83, v13, v14
    ds_write_b64 v107, v[82:83] offset:16
    v_lshlrev_b32 v13, 16, v84
    v_and_b32 v14, 0xffff0000, v84
    v_fma_f32 v13, v13, v11, -v10
    v_fma_f32 v14, v14, v11, -v10
    v_cvt_pk_bf16_f32 v84, v13, v14
    v_lshlrev_b32 v13, 16, v85
    v_and_b32 v14, 0xffff0000, v85
    v_fma_f32 v13, v13, v11, -v10
    v_fma_f32 v14, v14, v11, -v10
    v_cvt_pk_bf16_f32 v85, v13, v14
    ds_write_b64 v107, v[84:85] offset:32
    v_lshlrev_b32 v13, 16, v86
    v_and_b32 v14, 0xffff0000, v86
    v_fma_f32 v13, v13, v11, -v10
    v_fma_f32 v14, v14, v11, -v10
    v_cvt_pk_bf16_f32 v86, v13, v14
    v_lshlrev_b32 v13, 16, v87
    v_and_b32 v14, 0xffff0000, v87
    v_fma_f32 v13, v13, v11, -v10
    v_fma_f32 v14, v14, v11, -v10
    v_cvt_pk_bf16_f32 v87, v13, v14
    ds_write_b64 v107, v[86:87] offset:48
    s_waitcnt lgkmcnt(0)
    ds_read_b64_tr_b16 v[32:33], v106 offset:0
    ds_read_b64_tr_b16 v[34:35], v106 offset:288
    ds_read_b64_tr_b16 v[36:37], v106 offset:32
    ds_read_b64_tr_b16 v[38:39], v106 offset:320
    v_lshlrev_b32 v13, 16, v88
    v_and_b32 v14, 0xffff0000, v88
    v_fma_f32 v13, v13, v11, -v10
    v_fma_f32 v14, v14, v11, -v10
    v_cvt_pk_bf16_f32 v88, v13, v14
    v_lshlrev_b32 v13, 16, v89
    v_and_b32 v14, 0xffff0000, v89
    v_fma_f32 v13, v13, v11, -v10
    v_fma_f32 v14, v14, v11, -v10
    v_cvt_pk_bf16_f32 v89, v13, v14
    ds_write_b64 v107, v[88:89] offset:2304
    v_lshlrev_b32 v13, 16, v90
    v_and_b32 v14, 0xffff0000, v90
    v_fma_f32 v13, v13, v11, -v10
    v_fma_f32 v14, v14, v11, -v10
    v_cvt_pk_bf16_f32 v90, v13, v14
    v_lshlrev_b32 v13, 16, v91
    v_and_b32 v14, 0xffff0000, v91
    v_fma_f32 v13, v13, v11, -v10
    v_fma_f32 v14, v14, v11, -v10
    v_cvt_pk_bf16_f32 v91, v13, v14
    ds_write_b64 v107, v[90:91] offset:2320
    v_lshlrev_b32 v13, 16, v92
    v_and_b32 v14, 0xffff0000, v92
    v_fma_f32 v13, v13, v11, -v10
    v_fma_f32 v14, v14, v11, -v10
    v_cvt_pk_bf16_f32 v92, v13, v14
    v_lshlrev_b32 v13, 16, v93
    v_and_b32 v14, 0xffff0000, v93
    v_fma_f32 v13, v13, v11, -v10
    v_fma_f32 v14, v14, v11, -v10
    v_cvt_pk_bf16_f32 v93, v13, v14
    ds_write_b64 v107, v[92:93] offset:2336
    v_lshlrev_b32 v13, 16, v94
    v_and_b32 v14, 0xffff0000, v94
    v_fma_f32 v13, v13, v11, -v10
    v_fma_f32 v14, v14, v11, -v10
    v_cvt_pk_bf16_f32 v94, v13, v14
    v_lshlrev_b32 v13, 16, v95
    v_and_b32 v14, 0xffff0000, v95
    v_fma_f32 v13, v13, v11, -v10
    v_fma_f32 v14, v14, v11, -v10
    v_cvt_pk_bf16_f32 v95, v13, v14
    ds_write_b64 v107, v[94:95] offset:2352
    s_waitcnt lgkmcnt(6)
    s_add_u32 s30, s56, 0
    buffer_store_dwordx4 v[32:35], v1, s[16:19], s30 offen sc0 sc1
    s_waitcnt lgkmcnt(4)
    s_add_u32 s30, s56, 65536
    buffer_store_dwordx4 v[36:39], v1, s[16:19], s30 offen sc0 sc1
    s_waitcnt lgkmcnt(0)
    ds_read_b64_tr_b16 v[40:41], v106 offset:2304
    ds_read_b64_tr_b16 v[42:43], v106 offset:2592
    ds_read_b64_tr_b16 v[44:45], v106 offset:2336
    ds_read_b64_tr_b16 v[46:47], v106 offset:2624
    v_lshlrev_b32 v13, 16, v96
    v_and_b32 v14, 0xffff0000, v96
    v_fma_f32 v13, v13, v11, -v10
    v_fma_f32 v14, v14, v11, -v10
    v_cvt_pk_bf16_f32 v96, v13, v14
    v_lshlrev_b32 v13, 16, v97
    v_and_b32 v14, 0xffff0000, v97
    v_fma_f32 v13, v13, v11, -v10
    v_fma_f32 v14, v14, v11, -v10
    v_cvt_pk_bf16_f32 v97, v13, v14
    ds_write_b64 v107, v[96:97] offset:4608
    v_lshlrev_b32 v13, 16, v98
    v_and_b32 v14, 0xffff0000, v98
    v_fma_f32 v13, v13, v11, -v10
    v_fma_f32 v14, v14, v11, -v10
    v_cvt_pk_bf16_f32 v98, v13, v14
    v_lshlrev_b32 v13, 16, v99
    v_and_b32 v14, 0xffff0000, v99
    v_fma_f32 v13, v13, v11, -v10
    v_fma_f32 v14, v14, v11, -v10
    v_cvt_pk_bf16_f32 v99, v13, v14
    ds_write_b64 v107, v[98:99] offset:4624
    v_lshlrev_b32 v13, 16, v100
    v_and_b32 v14, 0xffff0000, v100
    v_fma_f32 v13, v13, v11, -v10
    v_fma_f32 v14, v14, v11, -v10
    v_cvt_pk_bf16_f32 v100, v13, v14
    v_lshlrev_b32 v13, 16, v101
    v_and_b32 v14, 0xffff0000, v101
    v_fma_f32 v13, v13, v11, -v10
    v_fma_f32 v14, v14, v11, -v10
    v_cvt_pk_bf16_f32 v101, v13, v14
    ds_write_b64 v107, v[100:101] offset:4640
    v_lshlrev_b32 v13, 16, v102
    v_and_b32 v14, 0xffff0000, v102
    v_fma_f32 v13, v13, v11, -v10
    v_fma_f32 v14, v14, v11, -v10
    v_cvt_pk_bf16_f32 v102, v13, v14
    v_lshlrev_b32 v13, 16, v103
    v_and_b32 v14, 0xffff0000, v103
    v_fma_f32 v13, v13, v11, -v10
    v_fma_f32 v14, v14, v11, -v10
    v_cvt_pk_bf16_f32 v103, v13, v14
    ds_write_b64 v107, v[102:103] offset:4656
    s_waitcnt lgkmcnt(6)
    s_add_u32 s30, s56, 131072
    buffer_store_dwordx4 v[40:43], v1, s[16:19], s30 offen sc0 sc1
    s_waitcnt lgkmcnt(4)
    s_add_u32 s30, s56, 196608
    buffer_store_dwordx4 v[44:47], v1, s[16:19], s30 offen sc0 sc1
    s_waitcnt lgkmcnt(0)
    ds_read_b64_tr_b16 v[32:33], v106 offset:4608
    ds_read_b64_tr_b16 v[34:35], v106 offset:4896
    ds_read_b64_tr_b16 v[36:37], v106 offset:4640
    ds_read_b64_tr_b16 v[38:39], v106 offset:4928
    s_waitcnt lgkmcnt(2)
    s_add_u32 s30, s57, 0
    buffer_store_dwordx4 v[32:35], v1, s[16:19], s30 offen sc0 sc1
    s_waitcnt lgkmcnt(0)
    s_add_u32 s30, s57, 65536
    buffer_store_dwordx4 v[36:39], v1, s[16:19], s30 offen sc0 sc1
    s_waitcnt lgkmcnt(0)
    s_barrier
    s_lshl_b32 s30, s26, 8
    v_lshl_add_u32 v4, v0, 2, s30
    v_add_u32 v13, 147456, v4
    ds_read_b32 v48, v13 offset:0
    ds_read_b32 v49, v13 offset:1520
    ds_read_b32 v50, v13 offset:3040
    ds_read_b32 v51, v13 offset:4560
    v_mov_b32 v14, 0x40000000
    v_cmp_gt_u32 vcc, 1520, v4
    s_nop 1
    v_cndmask_b32 v4, v14, v4, vcc
    s_waitcnt lgkmcnt(0)
    v_add_f32 v14, v48, v49
    v_add_f32 v15, v50, v51
    ds_read_b32 v48, v13 offset:6080
    ds_read_b32 v49, v13 offset:7600
    ds_read_b32 v50, v13 offset:9120
    ds_read_b32 v51, v13 offset:10640
    v_add_f32 v14, v14, v15
    s_waitcnt lgkmcnt(0)
    v_add_f32 v15, v48, v49
    v_add_f32 v14, v14, v50
    v_add_f32 v15, v15, v51
    v_add_f32 v14, v14, v15
    buffer_store_dword v14, v4, s[16:19], s55 offen
    s_endpgm
L_gemm1_kernel_vC:
    s_waitcnt vmcnt(10)
    s_barrier
    ds_read_b64_tr_b16 v[16:17], v5 offset:0
    ds_read_b64_tr_b16 v[18:19], v5 offset:256
    ds_read_b64_tr_b16 v[20:21], v5 offset:36864
    ds_read_b64_tr_b16 v[22:23], v5 offset:37120
    ds_read_b64_tr_b16 v[24:25], v5 offset:1024
    ds_read_b64_tr_b16 v[26:27], v5 offset:1280
    ds_read_b64_tr_b16 v[28:29], v5 offset:37888
    ds_read_b64_tr_b16 v[30:31], v5 offset:38144
    s_waitcnt vmcnt(9) lgkmcnt(6)
    v_mfma_f32_32x32x16_bf16 v[32:47], v[16:19], a[0:3], 0
    s_cmp_eq_u32 s99, 0
    s_cbranch_scc1 L_pr15
    s_setprio 1
L_pr15:
    buffer_load_dwordx4 a[40:43], v1, s[16:19], s29 offen offset:2048
    ds_read_b64_tr_b16 v[16:17], v5 offset:2048
    ds_read_b64_tr_b16 v[18:19], v5 offset:2304
    s_waitcnt lgkmcnt(6)
    v_mfma_f32_32x32x16_bf16 v[48:63], v[20:23], a[0:3], 0
    ds_read_b64_tr_b16 v[20:21], v5 offset:38912
    ds_read_b64_tr_b16 v[22:23], v5 offset:39168
    s_waitcnt vmcnt(9) lgkmcnt(6)
    v_mfma_f32_32x32x16_bf16 v[32:47], v[24:27], a[4:7], v[32:47]
    buffer_load_dwordx4 a[44:47], v1, s[16:19], s29 offen offset:3072
    ds_read_b64_tr_b16 v[24:25], v5 offset:3072
    ds_read_b64_tr_b16 v[26:27], v5 offset:3328
    s_waitcnt lgkmcnt(6)
    v_mfma_f32_32x32x16_bf16 v[48:63], v[28:31], a[4:7], v[48:63]
    ds_read_b64_tr_b16 v[28:29], v5 offset:39936
    ds_read_b64_tr_b16 v[30:31], v5 offset:40192
    s_waitcnt vmcnt(9) lgkmcnt(6)
    v_mfma_f32_32x32x16_bf16 v[32:47], v[16:19], a[8:11], v[32:47]
    s_add_u32 s29, s40, 12288
    buffer_load_dwordx4 a[48:51], v1, s[16:19], s29 offen offset:0
    ds_read_b64_tr_b16 v[16:17], v5 offset:4096
    ds_read_b64_tr_b16 v[18:19], v5 offset:4352
    s_waitcnt lgkmcnt(6)
    v_mfma_f32_32x32x16_bf16 v[48:63], v[20:23], a[8:11], v[48:63]
    ds_read_b64_tr_b16 v[20:21], v5 offset:40960
    ds_read_b64_tr_b16 v[22:23], v5 offset:41216
    s_waitcnt vmcnt(9) lgkmcnt(6)
    v_mfma_f32_32x32x16_bf16 v[32:47], v[24:27], a[12:15], v[32:47]
    buffer_load_dwordx4 a[52:55], v1, s[16:19], s29 offen offset:1024
    ds_read_b64_tr_b16 v[24:25], v5 offset:5120
    ds_read_b64_tr_b16 v[26:27], v5 offset:5376
    s_waitcnt lgkmcnt(6)
    v_mfma_f32_32x32x16_bf16 v[48:63], v[28:31], a[12:15], v[48:63]
    ds_read_b64_tr_b16 v[28:29], v5 offset:41984
    ds_read_b64_tr_b16 v[30:31], v5 offset:42240
    s_waitcnt vmcnt(9) lgkmcnt(6)
    v_mfma_f32_32x32x16_bf16 v[32:47], v[16:19], a[16:19], v[32:47]
    buffer_load_dwordx4 a[56:59], v1, s[16:19], s29 offen offset:2048
    ds_read_b64_tr_b16 v[16:17], v5 offset:6144
    ds_read_b64_tr_b16 v[18:19], v5 offset:6400
    s_waitcnt lgkmcnt(6)
    v_mfma_f32_32x32x16_bf16 v[48:63], v[20:23], a[16:19], v[48:63]
    ds_read_b64_tr_b16 v[20:21], v5 offset:43008
    ds_read_b64_tr_b16 v[22:23], v5 offset:43264
    s_waitcnt vmcnt(9) lgkmcnt(6)
    v_mfma_f32_32x32x16_bf16 v[32:47], v[24:27], a[20:23], v[32:47]
    buffer_load_dwordx4 a[60:63], v1, s[16:19], s29 offen offset:3072
    ds_read_b64_tr_b16 v[24:25], v5 offset:7168
    ds_read_b64_tr_b16 v[26:27], v5 offset:7424
    s_waitcnt lgkmcnt(6)
    v_mfma_f32_32x32x16_bf16 v[48:63], v[28:31], a[20:23], v[48:63]
    ds_read_b64_tr_b16 v[28:29], v5 offset:44032
    ds_read_b64_tr_b16 v[30:31], v5 offset:44288
    s_waitcnt vmcnt(9) lgkmcnt(6)
    v_mfma_f32_32x32x16_bf16 v[32:47], v[16:19], a[24:27], v[32:47]
    s_add_u32 s29, s40, 16384
    buffer_load_dwordx4 a[64:67], v1, s[16:19], s29 offen offset:0
    ds_read_b64_tr_b16 v[16:17], v5 offset:8192
    ds_read_b64_tr_b16 v[18:19], v5 offset:8448
    s_waitcnt lgkmcnt(6)
    v_mfma_f32_32x32x16_bf16 v[48:63], v[20:23], a[24:27], v[48:63]
    ds_read_b64_tr_b16 v[20:21], v5 offset:45056
    ds_read_b64_tr_b16 v[22:23], v5 offset:45312
    s_waitcnt vmcnt(9) lgkmcnt(6)
    v_mfma_f32_32x32x16_bf16 v[32:47], v[24:27], a[28:31], v[32:47]
    buffer_load_dwordx4 a[68:71], v1, s[16:19], s29 offen offset:1024
    ds_read_b64_tr_b16 v[24:25], v5 offset:9216
    ds_read_b64_tr_b16 v[26:27], v5 offset:9472
    s_waitcnt lgkmcnt(6)
    v_mfma_f32_32x32x16_bf16 v[48:63], v[28:31], a[28:31], v[48:63]
    ds_read_b64_tr_b16 v[28:29], v5 offset:46080
    ds_read_b64_tr_b16 v[30:31], v5 offset:46336
    s_waitcnt vmcnt(9) lgkmcnt(6)
    v_mfma_f32_32x32x16_bf16 v[32:47], v[16:19], a[32:35], v[32:47]
    buffer_load_dwordx4 a[72:75], v1, s[16:19], s29 offen offset:2048
    ds_read_b64_tr_b16 v[16:17], v5 offset:10240
    ds_read_b64_tr_b16 v[18:19], v5 offset:10496
    s_waitcnt lgkmcnt(6)
    v_mfma_f32_32x32x16_bf16 v[48:63], v[20:23], a[32:35], v[48:63]
    ds_read_b64_tr_b16 v[20:21], v5 offset:47104
    ds_read_b64_tr_b16 v[22:23], v5 offset:47360
    s_waitcnt vmcnt(9) lgkmcnt(6)
    v_mfma_f32_32x32x16_bf16 v[32:47], v[24:27], a[36:39], v[32:47]
    buffer_load_dwordx4 a[76:79], v1, s[16:19], s29 offen offset:3072
    ds_read_b64_tr_b16 v[24:25], v5 offset:11264
    ds_read_b64_tr_b16 v[26:27], v5 offset:11520
    s_waitcnt lgkmcnt(6)
    v_mfma_f32_32x32x16_bf16 v[48:63], v[28:31], a[36:39], v[48:63]
    ds_read_b64_tr_b16 v[28:29], v5 offset:48128
    ds_read_b64_tr_b16 v[30:31], v5 offset:48384
    s_waitcnt vmcnt(9) lgkmcnt(6)
    v_mfma_f32_32x32x16_bf16 v[32:47], v[16:19], a[40:43], v[32:47]
    s_add_u32 s29, s40, 20480
    buffer_load_dwordx4 a[80:83], v1, s[16:19], s29 offen offset:0
    ds_read_b64_tr_b16 v[16:17], v5 offset:12288
    ds_read_b64_tr_b16 v[18:19], v5 offset:12544
    s_waitcnt lgkmcnt(6)
    v_mfma_f32_32x32x16_bf16 v[48:63], v[20:23], a[40:43], v[48:63]
    ds_read_b64_tr_b16 v[20:21], v6 offset:0
    ds_read_b64_tr_b16 v[22:23], v6 offset:256
    s_waitcnt vmcnt(9) lgkmcnt(6)
    v_mfma_f32_32x32x16_bf16 v[32:47], v[24:27], a[44:47], v[32:47]
    buffer_load_dwordx4 a[84:87], v1, s[16:19], s29 offen offset:1024
    ds_read_b64_tr_b16 v[24:25], v5 offset:13312
    ds_read_b64_tr_b16 v[26:27], v5 offset:13568
    s_waitcnt lgkmcnt(6)
    v_mfma_f32_32x32x16_bf16 v[48:63], v[28:31], a[44:47], v[48:63]
    ds_read_b64_tr_b16 v[28:29], v6 offset:1024
    ds_read_b64_tr_b16 v[30:31], v6 offset:1280
    s_waitcnt vmcnt(9) lgkmcnt(6)
    v_mfma_f32_32x32x16_bf16 v[32:47], v[16:19], a[48:51], v[32:47]
    buffer_load_dwordx4 a[88:91], v1, s[16:19], s29 offen offset:2048
    ds_read_b64_tr_b16 v[16:17], v5 offset:14336
    ds_read_b64_tr_b16 v[18:19], v5 offset:14592
    s_waitcnt lgkmcnt(6)
    v_mfma_f32_32x32x16_bf16 v[48:63], v[20:23], a[48:51], v[48:63]
    ds_read_b64_tr_b16 v[20:21], v6 offset:2048
    ds_read_b64_tr_b16 v[22:23], v6 offset:2304
    s_waitcnt vmcnt(9) lgkmcnt(6)
    v_mfma_f32_32x32x16_bf16 v[32:47], v[24:27], a[52:55], v[32:47]
    buffer_load_dwordx4 a[92:95], v1, s[16:19], s29 offen offset:3072
    ds_read_b64_tr_b16 v[24:25], v5 offset:15360
    ds_read_b64_tr_b16 v[26:27], v5 offset:15616
    s_waitcnt lgkmcnt(6)
    v_mfma_f32_32x32x16_bf16 v[48:63], v[28:31], a[52:55], v[48:63]
    ds_read_b64_tr_b16 v[28:29], v6 offset:3072
    ds_read_b64_tr_b16 v[30:31], v6 offset:3328
    s_waitcnt vmcnt(9) lgkmcnt(6)
    v_mfma_f32_32x32x16_bf16 v[32:47], v[16:19], a[56:59], v[32:47]
    s_add_u32 s29, s40, 24576
    buffer_load_dwordx4 a[96:99], v1, s[16:19], s29 offen offset:0
    ds_read_b64_tr_b16 v[16:17], v5 offset:16384
    ds_read_b64_tr_b16 v[18:19], v5 offset:16640
    s_waitcnt lgkmcnt(6)
    v_mfma_f32_32x32x16_bf16 v[48:63], v[20:23], a[56:59], v[48:63]
    ds_read_b64_tr_b16 v[20:21], v6 offset:4096
    ds_read_b64_tr_b16 v[22:23], v6 offset:4352
    s_waitcnt vmcnt(9) lgkmcnt(6)
    v_mfma_f32_32x32x16_bf16 v[32:47], v[24:27], a[60:63], v[32:47]
    buffer_load_dwordx4 a[100:103], v1, s[16:19], s29 offen offset:1024
    ds_read_b64_tr_b16 v[24:25], v5 offset:17408
    ds_read_b64_tr_b16 v[26:27], v5 offset:17664
    s_waitcnt lgkmcnt(6)
    v_mfma_f32_32x32x16_bf16 v[48:63], v[28:31], a[60:63], v[48:63]
    ds_read_b64_tr_b16 v[28:29], v6 offset:5120
    ds_read_b64_tr_b16 v[30:31], v6 offset:5376
    s_waitcnt vmcnt(9) lgkmcnt(6)
    v_mfma_f32_32x32x16_bf16 v[32:47], v[16:19], a[64:67], v[32:47]
    buffer_load_dwordx4 a[104:107], v1, s[16:19], s29 offen offset:2048
    ds_read_b64_tr_b16 v[16:17], v5 offset:18432
    ds_read_b64_tr_b16 v[18:19], v5 offset:18688
    s_waitcnt lgkmcnt(6)
    v_mfma_f32_32x32x16_bf16 v[48:63], v[20:23], a[64:67], v[48:63]
    ds_read_b64_tr_b16 v[20:21], v6 offset:6144
    ds_read_b64_tr_b16 v[22:23], v6 offset:6400
    s_waitcnt vmcnt(9) lgkmcnt(6)
    v_mfma_f32_32x32x16_bf16 v[32:47], v[24:27], a[68:71], v[32:47]
    buffer_load_dwordx4 a[108:111], v1, s[16:19], s29 offen offset:3072
    ds_read_b64_tr_b16 v[24:25], v5 offset:19456
    ds_read_b64_tr_b16 v[26:27], v5 offset:19712
    s_waitcnt lgkmcnt(6)
    v_mfma_f32_32x32x16_bf16 v[48:63], v[28:31], a[68:71], v[48:63]
    ds_read_b64_tr_b16 v[28:29], v6 offset:7168
    ds_read_b64_tr_b16 v[30:31], v6 offset:7424
    s_waitcnt vmcnt(9) lgkmcnt(6)
    v_mfma_f32_32x32x16_bf16 v[32:47], v[16:19], a[72:75], v[32:47]
    s_cmp_eq_u32 s99, 0
    s_cbranch_scc1 L_pr16
    s_setprio 0
L_pr16:
    s_add_u32 s29, s40, 28672
    buffer_load_dwordx4 a[112:115], v1, s[16:19], s29 offen offset:0
    ds_read_b64_tr_b16 v[16:17], v5 offset:20480
    ds_read_b64_tr_b16 v[18:19], v5 offset:20736
    s_waitcnt lgkmcnt(6)
    v_mfma_f32_32x32x16_bf16 v[48:63], v[20:23], a[72:75], v[48:63]
    ds_read_b64_tr_b16 v[20:21], v6 offset:8192
    ds_read_b64_tr_b16 v[22:23], v6 offset:8448
    s_waitcnt vmcnt(9) lgkmcnt(6)
    v_mfma_f32_32x32x16_bf16 v[32:47], v[24:27], a[76:79], v[32:47]
    buffer_load_dwordx4 a[116:119], v1, s[16:19], s29 offen offset:1024
    ds_read_b64_tr_b16 v[24:25], v5 offset:21504
    ds_read_b64_tr_b16 v[26:27], v5 offset:21760
    s_waitcnt lgkmcnt(6)
    v_mfma_f32_32x32x16_bf16 v[48:63], v[28:31], a[76:79], v[48:63]
    ds_read_b64_tr_b16 v[28:29], v6 offset:9216
    ds_read_b64_tr_b16 v[30:31], v6 offset:9472
    s_waitcnt vmcnt(9) lgkmcnt(6)
    v_mfma_f32_32x32x16_bf16 v[32:47], v[16:19], a[80:83], v[32:47]
    buffer_load_dwordx4 a[120:123], v1, s[16:19], s29 offen offset:2048
    ds_read_b64_tr_b16 v[16:17], v5 offset:22528
    ds_read_b64_tr_b16 v[18:19], v5 offset:22784
    s_waitcnt lgkmcnt(6)
    v_mfma_f32_32x32x16_bf16 v[48:63], v[20:23], a[80:83], v[48:63]
    ds_read_b64_tr_b16 v[20:21], v6 offset:10240
    ds_read_b64_tr_b16 v[22:23], v6 offset:10496
    s_waitcnt vmcnt(9) lgkmcnt(6)
    v_mfma_f32_32x32x16_bf16 v[32:47], v[24:27], a[84:87], v[32:47]
    buffer_load_dwordx4 a[124:127], v1, s[16:19], s29 offen offset:3072
    ds_read_b64_tr_b16 v[24:25], v5 offset:23552
    ds_read_b64_tr_b16 v[26:27], v5 offset:23808
    s_waitcnt lgkmcnt(6)
    v_mfma_f32_32x32x16_bf16 v[48:63], v[28:31], a[84:87], v[48:63]
    ds_read_b64_tr_b16 v[28:29], v6 offset:11264
    ds_read_b64_tr_b16 v[30:31], v6 offset:11520
    s_waitcnt vmcnt(9) lgkmcnt(6)
    v_mfma_f32_32x32x16_bf16 v[32:47], v[16:19], a[88:91], v[32:47]
    s_add_u32 s29, s40, 32768
    buffer_load_dwordx4 a[128:131], v1, s[16:19], s29 offen offset:0
    ds_read_b64_tr_b16 v[16:17], v5 offset:24576
    ds_read_b64_tr_b16 v[18:19], v5 offset:24832
    s_waitcnt lgkmcnt(6)
    v_mfma_f32_32x32x16_bf16 v[48:63], v[20:23], a[88:91], v[48:63]
    ds_read_b64_tr_b16 v[20:21], v6 offset:12288
    ds_read_b64_tr_b16 v[22:23], v6 offset:12544
    s_waitcnt vmcnt(9) lgkmcnt(6)
    v_mfma_f32_32x32x16_bf16 v[32:47], v[24:27], a[92:95], v[32:47]
    buffer_load_dwordx4 a[132:135], v1, s[16:19], s29 offen offset:1024
    ds_read_b64_tr_b16 v[24:25], v5 offset:25600
    ds_read_b64_tr_b16 v[26:27], v5 offset:25856
    s_waitcnt lgkmcnt(6)
    v_mfma_f32_32x32x16_bf16 v[48:63], v[28:31], a[92:95], v[48:63]
    ds_read_b64_tr_b16 v[28:29], v6 offset:13312
    ds_read_b64_tr_b16 v[30:31], v6 offset:13568
    s_waitcnt vmcnt(9) lgkmcnt(6)
    v_mfma_f32_32x32x16_bf16 v[32:47], v[16:19], a[96:99], v[32:47]
    buffer_load_dwordx4 a[136:139], v1, s[16:19], s29 offen offset:2048
    ds_read_b64_tr_b16 v[16:17], v5 offset:26624
    ds_read_b64_tr_b16 v[18:19], v5 offset:26880
    s_waitcnt lgkmcnt(6)
    v_mfma_f32_32x32x16_bf16 v[48:63], v[20:23], a[96:99], v[48:63]
    ds_read_b64_tr_b16 v[20:21], v6 offset:14336
    ds_read_b64_tr_b16 v[22:23], v6 offset:14592
    s_waitcnt vmcnt(9) lgkmcnt(6)
    v_mfma_f32_32x32x16_bf16 v[32:47], v[24:27], a[100:103], v[32:47]
    buffer_load_dwordx4 a[140:143], v1, s[16:19], s29 offen offset:3072
    ds_read_b64_tr_b16 v[24:25], v5 offset:27648
    ds_read_b64_tr_b16 v[26:27], v5 offset:27904
    s_waitcnt lgkmcnt(6)
    v_mfma_f32_32x32x16_bf16 v[48:63], v[28:31], a[100:103], v[48:63]
    ds_read_b64_tr_b16 v[28:29], v6 offset:15360
    ds_read_b64_tr_b16 v[30:31], v6 offset:15616
    s_waitcnt vmcnt(9) lgkmcnt(6)
    v_mfma_f32_32x32x16_bf16 v[32:47], v[16:19], a[104:107], v[32:47]
    s_add_u32 m0, s31, 73728
    s_add_u32 s30, s35, 0
    buffer_load_dwordx4 v1, s[16:19], s30 offen lds
    ds_read_b64_tr_b16 v[16:17], v5 offset:28672
    ds_read_b64_tr_b16 v[18:19], v5 offset:28928
    s_waitcnt lgkmcnt(6)
    v_mfma_f32_32x32x16_bf16 v[48:63], v[20:23], a[104:107], v[48:63]
    ds_read_b64_tr_b16 v[20:21], v6 offset:16384
    ds_read_b64_tr_b16 v[22:23], v6 offset:16640
    s_waitcnt vmcnt(9) lgkmcnt(6)
    v_mfma_f32_32x32x16_bf16 v[32:47], v[24:27], a[108:111], v[32:47]
    s_add_u32 m0, s31, 110592
    s_add_u32 s30, s39, 0
    buffer_load_dwordx4 v1, s[16:19], s30 offen lds
    ds_read_b64_tr_b16 v[24:25], v5 offset:29696
    ds_read_b64_tr_b16 v[26:27], v5 offset:29952
    s_waitcnt lgkmcnt(6)
    v_mfma_f32_32x32x16_bf16 v[48:63], v[28:31], a[108:111], v[48:63]
    ds_read_b64_tr_b16 v[28:29], v6 offset:17408
    ds_read_b64_tr_b16 v[30:31], v6 offset:17664
    s_waitcnt vmcnt(9) lgkmcnt(6)
    v_mfma_f32_32x32x16_bf16 v[32:47], v[16:19], a[112:115], v[32:47]
    s_add_u32 m0, s31, 81920
    s_add_u32 s30, s35, 8192
    buffer_load_dwordx4 v1, s[16:19], s30 offen lds
    ds_read_b64_tr_b16 v[16:17], v5 offset:30720
    ds_read_b64_tr_b16 v[18:19], v5 offset:30976
    s_waitcnt lgkmcnt(6)
    v_mfma_f32_32x32x16_bf16 v[48:63], v[20:23], a[112:115], v[48:63]
    ds_read_b64_tr_b16 v[20:21], v6 offset:18432
    ds_read_b64_tr_b16 v[22:23], v6 offset:18688
    s_waitcnt vmcnt(9) lgkmcnt(6)
    v_mfma_f32_32x32x16_bf16 v[32:47], v[24:27], a[116:119], v[32:47]
    s_add_u32 m0, s31, 118784
    s_add_u32 s30, s39, 8192
    buffer_load_dwordx4 v1, s[16:19], s30 offen lds
    ds_read_b64_tr_b16 v[24:25], v5 offset:31744
    ds_read_b64_tr_b16 v[26:27], v5 offset:32000
    s_waitcnt lgkmcnt(6)
    v_mfma_f32_32x32x16_bf16 v[48:63], v[28:31], a[116:119], v[48:63]
    ds_read_b64_tr_b16 v[28:29], v6 offset:19456
    ds_read_b64_tr_b16 v[30:31], v6 offset:19712
    s_waitcnt vmcnt(9) lgkmcnt(6)
    v_mfma_f32_32x32x16_bf16 v[32:47], v[16:19], a[120:123], v[32:47]
    s_add_u32 m0, s31, 90112
    s_add_u32 s30, s35, 16384
    buffer_load_dwordx4 v1, s[16:19], s30 offen lds
    ds_read_b64_tr_b16 v[16:17], v5 offset:32768
    ds_read_b64_tr_b16 v[18:19], v5 offset:33024
    s_waitcnt lgkmcnt(6)
    v_mfma_f32_32x32x16_bf16 v[48:63], v[20:23], a[120:123], v[48:63]
    ds_read_b64_tr_b16 v[20:21], v6 offset:20480
    ds_read_b64_tr_b16 v[22:23], v6 offset:20736
    s_waitcnt vmcnt(9) lgkmcnt(6)
    v_mfma_f32_32x32x16_bf16 v[32:47], v[24:27], a[124:127], v[32:47]
    s_add_u32 m0, s31, 126976
    s_add_u32 s30, s39, 16384
    buffer_load_dwordx4 v1, s[16:19], s30 offen lds
    ds_read_b64_tr_b16 v[24:25], v5 offset:33792
    ds_read_b64_tr_b16 v[26:27], v5 offset:34048
    s_waitcnt lgkmcnt(6)
    v_mfma_f32_32x32x16_bf16 v[48:63], v[28:31], a[124:127], v[48:63]
    ds_read_b64_tr_b16 v[28:29], v6 offset:21504
    ds_read_b64_tr_b16 v[30:31], v6 offset:21760
    s_waitcnt vmcnt(9) lgkmcnt(6)
    v_mfma_f32_32x32x16_bf16 v[32:47], v[16:19], a[128:131], v[32:47]
    s_add_u32 m0, s31, 98304
    s_add_u32 s30, s35, 24576
    buffer_load_dwordx4 v1, s[16:19], s30 offen lds
    ds_read_b64_tr_b16 v[16:17], v5 offset:34816
    ds_read_b64_tr_b16 v[18:19], v5 offset:35072
    s_waitcnt lgkmcnt(6)
    v_mfma_f32_32x32x16_bf16 v[48:63], v[20:23], a[128:131], v[48:63]
    ds_read_b64_tr_b16 v[20:21], v6 offset:22528
    ds_read_b64_tr_b16 v[22:23], v6 offset:22784
    s_waitcnt vmcnt(9) lgkmcnt(6)
    v_mfma_f32_32x32x16_bf16 v[32:47], v[24:27], a[132:135], v[32:47]
    s_add_u32 m0, s31, 135168
    s_add_u32 s30, s39, 24576
    buffer_load_dwordx4 v1, s[16:19], s30 offen lds
    ds_read_b64_tr_b16 v[24:25], v5 offset:35840
    ds_read_b64_tr_b16 v[26:27], v5 offset:36096
    s_waitcnt lgkmcnt(6)
    v_mfma_f32_32x32x16_bf16 v[48:63], v[28:31], a[132:135], v[48:63]
    ds_read_b64_tr_b16 v[28:29], v6 offset:23552
    ds_read_b64_tr_b16 v[30:31], v6 offset:23808
    s_waitcnt vmcnt(9) lgkmcnt(6)
    v_mfma_f32_32x32x16_bf16 v[32:47], v[16:19], a[136:139], v[32:47]
    s_add_u32 s30, s50, 73728
    s_min_u32 m0, s30, 160768
    s_add_u32 s30, s35, 32768
    s_or_b32 s30, s30, s51
    buffer_load_dwordx4 v1, s[16:19], s30 offen lds
    s_waitcnt lgkmcnt(4)
    v_mfma_f32_32x32x16_bf16 v[48:63], v[20:23], a[136:139], v[48:63]
    s_waitcnt vmcnt(9) lgkmcnt(2)
    v_mfma_f32_32x32x16_bf16 v[32:47], v[24:27], a[140:143], v[32:47]
    s_add_u32 s30, s50, 110592
    s_min_u32 m0, s30, 160768
    s_add_u32 s30, s39, 32768
    s_or_b32 s30, s30, s51
    buffer_load_dwordx4 v1, s[16:19], s30 offen lds
    s_waitcnt lgkmcnt(0)
    v_mfma_f32_32x32x16_bf16 v[48:63], v[28:31], a[140:143], v[48:63]
    s_waitcnt vmcnt(0)
    s_barrier
    ds_read_b64_tr_b16 v[16:17], v6 offset:24576
    ds_read_b64_tr_b16 v[18:19], v6 offset:24832
    ds_read_b64_tr_b16 v[20:21], v6 offset:25600
    ds_read_b64_tr_b16 v[22:23], v6 offset:25856
    ds_read_b64_tr_b16 v[24:25], v6 offset:26624
    ds_read_b64_tr_b16 v[26:27], v6 offset:26880
    ds_read_b64_tr_b16 v[28:29], v6 offset:27648
    ds_read_b64_tr_b16 v[30:31], v6 offset:27904
    s_waitcnt lgkmcnt(6)
    v_mfma_f32_32x32x16_bf16 v[64:79], a[0:3], v[16:19], 0
    s_cmp_eq_u32 s99, 0
    s_cbranch_scc1 L_pr17
    s_setprio 1
L_pr17:
    s_add_u32 m0, s31, 0
    s_add_u32 s30, s33, 0
    buffer_load_dwordx4 v2, s[8:11], s30 offen lds
    ds_read_b64_tr_b16 v[16:17], v6 offset:28672
    ds_read_b64_tr_b16 v[18:19], v6 offset:28928
    s_waitcnt lgkmcnt(6)
    v_mfma_f32_32x32x16_bf16 v[64:79], a[4:7], v[20:23], v[64:79]
    v_mul_f32 v13, v32, v32
    v_mul_f32 v14, v33, v33
    v_fmaak_f32 v13, v12, v13, 0xc0135761
    v_fmaak_f32 v14, v12, v14, 0xc0135761
    v_mul_f32 v13, v13, v32
    ds_read_b64_tr_b16 v[20:21], v6 offset:29696
    ds_read_b64_tr_b16 v[22:23], v6 offset:29952
    s_waitcnt lgkmcnt(6)
    v_mfma_f32_32x32x16_bf16 v[64:79], a[8:11], v[24:27], v[64:79]
    v_mul_f32 v14, v14, v33
    v_exp_f32 v13, v13
    v_exp_f32 v14, v14
    v_add_f32 v13, 1.0, v13
    v_add_f32 v14, 1.0, v14
    ds_read_b64_tr_b16 v[24:25], v6 offset:30720
    ds_read_b64_tr_b16 v[26:27], v6 offset:30976
    s_waitcnt lgkmcnt(6)
    v_mfma_f32_32x32x16_bf16 v[64:79], a[12:15], v[28:31], v[64:79]
    v_rcp_f32 v13, v13
    v_rcp_f32 v14, v14
    v_mul_f32 v32, v32, v13
    v_mul_f32 v33, v33, v14
    v_add_f32 v10, v10, v32
    ds_read_b64_tr_b16 v[28:29], v6 offset:31744
    ds_read_b64_tr_b16 v[30:31], v6 offset:32000
    s_waitcnt lgkmcnt(6)
    v_mfma_f32_32x32x16_bf16 v[64:79], a[16:19], v[16:19], v[64:79]
    v_fmac_f32 v11, v32, v32
    v_add_f32 v10, v10, v33
    v_fmac_f32 v11, v33, v33
    v_cvt_pk_bf16_f32 v80, v32, v33
    v_mul_f32 v13, v34, v34
    s_add_u32 m0, s31, 36864
    s_add_u32 s30, s42, 0
    buffer_load_dwordx4 v2, s[8:11], s30 offen lds
    ds_read_b64_tr_b16 v[16:17], v6 offset:32768
    ds_read_b64_tr_b16 v[18:19], v6 offset:33024
    s_waitcnt lgkmcnt(6)
    v_mfma_f32_32x32x16_bf16 v[64:79], a[20:23], v[20:23], v[64:79]
    v_mul_f32 v14, v35, v35
    v_fmaak_f32 v13, v12, v13, 0xc0135761
    v_fmaak_f32 v14, v12, v14, 0xc0135761
    v_mul_f32 v13, v13, v34
    v_mul_f32 v14, v14, v35
    ds_read_b64_tr_b16 v[20:21], v6 offset:33792
    ds_read_b64_tr_b16 v[22:23], v6 offset:34048
    s_waitcnt lgkmcnt(6)
    v_mfma_f32_32x32x16_bf16 v[64:79], a[24:27], v[24:27], v[64:79]
    v_exp_f32 v13, v13
    v_exp_f32 v14, v14
    v_add_f32 v13, 1.0, v13
    v_add_f32 v14, 1.0, v14
    v_rcp_f32 v13, v13
    ds_read_b64_tr_b16 v[24:25], v6 offset:34816
    ds_read_b64_tr_b16 v[26:27], v6 offset:35072
    s_waitcnt lgkmcnt(6)
    v_mfma_f32_32x32x16_bf16 v[64:79], a[28:31], v[28:31], v[64:79]
    v_rcp_f32 v14, v14
    v_mul_f32 v34, v34, v13
    v_mul_f32 v35, v35, v14
    v_add_f32 v10, v10, v34
    v_fmac_f32 v11, v34, v34
    ds_read_b64_tr_b16 v[28:29], v6 offset:35840
    ds_read_b64_tr_b16 v[30:31], v6 offset:36096
    s_waitcnt lgkmcnt(6)
    v_mfma_f32_32x32x16_bf16 v[64:79], a[32:35], v[16:19], v[64:79]
    v_add_f32 v10, v10, v35
    v_fmac_f32 v11, v35, v35
    v_cvt_pk_bf16_f32 v81, v34, v35
    v_mul_f32 v13, v36, v36
    v_mul_f32 v14, v37, v37
    ds_read_b64_tr_b16 v[16:17], v6 offset:36864
    ds_read_b64_tr_b16 v[18:19], v6 offset:37120
    s_waitcnt lgkmcnt(6)
    v_mfma_f32_32x32x16_bf16 v[64:79], a[36:39], v[20:23], v[64:79]
    v_fmaak_f32 v13, v12, v13, 0xc0135761
    v_fmaak_f32 v14, v12, v14, 0xc0135761
    v_mul_f32 v13, v13, v36
    v_mul_f32 v14, v14, v37
    v_exp_f32 v13, v13
    s_add_u32 m0, s31, 8192
    s_add_u32 s30, s33, 1179648
    buffer_load_dwordx4 v2, s[8:11], s30 offen lds
    ds_read_b64_tr_b16 v[20:21], v6 offset:37888
    ds_read_b64_tr_b16 v[22:23], v6 offset:38144
    s_waitcnt lgkmcnt(6)
    v_mfma_f32_32x32x16_bf16 v[64:79], a[40:43], v[24:27], v[64:79]
    v_exp_f32 v14, v14
    v_add_f32 v13, 1.0, v13
    v_add_f32 v14, 1.0, v14
    v_rcp_f32 v13, v13
    v_rcp_f32 v14, v14
    ds_read_b64_tr_b16 v[24:25], v6 offset:38912
    ds_read_b64_tr_b16 v[26:27], v6 offset:39168
    s_waitcnt lgkmcnt(6)
    v_mfma_f32_32x32x16_bf16 v[64:79], a[44:47], v[28:31], v[64:79]
    v_mul_f32 v36, v36, v13
    v_mul_f32 v37, v37, v14
    v_add_f32 v10, v10, v36
    v_fmac_f32 v11, v36, v36
    v_add_f32 v10, v10, v37
    ds_read_b64_tr_b16 v[28:29], v6 offset:39936
    ds_read_b64_tr_b16 v[30:31], v6 offset:40192
    s_waitcnt lgkmcnt(6)
    v_mfma_f32_32x32x16_bf16 v[64:79], a[48:51], v[16:19], v[64:79]
    v_fmac_f32 v11, v37, v37
    v_cvt_pk_bf16_f32 v82, v36, v37
    v_mul_f32 v13, v38, v38
    v_mul_f32 v14, v39, v39
    v_fmaak_f32 v13, v12, v13, 0xc0135761
    ds_read_b64_tr_b16 v[16:17], v6 offset:40960
    ds_read_b64_tr_b16 v[18:19], v6 offset:41216
    s_waitcnt lgkmcnt(6)
    v_mfma_f32_32x32x16_bf16 v[64:79], a[52:55], v[20:23], v[64:79]
    v_fmaak_f32 v14, v12, v14, 0xc0135761
    v_mul_f32 v13, v13, v38
    v_mul_f32 v14, v14, v39
    v_exp_f32 v13, v13
    v_exp_f32 v14, v14
    ds_read_b64_tr_b16 v[20:21], v6 offset:41984
    ds_read_b64_tr_b16 v[22:23], v6 offset:42240
    s_waitcnt lgkmcnt(6)
    v_mfma_f32_32x32x16_bf16 v[64:79], a[56:59], v[24:27], v[64:79]
    v_add_f32 v13, 1.0, v13
    v_add_f32 v14, 1.0, v14
    v_rcp_f32 v13, v13
    v_rcp_f32 v14, v14
    v_mul_f32 v38, v38, v13
    s_add_u32 m0, s31, 45056
    s_add_u32 s30, s42, 1179648
    buffer_load_dwordx4 v2, s[8:11], s30 offen lds
    ds_read_b64_tr_b16 v[24:25], v6 offset:43008
    ds_read_b64_tr_b16 v[26:27], v6 offset:43264
    s_waitcnt lgkmcnt(6)
    v_mfma_f32_32x32x16_bf16 v[64:79], a[60:63], v[28:31], v[64:79]
    v_mul_f32 v39, v39, v14
    v_add_f32 v10, v10, v38
    v_fmac_f32 v11, v38, v38
    v_add_f32 v10, v10, v39
    v_fmac_f32 v11, v39, v39
    ds_read_b64_tr_b16 v[28:29], v6 offset:44032
    ds_read_b64_tr_b16 v[30:31], v6 offset:44288
    s_waitcnt lgkmcnt(6)
    v_mfma_f32_32x32x16_bf16 v[64:79], a[64:67], v[16:19], v[64:79]
    v_cvt_pk_bf16_f32 v83, v38, v39
    v_mul_f32 v13, v40, v40
    v_mul_f32 v14, v41, v41
    v_fmaak_f32 v13, v12, v13, 0xc0135761
    v_fmaak_f32 v14, v12, v14, 0xc0135761
    ds_read_b64_tr_b16 v[16:17], v6 offset:45056
    ds_read_b64_tr_b16 v[18:19], v6 offset:45312
    s_waitcnt lgkmcnt(6)
    v_mfma_f32_32x32x16_bf16 v[64:79], a[68:71], v[20:23], v[64:79]
    v_mul_f32 v13, v13, v40
    v_mul_f32 v14, v14, v41
    v_exp_f32 v13, v13
    v_exp_f32 v14, v14
    v_add_f32 v13, 1.0, v13
    ds_read_b64_tr_b16 v[20:21], v6 offset:46080
    ds_read_b64_tr_b16 v[22:23], v6 offset:46336
    s_waitcnt lgkmcnt(6)
    v_mfma_f32_32x32x16_bf16 v[64:79], a[72:75], v[24:27], v[64:79]
    v_add_f32 v14, 1.0, v14
    v_rcp_f32 v13, v13
    v_rcp_f32 v14, v14
    v_mul_f32 v40, v40, v13
    v_mul_f32 v41, v41, v14
    s_add_u32 m0, s31, 16384
    s_add_u32 s30, s33, 2359296
    buffer_load_dwordx4 v2, s[8:11], s30 offen lds
    ds_read_b64_tr_b16 v[24:25], v6 offset:47104
    ds_read_b64_tr_b16 v[26:27], v6 offset:47360
    s_waitcnt lgkmcnt(6)
    v_mfma_f32_32x32x16_bf16 v[64:79], a[76:79], v[28:31], v[64:79]
    v_add_f32 v10, v10, v40
    v_fmac_f32 v11, v40, v40
    v_add_f32 v10, v10, v41
    v_fmac_f32 v11, v41, v41
    v_cvt_pk_bf16_f32 v84, v40, v41
    ds_read_b64_tr_b16 v[28:29], v6 offset:48128
    ds_read_b64_tr_b16 v[30:31], v6 offset:48384
    s_waitcnt lgkmcnt(6)
    v_mfma_f32_32x32x16_bf16 v[64:79], a[80:83], v[16:19], v[64:79]
    v_mul_f32 v13, v42, v42
    v_mul_f32 v14, v43, v43
    v_fmaak_f32 v13, v12, v13, 0xc0135761
    v_fmaak_f32 v14, v12, v14, 0xc0135761
    v_mul_f32 v13, v13, v42
    ds_read_b64_tr_b16 v[16:17], v7 offset:0
    ds_read_b64_tr_b16 v[18:19], v7 offset:256
    s_waitcnt lgkmcnt(6)
    v_mfma_f32_32x32x16_bf16 v[64:79], a[84:87], v[20:23], v[64:79]
    v_mul_f32 v14, v14, v43
    v_exp_f32 v13, v13
    v_exp_f32 v14, v14
    v_add_f32 v13, 1.0, v13
    v_add_f32 v14, 1.0, v14
    ds_read_b64_tr_b16 v[20:21], v7 offset:1024
    ds_read_b64_tr_b16 v[22:23], v7 offset:1280
    s_waitcnt lgkmcnt(6)
    v_mfma_f32_32x32x16_bf16 v[64:79], a[88:91], v[24:27], v[64:79]
    v_rcp_f32 v13, v13
    v_rcp_f32 v14, v14
    v_mul_f32 v42, v42, v13
    v_mul_f32 v43, v43, v14
    v_add_f32 v10, v10, v42
    ds_read_b64_tr_b16 v[24:25], v7 offset:2048
    ds_read_b64_tr_b16 v[26:27], v7 offset:2304
    s_waitcnt lgkmcnt(6)
    v_mfma_f32_32x32x16_bf16 v[64:79], a[92:95], v[28:31], v[64:79]
    v_fmac_f32 v11, v42, v42
    v_add_f32 v10, v10, v43
    v_fmac_f32 v11, v43, v43
    v_cvt_pk_bf16_f32 v85, v42, v43
    v_mul_f32 v13, v44, v44
    s_add_u32 m0, s31, 53248
    s_add_u32 s30, s42, 2359296
    buffer_load_dwordx4 v2, s[8:11], s30 offen lds
    ds_read_b64_tr_b16 v[28:29], v7 offset:3072
    ds_read_b64_tr_b16 v[30:31], v7 offset:3328
    s_waitcnt lgkmcnt(6)
    v_mfma_f32_32x32x16_bf16 v[64:79], a[96:99], v[16:19], v[64:79]
    v_mul_f32 v14, v45, v45
    v_fmaak_f32 v13, v12, v13, 0xc0135761
    v_fmaak_f32 v14, v12, v14, 0xc0135761
    v_mul_f32 v13, v13, v44
    v_mul_f32 v14, v14, v45
    ds_read_b64_tr_b16 v[16:17], v7 offset:4096
    ds_read_b64_tr_b16 v[18:19], v7 offset:4352
    s_waitcnt lgkmcnt(6)
    v_mfma_f32_32x32x16_bf16 v[64:79], a[100:103], v[20:23], v[64:79]
    v_exp_f32 v13, v13
    v_exp_f32 v14, v14
    v_add_f32 v13, 1.0, v13
    v_add_f32 v14, 1.0, v14
    v_rcp_f32 v13, v13
    ds_read_b64_tr_b16 v[20:21], v7 offset:5120
    ds_read_b64_tr_b16 v[22:23], v7 offset:5376
    s_waitcnt lgkmcnt(6)
    v_mfma_f32_32x32x16_bf16 v[64:79], a[104:107], v[24:27], v[64:79]
    v_rcp_f32 v14, v14
    v_mul_f32 v44, v44, v13
    v_mul_f32 v45, v45, v14
    v_add_f32 v10, v10, v44
    v_fmac_f32 v11, v44, v44
    ds_read_b64_tr_b16 v[24:25], v7 offset:6144
    ds_read_b64_tr_b16 v[26:27], v7 offset:6400
    s_waitcnt lgkmcnt(6)
    v_mfma_f32_32x32x16_bf16 v[64:79], a[108:111], v[28:31], v[64:79]
    v_add_f32 v10, v10, v45
    v_fmac_f32 v11, v45, v45
    v_cvt_pk_bf16_f32 v86, v44, v45
    v_mul_f32 v13, v46, v46
    v_mul_f32 v14, v47, v47
    ds_read_b64_tr_b16 v[28:29], v7 offset:7168
    ds_read_b64_tr_b16 v[30:31], v7 offset:7424
    s_waitcnt lgkmcnt(6)
    v_mfma_f32_32x32x16_bf16 v[64:79], a[112:115], v[16:19], v[64:79]
    v_fmaak_f32 v13, v12, v13, 0xc0135761
    v_fmaak_f32 v14, v12, v14, 0xc0135761
    v_mul_f32 v13, v13, v46
    v_mul_f32 v14, v14, v47
    v_exp_f32 v13, v13
    s_add_u32 m0, s31, 24576
    s_add_u32 s30, s33, 3538944
    buffer_load_dwordx4 v2, s[8:11], s30 offen lds
    ds_read_b64_tr_b16 v[16:17], v7 offset:8192
    ds_read_b64_tr_b16 v[18:19], v7 offset:8448
    s_waitcnt lgkmcnt(6)
    v_mfma_f32_32x32x16_bf16 v[64:79], a[116:119], v[20:23], v[64:79]
    v_exp_f32 v14, v14
    v_add_f32 v13, 1.0, v13
    v_add_f32 v14, 1.0, v14
    v_rcp_f32 v13, v13
    v_rcp_f32 v14, v14
    ds_read_b64_tr_b16 v[20:21], v7 offset:9216
    ds_read_b64_tr_b16 v[22:23], v7 offset:9472
    s_waitcnt lgkmcnt(6)
    v_mfma_f32_32x32x16_bf16 v[64:79], a[120:123], v[24:27], v[64:79]
    v_mul_f32 v46, v46, v13
    v_mul_f32 v47, v47, v14
    v_add_f32 v10, v10, v46
    v_fmac_f32 v11, v46, v46
    v_add_f32 v10, v10, v47
    ds_read_b64_tr_b16 v[24:25], v7 offset:10240
    ds_read_b64_tr_b16 v[26:27], v7 offset:10496
    s_waitcnt lgkmcnt(6)
    v_mfma_f32_32x32x16_bf16 v[64:79], a[124:127], v[28:31], v[64:79]
    v_fmac_f32 v11, v47, v47
    v_cvt_pk_bf16_f32 v87, v46, v47
    v_mul_f32 v13, v48, v48
    v_mul_f32 v14, v49, v49
    v_fmaak_f32 v13, v12, v13, 0xc0135761
    ds_read_b64_tr_b16 v[28:29], v7 offset:11264
    ds_read_b64_tr_b16 v[30:31], v7 offset:11520
    s_waitcnt lgkmcnt(6)
    v_mfma_f32_32x32x16_bf16 v[64:79], a[128:131], v[16:19], v[64:79]
    v_fmaak_f32 v14, v12, v14, 0xc0135761
    v_mul_f32 v13, v13, v48
    v_mul_f32 v14, v14, v49
    v_exp_f32 v13, v13
    v_exp_f32 v14, v14
    s_add_u32 m0, s31, 61440
    s_add_u32 s30, s42, 3538944
    buffer_load_dwordx4 v2, s[8:11], s30 offen lds
    ds_read_b64_tr_b16 v[16:17], v7 offset:12288
    ds_read_b64_tr_b16 v[18:19], v7 offset:12544
    s_waitcnt lgkmcnt(6)
    v_mfma_f32_32x32x16_bf16 v[64:79], a[132:135], v[20:23], v[64:79]
    v_add_f32 v13, 1.0, v13
    v_add_f32 v14, 1.0, v14
    v_rcp_f32 v13, v13
    v_rcp_f32 v14, v14
    v_mul_f32 v48, v48, v13
    ds_read_b64_tr_b16 v[20:21], v7 offset:13312
    ds_read_b64_tr_b16 v[22:23], v7 offset:13568
    s_waitcnt lgkmcnt(6)
    v_mfma_f32_32x32x16_bf16 v[64:79], a[136:139], v[24:27], v[64:79]
    v_mul_f32 v49, v49, v14
    v_add_f32 v10, v10, v48
    v_fmac_f32 v11, v48, v48
    v_add_f32 v10, v10, v49
    ds_read_b64_tr_b16 v[24:25], v7 offset:14336
    ds_read_b64_tr_b16 v[26:27], v7 offset:14592
    s_waitcnt lgkmcnt(6)
    v_mfma_f32_32x32x16_bf16 v[64:79], a[140:143], v[28:31], v[64:79]
    ds_read_b64_tr_b16 v[28:29], v7 offset:15360
    ds_read_b64_tr_b16 v[30:31], v7 offset:15616
    s_waitcnt lgkmcnt(6)
    v_mfma_f32_32x32x16_bf16 v[32:47], a[0:3], v[16:19], 0
    s_cmp_eq_u32 s99, 0
    s_cbranch_scc1 L_pr18
    s_setprio 0
L_pr18:
    ds_read_b64_tr_b16 v[16:17], v7 offset:16384
    ds_read_b64_tr_b16 v[18:19], v7 offset:16640
    s_waitcnt lgkmcnt(6)
    v_mfma_f32_32x32x16_bf16 v[32:47], a[4:7], v[20:23], v[32:47]
    v_fmac_f32 v11, v49, v49
    v_cvt_pk_bf16_f32 v88, v48, v49
    v_mul_f32 v13, v50, v50
    v_mul_f32 v14, v51, v51
    v_fmaak_f32 v13, v12, v13, 0xc0135761
    v_fmaak_f32 v14, v12, v14, 0xc0135761
    s_add_u32 s30, s50, 0
    s_min_u32 m0, s30, 160768
    s_add_u32 s30, s33, 4718592
    s_or_b32 s30, s30, s51
    buffer_load_dwordx4 v2, s[8:11], s30 offen lds
    ds_read_b64_tr_b16 v[20:21], v7 offset:17408
    ds_read_b64_tr_b16 v[22:23], v7 offset:17664
    s_waitcnt lgkmcnt(6)
    v_mfma_f32_32x32x16_bf16 v[32:47], a[8:11], v[24:27], v[32:47]
    v_mul_f32 v13, v13, v50
    v_mul_f32 v14, v14, v51
    v_exp_f32 v13, v13
    v_exp_f32 v14, v14
    v_add_f32 v13, 1.0, v13
    ds_read_b64_tr_b16 v[24:25], v7 offset:18432
    ds_read_b64_tr_b16 v[26:27], v7 offset:18688
    s_waitcnt lgkmcnt(6)
    v_mfma_f32_32x32x16_bf16 v[32:47], a[12:15], v[28:31], v[32:47]
    v_add_f32 v14, 1.0, v14
    v_rcp_f32 v13, v13
    v_rcp_f32 v14, v14
    v_mul_f32 v50, v50, v13
    v_mul_f32 v51, v51, v14
    ds_read_b64_tr_b16 v[28:29], v7 offset:19456
    ds_read_b64_tr_b16 v[30:31], v7 offset:19712
    s_waitcnt lgkmcnt(6)
    v_mfma_f32_32x32x16_bf16 v[32:47], a[16:19], v[16:19], v[32:47]
    s_mov_b32 m0, 160768
    s_lshl_b32 s30, s98, 13
    s_add_u32 s30, s30, 0
    buffer_load_dwordx4 v1, s[12:15], s30 offen lds
    v_add_f32 v10, v10, v50
    v_fmac_f32 v11, v50, v50
    v_add_f32 v10, v10, v51
    v_fmac_f32 v11, v51, v51
    v_cvt_pk_bf16_f32 v89, v50, v51
    ds_read_b64_tr_b16 v[16:17], v7 offset:20480
    ds_read_b64_tr_b16 v[18:19], v7 offset:20736
    s_waitcnt lgkmcnt(6)
    v_mfma_f32_32x32x16_bf16 v[32:47], a[20:23], v[20:23], v[32:47]
    v_mul_f32 v13, v52, v52
    v_mul_f32 v14, v53, v53
    v_fmaak_f32 v13, v12, v13, 0xc0135761
    v_fmaak_f32 v14, v12, v14, 0xc0135761
    v_mul_f32 v13, v13, v52
    ds_read_b64_tr_b16 v[20:21], v7 offset:21504
    ds_read_b64_tr_b16 v[22:23], v7 offset:21760
    s_waitcnt lgkmcnt(6)
    v_mfma_f32_32x32x16_bf16 v[32:47], a[24:27], v[24:27], v[32:47]
    v_mul_f32 v14, v14, v53
    v_exp_f32 v13, v13
    v_exp_f32 v14, v14
    v_add_f32 v13, 1.0, v13
    v_add_f32 v14, 1.0, v14
    s_add_u32 s30, s50, 36864
    s_min_u32 m0, s30, 160768
    s_add_u32 s30, s42, 4718592
    s_or_b32 s30, s30, s51
    buffer_load_dwordx4 v2, s[8:11], s30 offen lds
    ds_read_b64_tr_b16 v[24:25], v7 offset:22528
    ds_read_b64_tr_b16 v[26:27], v7 offset:22784
    s_waitcnt lgkmcnt(6)
    v_mfma_f32_32x32x16_bf16 v[32:47], a[28:31], v[28:31], v[32:47]
    v_rcp_f32 v13, v13
    v_rcp_f32 v14, v14
    v_mul_f32 v52, v52, v13
    v_mul_f32 v53, v53, v14
    v_add_f32 v10, v10, v52
    ds_read_b64_tr_b16 v[28:29], v7 offset:23552
    ds_read_b64_tr_b16 v[30:31], v7 offset:23808
    s_waitcnt lgkmcnt(6)
    v_mfma_f32_32x32x16_bf16 v[32:47], a[32:35], v[16:19], v[32:47]
    s_mov_b32 m0, 160768
    s_lshl_b32 s30, s98, 13
    s_add_u32 s30, s30, 1024
    buffer_load_dwordx4 v1, s[12:15], s30 offen lds
    v_fmac_f32 v11, v52, v52
    v_add_f32 v10, v10, v53
    v_fmac_f32 v11, v53, v53
    v_cvt_pk_bf16_f32 v90, v52, v53
    v_mul_f32 v13, v54, v54
    ds_read_b64_tr_b16 v[16:17], v7 offset:24576
    ds_read_b64_tr_b16 v[18:19], v7 offset:24832
    s_waitcnt lgkmcnt(6)
    v_mfma_f32_32x32x16_bf16 v[32:47], a[36:39], v[20:23], v[32:47]
    v_mul_f32 v14, v55, v55
    v_fmaak_f32 v13, v12, v13, 0xc0135761
    v_fmaak_f32 v14, v12, v14, 0xc0135761
    v_mul_f32 v13, v13, v54
    v_mul_f32 v14, v14, v55
    ds_read_b64_tr_b16 v[20:21], v7 offset:25600
    ds_read_b64_tr_b16 v[22:23], v7 offset:25856
    s_waitcnt lgkmcnt(6)
    v_mfma_f32_32x32x16_bf16 v[32:47], a[40:43], v[24:27], v[32:47]
    v_exp_f32 v13, v13
    v_exp_f32 v14, v14
    v_add_f32 v13, 1.0, v13
    v_add_f32 v14, 1.0, v14
    v_rcp_f32 v13, v13
    ds_read_b64_tr_b16 v[24:25], v7 offset:26624
    ds_read_b64_tr_b16 v[26:27], v7 offset:26880
    s_waitcnt lgkmcnt(6)
    v_mfma_f32_32x32x16_bf16 v[32:47], a[44:47], v[28:31], v[32:47]
    v_rcp_f32 v14, v14
    v_mul_f32 v54, v54, v13
    v_mul_f32 v55, v55, v14
    v_add_f32 v10, v10, v54
    v_fmac_f32 v11, v54, v54
    ds_read_b64_tr_b16 v[28:29], v7 offset:27648
    ds_read_b64_tr_b16 v[30:31], v7 offset:27904
    s_waitcnt lgkmcnt(6)
    v_mfma_f32_32x32x16_bf16 v[32:47], a[48:51], v[16:19], v[32:47]
    v_add_f32 v10, v10, v55
    v_fmac_f32 v11, v55, v55
    v_cvt_pk_bf16_f32 v91, v54, v55
    v_mul_f32 v13, v56, v56
    v_mul_f32 v14, v57, v57
    v_fmaak_f32 v13, v12, v13, 0xc0135761
    ds_read_b64_tr_b16 v[16:17], v7 offset:28672
    ds_read_b64_tr_b16 v[18:19], v7 offset:28928
    s_waitcnt lgkmcnt(6)
    v_mfma_f32_32x32x16_bf16 v[32:47], a[52:55], v[20:23], v[32:47]
    s_mov_b32 m0, 160768
    s_lshl_b32 s30, s98, 13
    s_add_u32 s30, s30, 2048
    buffer_load_dwordx4 v1, s[12:15], s30 offen lds
    v_fmaak_f32 v14, v12, v14, 0xc0135761
    v_mul_f32 v13, v13, v56
    v_mul_f32 v14, v14, v57
    v_exp_f32 v13, v13
    v_exp_f32 v14, v14
    ds_read_b64_tr_b16 v[20:21], v7 offset:29696
    ds_read_b64_tr_b16 v[22:23], v7 offset:29952
    s_waitcnt lgkmcnt(6)
    v_mfma_f32_32x32x16_bf16 v[32:47], a[56:59], v[24:27], v[32:47]
    v_add_f32 v13, 1.0, v13
    v_add_f32 v14, 1.0, v14
    v_rcp_f32 v13, v13
    v_rcp_f32 v14, v14
    v_mul_f32 v56, v56, v13
    ds_read_b64_tr_b16 v[24:25], v7 offset:30720
    ds_read_b64_tr_b16 v[26:27], v7 offset:30976
    s_waitcnt lgkmcnt(6)
    v_mfma_f32_32x32x16_bf16 v[32:47], a[60:63], v[28:31], v[32:47]
    v_mul_f32 v57, v57, v14
    v_add_f32 v10, v10, v56
    v_fmac_f32 v11, v56, v56
    v_add_f32 v10, v10, v57
    v_fmac_f32 v11, v57, v57
    ds_read_b64_tr_b16 v[28:29], v7 offset:31744
    ds_read_b64_tr_b16 v[30:31], v7 offset:32000
    s_waitcnt lgkmcnt(6)
    v_mfma_f32_32x32x16_bf16 v[32:47], a[64:67], v[16:19], v[32:47]
    v_cvt_pk_bf16_f32 v92, v56, v57
    v_mul_f32 v13, v58, v58
    v_mul_f32 v14, v59, v59
    v_fmaak_f32 v13, v12, v13, 0xc0135761
    v_fmaak_f32 v14, v12, v14, 0xc0135761
    ds_read_b64_tr_b16 v[16:17], v7 offset:32768
    ds_read_b64_tr_b16 v[18:19], v7 offset:33024
    s_waitcnt lgkmcnt(6)
    v_mfma_f32_32x32x16_bf16 v[32:47], a[68:71], v[20:23], v[32:47]
    s_mov_b32 m0, 160768
    s_lshl_b32 s30, s98, 13
    s_add_u32 s30, s30, 3072
    buffer_load_dwordx4 v1, s[12:15], s30 offen lds
    v_mul_f32 v13, v13, v58
    v_mul_f32 v14, v14, v59
    v_exp_f32 v13, v13
    v_exp_f32 v14, v14
    v_add_f32 v13, 1.0, v13
    ds_read_b64_tr_b16 v[20:21], v7 offset:33792
    ds_read_b64_tr_b16 v[22:23], v7 offset:34048
    s_waitcnt lgkmcnt(6)
    v_mfma_f32_32x32x16_bf16 v[32:47], a[72:75], v[24:27], v[32:47]
    v_add_f32 v14, 1.0, v14
    v_rcp_f32 v13, v13
    v_rcp_f32 v14, v14
    v_mul_f32 v58, v58, v13
    v_mul_f32 v59, v59, v14
    ds_read_b64_tr_b16 v[24:25], v7 offset:34816
    ds_read_b64_tr_b16 v[26:27], v7 offset:35072
    s_waitcnt lgkmcnt(6)
    v_mfma_f32_32x32x16_bf16 v[32:47], a[76:79], v[28:31], v[32:47]
    v_add_f32 v10, v10, v58
    v_fmac_f32 v11, v58, v58
    v_add_f32 v10, v10, v59
    v_fmac_f32 v11, v59, v59
    v_cvt_pk_bf16_f32 v93, v58, v59
    ds_read_b64_tr_b16 v[28:29], v7 offset:35840
    ds_read_b64_tr_b16 v[30:31], v7 offset:36096
    s_waitcnt lgkmcnt(6)
    v_mfma_f32_32x32x16_bf16 v[32:47], a[80:83], v[16:19], v[32:47]
    v_mul_f32 v13, v60, v60
    v_mul_f32 v14, v61, v61
    v_fmaak_f32 v13, v12, v13, 0xc0135761
    v_fmaak_f32 v14, v12, v14, 0xc0135761
    v_mul_f32 v13, v13, v60
    ds_read_b64_tr_b16 v[16:17], v7 offset:36864
    ds_read_b64_tr_b16 v[18:19], v7 offset:37120
    s_waitcnt lgkmcnt(6)
    v_mfma_f32_32x32x16_bf16 v[32:47], a[84:87], v[20:23], v[32:47]
    v_mul_f32 v14, v14, v61
    v_exp_f32 v13, v13
    v_exp_f32 v14, v14
    v_add_f32 v13, 1.0, v13
    v_add_f32 v14, 1.0, v14
    ds_read_b64_tr_b16 v[20:21], v7 offset:37888
    ds_read_b64_tr_b16 v[22:23], v7 offset:38144
    s_waitcnt lgkmcnt(6)
    v_mfma_f32_32x32x16_bf16 v[32:47], a[88:91], v[24:27], v[32:47]
    s_mov_b32 m0, 160768
    s_lshl_b32 s30, s98, 13
    s_add_u32 s30, s30, 4096
    buffer_load_dwordx4 v1, s[12:15], s30 offen lds
    v_rcp_f32 v13, v13
    v_rcp_f32 v14, v14
    v_mul_f32 v60, v60, v13
    v_mul_f32 v61, v61, v14
    v_add_f32 v10, v10, v60
    ds_read_b64_tr_b16 v[24:25], v7 offset:38912
    ds_read_b64_tr_b16 v[26:27], v7 offset:39168
    s_waitcnt lgkmcnt(6)
    v_mfma_f32_32x32x16_bf16 v[32:47], a[92:95], v[28:31], v[32:47]
    v_fmac_f32 v11, v60, v60
    v_add_f32 v10, v10, v61
    v_fmac_f32 v11, v61, v61
    v_cvt_pk_bf16_f32 v94, v60, v61
    v_mul_f32 v13, v62, v62
    v_mul_f32 v14, v63, v63
    ds_read_b64_tr_b16 v[28:29], v7 offset:39936
    ds_read_b64_tr_b16 v[30:31], v7 offset:40192
    s_waitcnt lgkmcnt(6)
    v_mfma_f32_32x32x16_bf16 v[32:47], a[96:99], v[16:19], v[32:47]
    v_fmaak_f32 v13, v12, v13, 0xc0135761
    v_fmaak_f32 v14, v12, v14, 0xc0135761
    v_mul_f32 v13, v13, v62
    v_mul_f32 v14, v14, v63
    v_exp_f32 v13, v13
    ds_read_b64_tr_b16 v[16:17], v7 offset:40960
    ds_read_b64_tr_b16 v[18:19], v7 offset:41216
    s_waitcnt lgkmcnt(6)
    v_mfma_f32_32x32x16_bf16 v[32:47], a[100:103], v[20:23], v[32:47]
    v_exp_f32 v14, v14
    v_add_f32 v13, 1.0, v13
    v_add_f32 v14, 1.0, v14
    v_rcp_f32 v13, v13
    v_rcp_f32 v14, v14
    ds_read_b64_tr_b16 v[20:21], v7 offset:41984
    ds_read_b64_tr_b16 v[22:23], v7 offset:42240
    s_waitcnt lgkmcnt(6)
    v_mfma_f32_32x32x16_bf16 v[32:47], a[104:107], v[24:27], v[32:47]
    s_mov_b32 m0, 160768
    s_lshl_b32 s30, s98, 13
    s_add_u32 s30, s30, 5120
    buffer_load_dwordx4 v1, s[12:15], s30 offen lds
    v_mul_f32 v62, v62, v13
    v_mul_f32 v63, v63, v14
    v_add_f32 v10, v10, v62
    v_fmac_f32 v11, v62, v62
    v_add_f32 v10, v10, v63
    ds_read_b64_tr_b16 v[24:25], v7 offset:43008
    ds_read_b64_tr_b16 v[26:27], v7 offset:43264
    s_waitcnt lgkmcnt(6)
    v_mfma_f32_32x32x16_bf16 v[32:47], a[108:111], v[28:31], v[32:47]
    v_fmac_f32 v11, v63, v63
    v_cvt_pk_bf16_f32 v95, v62, v63
    s_nop 0
    v_permlane32_swap_b32 v10, v11
    v_add_f32 v10, v10, v11
    v_and_b32 v13, 15, v0
    ds_read_b64_tr_b16 v[28:29], v7 offset:44032
    ds_read_b64_tr_b16 v[30:31], v7 offset:44288
    s_waitcnt lgkmcnt(6)
    v_mfma_f32_32x32x16_bf16 v[32:47], a[112:115], v[16:19], v[32:47]
    v_lshlrev_b32 v13, 4, v13
    v_bfe_u32 v14, v0, 4, 1
    v_lshl_add_u32 v13, v14, 3, v13
    v_bfe_u32 v14, v0, 5, 1
    v_lshl_add_u32 v13, v14, 2, v13
    ds_read_b64_tr_b16 v[16:17], v7 offset:45056
    ds_read_b64_tr_b16 v[18:19], v7 offset:45312
    s_waitcnt lgkmcnt(6)
    v_mfma_f32_32x32x16_bf16 v[32:47], a[116:119], v[20:23], v[32:47]
    buffer_store_dword v10, v13, s[16:19], s38 offen sc0 sc1
    v_cndmask_b32 v3, 0, 1.0, s[44:45]
    v_mul_f32 v4, 0x358637bd, v3
    v_mov_b32 v15, 0xff800000
    v_cndmask_b32 v9, v15, 0, s[44:45]
    ds_read_b64_tr_b16 v[20:21], v7 offset:46080
    ds_read_b64_tr_b16 v[22:23], v7 offset:46336
    s_waitcnt lgkmcnt(6)
    v_mfma_f32_32x32x16_bf16 v[32:47], a[120:123], v[24:27], v[32:47]
    v_mov_b32 v15, 0x7f800000
    v_mul_f32 v13, 0x3fb8aa3b, v64
    v_mul_f32 v14, 0x3fb8aa3b, v65
    v_min_f32 v13, 0, v13
    v_min_f32 v14, 0, v14
    ds_read_b64_tr_b16 v[24:25], v7 offset:47104
    ds_read_b64_tr_b16 v[26:27], v7 offset:47360
    s_waitcnt lgkmcnt(6)
    v_mfma_f32_32x32x16_bf16 v[32:47], a[124:127], v[28:31], v[32:47]
    v_exp_f32 v13, v13
    v_exp_f32 v14, v14
    v_med3_f32 v64, v64, v9, v15
    v_med3_f32 v65, v65, v9, v15
    v_fma_f32 v13, v13, v3, v4
    ds_read_b64_tr_b16 v[28:29], v7 offset:48128
    ds_read_b64_tr_b16 v[30:31], v7 offset:48384
    s_waitcnt lgkmcnt(6)
    v_mfma_f32_32x32x16_bf16 v[32:47], a[128:131], v[16:19], v[32:47]
    v_fma_f32 v14, v14, v3, v4
    v_add_f32 v64, v64, v13
    v_add_f32 v65, v65, v14
    v_cvt_pk_bf16_f32 v64, v64, v65
    v_mul_f32 v13, 0x3fb8aa3b, v66
    s_waitcnt lgkmcnt(4)
    v_mfma_f32_32x32x16_bf16 v[32:47], a[132:135], v[20:23], v[32:47]
    v_mul_f32 v14, 0x3fb8aa3b, v67
    v_min_f32 v13, 0, v13
    v_min_f32 v14, 0, v14
    v_exp_f32 v13, v13
    v_exp_f32 v14, v14
    s_waitcnt lgkmcnt(2)
    v_mfma_f32_32x32x16_bf16 v[32:47], a[136:139], v[24:27], v[32:47]
    v_med3_f32 v66, v66, v9, v15
    v_med3_f32 v67, v67, v9, v15
    v_fma_f32 v13, v13, v3, v4
    v_fma_f32 v14, v14, v3, v4
    v_add_f32 v66, v66, v13
    s_waitcnt lgkmcnt(0)
    v_mfma_f32_32x32x16_bf16 v[32:47], a[140:143], v[28:31], v[32:47]
    s_waitcnt vmcnt(6)
    s_barrier
    ds_read_b64_tr_b16 v[16:17], v5 offset:0
    ds_read_b64_tr_b16 v[18:19], v5 offset:256
    ds_read_b64_tr_b16 v[20:21], v5 offset:1024
    ds_read_b64_tr_b16 v[22:23], v5 offset:1280
    ds_read_b64_tr_b16 v[24:25], v5 offset:2048
    ds_read_b64_tr_b16 v[26:27], v5 offset:2304
    ds_read_b64_tr_b16 v[28:29], v5 offset:3072
    ds_read_b64_tr_b16 v[30:31], v5 offset:3328
    s_waitcnt lgkmcnt(6)
    v_mfma_f32_32x32x16_bf16 v[48:63], v[16:19], a[0:3], 0
    s_cmp_eq_u32 s99, 0
    s_cbranch_scc1 L_pr19
    s_setprio 1
L_pr19:
    ds_read_b64_tr_b16 v[16:17], v5 offset:4096
    ds_read_b64_tr_b16 v[18:19], v5 offset:4352
    s_waitcnt lgkmcnt(6)
    v_mfma_f32_32x32x16_bf16 v[48:63], v[20:23], a[4:7], v[48:63]
    v_add_f32 v67, v67, v14
    v_cvt_pk_bf16_f32 v65, v66, v67
    v_mul_f32 v13, 0x3fb8aa3b, v68
    v_mul_f32 v14, 0x3fb8aa3b, v69
    v_min_f32 v13, 0, v13
    v_min_f32 v14, 0, v14
    v_exp_f32 v13, v13
    ds_read_b64_tr_b16 v[20:21], v5 offset:5120
    ds_read_b64_tr_b16 v[22:23], v5 offset:5376
    s_waitcnt lgkmcnt(6)
    v_mfma_f32_32x32x16_bf16 v[48:63], v[24:27], a[8:11], v[48:63]
    v_exp_f32 v14, v14
    v_med3_f32 v68, v68, v9, v15
    v_med3_f32 v69, v69, v9, v15
    v_fma_f32 v13, v13, v3, v4
    v_fma_f32 v14, v14, v3, v4
    v_add_f32 v68, v68, v13
    ds_read_b64_tr_b16 v[24:25], v5 offset:6144
    ds_read_b64_tr_b16 v[26:27], v5 offset:6400
    s_waitcnt lgkmcnt(6)
    v_mfma_f32_32x32x16_bf16 v[48:63], v[28:31], a[12:15], v[48:63]
    v_add_f32 v69, v69, v14
    v_cvt_pk_bf16_f32 v66, v68, v69
    v_mul_f32 v13, 0x3fb8aa3b, v70
    v_mul_f32 v14, 0x3fb8aa3b, v71
    v_min_f32 v13, 0, v13
    v_min_f32 v14, 0, v14
    ds_read_b64_tr_b16 v[28:29], v5 offset:7168
    ds_read_b64_tr_b16 v[30:31], v5 offset:7424
    s_waitcnt lgkmcnt(6)
    v_mfma_f32_32x32x16_bf16 v[48:63], v[16:19], a[16:19], v[48:63]
    s_mov_b32 m0, 160768
    s_lshl_b32 s30, s98, 13
    s_add_u32 s30, s30, 6144
    buffer_load_dwordx4 v1, s[12:15], s30 offen lds
    v_exp_f32 v13, v13
    v_exp_f32 v14, v14
    v_med3_f32 v70, v70, v9, v15
    v_med3_f32 v71, v71, v9, v15
    v_fma_f32 v13, v13, v3, v4
    v_fma_f32 v14, v14, v3, v4
    ds_read_b64_tr_b16 v[16:17], v5 offset:8192
    ds_read_b64_tr_b16 v[18:19], v5 offset:8448
    s_waitcnt lgkmcnt(6)
    v_mfma_f32_32x32x16_bf16 v[48:63], v[20:23], a[20:23], v[48:63]
    v_add_f32 v70, v70, v13
    v_add_f32 v71, v71, v14
    v_cvt_pk_bf16_f32 v67, v70, v71
    v_mul_f32 v13, 0x3fb8aa3b, v72
    v_mul_f32 v14, 0x3fb8aa3b, v73
    v_min_f32 v13, 0, v13
    v_min_f32 v14, 0, v14
    ds_read_b64_tr_b16 v[20:21], v5 offset:9216
    ds_read_b64_tr_b16 v[22:23], v5 offset:9472
    s_waitcnt lgkmcnt(6)
    v_mfma_f32_32x32x16_bf16 v[48:63], v[24:27], a[24:27], v[48:63]
    v_exp_f32 v13, v13
    v_exp_f32 v14, v14
    v_med3_f32 v72, v72, v9, v15
    v_med3_f32 v73, v73, v9, v15
    v_fma_f32 v13, v13, v3, v4
    v_fma_f32 v14, v14, v3, v4
    ds_read_b64_tr_b16 v[24:25], v5 offset:10240
    ds_read_b64_tr_b16 v[26:27], v5 offset:10496
    s_waitcnt lgkmcnt(6)
    v_mfma_f32_32x32x16_bf16 v[48:63], v[28:31], a[28:31], v[48:63]
    v_add_f32 v72, v72, v13
    v_add_f32 v73, v73, v14
    v_cvt_pk_bf16_f32 v68, v72, v73
    v_mul_f32 v13, 0x3fb8aa3b, v74
    v_mul_f32 v14, 0x3fb8aa3b, v75
    v_min_f32 v13, 0, v13
    ds_read_b64_tr_b16 v[28:29], v5 offset:11264
    ds_read_b64_tr_b16 v[30:31], v5 offset:11520
    s_waitcnt lgkmcnt(6)
    v_mfma_f32_32x32x16_bf16 v[48:63], v[16:19], a[32:35], v[48:63]
    v_min_f32 v14, 0, v14
    v_exp_f32 v13, v13
    v_exp_f32 v14, v14
    v_med3_f32 v74, v74, v9, v15
    v_med3_f32 v75, v75, v9, v15
    v_fma_f32 v13, v13, v3, v4
    ds_read_b64_tr_b16 v[16:17], v5 offset:12288
    ds_read_b64_tr_b16 v[18:19], v5 offset:12544
    s_waitcnt lgkmcnt(6)
    v_mfma_f32_32x32x16_bf16 v[48:63], v[20:23], a[36:39], v[48:63]
    s_mov_b32 m0, 160768
    s_lshl_b32 s30, s98, 13
    s_add_u32 s30, s30, 7168
    buffer_load_dwordx4 v1, s[12:15], s30 offen lds
    v_fma_f32 v14, v14, v3, v4
    v_add_f32 v74, v74, v13
    v_add_f32 v75, v75, v14
    v_cvt_pk_bf16_f32 v69, v74, v75
    v_mul_f32 v13, 0x3fb8aa3b, v76
    v_mul_f32 v14, 0x3fb8aa3b, v77
    v_min_f32 v13, 0, v13
    ds_read_b64_tr_b16 v[20:21], v5 offset:13312
    ds_read_b64_tr_b16 v[22:23], v5 offset:13568
    s_waitcnt lgkmcnt(6)
    v_mfma_f32_32x32x16_bf16 v[48:63], v[24:27], a[40:43], v[48:63]
    v_min_f32 v14, 0, v14
    v_exp_f32 v13, v13
    v_exp_f32 v14, v14
    v_med3_f32 v76, v76, v9, v15
    v_med3_f32 v77, v77, v9, v15
    v_fma_f32 v13, v13, v3, v4
    ds_read_b64_tr_b16 v[24:25], v5 offset:14336
    ds_read_b64_tr_b16 v[26:27], v5 offset:14592
    s_waitcnt lgkmcnt(6)
    v_mfma_f32_32x32x16_bf16 v[48:63], v[28:31], a[44:47], v[48:63]
    v_fma_f32 v14, v14, v3, v4
    v_add_f32 v76, v76, v13
    v_add_f32 v77, v77, v14
    v_cvt_pk_bf16_f32 v70, v76, v77
    v_mul_f32 v13, 0x3fb8aa3b, v78
    v_mul_f32 v14, 0x3fb8aa3b, v79
    ds_read_b64_tr_b16 v[28:29], v5 offset:15360
    ds_read_b64_tr_b16 v[30:31], v5 offset:15616
    s_waitcnt lgkmcnt(6)
    v_mfma_f32_32x32x16_bf16 v[48:63], v[16:19], a[48:51], v[48:63]
    v_min_f32 v13, 0, v13
    v_min_f32 v14, 0, v14
    v_exp_f32 v13, v13
    v_exp_f32 v14, v14
    v_med3_f32 v78, v78, v9, v15
    v_med3_f32 v79, v79, v9, v15
    ds_read_b64_tr_b16 v[16:17], v5 offset:16384
    ds_read_b64_tr_b16 v[18:19], v5 offset:16640
    s_waitcnt lgkmcnt(6)
    v_mfma_f32_32x32x16_bf16 v[48:63], v[20:23], a[52:55], v[48:63]
    v_fma_f32 v13, v13, v3, v4
    v_fma_f32 v14, v14, v3, v4
    v_add_f32 v78, v78, v13
    v_add_f32 v79, v79, v14
    v_cvt_pk_bf16_f32 v71, v78, v79
    v_and_b32 v13, 31, v0
    v_lshrrev_b32 v14, 5, v0
    ds_read_b64_tr_b16 v[20:21], v5 offset:17408
    ds_read_b64_tr_b16 v[22:23], v5 offset:17664
    s_waitcnt lgkmcnt(6)
    v_mfma_f32_32x32x16_bf16 v[48:63], v[24:27], a[56:59], v[48:63]
    s_mov_b32 m0, 160768
    s_mul_i32 s30, s98, 3072
    s_add_u32 s30, s30, 0
    buffer_load_dwordx4 v1, s[20:23], s30 offen lds
    v_mul_u32_u24 v105, 80, v13
    v_lshl_add_u32 v105, v14, 4, v105
    v_add_u32 v105, s37, v105
    v_subrev_u32 v104, 2560, v105
    v_subrev_u32 v13, 6, v13
    v_lshlrev_b32 v106, 12, v13
    ds_read_b64_tr_b16 v[24:25], v5 offset:18432
    ds_read_b64_tr_b16 v[26:27], v5 offset:18688
    s_waitcnt lgkmcnt(6)
    v_mfma_f32_32x32x16_bf16 v[48:63], v[28:31], a[60:63], v[48:63]
    v_lshl_add_u32 v106, v14, 4, v106
    v_cndmask_b32 v3, 0, 1.0, s[46:47]
    v_mul_f32 v4, 0x358637bd, v3
    v_mov_b32 v15, 0xff800000
    v_cndmask_b32 v9, v15, 0, s[46:47]
    v_mov_b32 v15, 0x7f800000
    ds_read_b64_tr_b16 v[28:29], v5 offset:19456
    ds_read_b64_tr_b16 v[30:31], v5 offset:19712
    s_waitcnt lgkmcnt(6)
    v_mfma_f32_32x32x16_bf16 v[48:63], v[16:19], a[64:67], v[48:63]
    v_cndmask_b32 v9, v9, 1.0, s[48:49]
    v_cndmask_b32 v15, v15, 1.0, s[48:49]
    v_mul_f32 v13, 0x3fb8aa3b, v32
    v_mul_f32 v14, 0x3fb8aa3b, v33
    v_min_f32 v13, 0, v13
    v_min_f32 v14, 0, v14
    ds_read_b64_tr_b16 v[16:17], v5 offset:20480
    ds_read_b64_tr_b16 v[18:19], v5 offset:20736
    s_waitcnt lgkmcnt(6)
    v_mfma_f32_32x32x16_bf16 v[48:63], v[20:23], a[68:71], v[48:63]
    v_exp_f32 v13, v13
    v_exp_f32 v14, v14
    v_med3_f32 v32, v32, v9, v15
    v_med3_f32 v33, v33, v9, v15
    v_fma_f32 v13, v13, v3, v4
    v_fma_f32 v14, v14, v3, v4
    ds_read_b64_tr_b16 v[20:21], v5 offset:21504
    ds_read_b64_tr_b16 v[22:23], v5 offset:21760
    s_waitcnt lgkmcnt(6)
    v_mfma_f32_32x32x16_bf16 v[48:63], v[24:27], a[72:75], v[48:63]
    v_add_f32 v32, v32, v13
    v_add_f32 v33, v33, v14
    v_cvt_pk_bf16_f32 v72, v32, v33
    v_mul_f32 v13, 0x3fb8aa3b, v34
    v_mul_f32 v14, 0x3fb8aa3b, v35
    v_min_f32 v13, 0, v13
    v_min_f32 v14, 0, v14
    ds_read_b64_tr_b16 v[24:25], v5 offset:22528
    ds_read_b64_tr_b16 v[26:27], v5 offset:22784
    s_waitcnt lgkmcnt(6)
    v_mfma_f32_32x32x16_bf16 v[48:63], v[28:31], a[76:79], v[48:63]
    v_exp_f32 v13, v13
    v_exp_f32 v14, v14
    v_med3_f32 v34, v34, v9, v15
    v_med3_f32 v35, v35, v9, v15
    v_fma_f32 v13, v13, v3, v4
    v_fma_f32 v14, v14, v3, v4
    ds_read_b64_tr_b16 v[28:29], v5 offset:23552
    ds_read_b64_tr_b16 v[30:31], v5 offset:23808
    s_waitcnt lgkmcnt(6)
    v_mfma_f32_32x32x16_bf16 v[48:63], v[16:19], a[80:83], v[48:63]
    s_mov_b32 m0, 160768
    s_mul_i32 s30, s98, 3072
    s_add_u32 s30, s30, 1024
    buffer_load_dwordx4 v1, s[20:23], s30 offen lds
    v_add_f32 v34, v34, v13
    v_add_f32 v35, v35, v14
    v_cvt_pk_bf16_f32 v73, v34, v35
    v_mul_f32 v13, 0x3fb8aa3b, v36
    v_mul_f32 v14, 0x3fb8aa3b, v37
    v_min_f32 v13, 0, v13
    ds_read_b64_tr_b16 v[16:17], v5 offset:24576
    ds_read_b64_tr_b16 v[18:19], v5 offset:24832
    s_waitcnt lgkmcnt(6)
    v_mfma_f32_32x32x16_bf16 v[48:63], v[20:23], a[84:87], v[48:63]
    v_min_f32 v14, 0, v14
    v_exp_f32 v13, v13
    v_exp_f32 v14, v14
    v_med3_f32 v36, v36, v9, v15
    v_med3_f32 v37, v37, v9, v15
    v_fma_f32 v13, v13, v3, v4
    ds_read_b64_tr_b16 v[20:21], v5 offset:25600
    ds_read_b64_tr_b16 v[22:23], v5 offset:25856
    s_waitcnt lgkmcnt(6)
    v_mfma_f32_32x32x16_bf16 v[48:63], v[24:27], a[88:91], v[48:63]
    v_fma_f32 v14, v14, v3, v4
    v_add_f32 v36, v36, v13
    v_add_f32 v37, v37, v14
    v_cvt_pk_bf16_f32 v74, v36, v37
    v_mul_f32 v13, 0x3fb8aa3b, v38
    v_mul_f32 v14, 0x3fb8aa3b, v39
    v_min_f32 v13, 0, v13
    ds_read_b64_tr_b16 v[24:25], v5 offset:26624
    ds_read_b64_tr_b16 v[26:27], v5 offset:26880
    s_waitcnt lgkmcnt(6)
    v_mfma_f32_32x32x16_bf16 v[48:63], v[28:31], a[92:95], v[48:63]
    v_min_f32 v14, 0, v14
    v_exp_f32 v13, v13
    v_exp_f32 v14, v14
    v_med3_f32 v38, v38, v9, v15
    v_med3_f32 v39, v39, v9, v15
    v_fma_f32 v13, v13, v3, v4
    ds_read_b64_tr_b16 v[28:29], v5 offset:27648
    ds_read_b64_tr_b16 v[30:31], v5 offset:27904
    s_waitcnt lgkmcnt(6)
    v_mfma_f32_32x32x16_bf16 v[48:63], v[16:19], a[96:99], v[48:63]
    v_fma_f32 v14, v14, v3, v4
    v_add_f32 v38, v38, v13
    v_add_f32 v39, v39, v14
    v_cvt_pk_bf16_f32 v75, v38, v39
    v_mul_f32 v13, 0x3fb8aa3b, v40
    v_mul_f32 v14, 0x3fb8aa3b, v41
    ds_read_b64_tr_b16 v[16:17], v5 offset:28672
    ds_read_b64_tr_b16 v[18:19], v5 offset:28928
    s_waitcnt lgkmcnt(6)
    v_mfma_f32_32x32x16_bf16 v[48:63], v[20:23], a[100:103], v[48:63]
    s_mov_b32 m0, 160768
    s_mul_i32 s30, s98, 3072
    s_add_u32 s30, s30, 2048
    buffer_load_dwordx4 v1, s[20:23], s30 offen lds
    v_min_f32 v13, 0, v13
    v_min_f32 v14, 0, v14
    v_exp_f32 v13, v13
    v_exp_f32 v14, v14
    v_med3_f32 v40, v40, v9, v15
    v_med3_f32 v41, v41, v9, v15
    ds_read_b64_tr_b16 v[20:21], v5 offset:29696
    ds_read_b64_tr_b16 v[22:23], v5 offset:29952
    s_waitcnt lgkmcnt(6)
    v_mfma_f32_32x32x16_bf16 v[48:63], v[24:27], a[104:107], v[48:63]
    v_fma_f32 v13, v13, v3, v4
    v_fma_f32 v14, v14, v3, v4
    v_add_f32 v40, v40, v13
    v_add_f32 v41, v41, v14
    v_cvt_pk_bf16_f32 v76, v40, v41
    v_mul_f32 v13, 0x3fb8aa3b, v42
    v_mul_f32 v14, 0x3fb8aa3b, v43
    ds_read_b64_tr_b16 v[24:25], v5 offset:30720
    ds_read_b64_tr_b16 v[26:27], v5 offset:30976
    s_waitcnt lgkmcnt(6)
    v_mfma_f32_32x32x16_bf16 v[48:63], v[28:31], a[108:111], v[48:63]
    v_min_f32 v13, 0, v13
    v_min_f32 v14, 0, v14
    v_exp_f32 v13, v13
    v_exp_f32 v14, v14
    v_med3_f32 v42, v42, v9, v15
    v_med3_f32 v43, v43, v9, v15
    ds_read_b64_tr_b16 v[28:29], v5 offset:31744
    ds_read_b64_tr_b16 v[30:31], v5 offset:32000
    s_waitcnt lgkmcnt(6)
    v_mfma_f32_32x32x16_bf16 v[48:63], v[16:19], a[112:115], v[48:63]
    v_fma_f32 v13, v13, v3, v4
    v_fma_f32 v14, v14, v3, v4
    v_add_f32 v42, v42, v13
    v_add_f32 v43, v43, v14
    v_cvt_pk_bf16_f32 v77, v42, v43
    v_mul_f32 v13, 0x3fb8aa3b, v44
    ds_read_b64_tr_b16 v[16:17], v5 offset:32768
    ds_read_b64_tr_b16 v[18:19], v5 offset:33024
    s_waitcnt lgkmcnt(6)
    v_mfma_f32_32x32x16_bf16 v[48:63], v[20:23], a[116:119], v[48:63]
    v_mul_f32 v14, 0x3fb8aa3b, v45
    v_min_f32 v13, 0, v13
    v_min_f32 v14, 0, v14
    v_exp_f32 v13, v13
    v_exp_f32 v14, v14
    v_med3_f32 v44, v44, v9, v15
    ds_read_b64_tr_b16 v[20:21], v5 offset:33792
    ds_read_b64_tr_b16 v[22:23], v5 offset:34048
    s_waitcnt lgkmcnt(6)
    v_mfma_f32_32x32x16_bf16 v[48:63], v[24:27], a[120:123], v[48:63]
    v_med3_f32 v45, v45, v9, v15
    v_fma_f32 v13, v13, v3, v4
    v_fma_f32 v14, v14, v3, v4
    v_add_f32 v44, v44, v13
    v_add_f32 v45, v45, v14
    v_cvt_pk_bf16_f32 v78, v44, v45
    v_mul_f32 v13, 0x3fb8aa3b, v46
    ds_read_b64_tr_b16 v[24:25], v5 offset:34816
    ds_read_b64_tr_b16 v[26:27], v5 offset:35072
    s_waitcnt lgkmcnt(6)
    v_mfma_f32_32x32x16_bf16 v[48:63], v[28:31], a[124:127], v[48:63]
    v_mul_f32 v14, 0x3fb8aa3b, v47
    v_min_f32 v13, 0, v13
    v_min_f32 v14, 0, v14
    v_exp_f32 v13, v13
    v_exp_f32 v14, v14
    v_med3_f32 v46, v46, v9, v15
    ds_read_b64_tr_b16 v[28:29], v5 offset:35840
    ds_read_b64_tr_b16 v[30:31], v5 offset:36096
    s_waitcnt lgkmcnt(6)
    v_mfma_f32_32x32x16_bf16 v[48:63], v[16:19], a[128:131], v[48:63]
    v_med3_f32 v47, v47, v9, v15
    v_fma_f32 v13, v13, v3, v4
    v_fma_f32 v14, v14, v3, v4
    v_add_f32 v46, v46, v13
    v_add_f32 v47, v47, v14
    v_cvt_pk_bf16_f32 v79, v46, v47
    ds_read_b64_tr_b16 v[16:17], v5 offset:36864
    ds_read_b64_tr_b16 v[18:19], v5 offset:37120
    s_waitcnt lgkmcnt(6)
    v_mfma_f32_32x32x16_bf16 v[48:63], v[20:23], a[132:135], v[48:63]
    v_mfma_f32_32x32x16_bf16 v[32:47], v[64:67], v[64:67], 0
    v_mfma_f32_32x32x16_bf16 v[32:47], v[68:71], v[68:71], v[32:47]
    s_mov_b32 exec_lo, 0xfffc0000
    s_mov_b32 exec_hi, 0xfffc0000
    s_nop 7
    s_nop 1
    ds_write_b128 v104, v[32:35]
    ds_write_b128 v104, v[36:39] offset:32
    s_mov_b32 exec_hi, 0
    ds_write_b128 v104, v[40:43] offset:64
    s_mov_b64 exec, -1
    s_waitcnt lgkmcnt(0)
    v_mfma_f32_32x32x16_bf16 v[32:47], v[64:67], v[72:75], 0
    v_mfma_f32_32x32x16_bf16 v[32:47], v[68:71], v[76:79], v[32:47]
    ds_read_b64_tr_b16 v[20:21], v5 offset:37888
    ds_read_b64_tr_b16 v[22:23], v5 offset:38144
    v_mfma_f32_32x32x16_bf16 v[48:63], v[24:27], a[136:139], v[48:63]
    v_permlane32_swap_b32 v72, v74
    v_permlane32_swap_b32 v73, v75
    v_permlane32_swap_b32 v76, v78
    v_permlane32_swap_b32 v77, v79
    s_mov_b32 exec_lo, 0x00ffffc0
    s_mov_b32 exec_hi, 0x00ffffc0
    buffer_store_dwordx4 v[72:75], v106, s[16:19], s36 offen
    buffer_store_dwordx4 v[76:79], v106, s[16:19], s36 offen offset:32
    s_mov_b64 exec, -1
    s_mov_b32 exec_lo, 0x0000001f
    s_mov_b32 exec_hi, 0x0000001f
    ds_write_b128 v105, v[32:35]
    ds_write_b128 v105, v[36:39] offset:32
    s_mov_b32 exec_hi, 0
    ds_write_b128 v105, v[40:43] offset:64
    s_mov_b64 exec, -1
    ds_read_b64_tr_b16 v[24:25], v5 offset:38912
    ds_read_b64_tr_b16 v[26:27], v5 offset:39168
    v_mfma_f32_32x32x16_bf16 v[48:63], v[28:31], a[140:143], v[48:63]
    ds_read_b64_tr_b16 v[28:29], v5 offset:39936
    ds_read_b64_tr_b16 v[30:31], v5 offset:40192
    v_mfma_f32_32x32x16_bf16 v[64:79], v[16:19], a[0:3], 0
    s_cmp_eq_u32 s99, 0
    s_cbranch_scc1 L_pr20
    s_setprio 0
L_pr20:
    ds_read_b64_tr_b16 v[16:17], v5 offset:40960
    ds_read_b64_tr_b16 v[18:19], v5 offset:41216
    s_waitcnt lgkmcnt(9)
    v_mfma_f32_32x32x16_bf16 v[64:79], v[20:23], a[4:7], v[64:79]
    s_add_u32 s29, s41, 4096
    buffer_load_dwordx4 v[32:35], v1, s[16:19], s41 offen offset:0 sc1
    buffer_load_dwordx4 v[36:39], v1, s[16:19], s41 offen offset:1024 sc1
    buffer_load_dwordx4 v[40:43], v1, s[16:19], s41 offen offset:2048 sc1
    buffer_load_dwordx4 v[44:47], v1, s[16:19], s41 offen offset:3072 sc1
    ds_read_b64_tr_b16 v[20:21], v5 offset:41984
    ds_read_b64_tr_b16 v[22:23], v5 offset:42240
    s_waitcnt lgkmcnt(6)
    v_mfma_f32_32x32x16_bf16 v[64:79], v[24:27], a[8:11], v[64:79]
    v_mul_f32 v13, v48, v48
    v_mul_f32 v14, v49, v49
    v_fmaak_f32 v13, v12, v13, 0xc0135761
    v_fmaak_f32 v14, v12, v14, 0xc0135761
    ds_read_b64_tr_b16 v[24:25], v5 offset:43008
    ds_read_b64_tr_b16 v[26:27], v5 offset:43264
    s_waitcnt lgkmcnt(6)
    v_mfma_f32_32x32x16_bf16 v[64:79], v[28:31], a[12:15], v[64:79]
    v_mul_f32 v13, v13, v48
    v_mul_f32 v14, v14, v49
    v_exp_f32 v13, v13
    v_exp_f32 v14, v14
    ds_read_b64_tr_b16 v[28:29], v5 offset:44032
    ds_read_b64_tr_b16 v[30:31], v5 offset:44288
    s_waitcnt lgkmcnt(6)
    v_mfma_f32_32x32x16_bf16 v[64:79], v[16:19], a[16:19], v[64:79]
    v_add_f32 v13, 1.0, v13
    v_add_f32 v14, 1.0, v14
    v_rcp_f32 v13, v13
    v_rcp_f32 v14, v14
    ds_read_b64_tr_b16 v[16:17], v5 offset:45056
    ds_read_b64_tr_b16 v[18:19], v5 offset:45312
    s_waitcnt lgkmcnt(6)
    v_mfma_f32_32x32x16_bf16 v[64:79], v[20:23], a[20:23], v[64:79]
    v_mul_f32 v48, v48, v13
    v_mul_f32 v49, v49, v14
    v_cvt_pk_bf16_f32 v48, v48, v49
    v_mul_f32 v13, v50, v50
    v_mul_f32 v14, v51, v51
    ds_read_b64_tr_b16 v[20:21], v5 offset:46080
    ds_read_b64_tr_b16 v[22:23], v5 offset:46336
    s_waitcnt lgkmcnt(6)
    v_mfma_f32_32x32x16_bf16 v[64:79], v[24:27], a[24:27], v[64:79]
    v_fmaak_f32 v13, v12, v13, 0xc0135761
    v_fmaak_f32 v14, v12, v14, 0xc0135761
    v_mul_f32 v13, v13, v50
    v_mul_f32 v14, v14, v51
    ds_read_b64_tr_b16 v[24:25], v5 offset:47104
    ds_read_b64_tr_b16 v[26:27], v5 offset:47360
    s_waitcnt lgkmcnt(6)
    v_mfma_f32_32x32x16_bf16 v[64:79], v[28:31], a[28:31], v[64:79]
    v_exp_f32 v13, v13
    v_exp_f32 v14, v14
    v_add_f32 v13, 1.0, v13
    v_add_f32 v14, 1.0, v14
    ds_read_b64_tr_b16 v[28:29], v5 offset:48128
    ds_read_b64_tr_b16 v[30:31], v5 offset:48384
    s_waitcnt lgkmcnt(6)
    v_mfma_f32_32x32x16_bf16 v[64:79], v[16:19], a[32:35], v[64:79]
    v_rcp_f32 v13, v13
    v_rcp_f32 v14, v14
    v_mul_f32 v50, v50, v13
    v_mul_f32 v51, v51, v14
    ds_read_b64_tr_b16 v[16:17], v6 offset:0
    ds_read_b64_tr_b16 v[18:19], v6 offset:256
    s_waitcnt lgkmcnt(6)
    v_mfma_f32_32x32x16_bf16 v[64:79], v[20:23], a[36:39], v[64:79]
    v_cvt_pk_bf16_f32 v49, v50, v51
    v_mul_f32 v13, v56, v56
    v_mul_f32 v14, v57, v57
    v_fmaak_f32 v13, v12, v13, 0xc0135761
    v_fmaak_f32 v14, v12, v14, 0xc0135761
    ds_read_b64_tr_b16 v[20:21], v6 offset:1024
    ds_read_b64_tr_b16 v[22:23], v6 offset:1280
    s_waitcnt lgkmcnt(6)
    v_mfma_f32_32x32x16_bf16 v[64:79], v[24:27], a[40:43], v[64:79]
    v_mul_f32 v13, v13, v56
    v_mul_f32 v14, v14, v57
    v_exp_f32 v13, v13
    v_exp_f32 v14, v14
    ds_read_b64_tr_b16 v[24:25], v6 offset:2048
    ds_read_b64_tr_b16 v[26:27], v6 offset:2304
    s_waitcnt lgkmcnt(6)
    v_mfma_f32_32x32x16_bf16 v[64:79], v[28:31], a[44:47], v[64:79]
    v_add_f32 v13, 1.0, v13
    v_add_f32 v14, 1.0, v14
    v_rcp_f32 v13, v13
    v_rcp_f32 v14, v14
    ds_read_b64_tr_b16 v[28:29], v6 offset:3072
    ds_read_b64_tr_b16 v[30:31], v6 offset:3328
    s_waitcnt lgkmcnt(6)
    v_mfma_f32_32x32x16_bf16 v[64:79], v[16:19], a[48:51], v[64:79]
    v_mul_f32 v56, v56, v13
    v_mul_f32 v57, v57, v14
    v_cvt_pk_bf16_f32 v50, v56, v57
    v_mul_f32 v13, v58, v58
    ds_read_b64_tr_b16 v[16:17], v6 offset:4096
    ds_read_b64_tr_b16 v[18:19], v6 offset:4352
    s_waitcnt lgkmcnt(6)
    v_mfma_f32_32x32x16_bf16 v[64:79], v[20:23], a[52:55], v[64:79]
    v_mul_f32 v14, v59, v59
    v_fmaak_f32 v13, v12, v13, 0xc0135761
    v_fmaak_f32 v14, v12, v14, 0xc0135761
    v_mul_f32 v13, v13, v58
    v_mul_f32 v14, v14, v59
    ds_read_b64_tr_b16 v[20:21], v6 offset:5120
    ds_read_b64_tr_b16 v[22:23], v6 offset:5376
    s_waitcnt lgkmcnt(6)
    v_mfma_f32_32x32x16_bf16 v[64:79], v[24:27], a[56:59], v[64:79]
    v_exp_f32 v13, v13
    v_exp_f32 v14, v14
    v_add_f32 v13, 1.0, v13
    v_add_f32 v14, 1.0, v14
    ds_read_b64_tr_b16 v[24:25], v6 offset:6144
    ds_read_b64_tr_b16 v[26:27], v6 offset:6400
    s_waitcnt lgkmcnt(6)
    v_mfma_f32_32x32x16_bf16 v[64:79], v[28:31], a[60:63], v[64:79]
    v_rcp_f32 v13, v13
    v_rcp_f32 v14, v14
    v_mul_f32 v58, v58, v13
    v_mul_f32 v59, v59, v14
    ds_read_b64_tr_b16 v[28:29], v6 offset:7168
    ds_read_b64_tr_b16 v[30:31], v6 offset:7424
    s_waitcnt lgkmcnt(6)
    v_mfma_f32_32x32x16_bf16 v[64:79], v[16:19], a[64:67], v[64:79]
    v_cvt_pk_bf16_f32 v51, v58, v59
    buffer_store_dwordx4 v[48:51], v8, s[16:19], s52 offen offset:0 sc0 sc1
    s_waitcnt vmcnt(1)
    v_add_f32 v108, v32, v36
    ds_read_b64_tr_b16 v[16:17], v6 offset:8192
    ds_read_b64_tr_b16 v[18:19], v6 offset:8448
    s_waitcnt lgkmcnt(6)
    v_mfma_f32_32x32x16_bf16 v[64:79], v[20:23], a[68:71], v[64:79]
    v_add_f32 v108, v108, v40
    v_add_f32 v108, v108, v44
    v_add_f32 v109, v33, v37
    v_add_f32 v109, v109, v41
    ds_read_b64_tr_b16 v[20:21], v6 offset:9216
    ds_read_b64_tr_b16 v[22:23], v6 offset:9472
    s_waitcnt lgkmcnt(6)
    v_mfma_f32_32x32x16_bf16 v[64:79], v[24:27], a[72:75], v[64:79]
    v_add_f32 v109, v109, v45
    v_add_f32 v110, v34, v38
    v_add_f32 v110, v110, v42
    v_add_f32 v110, v110, v46
    v_add_f32 v111, v35, v39
    ds_read_b64_tr_b16 v[24:25], v6 offset:10240
    ds_read_b64_tr_b16 v[26:27], v6 offset:10496
    s_waitcnt lgkmcnt(6)
    v_mfma_f32_32x32x16_bf16 v[64:79], v[28:31], a[76:79], v[64:79]
    v_add_f32 v111, v111, v43
    v_add_f32 v111, v111, v47
    buffer_load_dwordx4 v[32:35], v1, s[16:19], s29 offen offset:0 sc1
    buffer_load_dwordx4 v[36:39], v1, s[16:19], s29 offen offset:1024 sc1
    ds_read_b64_tr_b16 v[28:29], v6 offset:11264
    ds_read_b64_tr_b16 v[30:31], v6 offset:11520
    s_waitcnt lgkmcnt(6)
    v_mfma_f32_32x32x16_bf16 v[64:79], v[16:19], a[80:83], v[64:79]
    buffer_load_dwordx4 v[40:43], v1, s[16:19], s29 offen offset:2048 sc1
    buffer_load_dwordx4 v[44:47], v1, s[16:19], s29 offen offset:3072 sc1
    v_mul_f32 v13, v52, v52
    v_mul_f32 v14, v53, v53
    ds_read_b64_tr_b16 v[16:17], v6 offset:12288
    ds_read_b64_tr_b16 v[18:19], v6 offset:12544
    s_waitcnt lgkmcnt(6)
    v_mfma_f32_32x32x16_bf16 v[64:79], v[20:23], a[84:87], v[64:79]
    v_fmaak_f32 v13, v12, v13, 0xc0135761
    v_fmaak_f32 v14, v12, v14, 0xc0135761
    v_mul_f32 v13, v13, v52
    v_mul_f32 v14, v14, v53
    ds_read_b64_tr_b16 v[20:21], v6 offset:13312
    ds_read_b64_tr_b16 v[22:23], v6 offset:13568
    s_waitcnt lgkmcnt(6)
    v_mfma_f32_32x32x16_bf16 v[64:79], v[24:27], a[88:91], v[64:79]
    v_exp_f32 v13, v13
    v_exp_f32 v14, v14
    v_add_f32 v13, 1.0, v13
    v_add_f32 v14, 1.0, v14
    v_rcp_f32 v13, v13
    ds_read_b64_tr_b16 v[24:25], v6 offset:14336
    ds_read_b64_tr_b16 v[26:27], v6 offset:14592
    s_waitcnt lgkmcnt(6)
    v_mfma_f32_32x32x16_bf16 v[64:79], v[28:31], a[92:95], v[64:79]
    v_rcp_f32 v14, v14
    v_mul_f32 v52, v52, v13
    v_mul_f32 v53, v53, v14
    v_cvt_pk_bf16_f32 v52, v52, v53
    ds_read_b64_tr_b16 v[28:29], v6 offset:15360
    ds_read_b64_tr_b16 v[30:31], v6 offset:15616
    s_waitcnt lgkmcnt(6)
    v_mfma_f32_32x32x16_bf16 v[64:79], v[16:19], a[96:99], v[64:79]
    v_mul_f32 v13, v54, v54
    v_mul_f32 v14, v55, v55
    v_fmaak_f32 v13, v12, v13, 0xc0135761
    v_fmaak_f32 v14, v12, v14, 0xc0135761
    ds_read_b64_tr_b16 v[16:17], v6 offset:16384
    ds_read_b64_tr_b16 v[18:19], v6 offset:16640
    s_waitcnt lgkmcnt(6)
    v_mfma_f32_32x32x16_bf16 v[64:79], v[20:23], a[100:103], v[64:79]
    v_mul_f32 v13, v13, v54
    v_mul_f32 v14, v14, v55
    v_exp_f32 v13, v13
    v_exp_f32 v14, v14
    ds_read_b64_tr_b16 v[20:21], v6 offset:17408
    ds_read_b64_tr_b16 v[22:23], v6 offset:17664
    s_waitcnt lgkmcnt(6)
    v_mfma_f32_32x32x16_bf16 v[64:79], v[24:27], a[104:107], v[64:79]
    v_add_f32 v13, 1.0, v13
    v_add_f32 v14, 1.0, v14
    v_rcp_f32 v13, v13
    v_rcp_f32 v14, v14
    v_mul_f32 v54, v54, v13
    ds_read_b64_tr_b16 v[24:25], v6 offset:18432
    ds_read_b64_tr_b16 v[26:27], v6 offset:18688
    s_waitcnt lgkmcnt(6)
    v_mfma_f32_32x32x16_bf16 v[64:79], v[28:31], a[108:111], v[64:79]
    v_mul_f32 v55, v55, v14
    v_cvt_pk_bf16_f32 v53, v54, v55
    v_mul_f32 v13, v60, v60
    v_mul_f32 v14, v61, v61
    ds_read_b64_tr_b16 v[28:29], v6 offset:19456
    ds_read_b64_tr_b16 v[30:31], v6 offset:19712
    s_waitcnt lgkmcnt(6)
    v_mfma_f32_32x32x16_bf16 v[64:79], v[16:19], a[112:115], v[64:79]
    v_fmaak_f32 v13, v12, v13, 0xc0135761
    v_fmaak_f32 v14, v12, v14, 0xc0135761
    v_mul_f32 v13, v13, v60
    v_mul_f32 v14, v14, v61
    ds_read_b64_tr_b16 v[16:17], v6 offset:20480
    ds_read_b64_tr_b16 v[18:19], v6 offset:20736
    s_waitcnt lgkmcnt(6)
    v_mfma_f32_32x32x16_bf16 v[64:79], v[20:23], a[116:119], v[64:79]
    v_exp_f32 v13, v13
    v_exp_f32 v14, v14
    v_add_f32 v13, 1.0, v13
    v_add_f32 v14, 1.0, v14
    ds_read_b64_tr_b16 v[20:21], v6 offset:21504
    ds_read_b64_tr_b16 v[22:23], v6 offset:21760
    s_waitcnt lgkmcnt(6)
    v_mfma_f32_32x32x16_bf16 v[64:79], v[24:27], a[120:123], v[64:79]
    v_rcp_f32 v13, v13
    v_rcp_f32 v14, v14
    v_mul_f32 v60, v60, v13
    v_mul_f32 v61, v61, v14
    v_cvt_pk_bf16_f32 v54, v60, v61
    ds_read_b64_tr_b16 v[24:25], v6 offset:22528
    ds_read_b64_tr_b16 v[26:27], v6 offset:22784
    s_waitcnt lgkmcnt(6)
    v_mfma_f32_32x32x16_bf16 v[64:79], v[28:31], a[124:127], v[64:79]
    v_mul_f32 v13, v62, v62
    v_mul_f32 v14, v63, v63
    v_fmaak_f32 v13, v12, v13, 0xc0135761
    v_fmaak_f32 v14, v12, v14, 0xc0135761
    ds_read_b64_tr_b16 v[28:29], v6 offset:23552
    ds_read_b64_tr_b16 v[30:31], v6 offset:23808
    s_waitcnt lgkmcnt(6)
    v_mfma_f32_32x32x16_bf16 v[64:79], v[16:19], a[128:131], v[64:79]
    v_mul_f32 v13, v13, v62
    v_mul_f32 v14, v14, v63
    v_exp_f32 v13, v13
    v_exp_f32 v14, v14
    s_waitcnt lgkmcnt(4)
    v_mfma_f32_32x32x16_bf16 v[64:79], v[20:23], a[132:135], v[64:79]
    v_add_f32 v13, 1.0, v13
    v_add_f32 v14, 1.0, v14
    v_rcp_f32 v13, v13
    v_rcp_f32 v14, v14
    s_waitcnt lgkmcnt(2)
    v_mfma_f32_32x32x16_bf16 v[64:79], v[24:27], a[136:139], v[64:79]
    v_mul_f32 v62, v62, v13
    v_mul_f32 v63, v63, v14
    v_cvt_pk_bf16_f32 v55, v62, v63
    buffer_store_dwordx4 v[52:55], v8, s[16:19], s52 offen offset:512 sc0 sc1
    s_waitcnt lgkmcnt(0)
    v_mfma_f32_32x32x16_bf16 v[64:79], v[28:31], a[140:143], v[64:79]
    s_getpc_b64 s[64:65]
L_gemm1_kernel_pc:
    s_add_u32 s64, s64, gemm2_kernel-L_gemm1_kernel_pc
    s_addc_u32 s65, s65, 0
    s_mov_b32 s66, gemm3_kernel-gemm2_kernel
    s_mov_b32 s67, 0x20000
    s_bfe_u32 s30, s2, 0x20003
    s_lshl_b32 s30, s30, 1
    s_lshr_b32 s28, s2, 7
    s_add_u32 s30, s30, s28
    s_lshl_b32 s30, s30, 3
    s_add_u32 s30, s30, s26
    s_lshl_b32 s30, s30, 10
    s_mov_b32 m0, 160768
    s_nop 0
    buffer_load_dwordx4 v1, s[64:67], s30 offen lds
    v_mul_f32 v13, v64, v64
    v_mul_f32 v14, v65, v65
    v_fmaak_f32 v13, v12, v13, 0xc0135761
    v_fmaak_f32 v14, v12, v14, 0xc0135761
    v_mul_f32 v13, v13, v64
    v_mul_f32 v14, v14, v65
    v_exp_f32 v13, v13
    v_exp_f32 v14, v14
    v_add_f32 v13, 1.0, v13
    v_add_f32 v14, 1.0, v14
    v_rcp_f32 v13, v13
    v_rcp_f32 v14, v14
    v_mul_f32 v64, v64, v13
    v_mul_f32 v65, v65, v14
    v_cvt_pk_bf16_f32 v64, v64, v65
    v_mul_f32 v13, v66, v66
    v_mul_f32 v14, v67, v67
    v_fmaak_f32 v13, v12, v13, 0xc0135761
    v_fmaak_f32 v14, v12, v14, 0xc0135761
    v_mul_f32 v13, v13, v66
    v_mul_f32 v14, v14, v67
    v_exp_f32 v13, v13
    v_exp_f32 v14, v14
    v_add_f32 v13, 1.0, v13
    v_add_f32 v14, 1.0, v14
    v_rcp_f32 v13, v13
    v_rcp_f32 v14, v14
    v_mul_f32 v66, v66, v13
    v_mul_f32 v67, v67, v14
    v_cvt_pk_bf16_f32 v65, v66, v67
    v_mul_f32 v13, v72, v72
    v_mul_f32 v14, v73, v73
    v_fmaak_f32 v13, v12, v13, 0xc0135761
    v_fmaak_f32 v14, v12, v14, 0xc0135761
    v_mul_f32 v13, v13, v72
    v_mul_f32 v14, v14, v73
    v_exp_f32 v13, v13
    v_exp_f32 v14, v14
    v_add_f32 v13, 1.0, v13
    v_add_f32 v14, 1.0, v14
    v_rcp_f32 v13, v13
    v_rcp_f32 v14, v14
    v_mul_f32 v72, v72, v13
    v_mul_f32 v73, v73, v14
    v_cvt_pk_bf16_f32 v66, v72, v73
    v_mul_f32 v13, v74, v74
    v_mul_f32 v14, v75, v75
    v_fmaak_f32 v13, v12, v13, 0xc0135761
    v_fmaak_f32 v14, v12, v14, 0xc0135761
    v_mul_f32 v13, v13, v74
    v_mul_f32 v14, v14, v75
    v_exp_f32 v13, v13
    v_exp_f32 v14, v14
    v_add_f32 v13, 1.0, v13
    v_add_f32 v14, 1.0, v14
    v_rcp_f32 v13, v13
    v_rcp_f32 v14, v14
    v_mul_f32 v74, v74, v13
    v_mul_f32 v75, v75, v14
    v_cvt_pk_bf16_f32 v67, v74, v75
    buffer_store_dwordx4 v[64:67], v8, s[16:19], s53 offen offset:0 sc0 sc1
    v_mul_f32 v13, v68, v68
    v_mul_f32 v14, v69, v69
    v_fmaak_f32 v13, v12, v13, 0xc0135761
    v_fmaak_f32 v14, v12, v14, 0xc0135761
    v_mul_f32 v13, v13, v68
    v_mul_f32 v14, v14, v69
    v_exp_f32 v13, v13
    v_exp_f32 v14, v14
    v_add_f32 v13, 1.0, v13
    v_add_f32 v14, 1.0, v14
    v_rcp_f32 v13, v13
    v_rcp_f32 v14, v14
    v_mul_f32 v68, v68, v13
    v_mul_f32 v69, v69, v14
    v_cvt_pk_bf16_f32 v68, v68, v69
    v_mul_f32 v13, v70, v70
    v_mul_f32 v14, v71, v71
    v_fmaak_f32 v13, v12, v13, 0xc0135761
    v_fmaak_f32 v14, v12, v14, 0xc0135761
    v_mul_f32 v13, v13, v70
    v_mul_f32 v14, v14, v71
    v_exp_f32 v13, v13
    v_exp_f32 v14, v14
    v_add_f32 v13, 1.0, v13
    v_add_f32 v14, 1.0, v14
    v_rcp_f32 v13, v13
    v_rcp_f32 v14, v14
    v_mul_f32 v70, v70, v13
    v_mul_f32 v71, v71, v14
    v_cvt_pk_bf16_f32 v69, v70, v71
    v_mul_f32 v13, v76, v76
    v_mul_f32 v14, v77, v77
    v_fmaak_f32 v13, v12, v13, 0xc0135761
    v_fmaak_f32 v14, v12, v14, 0xc0135761
    v_mul_f32 v13, v13, v76
    v_mul_f32 v14, v14, v77
    v_exp_f32 v13, v13
    v_exp_f32 v14, v14
    v_add_f32 v13, 1.0, v13
    v_add_f32 v14, 1.0, v14
    v_rcp_f32 v13, v13
    v_rcp_f32 v14, v14
    v_mul_f32 v76, v76, v13
    v_mul_f32 v77, v77, v14
    v_cvt_pk_bf16_f32 v70, v76, v77
    v_mul_f32 v13, v78, v78
    v_mul_f32 v14, v79, v79
    v_fmaak_f32 v13, v12, v13, 0xc0135761
    v_fmaak_f32 v14, v12, v14, 0xc0135761
    v_mul_f32 v13, v13, v78
    v_mul_f32 v14, v14, v79
    v_exp_f32 v13, v13
    v_exp_f32 v14, v14
    v_add_f32 v13, 1.0, v13
    v_add_f32 v14, 1.0, v14
    v_rcp_f32 v13, v13
    v_rcp_f32 v14, v14
    v_mul_f32 v78, v78, v13
    v_mul_f32 v79, v79, v14
    v_cvt_pk_bf16_f32 v71, v78, v79
    buffer_store_dwordx4 v[68:71], v8, s[16:19], s53 offen offset:512 sc0 sc1
    s_waitcnt vmcnt(4)
    v_add_f32 v108, v108, v32
    v_add_f32 v108, v108, v36
    v_add_f32 v108, v108, v40
    v_add_f32 v108, v108, v44
    v_add_f32 v109, v109, v33
    v_add_f32 v109, v109, v37
    v_add_f32 v109, v109, v41
    v_add_f32 v109, v109, v45
    v_add_f32 v110, v110, v34
    v_add_f32 v110, v110, v38
    v_add_f32 v110, v110, v42
    v_add_f32 v110, v110, v46
    v_add_f32 v111, v111, v35
    v_add_f32 v111, v111, v39
    v_add_f32 v111, v111, v43
    v_add_f32 v111, v111, v47
    v_permlane32_swap_b32 v108, v109
    s_nop 0
    v_permlane32_swap_b32 v110, v111
    v_add_f32 v108, v108, v109
    v_add_f32 v110, v110, v111
    s_nop 1
    v_permlane16_swap_b32 v108, v110
    v_add_f32 v10, v108, v110
    v_cmp_u_f32 vcc, v10, v10
    s_cbranch_vccz L_gemm1_kernel_C_go
    s_mov_b32 s59, 0
L_gemm1_kernel_C_poll:
    buffer_load_dwordx4 v[32:35], v1, s[16:19], s41 offen offset:0 sc1
    buffer_load_dwordx4 v[36:39], v1, s[16:19], s41 offen offset:1024 sc1
    buffer_load_dwordx4 v[40:43], v1, s[16:19], s41 offen offset:2048 sc1
    buffer_load_dwordx4 v[44:47], v1, s[16:19], s41 offen offset:3072 sc1
    s_waitcnt vmcnt(0)
    v_add_f32 v108, v32, v36
    v_add_f32 v108, v108, v40
    v_add_f32 v108, v108, v44
    v_add_f32 v109, v33, v37
    v_add_f32 v109, v109, v41
    v_add_f32 v109, v109, v45
    v_add_f32 v110, v34, v38
    v_add_f32 v110, v110, v42
    v_add_f32 v110, v110, v46
    v_add_f32 v111, v35, v39
    v_add_f32 v111, v111, v43
    v_add_f32 v111, v111, v47
    buffer_load_dwordx4 v[32:35], v1, s[16:19], s29 offen offset:0 sc1
    buffer_load_dwordx4 v[36:39], v1, s[16:19], s29 offen offset:1024 sc1
    buffer_load_dwordx4 v[40:43], v1, s[16:19], s29 offen offset:2048 sc1
    buffer_load_dwordx4 v[44:47], v1, s[16:19], s29 offen offset:3072 sc1
    s_waitcnt vmcnt(0)
    v_add_f32 v108, v108, v32
    v_add_f32 v108, v108, v36
    v_add_f32 v108, v108, v40
    v_add_f32 v108, v108, v44
    v_add_f32 v109, v109, v33
    v_add_f32 v109, v109, v37
    v_add_f32 v109, v109, v41
    v_add_f32 v109, v109, v45
    v_add_f32 v110, v110, v34
    v_add_f32 v110, v110, v38
    v_add_f32 v110, v110, v42
    v_add_f32 v110, v110, v46
    v_add_f32 v111, v111, v35
    v_add_f32 v111, v111, v39
    v_add_f32 v111, v111, v43
    v_add_f32 v111, v111, v47
    v_permlane32_swap_b32 v108, v109
    s_nop 0
    v_permlane32_swap_b32 v110, v111
    v_add_f32 v108, v108, v109
    v_add_f32 v110, v110, v111
    s_nop 1
    v_permlane16_swap_b32 v108, v110
    v_add_f32 v10, v108, v110
    v_cmp_u_f32 vcc, v10, v10
    s_cbranch_vccz L_gemm1_kernel_C_go
    s_sleep 4
    s_add_u32 s59, s59, 1
    s_cmp_lt_u32 s59, 0x40000
    s_cbranch_scc1 L_gemm1_kernel_C_poll
L_gemm1_kernel_C_go:
    v_mov_b32 v11, v10
    s_nop 1
    v_permlane32_swap_b32 v10, v11
    v_mul_f32 v10, 0x39e38e39, v10
    v_mul_f32 v11, 0x39e38e39, v11
    v_fma_f32 v11, -v10, v10, v11
    v_max_f32 v11, 0, v11
    v_cvt_pk_bf16_f32 v13, v10, v11
    v_lshlrev_b32 v10, 16, v13
    v_and_b32 v11, 0xffff0000, v13
    v_add_f32 v11, 0x3727c5ac, v11
    v_cvt_pk_bf16_f32 v11, v11, v11
    v_and_b32 v11, 0xffff0000, v11
    v_sqrt_f32 v11, v11
    s_nop 0
    v_cvt_pk_bf16_f32 v11, v11, v11
    v_and_b32 v11, 0xffff0000, v11
    v_rcp_f32 v11, v11
    s_nop 0
    v_mul_f32 v10, v10, v11
    s_mul_i32 s28, s26, 6912
    s_add_u32 s28, s28, 73728
    v_and_b32 v13, 31, v0
    v_mul_u32_u24 v107, 72, v13
    v_lshrrev_b32 v13, 5, v0
    v_lshl_add_u32 v107, v13, 3, v107
    v_add_u32 v107, s28, v107
    v_lshrrev_b32 v13, 4, v0
    v_lshlrev_b32 v13, 3, v13
    v_bfe_u32 v14, v0, 2, 2
    v_add_u32 v13, v13, v14
    v_mul_u32_u24 v106, 72, v13
    v_and_b32 v13, 3, v0
    v_lshl_add_u32 v106, v13, 3, v106
    v_add_u32 v106, s28, v106
    v_lshlrev_b32 v13, 16, v80
    v_and_b32 v14, 0xffff0000, v80
    v_fma_f32 v13, v13, v11, -v10
    v_fma_f32 v14, v14, v11, -v10
    v_cvt_pk_bf16_f32 v80, v13, v14
    v_lshlrev_b32 v13, 16, v81
    v_and_b32 v14, 0xffff0000, v81
    v_fma_f32 v13, v13, v11, -v10
    v_fma_f32 v14, v14, v11, -v10
    v_cvt_pk_bf16_f32 v81, v13, v14
    ds_write_b64 v107, v[80:81] offset:0
    v_lshlrev_b32 v13, 16, v82
    v_and_b32 v14, 0xffff0000, v82
    v_fma_f32 v13, v13, v11, -v10
    v_fma_f32 v14, v14, v11, -v10
    v_cvt_pk_bf16_f32 v82, v13, v14
    v_lshlrev_b32 v13, 16, v83
    v_and_b32 v14, 0xffff0000, v83
    v_fma_f32 v13, v13, v11, -v10
    v_fma_f32 v14, v14, v11, -v10
    v_cvt_pk_bf16_f32 v83, v13, v14
    ds_write_b64 v107, v[82:83] offset:16
    v_lshlrev_b32 v13, 16, v84
    v_and_b32 v14, 0xffff0000, v84
    v_fma_f32 v13, v13, v11, -v10
    v_fma_f32 v14, v14, v11, -v10
    v_cvt_pk_bf16_f32 v84, v13, v14
    v_lshlrev_b32 v13, 16, v85
    v_and_b32 v14, 0xffff0000, v85
    v_fma_f32 v13, v13, v11, -v10
    v_fma_f32 v14, v14, v11, -v10
    v_cvt_pk_bf16_f32 v85, v13, v14
    ds_write_b64 v107, v[84:85] offset:32
    v_lshlrev_b32 v13, 16, v86
    v_and_b32 v14, 0xffff0000, v86
    v_fma_f32 v13, v13, v11, -v10
    v_fma_f32 v14, v14, v11, -v10
    v_cvt_pk_bf16_f32 v86, v13, v14
    v_lshlrev_b32 v13, 16, v87
    v_and_b32 v14, 0xffff0000, v87
    v_fma_f32 v13, v13, v11, -v10
    v_fma_f32 v14, v14, v11, -v10
    v_cvt_pk_bf16_f32 v87, v13, v14
    ds_write_b64 v107, v[86:87] offset:48
    s_waitcnt lgkmcnt(0)
    ds_read_b64_tr_b16 v[32:33], v106 offset:0
    ds_read_b64_tr_b16 v[34:35], v106 offset:288
    ds_read_b64_tr_b16 v[36:37], v106 offset:32
    ds_read_b64_tr_b16 v[38:39], v106 offset:320
    v_lshlrev_b32 v13, 16, v88
    v_and_b32 v14, 0xffff0000, v88
    v_fma_f32 v13, v13, v11, -v10
    v_fma_f32 v14, v14, v11, -v10
    v_cvt_pk_bf16_f32 v88, v13, v14
    v_lshlrev_b32 v13, 16, v89
    v_and_b32 v14, 0xffff0000, v89
    v_fma_f32 v13, v13, v11, -v10
    v_fma_f32 v14, v14, v11, -v10
    v_cvt_pk_bf16_f32 v89, v13, v14
    ds_write_b64 v107, v[88:89] offset:2304
    v_lshlrev_b32 v13, 16, v90
    v_and_b32 v14, 0xffff0000, v90
    v_fma_f32 v13, v13, v11, -v10
    v_fma_f32 v14, v14, v11, -v10
    v_cvt_pk_bf16_f32 v90, v13, v14
    v_lshlrev_b32 v13, 16, v91
    v_and_b32 v14, 0xffff0000, v91
    v_fma_f32 v13, v13, v11, -v10
    v_fma_f32 v14, v14, v11, -v10
    v_cvt_pk_bf16_f32 v91, v13, v14
    ds_write_b64 v107, v[90:91] offset:2320
    v_lshlrev_b32 v13, 16, v92
    v_and_b32 v14, 0xffff0000, v92
    v_fma_f32 v13, v13, v11, -v10
    v_fma_f32 v14, v14, v11, -v10
    v_cvt_pk_bf16_f32 v92, v13, v14
    v_lshlrev_b32 v13, 16, v93
    v_and_b32 v14, 0xffff0000, v93
    v_fma_f32 v13, v13, v11, -v10
    v_fma_f32 v14, v14, v11, -v10
    v_cvt_pk_bf16_f32 v93, v13, v14
    ds_write_b64 v107, v[92:93] offset:2336
    v_lshlrev_b32 v13, 16, v94
    v_and_b32 v14, 0xffff0000, v94
    v_fma_f32 v13, v13, v11, -v10
    v_fma_f32 v14, v14, v11, -v10
    v_cvt_pk_bf16_f32 v94, v13, v14
    v_lshlrev_b32 v13, 16, v95
    v_and_b32 v14, 0xffff0000, v95
    v_fma_f32 v13, v13, v11, -v10
    v_fma_f32 v14, v14, v11, -v10
    v_cvt_pk_bf16_f32 v95, v13, v14
    ds_write_b64 v107, v[94:95] offset:2352
    s_waitcnt lgkmcnt(6)
    s_add_u32 s30, s56, 0
    buffer_store_dwordx4 v[32:35], v1, s[16:19], s30 offen sc0 sc1
    s_waitcnt lgkmcnt(4)
    s_add_u32 s30, s56, 65536
    buffer_store_dwordx4 v[36:39], v1, s[16:19], s30 offen sc0 sc1
    s_waitcnt lgkmcnt(0)
    ds_read_b64_tr_b16 v[40:41], v106 offset:2304
    ds_read_b64_tr_b16 v[42:43], v106 offset:2592
    ds_read_b64_tr_b16 v[44:45], v106 offset:2336
    ds_read_b64_tr_b16 v[46:47], v106 offset:2624
    s_waitcnt lgkmcnt(2)
    s_add_u32 s30, s56, 131072
    buffer_store_dwordx4 v[40:43], v1, s[16:19], s30 offen sc0 sc1
    s_waitcnt lgkmcnt(0)
    s_add_u32 s30, s56, 196608
    buffer_store_dwordx4 v[44:47], v1, s[16:19], s30 offen sc0 sc1
    s_waitcnt lgkmcnt(0)
    s_barrier
    s_lshl_b32 s30, s26, 8
    v_lshl_add_u32 v4, v0, 2, s30
    v_add_u32 v13, 147456, v4
    ds_read_b32 v48, v13 offset:0
    ds_read_b32 v49, v13 offset:1520
    ds_read_b32 v50, v13 offset:3040
    ds_read_b32 v51, v13 offset:4560
    v_mov_b32 v14, 0x40000000
    v_cmp_gt_u32 vcc, 1520, v4
    s_nop 1
    v_cndmask_b32 v4, v14, v4, vcc
    s_waitcnt lgkmcnt(0)
    v_add_f32 v14, v48, v49
    v_add_f32 v15, v50, v51
    ds_read_b32 v48, v13 offset:6080
    ds_read_b32 v49, v13 offset:7600
    ds_read_b32 v50, v13 offset:9120
    ds_read_b32 v51, v13 offset:10640
    v_add_f32 v14, v14, v15
    s_waitcnt lgkmcnt(0)
    v_add_f32 v15, v48, v49
    v_add_f32 v14, v14, v50
    v_add_f32 v15, v15, v51
    v_add_f32 v14, v14, v15
    buffer_store_dword v14, v4, s[16:19], s55 offen
    s_endpgm
L_gemm1_kernel_end:
    s_endpgm
.globl gemm2_kernel
.p2align 8
.type gemm2_kernel,@function
gemm2_kernel:
    s_cmp_ge_u32 s2, 256
    s_cbranch_scc1 L_gemm2_kernel_end
    s_load_dwordx4 s[4:7], s[0:1], 40
    s_load_dwordx2 s[62:63], s[0:1], 80
    s_load_dwordx2 s[64:65], s[0:1], 16
    s_load_dwordx2 s[66:67], s[0:1], 56
    v_mov_b32 v15, v0
    v_lshrrev_b32 v1, 6, v0
    v_and_b32 v0, 63, v0
    v_readfirstlane_b32 s26, v1
    s_and_b32 s28, s2, 7
    s_lshr_b32 s29, s2, 3
    s_and_b32 s24, s28, 1
    s_lshl_b32 s24, s24, 3
    s_and_b32 s30, s29, 7
    s_add_u32 s24, s24, s30
    s_lshr_b32 s25, s28, 1
    s_lshl_b32 s25, s25, 2
    s_lshr_b32 s30, s29, 3
    s_add_u32 s25, s25, s30
    s_mul_i32 s33, s26, 36864
    s_mul_i32 s32, s25, 589824
    s_lshl_b32 s30, s26, 11
    s_add_u32 s32, s32, s30
    s_add_u32 s32, s32, 16777216
    s_lshl_b32 s31, s24, 19
    s_lshl_b32 s30, s26, 7
    s_add_u32 s31, s31, s30
    s_lshl_b32 s34, s26, 17
    s_add_u32 s30, s34, 0
    s_and_b32 s30, s30, 0x7ffff
    s_add_u32 s40, s30, s31
    s_add_u32 s30, s34, 65536
    s_and_b32 s30, s30, 0x7ffff
    s_add_u32 s41, s30, s31
    s_add_u32 s30, s34, 131072
    s_and_b32 s30, s30, 0x7ffff
    s_add_u32 s42, s30, s31
    s_add_u32 s30, s34, 196608
    s_and_b32 s30, s30, 0x7ffff
    s_add_u32 s43, s30, s31
    s_add_u32 s30, s34, 262144
    s_and_b32 s30, s30, 0x7ffff
    s_add_u32 s44, s30, s31
    s_add_u32 s30, s34, 327680
    s_and_b32 s30, s30, 0x7ffff
    s_add_u32 s45, s30, s31
    s_add_u32 s30, s34, 393216
    s_and_b32 s30, s30, 0x7ffff
    s_add_u32 s46, s30, s31
    s_add_u32 s30, s34, 458752
    s_and_b32 s30, s30, 0x7ffff
    s_add_u32 s47, s30, s31
    s_mul_i32 s30, s28, 512
    s_mul_i32 s31, s24, 0
    s_add_u32 s30, s30, s31
    s_mul_i32 s31, s25, 0
    s_add_u32 s30, s30, s31
    s_add_u32 s31, s30, 0
    s_and_b32 s88, s31, 0xfff
    s_add_u32 s31, s30, 512
    s_and_b32 s89, s31, 0xfff
    s_add_u32 s31, s30, 1024
    s_and_b32 s90, s31, 0xfff
    s_add_u32 s31, s30, 1536
    s_and_b32 s91, s31, 0xfff
    s_add_u32 s31, s30, 2048
    s_and_b32 s92, s31, 0xfff
    s_add_u32 s31, s30, 2560
    s_and_b32 s93, s31, 0xfff
    s_add_u32 s31, s30, 3072
    s_and_b32 s94, s31, 0xfff
    s_add_u32 s31, s30, 3584
    s_and_b32 s95, s31, 0xfff
    v_lshlrev_b32 v1, 4, v0
    v_lshrrev_b32 v6, 3, v0
    v_lshlrev_b32 v2, 12, v6
    v_and_b32 v6, 7, v0
    v_lshrrev_b32 v7, 4, v0
    v_xor_b32 v6, v6, v7
    v_lshl_add_u32 v2, v6, 4, v2
    v_xor_b32 v3, 64, v2
    v_add_u32 v3, 32768, v3
    v_add_u32 v6, 0, v1
    v_add_u32 v7, 65536, v1
    v_add_u32 v8, 131072, v1
    v_add_u32 v9, 196608, v1
    v_add_u32 v10, 262144, v1
    v_add_u32 v11, 327680, v1
    v_add_u32 v12, 393216, v1
    v_add_u32 v13, 458752, v1
    v_add_u32 v14, 524288, v1
    s_waitcnt lgkmcnt(0)
    s_mov_b32 s8, s4
    s_mov_b32 s9, s5
    s_mov_b32 s10, 8388608
    s_mov_b32 s11, 0x20000
    s_mov_b32 s12, s62
    s_mov_b32 s13, s63
    s_mov_b32 s14, 67108864
    s_mov_b32 s15, 0x20000
    s_add_u32 m0, s33, 0
    s_add_u32 s30, s40, s88
    buffer_load_dwordx4 v2, s[8:11], s30 offen lds
    s_add_u32 m0, s33, 1024
    s_add_u32 s30, s40, s88
    buffer_load_dwordx4 v3, s[8:11], s30 offen lds
    s_add_u32 m0, s33, 2048
    s_add_u32 s30, s41, s88
    buffer_load_dwordx4 v2, s[8:11], s30 offen lds
    s_add_u32 m0, s33, 3072
    s_add_u32 s30, s41, s88
    buffer_load_dwordx4 v3, s[8:11], s30 offen lds
    s_add_u32 m0, s33, 4096
    s_add_u32 s30, s42, s88
    buffer_load_dwordx4 v2, s[8:11], s30 offen lds
    s_add_u32 m0, s33, 5120
    s_add_u32 s30, s42, s88
    buffer_load_dwordx4 v3, s[8:11], s30 offen lds
    s_add_u32 m0, s33, 6144
    s_add_u32 s30, s43, s88
    buffer_load_dwordx4 v2, s[8:11], s30 offen lds
    s_add_u32 m0, s33, 7168
    s_add_u32 s30, s43, s88
    buffer_load_dwordx4 v3, s[8:11], s30 offen lds
    s_lshl_b32 s31, s88, 4
    s_add_u32 s31, s31, s32
    buffer_load_dwordx4 v[16:19], v6, s[12:15], s31 offen offset:0
    buffer_load_dwordx4 v[20:23], v7, s[12:15], s31 offen offset:0
    buffer_load_dwordx4 v[24:27], v8, s[12:15], s31 offen offset:0
    buffer_load_dwordx4 v[28:31], v9, s[12:15], s31 offen offset:0
    buffer_load_dwordx4 v[32:35], v10, s[12:15], s31 offen offset:0
    buffer_load_dwordx4 v[36:39], v11, s[12:15], s31 offen offset:0
    buffer_load_dwordx4 v[40:43], v12, s[12:15], s31 offen offset:0
    buffer_load_dwordx4 v[44:47], v13, s[12:15], s31 offen offset:0
    buffer_load_dwordx4 v[48:51], v14, s[12:15], s31 offen offset:0
    s_add_u32 m0, s33, 8192
    s_add_u32 s30, s44, s88
    buffer_load_dwordx4 v2, s[8:11], s30 offen lds
    s_add_u32 m0, s33, 9216
    s_add_u32 s30, s44, s88
    buffer_load_dwordx4 v3, s[8:11], s30 offen lds
    s_add_u32 m0, s33, 10240
    s_add_u32 s30, s45, s88
    buffer_load_dwordx4 v2, s[8:11], s30 offen lds
    s_add_u32 m0, s33, 11264
    s_add_u32 s30, s45, s88
    buffer_load_dwordx4 v3, s[8:11], s30 offen lds
    s_add_u32 m0, s33, 12288
    s_add_u32 s30, s46, s88
    buffer_load_dwordx4 v2, s[8:11], s30 offen lds
    s_add_u32 m0, s33, 13312
    s_add_u32 s30, s46, s88
    buffer_load_dwordx4 v3, s[8:11], s30 offen lds
    s_add_u32 m0, s33, 14336
    s_add_u32 s30, s47, s88
    buffer_load_dwordx4 v2, s[8:11], s30 offen lds
    s_add_u32 m0, s33, 15360
    s_add_u32 s30, s47, s88
    buffer_load_dwordx4 v3, s[8:11], s30 offen lds
    s_mul_i32 s50, s29, 1520
    s_add_u32 s50, s50, 54525952
    s_mul_i32 s51, s29, 73728
    s_lshl_b32 s30, s28, 9
    s_add_u32 s51, s51, s30
    s_add_u32 s51, s51, 50331648
    s_mul_i32 s55, s28, 144
    s_mul_i32 s52, s29, 20736
    s_add_u32 s52, s52, s55
    s_add_u32 s55, s55, 56623104
    s_mul_i32 s53, s28, 1474560
    s_add_u32 s53, s53, 33554432
    s_mul_i32 s54, s29, 9
    s_lshl_b32 s30, s24, 3
    s_lshl_b32 s31, s26, 1
    s_add_u32 s30, s30, s31
    s_mul_i32 s31, s25, 9
    s_lshr_b32 s31, s31, 1
    s_lshl_b32 s31, s31, 10
    s_mul_i32 s56, s30, 73728
    s_add_u32 s56, s56, s31
    s_add_u32 s56, s56, 4194304
    s_add_u32 s57, s56, 73728
    s_mul_i32 s58, s30, 92160
    s_add_u32 s58, s58, s31
    s_add_u32 s58, s58, 33572864
    s_add_u32 s59, s58, 92160
    s_lshl_b32 s60, s30, 5
    s_mov_b32 s16, s64
    s_mov_b32 s17, s65
    s_mov_b32 s18, 663552
    s_mov_b32 s19, 0x20000
    s_mov_b32 s36, s66
    s_mov_b32 s37, s67
    s_mov_b32 s38, 2654208
    s_mov_b32 s39, 0x20000
    s_lshl_b32 s61, s29, 2
    s_add_u32 s61, s61, s26
    s_mul_i32 s61, s61, 21504
    s_mov_b32 s20, s6
    s_mov_b32 s21, s7
    s_mov_b32 s22, 4096
    s_mov_b32 s23, 0x20000
    v_mov_b32 v252, 0xbdd2d3e8
    v_and_b32 v246, 15, v0
    v_lshlrev_b32 v4, 7, v246
    v_lshrrev_b32 v246, 1, v246
    v_lshrrev_b32 v247, 4, v0
    v_xor_b32 v246, v246, v247
    v_lshl_add_u32 v4, v246, 4, v4
    v_xor_b32 v5, 64, v4
    v_add_u32 v4, s33, v4
    v_add_u32 v5, s33, v5
    v_mov_b32 v244, 0
    v_mov_b32 v248, 0
    v_and_b32 v255, 15, v0
    v_lshlrev_b32 v255, 1, v255
    buffer_load_short_d16_hi v244, v255, s[20:23], s60 offen
    buffer_load_short_d16_hi v248, v255, s[20:23], s60 offen offset:32
    s_waitcnt vmcnt(19)
    ds_read_b128 v[160:163], v4 offset:4096
    ds_read_b128 v[164:167], v4 offset:6144
    s_waitcnt vmcnt(10)
    s_waitcnt vmcnt(2)
    ds_read_b128 v[168:171], v4 offset:8192
    s_waitcnt lgkmcnt(2)
    v_mfma_f32_16x16x32_bf16 a[0:3], v[16:19], v[160:163], 0
    s_lshl_b32 s31, s88, 4
    s_add_u32 s31, s31, s32
    buffer_load_dwordx4 v[52:55], v6, s[12:15], s31 offen offset:1024
    v_mfma_f32_16x16x32_bf16 a[4:7], v[20:23], v[160:163], 0
    v_mfma_f32_16x16x32_bf16 a[8:11], v[24:27], v[160:163], 0
    buffer_load_dwordx4 v[56:59], v7, s[12:15], s31 offen offset:1024
    v_mfma_f32_16x16x32_bf16 a[12:15], v[28:31], v[160:163], 0
    v_mfma_f32_16x16x32_bf16 a[16:19], v[32:35], v[160:163], 0
    buffer_load_dwordx4 v[60:63], v8, s[12:15], s31 offen offset:1024
    v_mfma_f32_16x16x32_bf16 a[20:23], v[36:39], v[160:163], 0
    v_mfma_f32_16x16x32_bf16 a[24:27], v[40:43], v[160:163], 0
    buffer_load_dwordx4 v[64:67], v9, s[12:15], s31 offen offset:1024
    v_mfma_f32_16x16x32_bf16 a[28:31], v[44:47], v[160:163], 0
    v_mfma_f32_16x16x32_bf16 a[32:35], v[48:51], v[160:163], 0
    buffer_load_dwordx4 v[68:71], v10, s[12:15], s31 offen offset:1024
    ds_read_b128 v[160:163], v4 offset:10240
    s_waitcnt lgkmcnt(2)
    v_mfma_f32_16x16x32_bf16 a[36:39], v[16:19], v[164:167], 0
    v_mfma_f32_16x16x32_bf16 a[40:43], v[20:23], v[164:167], 0
    buffer_load_dwordx4 v[72:75], v11, s[12:15], s31 offen offset:1024
    v_mfma_f32_16x16x32_bf16 a[44:47], v[24:27], v[164:167], 0
    v_mfma_f32_16x16x32_bf16 a[48:51], v[28:31], v[164:167], 0
    buffer_load_dwordx4 v[76:79], v12, s[12:15], s31 offen offset:1024
    v_mfma_f32_16x16x32_bf16 a[52:55], v[32:35], v[164:167], 0
    v_mfma_f32_16x16x32_bf16 a[56:59], v[36:39], v[164:167], 0
    buffer_load_dwordx4 v[80:83], v13, s[12:15], s31 offen offset:1024
    v_mfma_f32_16x16x32_bf16 a[60:63], v[40:43], v[164:167], 0
    v_mfma_f32_16x16x32_bf16 a[64:67], v[44:47], v[164:167], 0
    buffer_load_dwordx4 v[84:87], v14, s[12:15], s31 offen offset:1024
    v_mfma_f32_16x16x32_bf16 a[68:71], v[48:51], v[164:167], 0
    ds_read_b128 v[164:167], v4 offset:12288
    s_waitcnt lgkmcnt(2)
    v_mfma_f32_16x16x32_bf16 a[72:75], v[16:19], v[168:171], 0
    s_add_u32 m0, s33, 16384
    s_add_u32 s30, s40, s89
    buffer_load_dwordx4 v2, s[8:11], s30 offen lds
    v_mfma_f32_16x16x32_bf16 a[76:79], v[20:23], v[168:171], 0
    v_mfma_f32_16x16x32_bf16 a[80:83], v[24:27], v[168:171], 0
    s_add_u32 m0, s33, 17408
    s_add_u32 s30, s40, s89
    buffer_load_dwordx4 v3, s[8:11], s30 offen lds
    v_mfma_f32_16x16x32_bf16 a[84:87], v[28:31], v[168:171], 0
    v_mfma_f32_16x16x32_bf16 a[88:91], v[32:35], v[168:171], 0
    s_add_u32 m0, s33, 18432
    s_add_u32 s30, s41, s89
    buffer_load_dwordx4 v2, s[8:11], s30 offen lds
    v_mfma_f32_16x16x32_bf16 a[92:95], v[36:39], v[168:171], 0
    v_mfma_f32_16x16x32_bf16 a[96:99], v[40:43], v[168:171], 0
    v_mfma_f32_16x16x32_bf16 a[100:103], v[44:47], v[168:171], 0
    s_add_u32 m0, s33, 19456
    s_add_u32 s30, s41, s89
    buffer_load_dwordx4 v3, s[8:11], s30 offen lds
    v_mfma_f32_16x16x32_bf16 a[104:107], v[48:51], v[168:171], 0
    ds_read_b128 v[168:171], v4 offset:14336
    s_waitcnt lgkmcnt(2)
    v_mfma_f32_16x16x32_bf16 a[108:111], v[16:19], v[160:163], 0
    s_add_u32 m0, s33, 20480
    s_add_u32 s30, s42, s89
    buffer_load_dwordx4 v2, s[8:11], s30 offen lds
    v_mfma_f32_16x16x32_bf16 a[112:115], v[20:23], v[160:163], 0
    v_mfma_f32_16x16x32_bf16 a[116:119], v[24:27], v[160:163], 0
    s_add_u32 m0, s33, 21504
    s_add_u32 s30, s42, s89
    buffer_load_dwordx4 v3, s[8:11], s30 offen lds
    v_mfma_f32_16x16x32_bf16 a[120:123], v[28:31], v[160:163], 0
    v_mfma_f32_16x16x32_bf16 a[124:127], v[32:35], v[160:163], 0
    s_add_u32 m0, s33, 22528
    s_add_u32 s30, s43, s89
    buffer_load_dwordx4 v2, s[8:11], s30 offen lds
    v_mfma_f32_16x16x32_bf16 a[128:131], v[36:39], v[160:163], 0
    v_mfma_f32_16x16x32_bf16 a[132:135], v[40:43], v[160:163], 0
    s_add_u32 m0, s33, 23552
    s_add_u32 s30, s43, s89
    buffer_load_dwordx4 v3, s[8:11], s30 offen lds
    v_mfma_f32_16x16x32_bf16 a[136:139], v[44:47], v[160:163], 0
    v_mfma_f32_16x16x32_bf16 a[140:143], v[48:51], v[160:163], 0
    s_add_u32 m0, s33, 24576
    s_add_u32 s30, s44, s89
    buffer_load_dwordx4 v2, s[8:11], s30 offen lds
    ds_read_b128 v[160:163], v4 offset:0
    s_waitcnt lgkmcnt(2)
    v_mfma_f32_16x16x32_bf16 a[144:147], v[16:19], v[164:167], 0
    v_mfma_f32_16x16x32_bf16 a[148:151], v[20:23], v[164:167], 0
    s_lshl_b32 s31, s89, 4
    s_add_u32 s31, s31, s32
    buffer_load_dwordx4 v[88:91], v6, s[12:15], s31 offen offset:0
    v_mfma_f32_16x16x32_bf16 a[152:155], v[24:27], v[164:167], 0
    v_mfma_f32_16x16x32_bf16 a[156:159], v[28:31], v[164:167], 0
    buffer_load_dwordx4 v[92:95], v7, s[12:15], s31 offen offset:0
    v_mfma_f32_16x16x32_bf16 a[160:163], v[32:35], v[164:167], 0
    v_mfma_f32_16x16x32_bf16 a[164:167], v[36:39], v[164:167], 0
    s_add_u32 m0, s33, 25600
    s_add_u32 s30, s44, s89
    buffer_load_dwordx4 v3, s[8:11], s30 offen lds
    v_mfma_f32_16x16x32_bf16 a[168:171], v[40:43], v[164:167], 0
    v_mfma_f32_16x16x32_bf16 a[172:175], v[44:47], v[164:167], 0
    buffer_load_dwordx4 v[96:99], v8, s[12:15], s31 offen offset:0
    v_mfma_f32_16x16x32_bf16 a[176:179], v[48:51], v[164:167], 0
    ds_read_b128 v[164:167], v4 offset:2048
    s_waitcnt vmcnt(22) lgkmcnt(2)
    v_mov_b32 v245, v244
    v_mov_b32 v246, v244
    v_mov_b32 v247, v244
    v_mov_b32 v249, v248
    v_mov_b32 v250, v248
    v_mov_b32 v251, v248
    v_mfma_f32_16x16x32_bf16 a[180:183], v[16:19], v[168:171], 0
    s_add_u32 m0, s33, 26624
    s_add_u32 s30, s45, s89
    buffer_load_dwordx4 v2, s[8:11], s30 offen lds
    v_mfma_f32_16x16x32_bf16 a[184:187], v[20:23], v[168:171], 0
    v_mfma_f32_16x16x32_bf16 a[188:191], v[24:27], v[168:171], 0
    v_mfma_f32_16x16x32_bf16 a[192:195], v[28:31], v[168:171], 0
    buffer_load_dwordx4 v[100:103], v9, s[12:15], s31 offen offset:0
    v_mfma_f32_16x16x32_bf16 a[196:199], v[32:35], v[168:171], 0
    v_mfma_f32_16x16x32_bf16 a[200:203], v[36:39], v[168:171], 0
    s_add_u32 m0, s33, 27648
    s_add_u32 s30, s45, s89
    buffer_load_dwordx4 v3, s[8:11], s30 offen lds
    v_mfma_f32_16x16x32_bf16 a[204:207], v[40:43], v[168:171], 0
    v_mfma_f32_16x16x32_bf16 a[208:211], v[44:47], v[168:171], 0
    buffer_load_dwordx4 v[104:107], v10, s[12:15], s31 offen offset:0
    v_mfma_f32_16x16x32_bf16 a[212:215], v[48:51], v[168:171], 0
    ds_read_b128 v[168:171], v5 offset:0
    s_waitcnt lgkmcnt(2)
    v_mfma_f32_16x16x32_bf16 v[172:175], v[16:19], v[160:163], v[244:247]
    s_add_u32 m0, s33, 28672
    s_add_u32 s30, s46, s89
    buffer_load_dwordx4 v2, s[8:11], s30 offen lds
    v_mfma_f32_16x16x32_bf16 v[176:179], v[20:23], v[160:163], v[244:247]
    v_mfma_f32_16x16x32_bf16 v[180:183], v[24:27], v[160:163], v[244:247]
    buffer_load_dwordx4 v[108:111], v11, s[12:15], s31 offen offset:0
    v_mfma_f32_16x16x32_bf16 v[184:187], v[28:31], v[160:163], v[244:247]
    v_mfma_f32_16x16x32_bf16 v[188:191], v[32:35], v[160:163], v[244:247]
    s_add_u32 m0, s33, 29696
    s_add_u32 s30, s46, s89
    buffer_load_dwordx4 v3, s[8:11], s30 offen lds
    v_mfma_f32_16x16x32_bf16 v[192:195], v[36:39], v[160:163], v[244:247]
    v_mfma_f32_16x16x32_bf16 v[196:199], v[40:43], v[160:163], v[244:247]
    buffer_load_dwordx4 v[112:115], v12, s[12:15], s31 offen offset:0
    v_mfma_f32_16x16x32_bf16 v[200:203], v[44:47], v[160:163], v[244:247]
    v_mfma_f32_16x16x32_bf16 v[204:207], v[48:51], v[160:163], v[244:247]
    s_add_u32 m0, s33, 30720
    s_add_u32 s30, s47, s89
    buffer_load_dwordx4 v2, s[8:11], s30 offen lds
    ds_read_b128 v[160:163], v5 offset:2048
    s_waitcnt lgkmcnt(2)
    v_mfma_f32_16x16x32_bf16 v[208:211], v[16:19], v[164:167], v[248:251]
    v_mfma_f32_16x16x32_bf16 v[212:215], v[20:23], v[164:167], v[248:251]
    buffer_load_dwordx4 v[116:119], v13, s[12:15], s31 offen offset:0
    v_mfma_f32_16x16x32_bf16 v[216:219], v[24:27], v[164:167], v[248:251]
    v_mfma_f32_16x16x32_bf16 v[220:223], v[28:31], v[164:167], v[248:251]
    s_add_u32 m0, s33, 31744
    s_add_u32 s30, s47, s89
    buffer_load_dwordx4 v3, s[8:11], s30 offen lds
    v_mfma_f32_16x16x32_bf16 v[224:227], v[32:35], v[164:167], v[248:251]
    v_mfma_f32_16x16x32_bf16 v[228:231], v[36:39], v[164:167], v[248:251]
    buffer_load_dwordx4 v[120:123], v14, s[12:15], s31 offen offset:0
    v_mfma_f32_16x16x32_bf16 v[232:235], v[40:43], v[164:167], v[248:251]
    v_mfma_f32_16x16x32_bf16 v[236:239], v[44:47], v[164:167], v[248:251]
    v_mfma_f32_16x16x32_bf16 v[240:243], v[48:51], v[164:167], v[248:251]
    s_waitcnt vmcnt(25)
    ds_read_b128 v[164:167], v5 offset:4096
    s_waitcnt lgkmcnt(2)
    v_mfma_f32_16x16x32_bf16 v[172:175], v[52:55], v[168:171], v[172:175]
    s_lshl_b32 s31, s89, 4
    s_add_u32 s31, s31, s32
    buffer_load_dwordx4 v[16:19], v6, s[12:15], s31 offen offset:1024
    v_mfma_f32_16x16x32_bf16 v[176:179], v[56:59], v[168:171], v[176:179]
    v_mfma_f32_16x16x32_bf16 v[180:183], v[60:63], v[168:171], v[180:183]
    v_mfma_f32_16x16x32_bf16 v[184:187], v[64:67], v[168:171], v[184:187]
    v_mfma_f32_16x16x32_bf16 v[188:191], v[68:71], v[168:171], v[188:191]
    buffer_load_dwordx4 v[20:23], v7, s[12:15], s31 offen offset:1024
    v_mfma_f32_16x16x32_bf16 v[192:195], v[72:75], v[168:171], v[192:195]
    v_mfma_f32_16x16x32_bf16 v[196:199], v[76:79], v[168:171], v[196:199]
    v_mfma_f32_16x16x32_bf16 v[200:203], v[80:83], v[168:171], v[200:203]
    v_mfma_f32_16x16x32_bf16 v[204:207], v[84:87], v[168:171], v[204:207]
    buffer_load_dwordx4 v[24:27], v8, s[12:15], s31 offen offset:1024
    ds_read_b128 v[168:171], v5 offset:6144
    s_waitcnt lgkmcnt(2)
    v_mfma_f32_16x16x32_bf16 v[208:211], v[52:55], v[160:163], v[208:211]
    v_mfma_f32_16x16x32_bf16 v[212:215], v[56:59], v[160:163], v[212:215]
    v_mfma_f32_16x16x32_bf16 v[216:219], v[60:63], v[160:163], v[216:219]
    v_mfma_f32_16x16x32_bf16 v[220:223], v[64:67], v[160:163], v[220:223]
    buffer_load_dwordx4 v[28:31], v9, s[12:15], s31 offen offset:1024
    v_mfma_f32_16x16x32_bf16 v[224:227], v[68:71], v[160:163], v[224:227]
    v_mfma_f32_16x16x32_bf16 v[228:231], v[72:75], v[160:163], v[228:231]
    v_mfma_f32_16x16x32_bf16 v[232:235], v[76:79], v[160:163], v[232:235]
    v_mfma_f32_16x16x32_bf16 v[236:239], v[80:83], v[160:163], v[236:239]
    buffer_load_dwordx4 v[32:35], v10, s[12:15], s31 offen offset:1024
    v_mfma_f32_16x16x32_bf16 v[240:243], v[84:87], v[160:163], v[240:243]
    ds_read_b128 v[160:163], v5 offset:8192
    s_waitcnt lgkmcnt(2)
    v_mfma_f32_16x16x32_bf16 a[0:3], v[52:55], v[164:167], a[0:3]
    v_mfma_f32_16x16x32_bf16 a[4:7], v[56:59], v[164:167], a[4:7]
    v_mfma_f32_16x16x32_bf16 a[8:11], v[60:63], v[164:167], a[8:11]
    buffer_load_dwordx4 v[36:39], v11, s[12:15], s31 offen offset:1024
    v_mfma_f32_16x16x32_bf16 a[12:15], v[64:67], v[164:167], a[12:15]
    v_mfma_f32_16x16x32_bf16 a[16:19], v[68:71], v[164:167], a[16:19]
    v_mfma_f32_16x16x32_bf16 a[20:23], v[72:75], v[164:167], a[20:23]
    v_mfma_f32_16x16x32_bf16 a[24:27], v[76:79], v[164:167], a[24:27]
    buffer_load_dwordx4 v[40:43], v12, s[12:15], s31 offen offset:1024
    v_mfma_f32_16x16x32_bf16 a[28:31], v[80:83], v[164:167], a[28:31]
    v_mfma_f32_16x16x32_bf16 a[32:35], v[84:87], v[164:167], a[32:35]
    ds_read_b128 v[164:167], v5 offset:10240
    s_waitcnt lgkmcnt(2)
    v_mfma_f32_16x16x32_bf16 a[36:39], v[52:55], v[168:171], a[36:39]
    v_mfma_f32_16x16x32_bf16 a[40:43], v[56:59], v[168:171], a[40:43]
    buffer_load_dwordx4 v[44:47], v13, s[12:15], s31 offen offset:1024
    v_mfma_f32_16x16x32_bf16 a[44:47], v[60:63], v[168:171], a[44:47]
    v_mfma_f32_16x16x32_bf16 a[48:51], v[64:67], v[168:171], a[48:51]
    v_mfma_f32_16x16x32_bf16 a[52:55], v[68:71], v[168:171], a[52:55]
    v_mfma_f32_16x16x32_bf16 a[56:59], v[72:75], v[168:171], a[56:59]
    buffer_load_dwordx4 v[48:51], v14, s[12:15], s31 offen offset:1024
    v_mfma_f32_16x16x32_bf16 a[60:63], v[76:79], v[168:171], a[60:63]
    v_mfma_f32_16x16x32_bf16 a[64:67], v[80:83], v[168:171], a[64:67]
    v_mfma_f32_16x16x32_bf16 a[68:71], v[84:87], v[168:171], a[68:71]
    ds_read_b128 v[168:171], v5 offset:12288
    s_waitcnt lgkmcnt(2)
    v_mfma_f32_16x16x32_bf16 a[72:75], v[52:55], v[160:163], a[72:75]
    v_mfma_f32_16x16x32_bf16 a[76:79], v[56:59], v[160:163], a[76:79]
    v_mfma_f32_16x16x32_bf16 a[80:83], v[60:63], v[160:163], a[80:83]
    s_add_u32 m0, s33, 0
    s_add_u32 s30, s40, s90
    buffer_load_dwordx4 v2, s[8:11], s30 offen lds
    v_mfma_f32_16x16x32_bf16 a[84:87], v[64:67], v[160:163], a[84:87]
    v_mfma_f32_16x16x32_bf16 a[88:91], v[68:71], v[160:163], a[88:91]
    v_mfma_f32_16x16x32_bf16 a[92:95], v[72:75], v[160:163], a[92:95]
    v_mfma_f32_16x16x32_bf16 a[96:99], v[76:79], v[160:163], a[96:99]
    s_add_u32 m0, s33, 1024
    s_add_u32 s30, s40, s90
    buffer_load_dwordx4 v3, s[8:11], s30 offen lds
    v_mfma_f32_16x16x32_bf16 a[100:103], v[80:83], v[160:163], a[100:103]
    v_mfma_f32_16x16x32_bf16 a[104:107], v[84:87], v[160:163], a[104:107]
    ds_read_b128 v[160:163], v5 offset:14336
    s_waitcnt lgkmcnt(2)
    v_mfma_f32_16x16x32_bf16 a[108:111], v[52:55], v[164:167], a[108:111]
    v_mfma_f32_16x16x32_bf16 a[112:115], v[56:59], v[164:167], a[112:115]
    s_add_u32 m0, s33, 2048
    s_add_u32 s30, s41, s90
    buffer_load_dwordx4 v2, s[8:11], s30 offen lds
    v_mfma_f32_16x16x32_bf16 a[116:119], v[60:63], v[164:167], a[116:119]
    v_mfma_f32_16x16x32_bf16 a[120:123], v[64:67], v[164:167], a[120:123]
    v_mfma_f32_16x16x32_bf16 a[124:127], v[68:71], v[164:167], a[124:127]
    v_mfma_f32_16x16x32_bf16 a[128:131], v[72:75], v[164:167], a[128:131]
    s_add_u32 m0, s33, 3072
    s_add_u32 s30, s41, s90
    buffer_load_dwordx4 v3, s[8:11], s30 offen lds
    v_mfma_f32_16x16x32_bf16 a[132:135], v[76:79], v[164:167], a[132:135]
    v_mfma_f32_16x16x32_bf16 a[136:139], v[80:83], v[164:167], a[136:139]
    v_mfma_f32_16x16x32_bf16 a[140:143], v[84:87], v[164:167], a[140:143]
    s_waitcnt vmcnt(30)
    ds_read_b128 v[164:167], v4 offset:16384
    s_waitcnt lgkmcnt(2)
    v_mfma_f32_16x16x32_bf16 a[144:147], v[52:55], v[168:171], a[144:147]
    s_add_u32 m0, s33, 4096
    s_add_u32 s30, s42, s90
    buffer_load_dwordx4 v2, s[8:11], s30 offen lds
    v_mfma_f32_16x16x32_bf16 a[148:151], v[56:59], v[168:171], a[148:151]
    v_mfma_f32_16x16x32_bf16 a[152:155], v[60:63], v[168:171], a[152:155]
    v_mfma_f32_16x16x32_bf16 a[156:159], v[64:67], v[168:171], a[156:159]
    v_mfma_f32_16x16x32_bf16 a[160:163], v[68:71], v[168:171], a[160:163]
    s_add_u32 m0, s33, 5120
    s_add_u32 s30, s42, s90
    buffer_load_dwordx4 v3, s[8:11], s30 offen lds
    v_mfma_f32_16x16x32_bf16 a[164:167], v[72:75], v[168:171], a[164:167]
    v_mfma_f32_16x16x32_bf16 a[168:171], v[76:79], v[168:171], a[168:171]
    v_mfma_f32_16x16x32_bf16 a[172:175], v[80:83], v[168:171], a[172:175]
    v_mfma_f32_16x16x32_bf16 a[176:179], v[84:87], v[168:171], a[176:179]
    s_add_u32 m0, s33, 6144
    s_add_u32 s30, s43, s90
    buffer_load_dwordx4 v2, s[8:11], s30 offen lds
    ds_read_b128 v[168:171], v4 offset:18432
    s_waitcnt lgkmcnt(2)
    v_mfma_f32_16x16x32_bf16 a[180:183], v[52:55], v[160:163], a[180:183]
    v_mfma_f32_16x16x32_bf16 a[184:187], v[56:59], v[160:163], a[184:187]
    v_mfma_f32_16x16x32_bf16 a[188:191], v[60:63], v[160:163], a[188:191]
    v_mfma_f32_16x16x32_bf16 a[192:195], v[64:67], v[160:163], a[192:195]
    s_add_u32 m0, s33, 7168
    s_add_u32 s30, s43, s90
    buffer_load_dwordx4 v3, s[8:11], s30 offen lds
    v_mfma_f32_16x16x32_bf16 a[196:199], v[68:71], v[160:163], a[196:199]
    v_mfma_f32_16x16x32_bf16 a[200:203], v[72:75], v[160:163], a[200:203]
    v_mfma_f32_16x16x32_bf16 a[204:207], v[76:79], v[160:163], a[204:207]
    v_mfma_f32_16x16x32_bf16 a[208:211], v[80:83], v[160:163], a[208:211]
    v_mfma_f32_16x16x32_bf16 a[212:215], v[84:87], v[160:163], a[212:215]
    s_waitcnt vmcnt(17)
    ds_read_b128 v[160:163], v4 offset:20480
    s_waitcnt lgkmcnt(2)
    v_mfma_f32_16x16x32_bf16 v[172:175], v[88:91], v[164:167], v[172:175]
    s_add_u32 m0, s33, 8192
    s_add_u32 s30, s44, s90
    buffer_load_dwordx4 v2, s[8:11], s30 offen lds
    v_mfma_f32_16x16x32_bf16 v[176:179], v[92:95], v[164:167], v[176:179]
    v_mfma_f32_16x16x32_bf16 v[180:183], v[96:99], v[164:167], v[180:183]
    v_lshrrev_b32 v250, 5, v0
    v_lshlrev_b32 v250, 12, v250
    v_and_b32 v251, 31, v0
    v_lshl_add_u32 v250, v251, 4, v250
    v_mfma_f32_16x16x32_bf16 v[184:187], v[100:103], v[164:167], v[184:187]
    v_mfma_f32_16x16x32_bf16 v[188:191], v[104:107], v[164:167], v[188:191]
    s_lshl_b32 s31, s90, 4
    s_add_u32 s31, s31, s32
    buffer_load_dwordx4 v[52:55], v6, s[12:15], s31 offen offset:0
    v_mfma_f32_16x16x32_bf16 v[192:195], v[108:111], v[164:167], v[192:195]
    v_mfma_f32_16x16x32_bf16 v[196:199], v[112:115], v[164:167], v[196:199]
    s_add_u32 s34, s26, 0
    s_lshl_b32 s35, s34, 10
    s_add_u32 m0, s35, 148992
    s_lshl_b32 s30, s34, 13
    s_add_u32 s30, s30, s51
    buffer_load_dwordx4 v250, s[12:15], s30 offen lds
    v_mfma_f32_16x16x32_bf16 v[200:203], v[116:119], v[164:167], v[200:203]
    v_mfma_f32_16x16x32_bf16 v[204:207], v[120:123], v[164:167], v[204:207]
    buffer_load_dwordx4 v[56:59], v7, s[12:15], s31 offen offset:0
    ds_read_b128 v[164:167], v4 offset:22528
    s_waitcnt lgkmcnt(2)
    v_mfma_f32_16x16x32_bf16 v[208:211], v[88:91], v[168:171], v[208:211]
    v_mfma_f32_16x16x32_bf16 v[212:215], v[92:95], v[168:171], v[212:215]
    v_mfma_f32_16x16x32_bf16 v[216:219], v[96:99], v[168:171], v[216:219]
    s_add_u32 s34, s26, 4
    s_lshl_b32 s35, s34, 10
    s_add_u32 m0, s35, 148992
    s_lshl_b32 s30, s34, 13
    s_add_u32 s30, s30, s51
    buffer_load_dwordx4 v250, s[12:15], s30 offen lds
    v_mfma_f32_16x16x32_bf16 v[220:223], v[100:103], v[168:171], v[220:223]
    s_add_u32 m0, s33, 9216
    s_add_u32 s30, s44, s90
    buffer_load_dwordx4 v3, s[8:11], s30 offen lds
    v_mfma_f32_16x16x32_bf16 v[224:227], v[104:107], v[168:171], v[224:227]
    v_mfma_f32_16x16x32_bf16 v[228:231], v[108:111], v[168:171], v[228:231]
    v_mfma_f32_16x16x32_bf16 v[232:235], v[112:115], v[168:171], v[232:235]
    s_add_u32 s34, s26, 8
    s_lshl_b32 s35, s34, 10
    s_add_u32 m0, s35, 148992
    s_lshl_b32 s30, s34, 13
    s_add_u32 s30, s30, s51
    s_cmp_gt_u32 s34, 8
    s_cselect_b32 s30, 0x40000000, s30
    s_cselect_b32 m0, 158208, m0
    s_nop 0
    buffer_load_dwordx4 v250, s[12:15], s30 offen lds
    v_mfma_f32_16x16x32_bf16 v[236:239], v[116:119], v[168:171], v[236:239]
    buffer_load_dwordx4 v[60:63], v8, s[12:15], s31 offen offset:0
    v_mfma_f32_16x16x32_bf16 v[240:243], v[120:123], v[168:171], v[240:243]
    ds_read_b128 v[168:171], v4 offset:24576
    s_waitcnt lgkmcnt(2)
    v_mfma_f32_16x16x32_bf16 a[0:3], v[88:91], v[160:163], a[0:3]
    v_mfma_f32_16x16x32_bf16 a[4:7], v[92:95], v[160:163], a[4:7]
    v_mfma_f32_16x16x32_bf16 a[8:11], v[96:99], v[160:163], a[8:11]
    v_mul_u32_u24 v250, 7282, v15
    v_lshrrev_b32 v250, 16, v250
    v_mul_u32_u24 v251, 9, v250
    v_sub_u32 v251, v15, v251
    v_mul_u32_u24 v250, 1152, v250
    v_lshl_add_u32 v250, v251, 4, v250
    s_add_u32 m0, s33, 10240
    s_add_u32 s30, s45, s90
    buffer_load_dwordx4 v2, s[8:11], s30 offen lds
    v_mfma_f32_16x16x32_bf16 a[12:15], v[100:103], v[160:163], a[12:15]
    v_mfma_f32_16x16x32_bf16 a[16:19], v[104:107], v[160:163], a[16:19]
    v_mfma_f32_16x16x32_bf16 a[20:23], v[108:111], v[160:163], a[20:23]
    v_mfma_f32_16x16x32_bf16 a[24:27], v[112:115], v[160:163], a[24:27]
    v_mfma_f32_16x16x32_bf16 a[28:31], v[116:119], v[160:163], a[28:31]
    v_mov_b32 v251, 0x40000000
    v_cmp_gt_u32 vcc, 162, v15
    s_lshl_b32 s35, s26, 10
    s_add_u32 m0, s35, 159232
    v_cndmask_b32 v250, v251, v250, vcc
    buffer_load_dwordx4 v250, s[16:19], s52 offen lds
    buffer_load_dwordx4 v[64:67], v9, s[12:15], s31 offen offset:0
    v_mfma_f32_16x16x32_bf16 a[32:35], v[120:123], v[160:163], a[32:35]
    ds_read_b128 v[160:163], v4 offset:26624
    s_waitcnt lgkmcnt(2)
    v_mfma_f32_16x16x32_bf16 a[36:39], v[88:91], v[164:167], a[36:39]
    v_mfma_f32_16x16x32_bf16 a[40:43], v[92:95], v[164:167], a[40:43]
    v_mfma_f32_16x16x32_bf16 a[44:47], v[96:99], v[164:167], a[44:47]
    v_min_u32 v250, 189, v15
    v_lshlrev_b32 v250, 3, v250
    s_add_u32 m0, s33, 11264
    s_add_u32 s30, s45, s90
    buffer_load_dwordx4 v3, s[8:11], s30 offen lds
    v_mfma_f32_16x16x32_bf16 a[48:51], v[100:103], v[164:167], a[48:51]
    v_mfma_f32_16x16x32_bf16 a[52:55], v[104:107], v[164:167], a[52:55]
    v_mfma_f32_16x16x32_bf16 a[56:59], v[108:111], v[164:167], a[56:59]
    v_mfma_f32_16x16x32_bf16 a[60:63], v[112:115], v[164:167], a[60:63]
    buffer_load_dwordx4 v[68:71], v10, s[12:15], s31 offen offset:0
    v_mfma_f32_16x16x32_bf16 a[64:67], v[116:119], v[164:167], a[64:67]
    s_add_u32 s30, s50, 0
    buffer_load_dwordx2 v[124:125], v250, s[12:15], s30 offen
    v_mfma_f32_16x16x32_bf16 a[68:71], v[120:123], v[164:167], a[68:71]
    ds_read_b128 v[164:167], v4 offset:28672
    s_waitcnt lgkmcnt(2)
    v_mfma_f32_16x16x32_bf16 a[72:75], v[88:91], v[168:171], a[72:75]
    v_mfma_f32_16x16x32_bf16 a[76:79], v[92:95], v[168:171], a[76:79]
    s_add_u32 m0, s33, 12288
    s_add_u32 s30, s46, s90
    buffer_load_dwordx4 v2, s[8:11], s30 offen lds
    v_mfma_f32_16x16x32_bf16 a[80:83], v[96:99], v[168:171], a[80:83]
    s_add_u32 s30, s50, 48640
    buffer_load_dwordx2 v[126:127], v250, s[12:15], s30 offen
    v_mfma_f32_16x16x32_bf16 a[84:87], v[100:103], v[168:171], a[84:87]
    v_mfma_f32_16x16x32_bf16 a[88:91], v[104:107], v[168:171], a[88:91]
    v_mfma_f32_16x16x32_bf16 a[92:95], v[108:111], v[168:171], a[92:95]
    buffer_load_dwordx4 v[72:75], v11, s[12:15], s31 offen offset:0
    v_mfma_f32_16x16x32_bf16 a[96:99], v[112:115], v[168:171], a[96:99]
    v_mfma_f32_16x16x32_bf16 a[100:103], v[116:119], v[168:171], a[100:103]
    s_add_u32 s30, s50, 97280
    buffer_load_dwordx2 v[128:129], v250, s[12:15], s30 offen
    v_mfma_f32_16x16x32_bf16 a[104:107], v[120:123], v[168:171], a[104:107]
    ds_read_b128 v[168:171], v4 offset:30720
    s_waitcnt lgkmcnt(2)
    v_mfma_f32_16x16x32_bf16 a[108:111], v[88:91], v[160:163], a[108:111]
    s_add_u32 m0, s33, 13312
    s_add_u32 s30, s46, s90
    buffer_load_dwordx4 v3, s[8:11], s30 offen lds
    v_mfma_f32_16x16x32_bf16 a[112:115], v[92:95], v[160:163], a[112:115]
    v_mfma_f32_16x16x32_bf16 a[116:119], v[96:99], v[160:163], a[116:119]
    v_mfma_f32_16x16x32_bf16 a[120:123], v[100:103], v[160:163], a[120:123]
    s_add_u32 s30, s50, 145920
    buffer_load_dwordx2 v[130:131], v250, s[12:15], s30 offen
    v_mfma_f32_16x16x32_bf16 a[124:127], v[104:107], v[160:163], a[124:127]
    v_mfma_f32_16x16x32_bf16 a[128:131], v[108:111], v[160:163], a[128:131]
    buffer_load_dwordx4 v[76:79], v12, s[12:15], s31 offen offset:0
    v_mfma_f32_16x16x32_bf16 a[132:135], v[112:115], v[160:163], a[132:135]
    v_mfma_f32_16x16x32_bf16 a[136:139], v[116:119], v[160:163], a[136:139]
    s_add_u32 s30, s50, 194560
    buffer_load_dwordx2 v[132:133], v250, s[12:15], s30 offen
    v_mfma_f32_16x16x32_bf16 a[140:143], v[120:123], v[160:163], a[140:143]
    ds_read_b128 v[160:163], v5 offset:16384
    s_waitcnt lgkmcnt(2)
    v_mfma_f32_16x16x32_bf16 a[144:147], v[88:91], v[164:167], a[144:147]
    s_add_u32 m0, s33, 14336
    s_add_u32 s30, s47, s90
    buffer_load_dwordx4 v2, s[8:11], s30 offen lds
    v_mfma_f32_16x16x32_bf16 a[148:151], v[92:95], v[164:167], a[148:151]
    v_mfma_f32_16x16x32_bf16 a[152:155], v[96:99], v[164:167], a[152:155]
    v_mfma_f32_16x16x32_bf16 a[156:159], v[100:103], v[164:167], a[156:159]
    s_add_u32 s30, s50, 243200
    buffer_load_dwordx2 v[134:135], v250, s[12:15], s30 offen
    v_mfma_f32_16x16x32_bf16 a[160:163], v[104:107], v[164:167], a[160:163]
    buffer_load_dwordx4 v[80:83], v13, s[12:15], s31 offen offset:0
    v_mfma_f32_16x16x32_bf16 a[164:167], v[108:111], v[164:167], a[164:167]
    v_mfma_f32_16x16x32_bf16 a[168:171], v[112:115], v[164:167], a[168:171]
    v_mfma_f32_16x16x32_bf16 a[172:175], v[116:119], v[164:167], a[172:175]
    s_add_u32 s30, s50, 291840
    buffer_load_dwordx2 v[136:137], v250, s[12:15], s30 offen
    v_mfma_f32_16x16x32_bf16 a[176:179], v[120:123], v[164:167], a[176:179]
    s_add_u32 m0, s33, 15360
    s_add_u32 s30, s47, s90
    buffer_load_dwordx4 v3, s[8:11], s30 offen lds
    ds_read_b128 v[164:167], v5 offset:18432
    s_waitcnt lgkmcnt(2)
    v_mfma_f32_16x16x32_bf16 a[180:183], v[88:91], v[168:171], a[180:183]
    v_mfma_f32_16x16x32_bf16 a[184:187], v[92:95], v[168:171], a[184:187]
    v_mfma_f32_16x16x32_bf16 a[188:191], v[96:99], v[168:171], a[188:191]
    v_mfma_f32_16x16x32_bf16 a[192:195], v[100:103], v[168:171], a[192:195]
    s_add_u32 s30, s50, 340480
    buffer_load_dwordx2 v[138:139], v250, s[12:15], s30 offen
    buffer_load_dwordx4 v[84:87], v14, s[12:15], s31 offen offset:0
    v_mfma_f32_16x16x32_bf16 a[196:199], v[104:107], v[168:171], a[196:199]
    v_mfma_f32_16x16x32_bf16 a[200:203], v[108:111], v[168:171], a[200:203]
    v_mfma_f32_16x16x32_bf16 a[204:207], v[112:115], v[168:171], a[204:207]
    v_mfma_f32_16x16x32_bf16 a[208:211], v[116:119], v[168:171], a[208:211]
    v_mfma_f32_16x16x32_bf16 a[212:215], v[120:123], v[168:171], a[212:215]
    s_waitcnt vmcnt(37)
    ds_read_b128 v[168:171], v5 offset:20480
    s_waitcnt lgkmcnt(2)
    v_mfma_f32_16x16x32_bf16 v[172:175], v[16:19], v[160:163], v[172:175]
    s_lshl_b32 s31, s90, 4
    s_add_u32 s31, s31, s32
    buffer_load_dwordx4 v[88:91], v6, s[12:15], s31 offen offset:1024
    v_mfma_f32_16x16x32_bf16 v[176:179], v[20:23], v[160:163], v[176:179]
    v_mfma_f32_16x16x32_bf16 v[180:183], v[24:27], v[160:163], v[180:183]
    v_mfma_f32_16x16x32_bf16 v[184:187], v[28:31], v[160:163], v[184:187]
    v_mfma_f32_16x16x32_bf16 v[188:191], v[32:35], v[160:163], v[188:191]
    buffer_load_dwordx4 v[92:95], v7, s[12:15], s31 offen offset:1024
    v_mfma_f32_16x16x32_bf16 v[192:195], v[36:39], v[160:163], v[192:195]
    v_mfma_f32_16x16x32_bf16 v[196:199], v[40:43], v[160:163], v[196:199]
    v_mfma_f32_16x16x32_bf16 v[200:203], v[44:47], v[160:163], v[200:203]
    v_mfma_f32_16x16x32_bf16 v[204:207], v[48:51], v[160:163], v[204:207]
    buffer_load_dwordx4 v[96:99], v8, s[12:15], s31 offen offset:1024
    ds_read_b128 v[160:163], v5 offset:22528
    s_waitcnt lgkmcnt(2)
    v_mfma_f32_16x16x32_bf16 v[208:211], v[16:19], v[164:167], v[208:211]
    v_mfma_f32_16x16x32_bf16 v[212:215], v[20:23], v[164:167], v[212:215]
    v_mfma_f32_16x16x32_bf16 v[216:219], v[24:27], v[164:167], v[216:219]
    v_mfma_f32_16x16x32_bf16 v[220:223], v[28:31], v[164:167], v[220:223]
    buffer_load_dwordx4 v[100:103], v9, s[12:15], s31 offen offset:1024
    v_mfma_f32_16x16x32_bf16 v[224:227], v[32:35], v[164:167], v[224:227]
    v_mfma_f32_16x16x32_bf16 v[228:231], v[36:39], v[164:167], v[228:231]
    v_mfma_f32_16x16x32_bf16 v[232:235], v[40:43], v[164:167], v[232:235]
    v_mfma_f32_16x16x32_bf16 v[236:239], v[44:47], v[164:167], v[236:239]
    buffer_load_dwordx4 v[104:107], v10, s[12:15], s31 offen offset:1024
    v_mfma_f32_16x16x32_bf16 v[240:243], v[48:51], v[164:167], v[240:243]
    ds_read_b128 v[164:167], v5 offset:24576
    s_waitcnt lgkmcnt(2)
    v_mfma_f32_16x16x32_bf16 a[0:3], v[16:19], v[168:171], a[0:3]
    v_mfma_f32_16x16x32_bf16 a[4:7], v[20:23], v[168:171], a[4:7]
    v_mfma_f32_16x16x32_bf16 a[8:11], v[24:27], v[168:171], a[8:11]
    buffer_load_dwordx4 v[108:111], v11, s[12:15], s31 offen offset:1024
    v_mfma_f32_16x16x32_bf16 a[12:15], v[28:31], v[168:171], a[12:15]
    v_mfma_f32_16x16x32_bf16 a[16:19], v[32:35], v[168:171], a[16:19]
    v_mfma_f32_16x16x32_bf16 a[20:23], v[36:39], v[168:171], a[20:23]
    v_mfma_f32_16x16x32_bf16 a[24:27], v[40:43], v[168:171], a[24:27]
    buffer_load_dwordx4 v[112:115], v12, s[12:15], s31 offen offset:1024
    v_mfma_f32_16x16x32_bf16 a[28:31], v[44:47], v[168:171], a[28:31]
    v_mfma_f32_16x16x32_bf16 a[32:35], v[48:51], v[168:171], a[32:35]
    ds_read_b128 v[168:171], v5 offset:26624
    s_waitcnt lgkmcnt(2)
    v_mfma_f32_16x16x32_bf16 a[36:39], v[16:19], v[160:163], a[36:39]
    v_mfma_f32_16x16x32_bf16 a[40:43], v[20:23], v[160:163], a[40:43]
    buffer_load_dwordx4 v[116:119], v13, s[12:15], s31 offen offset:1024
    v_mfma_f32_16x16x32_bf16 a[44:47], v[24:27], v[160:163], a[44:47]
    v_mfma_f32_16x16x32_bf16 a[48:51], v[28:31], v[160:163], a[48:51]
    v_mfma_f32_16x16x32_bf16 a[52:55], v[32:35], v[160:163], a[52:55]
    v_mfma_f32_16x16x32_bf16 a[56:59], v[36:39], v[160:163], a[56:59]
    buffer_load_dwordx4 v[120:123], v14, s[12:15], s31 offen offset:1024
    v_mfma_f32_16x16x32_bf16 a[60:63], v[40:43], v[160:163], a[60:63]
    v_mfma_f32_16x16x32_bf16 a[64:67], v[44:47], v[160:163], a[64:67]
    v_mfma_f32_16x16x32_bf16 a[68:71], v[48:51], v[160:163], a[68:71]
    ds_read_b128 v[160:163], v5 offset:28672
    s_waitcnt lgkmcnt(2)
    v_mfma_f32_16x16x32_bf16 a[72:75], v[16:19], v[164:167], a[72:75]
    v_mfma_f32_16x16x32_bf16 a[76:79], v[20:23], v[164:167], a[76:79]
    v_mfma_f32_16x16x32_bf16 a[80:83], v[24:27], v[164:167], a[80:83]
    s_add_u32 m0, s33, 16384
    s_add_u32 s30, s40, s91
    buffer_load_dwordx4 v2, s[8:11], s30 offen lds
    v_mfma_f32_16x16x32_bf16 a[84:87], v[28:31], v[164:167], a[84:87]
    v_mfma_f32_16x16x32_bf16 a[88:91], v[32:35], v[164:167], a[88:91]
    v_mfma_f32_16x16x32_bf16 a[92:95], v[36:39], v[164:167], a[92:95]
    v_mfma_f32_16x16x32_bf16 a[96:99], v[40:43], v[164:167], a[96:99]
    s_add_u32 m0, s33, 17408
    s_add_u32 s30, s40, s91
    buffer_load_dwordx4 v3, s[8:11], s30 offen lds
    v_mfma_f32_16x16x32_bf16 a[100:103], v[44:47], v[164:167], a[100:103]
    v_mfma_f32_16x16x32_bf16 a[104:107], v[48:51], v[164:167], a[104:107]
    ds_read_b128 v[164:167], v5 offset:30720
    s_waitcnt lgkmcnt(2)
    v_mfma_f32_16x16x32_bf16 a[108:111], v[16:19], v[168:171], a[108:111]
    v_mfma_f32_16x16x32_bf16 a[112:115], v[20:23], v[168:171], a[112:115]
    s_add_u32 m0, s33, 18432
    s_add_u32 s30, s41, s91
    buffer_load_dwordx4 v2, s[8:11], s30 offen lds
    v_mfma_f32_16x16x32_bf16 a[116:119], v[24:27], v[168:171], a[116:119]
    v_mfma_f32_16x16x32_bf16 a[120:123], v[28:31], v[168:171], a[120:123]
    v_mfma_f32_16x16x32_bf16 a[124:127], v[32:35], v[168:171], a[124:127]
    v_mfma_f32_16x16x32_bf16 a[128:131], v[36:39], v[168:171], a[128:131]
    s_add_u32 m0, s33, 19456
    s_add_u32 s30, s41, s91
    buffer_load_dwordx4 v3, s[8:11], s30 offen lds
    v_mfma_f32_16x16x32_bf16 a[132:135], v[40:43], v[168:171], a[132:135]
    v_mfma_f32_16x16x32_bf16 a[136:139], v[44:47], v[168:171], a[136:139]
    v_mfma_f32_16x16x32_bf16 a[140:143], v[48:51], v[168:171], a[140:143]
    s_waitcnt vmcnt(42)
    ds_read_b128 v[168:171], v4 offset:0
    s_waitcnt lgkmcnt(2)
    v_mfma_f32_16x16x32_bf16 a[144:147], v[16:19], v[160:163], a[144:147]
    s_add_u32 m0, s33, 20480
    s_add_u32 s30, s42, s91
    buffer_load_dwordx4 v2, s[8:11], s30 offen lds
    v_mfma_f32_16x16x32_bf16 a[148:151], v[20:23], v[160:163], a[148:151]
    v_mfma_f32_16x16x32_bf16 a[152:155], v[24:27], v[160:163], a[152:155]
    v_mfma_f32_16x16x32_bf16 a[156:159], v[28:31], v[160:163], a[156:159]
    v_mfma_f32_16x16x32_bf16 a[160:163], v[32:35], v[160:163], a[160:163]
    s_add_u32 m0, s33, 21504
    s_add_u32 s30, s42, s91
    buffer_load_dwordx4 v3, s[8:11], s30 offen lds
    v_mfma_f32_16x16x32_bf16 a[164:167], v[36:39], v[160:163], a[164:167]
    v_mfma_f32_16x16x32_bf16 a[168:171], v[40:43], v[160:163], a[168:171]
    v_mfma_f32_16x16x32_bf16 a[172:175], v[44:47], v[160:163], a[172:175]
    v_mfma_f32_16x16x32_bf16 a[176:179], v[48:51], v[160:163], a[176:179]
    s_add_u32 m0, s33, 22528
    s_add_u32 s30, s43, s91
    buffer_load_dwordx4 v2, s[8:11], s30 offen lds
    ds_read_b128 v[160:163], v4 offset:2048
    s_waitcnt lgkmcnt(2)
    v_mfma_f32_16x16x32_bf16 a[180:183], v[16:19], v[164:167], a[180:183]
    v_mfma_f32_16x16x32_bf16 a[184:187], v[20:23], v[164:167], a[184:187]
    v_mfma_f32_16x16x32_bf16 a[188:191], v[24:27], v[164:167], a[188:191]
    v_mfma_f32_16x16x32_bf16 a[192:195], v[28:31], v[164:167], a[192:195]
    s_add_u32 m0, s33, 23552
    s_add_u32 s30, s43, s91
    buffer_load_dwordx4 v3, s[8:11], s30 offen lds
    v_mfma_f32_16x16x32_bf16 a[196:199], v[32:35], v[164:167], a[196:199]
    v_mfma_f32_16x16x32_bf16 a[200:203], v[36:39], v[164:167], a[200:203]
    v_mfma_f32_16x16x32_bf16 a[204:207], v[40:43], v[164:167], a[204:207]
    v_mfma_f32_16x16x32_bf16 a[208:211], v[44:47], v[164:167], a[208:211]
    v_mfma_f32_16x16x32_bf16 a[212:215], v[48:51], v[164:167], a[212:215]
    s_waitcnt vmcnt(17)
    ds_read_b128 v[164:167], v4 offset:4096
    s_waitcnt lgkmcnt(2)
    v_mfma_f32_16x16x32_bf16 v[172:175], v[52:55], v[168:171], v[172:175]
    s_add_u32 m0, s33, 24576
    s_add_u32 s30, s44, s91
    buffer_load_dwordx4 v2, s[8:11], s30 offen lds
    v_mfma_f32_16x16x32_bf16 v[176:179], v[56:59], v[168:171], v[176:179]
    v_mfma_f32_16x16x32_bf16 v[180:183], v[60:63], v[168:171], v[180:183]
    v_mfma_f32_16x16x32_bf16 v[184:187], v[64:67], v[168:171], v[184:187]
    v_mfma_f32_16x16x32_bf16 v[188:191], v[68:71], v[168:171], v[188:191]
    s_lshl_b32 s31, s91, 4
    s_add_u32 s31, s31, s32
    buffer_load_dwordx4 v[16:19], v6, s[12:15], s31 offen offset:0
    v_mfma_f32_16x16x32_bf16 v[192:195], v[72:75], v[168:171], v[192:195]
    v_mfma_f32_16x16x32_bf16 v[196:199], v[76:79], v[168:171], v[196:199]
    v_mfma_f32_16x16x32_bf16 v[200:203], v[80:83], v[168:171], v[200:203]
    v_mfma_f32_16x16x32_bf16 v[204:207], v[84:87], v[168:171], v[204:207]
    buffer_load_dwordx4 v[20:23], v7, s[12:15], s31 offen offset:0
    ds_read_b128 v[168:171], v4 offset:6144
    s_waitcnt lgkmcnt(2)
    v_mfma_f32_16x16x32_bf16 v[208:211], v[52:55], v[160:163], v[208:211]
    v_mfma_f32_16x16x32_bf16 v[212:215], v[56:59], v[160:163], v[212:215]
    v_mfma_f32_16x16x32_bf16 v[216:219], v[60:63], v[160:163], v[216:219]
    v_mfma_f32_16x16x32_bf16 v[220:223], v[64:67], v[160:163], v[220:223]
    s_add_u32 m0, s33, 25600
    s_add_u32 s30, s44, s91
    buffer_load_dwordx4 v3, s[8:11], s30 offen lds
    v_mfma_f32_16x16x32_bf16 v[224:227], v[68:71], v[160:163], v[224:227]
    v_mfma_f32_16x16x32_bf16 v[228:231], v[72:75], v[160:163], v[228:231]
    v_mfma_f32_16x16x32_bf16 v[232:235], v[76:79], v[160:163], v[232:235]
    v_mfma_f32_16x16x32_bf16 v[236:239], v[80:83], v[160:163], v[236:239]
    buffer_load_dwordx4 v[24:27], v8, s[12:15], s31 offen offset:0
    v_mfma_f32_16x16x32_bf16 v[240:243], v[84:87], v[160:163], v[240:243]
    ds_read_b128 v[160:163], v4 offset:8192
    s_waitcnt lgkmcnt(2)
    v_mfma_f32_16x16x32_bf16 a[0:3], v[52:55], v[164:167], a[0:3]
    v_mfma_f32_16x16x32_bf16 a[4:7], v[56:59], v[164:167], a[4:7]
    v_mfma_f32_16x16x32_bf16 a[8:11], v[60:63], v[164:167], a[8:11]
    s_add_u32 m0, s33, 26624
    s_add_u32 s30, s45, s91
    buffer_load_dwordx4 v2, s[8:11], s30 offen lds
    v_mfma_f32_16x16x32_bf16 a[12:15], v[64:67], v[164:167], a[12:15]
    v_mfma_f32_16x16x32_bf16 a[16:19], v[68:71], v[164:167], a[16:19]
    v_add_f32 v124, v124, v126
    v_mfma_f32_16x16x32_bf16 a[20:23], v[72:75], v[164:167], a[20:23]
    v_mfma_f32_16x16x32_bf16 a[24:27], v[76:79], v[164:167], a[24:27]
    v_mfma_f32_16x16x32_bf16 a[28:31], v[80:83], v[164:167], a[28:31]
    v_add_f32 v125, v125, v127
    buffer_load_dwordx4 v[28:31], v9, s[12:15], s31 offen offset:0
    v_mfma_f32_16x16x32_bf16 a[32:35], v[84:87], v[164:167], a[32:35]
    ds_read_b128 v[164:167], v4 offset:10240
    s_waitcnt lgkmcnt(2)
    v_mfma_f32_16x16x32_bf16 a[36:39], v[52:55], v[168:171], a[36:39]
    v_mfma_f32_16x16x32_bf16 a[40:43], v[56:59], v[168:171], a[40:43]
    v_add_f32 v124, v124, v128
    v_mfma_f32_16x16x32_bf16 a[44:47], v[60:63], v[168:171], a[44:47]
    s_add_u32 m0, s33, 27648
    s_add_u32 s30, s45, s91
    buffer_load_dwordx4 v3, s[8:11], s30 offen lds
    v_mfma_f32_16x16x32_bf16 a[48:51], v[64:67], v[168:171], a[48:51]
    v_mfma_f32_16x16x32_bf16 a[52:55], v[68:71], v[168:171], a[52:55]
    v_add_f32 v125, v125, v129
    v_mfma_f32_16x16x32_bf16 a[56:59], v[72:75], v[168:171], a[56:59]
    v_mfma_f32_16x16x32_bf16 a[60:63], v[76:79], v[168:171], a[60:63]
    buffer_load_dwordx4 v[32:35], v10, s[12:15], s31 offen offset:0
    v_mfma_f32_16x16x32_bf16 a[64:67], v[80:83], v[168:171], a[64:67]
    v_add_f32 v124, v124, v130
    v_mfma_f32_16x16x32_bf16 a[68:71], v[84:87], v[168:171], a[68:71]
    ds_read_b128 v[168:171], v4 offset:12288
    s_waitcnt lgkmcnt(2)
    v_mfma_f32_16x16x32_bf16 a[72:75], v[52:55], v[160:163], a[72:75]
    v_mfma_f32_16x16x32_bf16 a[76:79], v[56:59], v[160:163], a[76:79]
    v_add_f32 v125, v125, v131
    s_add_u32 m0, s33, 28672
    s_add_u32 s30, s46, s91
    buffer_load_dwordx4 v2, s[8:11], s30 offen lds
    v_mfma_f32_16x16x32_bf16 a[80:83], v[60:63], v[160:163], a[80:83]
    v_mfma_f32_16x16x32_bf16 a[84:87], v[64:67], v[160:163], a[84:87]
    v_add_f32 v124, v124, v132
    v_mfma_f32_16x16x32_bf16 a[88:91], v[68:71], v[160:163], a[88:91]
    v_mfma_f32_16x16x32_bf16 a[92:95], v[72:75], v[160:163], a[92:95]
    buffer_load_dwordx4 v[36:39], v11, s[12:15], s31 offen offset:0
    v_mfma_f32_16x16x32_bf16 a[96:99], v[76:79], v[160:163], a[96:99]
    v_add_f32 v125, v125, v133
    v_mfma_f32_16x16x32_bf16 a[100:103], v[80:83], v[160:163], a[100:103]
    v_mfma_f32_16x16x32_bf16 a[104:107], v[84:87], v[160:163], a[104:107]
    ds_read_b128 v[160:163], v4 offset:14336
    s_waitcnt lgkmcnt(2)
    v_mfma_f32_16x16x32_bf16 a[108:111], v[52:55], v[164:167], a[108:111]
    v_add_f32 v124, v124, v134
    s_add_u32 m0, s33, 29696
    s_add_u32 s30, s46, s91
    buffer_load_dwordx4 v3, s[8:11], s30 offen lds
    v_mfma_f32_16x16x32_bf16 a[112:115], v[56:59], v[164:167], a[112:115]
    v_mfma_f32_16x16x32_bf16 a[116:119], v[60:63], v[164:167], a[116:119]
    v_mfma_f32_16x16x32_bf16 a[120:123], v[64:67], v[164:167], a[120:123]
    v_add_f32 v125, v125, v135
    v_mfma_f32_16x16x32_bf16 a[124:127], v[68:71], v[164:167], a[124:127]
    v_mfma_f32_16x16x32_bf16 a[128:131], v[72:75], v[164:167], a[128:131]
    buffer_load_dwordx4 v[40:43], v12, s[12:15], s31 offen offset:0
    v_mfma_f32_16x16x32_bf16 a[132:135], v[76:79], v[164:167], a[132:135]
    v_add_f32 v124, v124, v136
    v_mfma_f32_16x16x32_bf16 a[136:139], v[80:83], v[164:167], a[136:139]
    v_mfma_f32_16x16x32_bf16 a[140:143], v[84:87], v[164:167], a[140:143]
    ds_read_b128 v[164:167], v5 offset:0
    s_waitcnt lgkmcnt(2)
    v_mfma_f32_16x16x32_bf16 a[144:147], v[52:55], v[168:171], a[144:147]
    v_add_f32 v125, v125, v137
    s_add_u32 m0, s33, 30720
    s_add_u32 s30, s47, s91
    buffer_load_dwordx4 v2, s[8:11], s30 offen lds
    v_mfma_f32_16x16x32_bf16 a[148:151], v[56:59], v[168:171], a[148:151]
    v_mfma_f32_16x16x32_bf16 a[152:155], v[60:63], v[168:171], a[152:155]
    v_add_f32 v124, v124, v138
    v_mfma_f32_16x16x32_bf16 a[156:159], v[64:67], v[168:171], a[156:159]
    v_mfma_f32_16x16x32_bf16 a[160:163], v[68:71], v[168:171], a[160:163]
    buffer_load_dwordx4 v[44:47], v13, s[12:15], s31 offen offset:0
    v_mfma_f32_16x16x32_bf16 a[164:167], v[72:75], v[168:171], a[164:167]
    v_add_f32 v125, v125, v139
    v_mfma_f32_16x16x32_bf16 a[168:171], v[76:79], v[168:171], a[168:171]
    v_mfma_f32_16x16x32_bf16 a[172:175], v[80:83], v[168:171], a[172:175]
    v_mfma_f32_16x16x32_bf16 a[176:179], v[84:87], v[168:171], a[176:179]
    v_add_u32 v250, 147456, v250
    s_add_u32 m0, s33, 31744
    s_add_u32 s30, s47, s91
    buffer_load_dwordx4 v3, s[8:11], s30 offen lds
    ds_read_b128 v[168:171], v5 offset:2048
    s_waitcnt lgkmcnt(2)
    v_mfma_f32_16x16x32_bf16 a[180:183], v[52:55], v[160:163], a[180:183]
    v_mfma_f32_16x16x32_bf16 a[184:187], v[56:59], v[160:163], a[184:187]
    v_mfma_f32_16x16x32_bf16 a[188:191], v[60:63], v[160:163], a[188:191]
    ds_write_b64 v250, v[124:125]
    v_mfma_f32_16x16x32_bf16 a[192:195], v[64:67], v[160:163], a[192:195]
    buffer_load_dwordx4 v[48:51], v14, s[12:15], s31 offen offset:0
    v_mfma_f32_16x16x32_bf16 a[196:199], v[68:71], v[160:163], a[196:199]
    v_mfma_f32_16x16x32_bf16 a[200:203], v[72:75], v[160:163], a[200:203]
    s_waitcnt lgkmcnt(0)
    s_barrier
    v_mfma_f32_16x16x32_bf16 a[204:207], v[76:79], v[160:163], a[204:207]
    v_mfma_f32_16x16x32_bf16 a[208:211], v[80:83], v[160:163], a[208:211]
    v_mfma_f32_16x16x32_bf16 a[212:215], v[84:87], v[160:163], a[212:215]
    s_waitcnt vmcnt(25)
    ds_read_b128 v[160:163], v5 offset:4096
    v_mfma_f32_16x16x32_bf16 v[172:175], v[88:91], v[164:167], v[172:175]
    v_mov_b32 v250, 148896
    s_lshl_b32 s31, s91, 4
    s_add_u32 s31, s31, s32
    buffer_load_dwordx4 v[52:55], v6, s[12:15], s31 offen offset:1024
    v_mfma_f32_16x16x32_bf16 v[176:179], v[92:95], v[164:167], v[176:179]
    v_lshlrev_b32 v253, 1, v15
    v_mfma_f32_16x16x32_bf16 v[180:183], v[96:99], v[164:167], v[180:183]
    v_mfma_f32_16x16x32_bf16 v[184:187], v[100:103], v[164:167], v[184:187]
    v_add_u32 v253, 148992, v253
    v_mfma_f32_16x16x32_bf16 v[188:191], v[104:107], v[164:167], v[188:191]
    ds_read_b128 v[124:127], v250 offset:0
    buffer_load_dwordx4 v[56:59], v7, s[12:15], s31 offen offset:1024
    v_mfma_f32_16x16x32_bf16 v[192:195], v[108:111], v[164:167], v[192:195]
    v_mfma_f32_16x16x32_bf16 v[196:199], v[112:115], v[164:167], v[196:199]
    ds_read_b128 v[128:131], v250 offset:16
    v_mfma_f32_16x16x32_bf16 v[200:203], v[116:119], v[164:167], v[200:203]
    ds_read_b128 v[132:135], v250 offset:32
    v_mfma_f32_16x16x32_bf16 v[204:207], v[120:123], v[164:167], v[204:207]
    buffer_load_dwordx4 v[60:63], v8, s[12:15], s31 offen offset:1024
    ds_read_b128 v[164:167], v5 offset:6144
    v_mfma_f32_16x16x32_bf16 v[208:211], v[88:91], v[168:171], v[208:211]
    ds_read_b128 v[136:139], v250 offset:48
    v_mfma_f32_16x16x32_bf16 v[212:215], v[92:95], v[168:171], v[212:215]
    ds_read_b64 v[140:141], v250 offset:64
    v_mfma_f32_16x16x32_bf16 v[216:219], v[96:99], v[168:171], v[216:219]
    v_mfma_f32_16x16x32_bf16 v[220:223], v[100:103], v[168:171], v[220:223]
    v_mov_b32 v142, 0
    ds_read_u16_d16_hi v142, v253 offset:0
    buffer_load_dwordx4 v[64:67], v9, s[12:15], s31 offen offset:1024
    v_mfma_f32_16x16x32_bf16 v[224:227], v[104:107], v[168:171], v[224:227]
    v_mov_b32 v143, 0
    ds_read_u16_d16_hi v143, v253 offset:512
    v_mfma_f32_16x16x32_bf16 v[228:231], v[108:111], v[168:171], v[228:231]
    v_mfma_f32_16x16x32_bf16 v[232:235], v[112:115], v[168:171], v[232:235]
    v_mov_b32 v144, 0
    ds_read_u16_d16_hi v144, v253 offset:1024
    v_mfma_f32_16x16x32_bf16 v[236:239], v[116:119], v[168:171], v[236:239]
    v_mov_b32 v145, 0
    ds_read_u16_d16_hi v145, v253 offset:1536
    buffer_load_dwordx4 v[68:71], v10, s[12:15], s31 offen offset:1024
    v_mfma_f32_16x16x32_bf16 v[240:243], v[120:123], v[168:171], v[240:243]
    ds_read_b128 v[168:171], v5 offset:8192
    s_waitcnt lgkmcnt(11)
    v_mfma_f32_16x16x32_bf16 a[0:3], v[88:91], v[160:163], a[0:3]
    v_mov_b32 v146, 0
    ds_read_u16_d16_hi v146, v253 offset:2048
    v_mfma_f32_16x16x32_bf16 a[4:7], v[92:95], v[160:163], a[4:7]
    v_mov_b32 v147, 0
    ds_read_u16_d16_hi v147, v253 offset:2560
    v_mfma_f32_16x16x32_bf16 a[8:11], v[96:99], v[160:163], a[8:11]
    buffer_load_dwordx4 v[72:75], v11, s[12:15], s31 offen offset:1024
    v_mfma_f32_16x16x32_bf16 a[12:15], v[100:103], v[160:163], a[12:15]
    v_mov_b32 v148, 0
    ds_read_u16_d16_hi v148, v253 offset:3072
    v_mfma_f32_16x16x32_bf16 a[16:19], v[104:107], v[160:163], a[16:19]
    v_mov_b32 v149, 0
    ds_read_u16_d16_hi v149, v253 offset:3584
    v_mfma_f32_16x16x32_bf16 a[20:23], v[108:111], v[160:163], a[20:23]
    v_mfma_f32_16x16x32_bf16 a[24:27], v[112:115], v[160:163], a[24:27]
    v_mov_b32 v150, 0
    ds_read_u16_d16_hi v150, v253 offset:4096
    buffer_load_dwordx4 v[76:79], v12, s[12:15], s31 offen offset:1024
    v_mfma_f32_16x16x32_bf16 a[28:31], v[116:119], v[160:163], a[28:31]
    v_mfma_f32_16x16x32_bf16 a[32:35], v[120:123], v[160:163], a[32:35]
    v_mov_b32 v151, 0
    ds_read_u16_d16_hi v151, v253 offset:4608
    ds_read_b128 v[160:163], v5 offset:10240
    s_waitcnt lgkmcnt(14)
    v_mfma_f32_16x16x32_bf16 a[36:39], v[88:91], v[164:167], a[36:39]
    v_mov_b32 v152, 0
    ds_read_u16_d16_hi v152, v253 offset:5120
    v_mfma_f32_16x16x32_bf16 a[40:43], v[92:95], v[164:167], a[40:43]
    buffer_load_dwordx4 v[80:83], v13, s[12:15], s31 offen offset:1024
    v_mfma_f32_16x16x32_bf16 a[44:47], v[96:99], v[164:167], a[44:47]
    v_mov_b32 v153, 0
    ds_read_u16_d16_hi v153, v253 offset:5632
    v_mfma_f32_16x16x32_bf16 a[48:51], v[100:103], v[164:167], a[48:51]
    v_mov_b32 v154, 0
    ds_read_u16_d16_hi v154, v253 offset:6144
    v_mfma_f32_16x16x32_bf16 a[52:55], v[104:107], v[164:167], a[52:55]
    v_mfma_f32_16x16x32_bf16 a[56:59], v[108:111], v[164:167], a[56:59]
    v_mov_b32 v155, 0
    ds_read_u16_d16_hi v155, v253 offset:6656
    buffer_load_dwordx4 v[84:87], v14, s[12:15], s31 offen offset:1024
    v_mfma_f32_16x16x32_bf16 a[60:63], v[112:115], v[164:167], a[60:63]
    v_mov_b32 v156, 0
    ds_read_u16_d16_hi v156, v253 offset:7168
    v_mfma_f32_16x16x32_bf16 a[64:67], v[116:119], v[164:167], a[64:67]
    v_mfma_f32_16x16x32_bf16 a[68:71], v[120:123], v[164:167], a[68:71]
    v_mov_b32 v157, 0
    ds_read_u16_d16_hi v157, v253 offset:7680
    ds_read_b128 v[164:167], v5 offset:12288
    s_waitcnt lgkmcnt(14)
    v_mfma_f32_16x16x32_bf16 a[72:75], v[88:91], v[168:171], a[72:75]
    v_mov_b32 v158, 0
    ds_read_u16_d16_hi v158, v253 offset:8192
    v_mfma_f32_16x16x32_bf16 a[76:79], v[92:95], v[168:171], a[76:79]
    v_mfma_f32_16x16x32_bf16 a[80:83], v[96:99], v[168:171], a[80:83]
    v_mov_b32 v159, 0
    ds_read_u16_d16_hi v159, v253 offset:8704
    s_add_u32 m0, s33, 0
    s_add_u32 s30, s40, s92
    buffer_load_dwordx4 v2, s[8:11], s30 offen lds
    v_mfma_f32_16x16x32_bf16 a[84:87], v[100:103], v[168:171], a[84:87]
    v_lshrrev_b32 v251, 4, v15
    v_mfma_f32_16x16x32_bf16 a[88:91], v[104:107], v[168:171], a[88:91]
    v_mfma_f32_16x16x32_bf16 a[92:95], v[108:111], v[168:171], a[92:95]
    s_mov_b32 s34, 92160
    v_mul_lo_u32 v251, v251, s34
    v_mfma_f32_16x16x32_bf16 a[96:99], v[112:115], v[168:171], a[96:99]
    v_and_b32 v255, 15, v15
    s_add_u32 m0, s33, 1024
    s_add_u32 s30, s40, s92
    buffer_load_dwordx4 v3, s[8:11], s30 offen lds
    v_mfma_f32_16x16x32_bf16 a[100:103], v[116:119], v[168:171], a[100:103]
    v_mfma_f32_16x16x32_bf16 a[104:107], v[120:123], v[168:171], a[104:107]
    v_lshl_add_u32 v251, v255, 4, v251
    ds_read_b128 v[168:171], v5 offset:14336
    s_waitcnt lgkmcnt(10)
    v_mfma_f32_16x16x32_bf16 a[108:111], v[88:91], v[160:163], a[108:111]
    v_mov_b32 v255, 0x358637bd
    v_mfma_f32_16x16x32_bf16 a[112:115], v[92:95], v[160:163], a[112:115]
    s_add_u32 m0, s33, 2048
    s_add_u32 s30, s41, s92
    buffer_load_dwordx4 v2, s[8:11], s30 offen lds
    v_mfma_f32_16x16x32_bf16 a[116:119], v[96:99], v[160:163], a[116:119]
    v_mfma_f32_16x16x32_bf16 a[120:123], v[100:103], v[160:163], a[120:123]
    v_mfma_f32_16x16x32_bf16 a[124:127], v[104:107], v[160:163], a[124:127]
    v_fmac_f32 v255, v142, v124
    v_mfma_f32_16x16x32_bf16 a[128:131], v[108:111], v[160:163], a[128:131]
    v_fmac_f32 v255, v143, v125
    s_add_u32 m0, s33, 3072
    s_add_u32 s30, s41, s92
    buffer_load_dwordx4 v3, s[8:11], s30 offen lds
    v_mfma_f32_16x16x32_bf16 a[132:135], v[112:115], v[160:163], a[132:135]
    v_mfma_f32_16x16x32_bf16 a[136:139], v[116:119], v[160:163], a[136:139]
    v_fmac_f32 v255, v144, v126
    v_mfma_f32_16x16x32_bf16 a[140:143], v[120:123], v[160:163], a[140:143]
    v_fmac_f32 v255, v145, v127
    s_waitcnt vmcnt(30)
    ds_read_b128 v[160:163], v4 offset:16384
    s_waitcnt lgkmcnt(4)
    v_mfma_f32_16x16x32_bf16 a[144:147], v[88:91], v[164:167], a[144:147]
    s_add_u32 m0, s33, 4096
    s_add_u32 s30, s42, s92
    buffer_load_dwordx4 v2, s[8:11], s30 offen lds
    v_mfma_f32_16x16x32_bf16 a[148:151], v[92:95], v[164:167], a[148:151]
    v_fmac_f32 v255, v146, v128
    v_mfma_f32_16x16x32_bf16 a[152:155], v[96:99], v[164:167], a[152:155]
    v_fmac_f32 v255, v147, v129
    v_mfma_f32_16x16x32_bf16 a[156:159], v[100:103], v[164:167], a[156:159]
    v_mfma_f32_16x16x32_bf16 a[160:163], v[104:107], v[164:167], a[160:163]
    s_add_u32 m0, s33, 5120
    s_add_u32 s30, s42, s92
    buffer_load_dwordx4 v3, s[8:11], s30 offen lds
    v_mfma_f32_16x16x32_bf16 a[164:167], v[108:111], v[164:167], a[164:167]
    v_fmac_f32 v255, v148, v130
    v_mfma_f32_16x16x32_bf16 a[168:171], v[112:115], v[164:167], a[168:171]
    v_mfma_f32_16x16x32_bf16 a[172:175], v[116:119], v[164:167], a[172:175]
    v_fmac_f32 v255, v149, v131
    v_mfma_f32_16x16x32_bf16 a[176:179], v[120:123], v[164:167], a[176:179]
    v_fmac_f32 v255, v150, v132
    s_add_u32 m0, s33, 6144
    s_add_u32 s30, s43, s92
    buffer_load_dwordx4 v2, s[8:11], s30 offen lds
    ds_read_b128 v[164:167], v4 offset:18432
    s_waitcnt lgkmcnt(2)
    v_mfma_f32_16x16x32_bf16 a[180:183], v[88:91], v[168:171], a[180:183]
    v_mfma_f32_16x16x32_bf16 a[184:187], v[92:95], v[168:171], a[184:187]
    v_fmac_f32 v255, v151, v133
    v_mfma_f32_16x16x32_bf16 a[188:191], v[96:99], v[168:171], a[188:191]
    v_fmac_f32 v255, v152, v134
    v_mfma_f32_16x16x32_bf16 a[192:195], v[100:103], v[168:171], a[192:195]
    s_add_u32 m0, s33, 7168
    s_add_u32 s30, s43, s92
    buffer_load_dwordx4 v3, s[8:11], s30 offen lds
    v_mfma_f32_16x16x32_bf16 a[196:199], v[104:107], v[168:171], a[196:199]
    v_fmac_f32 v255, v153, v135
    v_mfma_f32_16x16x32_bf16 a[200:203], v[108:111], v[168:171], a[200:203]
    v_mfma_f32_16x16x32_bf16 a[204:207], v[112:115], v[168:171], a[204:207]
    v_mfma_f32_16x16x32_bf16 a[208:211], v[116:119], v[168:171], a[208:211]
    v_fmac_f32 v255, v154, v136
    v_mfma_f32_16x16x32_bf16 a[212:215], v[120:123], v[168:171], a[212:215]
    s_waitcnt vmcnt(17)
    ds_read_b128 v[168:171], v4 offset:20480
    s_waitcnt lgkmcnt(2)
    v_mfma_f32_16x16x32_bf16 v[172:175], v[16:19], v[160:163], v[172:175]
    v_fmac_f32 v255, v155, v137
    s_add_u32 m0, s33, 8192
    s_add_u32 s30, s44, s92
    buffer_load_dwordx4 v2, s[8:11], s30 offen lds
    v_mfma_f32_16x16x32_bf16 v[176:179], v[20:23], v[160:163], v[176:179]
    v_fmac_f32 v255, v156, v138
    v_mfma_f32_16x16x32_bf16 v[180:183], v[24:27], v[160:163], v[180:183]
    v_mfma_f32_16x16x32_bf16 v[184:187], v[28:31], v[160:163], v[184:187]
    v_fmac_f32 v255, v157, v139
    v_mfma_f32_16x16x32_bf16 v[188:191], v[32:35], v[160:163], v[188:191]
    v_fmac_f32 v255, v158, v140
    s_lshl_b32 s31, s92, 4
    s_add_u32 s31, s31, s32
    buffer_load_dwordx4 v[88:91], v6, s[12:15], s31 offen offset:0
    v_mfma_f32_16x16x32_bf16 v[192:195], v[36:39], v[160:163], v[192:195]
    v_mfma_f32_16x16x32_bf16 v[196:199], v[40:43], v[160:163], v[196:199]
    v_fmac_f32 v255, v159, v141
    v_mfma_f32_16x16x32_bf16 v[200:203], v[44:47], v[160:163], v[200:203]
    v_rcp_f32 v255, v255
    v_mfma_f32_16x16x32_bf16 v[204:207], v[48:51], v[160:163], v[204:207]
    buffer_load_dwordx4 v[92:95], v7, s[12:15], s31 offen offset:0
    ds_read_b128 v[160:163], v4 offset:22528
    s_waitcnt lgkmcnt(2)
    v_mfma_f32_16x16x32_bf16 v[208:211], v[16:19], v[164:167], v[208:211]
    v_mul_f32 v142, v142, v255
    v_mfma_f32_16x16x32_bf16 v[212:215], v[20:23], v[164:167], v[212:215]
    v_mul_f32 v143, v143, v255
    v_mfma_f32_16x16x32_bf16 v[216:219], v[24:27], v[164:167], v[216:219]
    v_mfma_f32_16x16x32_bf16 v[220:223], v[28:31], v[164:167], v[220:223]
    s_add_u32 s34, s54, 0
    s_add_u32 m0, s33, 9216
    s_add_u32 s30, s44, s92
    buffer_load_dwordx4 v3, s[8:11], s30 offen lds
    v_mfma_f32_16x16x32_bf16 v[224:227], v[32:35], v[164:167], v[224:227]
    s_lshr_b32 s35, s34, 2
    v_mfma_f32_16x16x32_bf16 v[228:231], v[36:39], v[164:167], v[228:231]
    v_mfma_f32_16x16x32_bf16 v[232:235], v[40:43], v[164:167], v[232:235]
    s_lshl_b32 s35, s35, 8
    v_mfma_f32_16x16x32_bf16 v[236:239], v[44:47], v[164:167], v[236:239]
    v_cvt_pk_bf16_f32 v142, v142, v143
    buffer_load_dwordx4 v[96:99], v8, s[12:15], s31 offen offset:0
    v_mfma_f32_16x16x32_bf16 v[240:243], v[48:51], v[164:167], v[240:243]
    ds_read_b128 v[164:167], v4 offset:24576
    s_waitcnt lgkmcnt(2)
    v_mfma_f32_16x16x32_bf16 a[0:3], v[16:19], v[168:171], a[0:3]
    s_and_b32 s34, s34, 3
    v_mfma_f32_16x16x32_bf16 a[4:7], v[20:23], v[168:171], a[4:7]
    s_lshl_b32 s34, s34, 2
    v_mfma_f32_16x16x32_bf16 a[8:11], v[24:27], v[168:171], a[8:11]
    s_add_u32 m0, s33, 10240
    s_add_u32 s30, s45, s92
    buffer_load_dwordx4 v2, s[8:11], s30 offen lds
    v_mfma_f32_16x16x32_bf16 a[12:15], v[28:31], v[168:171], a[12:15]
    s_add_u32 s35, s35, s34
    v_mfma_f32_16x16x32_bf16 a[16:19], v[32:35], v[168:171], a[16:19]
    s_add_u32 s35, s35, s53
    buffer_store_dword v142, v251, s[12:15], s35 offen
    v_mfma_f32_16x16x32_bf16 a[20:23], v[36:39], v[168:171], a[20:23]
    v_mfma_f32_16x16x32_bf16 a[24:27], v[40:43], v[168:171], a[24:27]
    v_mul_f32 v144, v144, v255
    v_mfma_f32_16x16x32_bf16 a[28:31], v[44:47], v[168:171], a[28:31]
    buffer_load_dwordx4 v[100:103], v9, s[12:15], s31 offen offset:0
    v_mfma_f32_16x16x32_bf16 a[32:35], v[48:51], v[168:171], a[32:35]
    v_mul_f32 v145, v145, v255
    ds_read_b128 v[168:171], v4 offset:26624
    s_waitcnt lgkmcnt(2)
    v_mfma_f32_16x16x32_bf16 a[36:39], v[16:19], v[160:163], a[36:39]
    s_add_u32 s34, s54, 1
    v_mfma_f32_16x16x32_bf16 a[40:43], v[20:23], v[160:163], a[40:43]
    v_mfma_f32_16x16x32_bf16 a[44:47], v[24:27], v[160:163], a[44:47]
    s_lshr_b32 s35, s34, 2
    s_add_u32 m0, s33, 11264
    s_add_u32 s30, s45, s92
    buffer_load_dwordx4 v3, s[8:11], s30 offen lds
    v_mfma_f32_16x16x32_bf16 a[48:51], v[28:31], v[160:163], a[48:51]
    s_lshl_b32 s35, s35, 8
    v_mfma_f32_16x16x32_bf16 a[52:55], v[32:35], v[160:163], a[52:55]
    v_mfma_f32_16x16x32_bf16 a[56:59], v[36:39], v[160:163], a[56:59]
    v_cvt_pk_bf16_f32 v144, v144, v145
    v_mfma_f32_16x16x32_bf16 a[60:63], v[40:43], v[160:163], a[60:63]
    s_and_b32 s34, s34, 3
    buffer_load_dwordx4 v[104:107], v10, s[12:15], s31 offen offset:0
    v_mfma_f32_16x16x32_bf16 a[64:67], v[44:47], v[160:163], a[64:67]
    v_mfma_f32_16x16x32_bf16 a[68:71], v[48:51], v[160:163], a[68:71]
    s_lshl_b32 s34, s34, 2
    ds_read_b128 v[160:163], v4 offset:28672
    s_waitcnt lgkmcnt(2)
    v_mfma_f32_16x16x32_bf16 a[72:75], v[16:19], v[164:167], a[72:75]
    s_add_u32 s35, s35, s34
    v_mfma_f32_16x16x32_bf16 a[76:79], v[20:23], v[164:167], a[76:79]
    s_add_u32 m0, s33, 12288
    s_add_u32 s30, s46, s92
    buffer_load_dwordx4 v2, s[8:11], s30 offen lds
    v_mfma_f32_16x16x32_bf16 a[80:83], v[24:27], v[164:167], a[80:83]
    s_add_u32 s35, s35, s53
    buffer_store_dword v144, v251, s[12:15], s35 offen
    v_mfma_f32_16x16x32_bf16 a[84:87], v[28:31], v[164:167], a[84:87]
    v_mul_f32 v146, v146, v255
    v_mfma_f32_16x16x32_bf16 a[88:91], v[32:35], v[164:167], a[88:91]
    v_mfma_f32_16x16x32_bf16 a[92:95], v[36:39], v[164:167], a[92:95]
    v_mul_f32 v147, v147, v255
    buffer_load_dwordx4 v[108:111], v11, s[12:15], s31 offen offset:0
    v_mfma_f32_16x16x32_bf16 a[96:99], v[40:43], v[164:167], a[96:99]
    s_add_u32 s34, s54, 2
    v_mfma_f32_16x16x32_bf16 a[100:103], v[44:47], v[164:167], a[100:103]
    v_mfma_f32_16x16x32_bf16 a[104:107], v[48:51], v[164:167], a[104:107]
    s_lshr_b32 s35, s34, 2
    ds_read_b128 v[164:167], v4 offset:30720
    s_waitcnt lgkmcnt(2)
    v_mfma_f32_16x16x32_bf16 a[108:111], v[16:19], v[168:171], a[108:111]
    s_lshl_b32 s35, s35, 8
    s_add_u32 m0, s33, 13312
    s_add_u32 s30, s46, s92
    buffer_load_dwordx4 v3, s[8:11], s30 offen lds
    v_mfma_f32_16x16x32_bf16 a[112:115], v[20:23], v[168:171], a[112:115]
    v_mfma_f32_16x16x32_bf16 a[116:119], v[24:27], v[168:171], a[116:119]
    v_cvt_pk_bf16_f32 v146, v146, v147
    v_mfma_f32_16x16x32_bf16 a[120:123], v[28:31], v[168:171], a[120:123]
    v_mfma_f32_16x16x32_bf16 a[124:127], v[32:35], v[168:171], a[124:127]
    s_and_b32 s34, s34, 3
    v_mfma_f32_16x16x32_bf16 a[128:131], v[36:39], v[168:171], a[128:131]
    s_lshl_b32 s34, s34, 2
    buffer_load_dwordx4 v[112:115], v12, s[12:15], s31 offen offset:0
    v_mfma_f32_16x16x32_bf16 a[132:135], v[40:43], v[168:171], a[132:135]
    v_mfma_f32_16x16x32_bf16 a[136:139], v[44:47], v[168:171], a[136:139]
    s_add_u32 s35, s35, s34
    v_mfma_f32_16x16x32_bf16 a[140:143], v[48:51], v[168:171], a[140:143]
    s_add_u32 s35, s35, s53
    buffer_store_dword v146, v251, s[12:15], s35 offen
    ds_read_b128 v[168:171], v5 offset:16384
    s_waitcnt lgkmcnt(2)
    v_mfma_f32_16x16x32_bf16 a[144:147], v[16:19], v[160:163], a[144:147]
    s_add_u32 m0, s33, 14336
    s_add_u32 s30, s47, s92
    buffer_load_dwordx4 v2, s[8:11], s30 offen lds
    v_mfma_f32_16x16x32_bf16 a[148:151], v[20:23], v[160:163], a[148:151]
    v_mul_f32 v148, v148, v255
    v_mfma_f32_16x16x32_bf16 a[152:155], v[24:27], v[160:163], a[152:155]
    v_mul_f32 v149, v149, v255
    v_mfma_f32_16x16x32_bf16 a[156:159], v[28:31], v[160:163], a[156:159]
    v_mfma_f32_16x16x32_bf16 a[160:163], v[32:35], v[160:163], a[160:163]
    s_add_u32 s34, s54, 3
    buffer_load_dwordx4 v[116:119], v13, s[12:15], s31 offen offset:0
    v_mfma_f32_16x16x32_bf16 a[164:167], v[36:39], v[160:163], a[164:167]
    s_lshr_b32 s35, s34, 2
    v_mfma_f32_16x16x32_bf16 a[168:171], v[40:43], v[160:163], a[168:171]
    v_mfma_f32_16x16x32_bf16 a[172:175], v[44:47], v[160:163], a[172:175]
    s_lshl_b32 s35, s35, 8
    v_mfma_f32_16x16x32_bf16 a[176:179], v[48:51], v[160:163], a[176:179]
    v_cvt_pk_bf16_f32 v148, v148, v149
    s_add_u32 m0, s33, 15360
    s_add_u32 s30, s47, s92
    buffer_load_dwordx4 v3, s[8:11], s30 offen lds
    ds_read_b128 v[160:163], v5 offset:18432
    s_waitcnt lgkmcnt(2)
    v_mfma_f32_16x16x32_bf16 a[180:183], v[16:19], v[164:167], a[180:183]
    v_mfma_f32_16x16x32_bf16 a[184:187], v[20:23], v[164:167], a[184:187]
    s_and_b32 s34, s34, 3
    v_mfma_f32_16x16x32_bf16 a[188:191], v[24:27], v[164:167], a[188:191]
    s_lshl_b32 s34, s34, 2
    v_mfma_f32_16x16x32_bf16 a[192:195], v[28:31], v[164:167], a[192:195]
    buffer_load_dwordx4 v[120:123], v14, s[12:15], s31 offen offset:0
    v_mfma_f32_16x16x32_bf16 a[196:199], v[32:35], v[164:167], a[196:199]
    s_add_u32 s35, s35, s34
    v_mfma_f32_16x16x32_bf16 a[200:203], v[36:39], v[164:167], a[200:203]
    s_add_u32 s35, s35, s53
    buffer_store_dword v148, v251, s[12:15], s35 offen
    v_mfma_f32_16x16x32_bf16 a[204:207], v[40:43], v[164:167], a[204:207]
    v_mfma_f32_16x16x32_bf16 a[208:211], v[44:47], v[164:167], a[208:211]
    v_mul_f32 v150, v150, v255
    v_mfma_f32_16x16x32_bf16 a[212:215], v[48:51], v[164:167], a[212:215]
    s_waitcnt vmcnt(29)
    ds_read_b128 v[164:167], v5 offset:20480
    s_waitcnt lgkmcnt(2)
    v_mfma_f32_16x16x32_bf16 v[172:175], v[52:55], v[168:171], v[172:175]
    v_mul_f32 v151, v151, v255
    s_lshl_b32 s31, s92, 4
    s_add_u32 s31, s31, s32
    buffer_load_dwordx4 v[16:19], v6, s[12:15], s31 offen offset:1024
    v_mfma_f32_16x16x32_bf16 v[176:179], v[56:59], v[168:171], v[176:179]
    s_add_u32 s34, s54, 4
    v_mfma_f32_16x16x32_bf16 v[180:183], v[60:63], v[168:171], v[180:183]
    v_mfma_f32_16x16x32_bf16 v[184:187], v[64:67], v[168:171], v[184:187]
    s_lshr_b32 s35, s34, 2
    v_mfma_f32_16x16x32_bf16 v[188:191], v[68:71], v[168:171], v[188:191]
    s_lshl_b32 s35, s35, 8
    buffer_load_dwordx4 v[20:23], v7, s[12:15], s31 offen offset:1024
    v_mfma_f32_16x16x32_bf16 v[192:195], v[72:75], v[168:171], v[192:195]
    v_mfma_f32_16x16x32_bf16 v[196:199], v[76:79], v[168:171], v[196:199]
    v_cvt_pk_bf16_f32 v150, v150, v151
    v_mfma_f32_16x16x32_bf16 v[200:203], v[80:83], v[168:171], v[200:203]
    s_and_b32 s34, s34, 3
    v_mfma_f32_16x16x32_bf16 v[204:207], v[84:87], v[168:171], v[204:207]
    buffer_load_dwordx4 v[24:27], v8, s[12:15], s31 offen offset:1024
    ds_read_b128 v[168:171], v5 offset:22528
    s_waitcnt lgkmcnt(2)
    v_mfma_f32_16x16x32_bf16 v[208:211], v[52:55], v[160:163], v[208:211]
    s_lshl_b32 s34, s34, 2
    v_mfma_f32_16x16x32_bf16 v[212:215], v[56:59], v[160:163], v[212:215]
    s_add_u32 s35, s35, s34
    v_mfma_f32_16x16x32_bf16 v[216:219], v[60:63], v[160:163], v[216:219]
    v_mfma_f32_16x16x32_bf16 v[220:223], v[64:67], v[160:163], v[220:223]
    s_add_u32 s35, s35, s53
    buffer_store_dword v150, v251, s[12:15], s35 offen
    buffer_load_dwordx4 v[28:31], v9, s[12:15], s31 offen offset:1024
    v_mfma_f32_16x16x32_bf16 v[224:227], v[68:71], v[160:163], v[224:227]
    v_mul_f32 v152, v152, v255
    v_mfma_f32_16x16x32_bf16 v[228:231], v[72:75], v[160:163], v[228:231]
    v_mfma_f32_16x16x32_bf16 v[232:235], v[76:79], v[160:163], v[232:235]
    v_mul_f32 v153, v153, v255
    v_mfma_f32_16x16x32_bf16 v[236:239], v[80:83], v[160:163], v[236:239]
    s_add_u32 s34, s54, 5
    buffer_load_dwordx4 v[32:35], v10, s[12:15], s31 offen offset:1024
    v_mfma_f32_16x16x32_bf16 v[240:243], v[84:87], v[160:163], v[240:243]
    ds_read_b128 v[160:163], v5 offset:24576
    s_waitcnt lgkmcnt(2)
    v_mfma_f32_16x16x32_bf16 a[0:3], v[52:55], v[164:167], a[0:3]
    s_lshr_b32 s35, s34, 2
    v_mfma_f32_16x16x32_bf16 a[4:7], v[56:59], v[164:167], a[4:7]
    s_lshl_b32 s35, s35, 8
    v_mfma_f32_16x16x32_bf16 a[8:11], v[60:63], v[164:167], a[8:11]
    buffer_load_dwordx4 v[36:39], v11, s[12:15], s31 offen offset:1024
    v_mfma_f32_16x16x32_bf16 a[12:15], v[64:67], v[164:167], a[12:15]
    v_cvt_pk_bf16_f32 v152, v152, v153
    v_mfma_f32_16x16x32_bf16 a[16:19], v[68:71], v[164:167], a[16:19]
    s_and_b32 s34, s34, 3
    v_mfma_f32_16x16x32_bf16 a[20:23], v[72:75], v[164:167], a[20:23]
    v_mfma_f32_16x16x32_bf16 a[24:27], v[76:79], v[164:167], a[24:27]
    s_lshl_b32 s34, s34, 2
    buffer_load_dwordx4 v[40:43], v12, s[12:15], s31 offen offset:1024
    v_mfma_f32_16x16x32_bf16 a[28:31], v[80:83], v[164:167], a[28:31]
    s_add_u32 s35, s35, s34
    v_mfma_f32_16x16x32_bf16 a[32:35], v[84:87], v[164:167], a[32:35]
    ds_read_b128 v[164:167], v5 offset:26624
    s_waitcnt lgkmcnt(2)
    v_mfma_f32_16x16x32_bf16 a[36:39], v[52:55], v[168:171], a[36:39]
    s_add_u32 s35, s35, s53
    buffer_store_dword v152, v251, s[12:15], s35 offen
    v_mfma_f32_16x16x32_bf16 a[40:43], v[56:59], v[168:171], a[40:43]
    v_mul_f32 v154, v154, v255
    buffer_load_dwordx4 v[44:47], v13, s[12:15], s31 offen offset:1024
    v_mfma_f32_16x16x32_bf16 a[44:47], v[60:63], v[168:171], a[44:47]
    v_mfma_f32_16x16x32_bf16 a[48:51], v[64:67], v[168:171], a[48:51]
    v_mul_f32 v155, v155, v255
    v_mfma_f32_16x16x32_bf16 a[52:55], v[68:71], v[168:171], a[52:55]
    s_add_u32 s34, s54, 6
    v_mfma_f32_16x16x32_bf16 a[56:59], v[72:75], v[168:171], a[56:59]
    buffer_load_dwordx4 v[48:51], v14, s[12:15], s31 offen offset:1024
    v_mfma_f32_16x16x32_bf16 a[60:63], v[76:79], v[168:171], a[60:63]
    s_lshr_b32 s35, s34, 2
    v_mfma_f32_16x16x32_bf16 a[64:67], v[80:83], v[168:171], a[64:67]
    s_lshl_b32 s35, s35, 8
    v_mfma_f32_16x16x32_bf16 a[68:71], v[84:87], v[168:171], a[68:71]
    ds_read_b128 v[168:171], v5 offset:28672
    s_waitcnt lgkmcnt(2)
    v_mfma_f32_16x16x32_bf16 a[72:75], v[52:55], v[160:163], a[72:75]
    v_cvt_pk_bf16_f32 v154, v154, v155
    v_mfma_f32_16x16x32_bf16 a[76:79], v[56:59], v[160:163], a[76:79]
    s_and_b32 s34, s34, 3
    v_mfma_f32_16x16x32_bf16 a[80:83], v[60:63], v[160:163], a[80:83]
    s_add_u32 m0, s33, 16384
    s_add_u32 s30, s40, s93
    buffer_load_dwordx4 v2, s[8:11], s30 offen lds
    v_mfma_f32_16x16x32_bf16 a[84:87], v[64:67], v[160:163], a[84:87]
    s_lshl_b32 s34, s34, 2
    v_mfma_f32_16x16x32_bf16 a[88:91], v[68:71], v[160:163], a[88:91]
    s_add_u32 s35, s35, s34
    v_mfma_f32_16x16x32_bf16 a[92:95], v[72:75], v[160:163], a[92:95]
    v_mfma_f32_16x16x32_bf16 a[96:99], v[76:79], v[160:163], a[96:99]
    s_add_u32 s35, s35, s53
    buffer_store_dword v154, v251, s[12:15], s35 offen
    s_add_u32 m0, s33, 17408
    s_add_u32 s30, s40, s93
    buffer_load_dwordx4 v3, s[8:11], s30 offen lds
    v_mfma_f32_16x16x32_bf16 a[100:103], v[80:83], v[160:163], a[100:103]
    v_mul_f32 v156, v156, v255
    v_mfma_f32_16x16x32_bf16 a[104:107], v[84:87], v[160:163], a[104:107]
    ds_read_b128 v[160:163], v5 offset:30720
    s_waitcnt lgkmcnt(2)
    v_mfma_f32_16x16x32_bf16 a[108:111], v[52:55], v[164:167], a[108:111]
    v_mul_f32 v157, v157, v255
    v_mfma_f32_16x16x32_bf16 a[112:115], v[56:59], v[164:167], a[112:115]
    s_add_u32 s34, s54, 7
    s_add_u32 m0, s33, 18432
    s_add_u32 s30, s41, s93
    buffer_load_dwordx4 v2, s[8:11], s30 offen lds
    v_mfma_f32_16x16x32_bf16 a[116:119], v[60:63], v[164:167], a[116:119]
    v_mfma_f32_16x16x32_bf16 a[120:123], v[64:67], v[164:167], a[120:123]
    s_lshr_b32 s35, s34, 2
    v_mfma_f32_16x16x32_bf16 a[124:127], v[68:71], v[164:167], a[124:127]
    s_lshl_b32 s35, s35, 8
    v_mfma_f32_16x16x32_bf16 a[128:131], v[72:75], v[164:167], a[128:131]
    s_add_u32 m0, s33, 19456
    s_add_u32 s30, s41, s93
    buffer_load_dwordx4 v3, s[8:11], s30 offen lds
    v_mfma_f32_16x16x32_bf16 a[132:135], v[76:79], v[164:167], a[132:135]
    v_cvt_pk_bf16_f32 v156, v156, v157
    v_mfma_f32_16x16x32_bf16 a[136:139], v[80:83], v[164:167], a[136:139]
    s_and_b32 s34, s34, 3
    v_mfma_f32_16x16x32_bf16 a[140:143], v[84:87], v[164:167], a[140:143]
    s_waitcnt vmcnt(37)
    ds_read_b128 v[164:167], v4 offset:0
    s_waitcnt lgkmcnt(2)
    v_mfma_f32_16x16x32_bf16 a[144:147], v[52:55], v[168:171], a[144:147]
    s_lshl_b32 s34, s34, 2
    s_add_u32 m0, s33, 20480
    s_add_u32 s30, s42, s93
    buffer_load_dwordx4 v2, s[8:11], s30 offen lds
    v_mfma_f32_16x16x32_bf16 a[148:151], v[56:59], v[168:171], a[148:151]
    s_add_u32 s35, s35, s34
    v_mfma_f32_16x16x32_bf16 a[152:155], v[60:63], v[168:171], a[152:155]
    v_mfma_f32_16x16x32_bf16 a[156:159], v[64:67], v[168:171], a[156:159]
    s_add_u32 s35, s35, s53
    buffer_store_dword v156, v251, s[12:15], s35 offen
    v_mfma_f32_16x16x32_bf16 a[160:163], v[68:71], v[168:171], a[160:163]
    v_mul_f32 v158, v158, v255
    s_add_u32 m0, s33, 21504
    s_add_u32 s30, s42, s93
    buffer_load_dwordx4 v3, s[8:11], s30 offen lds
    v_mfma_f32_16x16x32_bf16 a[164:167], v[72:75], v[168:171], a[164:167]
    v_mfma_f32_16x16x32_bf16 a[168:171], v[76:79], v[168:171], a[168:171]
    v_mul_f32 v159, v159, v255
    v_mfma_f32_16x16x32_bf16 a[172:175], v[80:83], v[168:171], a[172:175]
    s_add_u32 s34, s54, 8
    v_mfma_f32_16x16x32_bf16 a[176:179], v[84:87], v[168:171], a[176:179]
    s_add_u32 m0, s33, 22528
    s_add_u32 s30, s43, s93
    buffer_load_dwordx4 v2, s[8:11], s30 offen lds
    ds_read_b128 v[168:171], v4 offset:2048
    s_waitcnt lgkmcnt(2)
    v_mfma_f32_16x16x32_bf16 a[180:183], v[52:55], v[160:163], a[180:183]
    s_lshr_b32 s35, s34, 2
    v_mfma_f32_16x16x32_bf16 a[184:187], v[56:59], v[160:163], a[184:187]
    s_lshl_b32 s35, s35, 8
    v_mfma_f32_16x16x32_bf16 a[188:191], v[60:63], v[160:163], a[188:191]
    v_mfma_f32_16x16x32_bf16 a[192:195], v[64:67], v[160:163], a[192:195]
    v_cvt_pk_bf16_f32 v158, v158, v159
    s_add_u32 m0, s33, 23552
    s_add_u32 s30, s43, s93
    buffer_load_dwordx4 v3, s[8:11], s30 offen lds
    v_mfma_f32_16x16x32_bf16 a[196:199], v[68:71], v[160:163], a[196:199]
    s_and_b32 s34, s34, 3
    v_mfma_f32_16x16x32_bf16 a[200:203], v[72:75], v[160:163], a[200:203]
    v_mfma_f32_16x16x32_bf16 a[204:207], v[76:79], v[160:163], a[204:207]
    s_lshl_b32 s34, s34, 2
    v_mfma_f32_16x16x32_bf16 a[208:211], v[80:83], v[160:163], a[208:211]
    s_add_u32 s35, s35, s34
    v_mfma_f32_16x16x32_bf16 a[212:215], v[84:87], v[160:163], a[212:215]
    s_waitcnt vmcnt(22)
    ds_read_b128 v[160:163], v4 offset:4096
    s_waitcnt lgkmcnt(2)
    v_mfma_f32_16x16x32_bf16 v[172:175], v[88:91], v[164:167], v[172:175]
    s_add_u32 s35, s35, s53
    buffer_store_dword v158, v251, s[12:15], s35 offen
    s_add_u32 m0, s33, 24576
    s_add_u32 s30, s44, s93
    buffer_load_dwordx4 v2, s[8:11], s30 offen lds
    v_mfma_f32_16x16x32_bf16 v[176:179], v[92:95], v[164:167], v[176:179]
    v_mul_u32_u24 v253, 1821, v15
    v_mfma_f32_16x16x32_bf16 v[180:183], v[96:99], v[164:167], v[180:183]
    v_mfma_f32_16x16x32_bf16 v[184:187], v[100:103], v[164:167], v[184:187]
    v_lshrrev_b32 v253, 16, v253
    v_mfma_f32_16x16x32_bf16 v[188:191], v[104:107], v[164:167], v[188:191]
    v_mul_u32_u24 v254, 36, v253
    s_lshl_b32 s31, s93, 4
    s_add_u32 s31, s31, s32
    buffer_load_dwordx4 v[52:55], v6, s[12:15], s31 offen offset:0
    v_mfma_f32_16x16x32_bf16 v[192:195], v[108:111], v[164:167], v[192:195]
    v_mfma_f32_16x16x32_bf16 v[196:199], v[112:115], v[164:167], v[196:199]
    v_sub_u32 v254, v15, v254
    v_mfma_f32_16x16x32_bf16 v[200:203], v[116:119], v[164:167], v[200:203]
    v_lshlrev_b32 v254, 2, v254
    v_mfma_f32_16x16x32_bf16 v[204:207], v[120:123], v[164:167], v[204:207]
    buffer_load_dwordx4 v[56:59], v7, s[12:15], s31 offen offset:0
    ds_read_b128 v[164:167], v4 offset:6144
    s_waitcnt lgkmcnt(2)
    v_mfma_f32_16x16x32_bf16 v[208:211], v[88:91], v[168:171], v[208:211]
    v_min_u32 v250, 4, v253
    v_mfma_f32_16x16x32_bf16 v[212:215], v[92:95], v[168:171], v[212:215]
    v_lshlrev_b32 v250, 4, v250
    v_mfma_f32_16x16x32_bf16 v[216:219], v[96:99], v[168:171], v[216:219]
    v_mfma_f32_16x16x32_bf16 v[220:223], v[100:103], v[168:171], v[220:223]
    v_add_u32 v250, 147456, v250
    s_add_u32 m0, s33, 25600
    s_add_u32 s30, s44, s93
    buffer_load_dwordx4 v3, s[8:11], s30 offen lds
    v_mfma_f32_16x16x32_bf16 v[224:227], v[104:107], v[168:171], v[224:227]
    v_add_u32 v255, 159232, v254
    v_mfma_f32_16x16x32_bf16 v[228:231], v[108:111], v[168:171], v[228:231]
    v_mfma_f32_16x16x32_bf16 v[232:235], v[112:115], v[168:171], v[232:235]
    v_mov_b32 v144, 0
    v_mfma_f32_16x16x32_bf16 v[236:239], v[116:119], v[168:171], v[236:239]
    v_mov_b32 v145, 0
    buffer_load_dwordx4 v[60:63], v8, s[12:15], s31 offen offset:0
    v_mfma_f32_16x16x32_bf16 v[240:243], v[120:123], v[168:171], v[240:243]
    ds_read_b128 v[168:171], v4 offset:8192
    s_waitcnt lgkmcnt(2)
    v_mfma_f32_16x16x32_bf16 a[0:3], v[88:91], v[160:163], a[0:3]
    v_mov_b32 v146, 0
    v_mfma_f32_16x16x32_bf16 a[4:7], v[92:95], v[160:163], a[4:7]
    v_mov_b32 v147, 0
    v_mfma_f32_16x16x32_bf16 a[8:11], v[96:99], v[160:163], a[8:11]
    s_add_u32 m0, s33, 26624
    s_add_u32 s30, s45, s93
    buffer_load_dwordx4 v2, s[8:11], s30 offen lds
    v_mfma_f32_16x16x32_bf16 a[12:15], v[100:103], v[160:163], a[12:15]
    v_mov_b32 v148, 0
    v_mfma_f32_16x16x32_bf16 a[16:19], v[104:107], v[160:163], a[16:19]
    v_mov_b32 v149, 0
    v_mfma_f32_16x16x32_bf16 a[20:23], v[108:111], v[160:163], a[20:23]
    v_mfma_f32_16x16x32_bf16 a[24:27], v[112:115], v[160:163], a[24:27]
    v_mov_b32 v150, 0
    v_mfma_f32_16x16x32_bf16 a[28:31], v[116:119], v[160:163], a[28:31]
    buffer_load_dwordx4 v[64:67], v9, s[12:15], s31 offen offset:0
    v_mfma_f32_16x16x32_bf16 a[32:35], v[120:123], v[160:163], a[32:35]
    v_mov_b32 v151, 0
    ds_read_b128 v[160:163], v4 offset:10240
    s_waitcnt lgkmcnt(2)
    v_mfma_f32_16x16x32_bf16 a[36:39], v[88:91], v[164:167], a[36:39]
    ds_read_b128 v[124:127], v250 offset:0
    v_mfma_f32_16x16x32_bf16 a[40:43], v[92:95], v[164:167], a[40:43]
    v_mfma_f32_16x16x32_bf16 a[44:47], v[96:99], v[164:167], a[44:47]
    ds_read_b32 v140, v255 offset:0
    s_add_u32 m0, s33, 27648
    s_add_u32 s30, s45, s93
    buffer_load_dwordx4 v3, s[8:11], s30 offen lds
    v_mfma_f32_16x16x32_bf16 a[48:51], v[100:103], v[164:167], a[48:51]
    ds_read_b128 v[128:131], v250 offset:80
    v_mfma_f32_16x16x32_bf16 a[52:55], v[104:107], v[164:167], a[52:55]
    v_mfma_f32_16x16x32_bf16 a[56:59], v[108:111], v[164:167], a[56:59]
    ds_read_b32 v141, v255 offset:144
    v_mfma_f32_16x16x32_bf16 a[60:63], v[112:115], v[164:167], a[60:63]
    ds_read_b128 v[132:135], v250 offset:160
    buffer_load_dwordx4 v[68:71], v10, s[12:15], s31 offen offset:0
    v_mfma_f32_16x16x32_bf16 a[64:67], v[116:119], v[164:167], a[64:67]
    v_mfma_f32_16x16x32_bf16 a[68:71], v[120:123], v[164:167], a[68:71]
    ds_read_b32 v142, v255 offset:288
    ds_read_b128 v[164:167], v4 offset:12288
    s_waitcnt lgkmcnt(8)
    v_mfma_f32_16x16x32_bf16 a[72:75], v[88:91], v[168:171], a[72:75]
    ds_read_b128 v[136:139], v250 offset:240
    v_mfma_f32_16x16x32_bf16 a[76:79], v[92:95], v[168:171], a[76:79]
    s_add_u32 m0, s33, 28672
    s_add_u32 s30, s46, s93
    buffer_load_dwordx4 v2, s[8:11], s30 offen lds
    v_mfma_f32_16x16x32_bf16 a[80:83], v[96:99], v[168:171], a[80:83]
    ds_read_b32 v143, v255 offset:432
    v_mfma_f32_16x16x32_bf16 a[84:87], v[100:103], v[168:171], a[84:87]
    s_waitcnt lgkmcnt(7)
    v_mfma_f32_16x16x32_bf16 a[88:91], v[104:107], v[168:171], a[88:91]
    v_mfma_f32_16x16x32_bf16 a[92:95], v[108:111], v[168:171], a[92:95]
    v_lshlrev_b32 v152, 16, v140
    buffer_load_dwordx4 v[72:75], v11, s[12:15], s31 offen offset:0
    v_mfma_f32_16x16x32_bf16 a[96:99], v[112:115], v[168:171], a[96:99]
    v_and_b32 v153, 0xffff0000, v140
    v_mfma_f32_16x16x32_bf16 a[100:103], v[116:119], v[168:171], a[100:103]
    v_mfma_f32_16x16x32_bf16 a[104:107], v[120:123], v[168:171], a[104:107]
    v_fmac_f32 v144, v124, v152
    ds_read_b128 v[168:171], v4 offset:14336
    v_mfma_f32_16x16x32_bf16 a[108:111], v[88:91], v[160:163], a[108:111]
    v_fmac_f32 v145, v124, v153
    s_add_u32 m0, s33, 29696
    s_add_u32 s30, s46, s93
    buffer_load_dwordx4 v3, s[8:11], s30 offen lds
    v_mfma_f32_16x16x32_bf16 a[112:115], v[92:95], v[160:163], a[112:115]
    v_mfma_f32_16x16x32_bf16 a[116:119], v[96:99], v[160:163], a[116:119]
    v_fmac_f32 v146, v125, v152
    v_mfma_f32_16x16x32_bf16 a[120:123], v[100:103], v[160:163], a[120:123]
    v_mfma_f32_16x16x32_bf16 a[124:127], v[104:107], v[160:163], a[124:127]
    v_fmac_f32 v147, v125, v153
    v_mfma_f32_16x16x32_bf16 a[128:131], v[108:111], v[160:163], a[128:131]
    v_fmac_f32 v148, v126, v152
    buffer_load_dwordx4 v[76:79], v12, s[12:15], s31 offen offset:0
    v_mfma_f32_16x16x32_bf16 a[132:135], v[112:115], v[160:163], a[132:135]
    v_mfma_f32_16x16x32_bf16 a[136:139], v[116:119], v[160:163], a[136:139]
    v_fmac_f32 v149, v126, v153
    v_mfma_f32_16x16x32_bf16 a[140:143], v[120:123], v[160:163], a[140:143]
    v_fmac_f32 v150, v127, v152
    ds_read_b128 v[160:163], v5 offset:0
    s_waitcnt lgkmcnt(4)
    v_mfma_f32_16x16x32_bf16 a[144:147], v[88:91], v[164:167], a[144:147]
    s_add_u32 m0, s33, 30720
    s_add_u32 s30, s47, s93
    buffer_load_dwordx4 v2, s[8:11], s30 offen lds
    v_mfma_f32_16x16x32_bf16 a[148:151], v[92:95], v[164:167], a[148:151]
    v_fmac_f32 v151, v127, v153
    v_mfma_f32_16x16x32_bf16 a[152:155], v[96:99], v[164:167], a[152:155]
    ds_read_b128 v[124:127], v250 offset:320
    v_mfma_f32_16x16x32_bf16 a[156:159], v[100:103], v[164:167], a[156:159]
    v_mfma_f32_16x16x32_bf16 a[160:163], v[104:107], v[164:167], a[160:163]
    ds_read_b32 v140, v255 offset:576
    buffer_load_dwordx4 v[80:83], v13, s[12:15], s31 offen offset:0
    v_mfma_f32_16x16x32_bf16 a[164:167], v[108:111], v[164:167], a[164:167]
    v_mfma_f32_16x16x32_bf16 a[168:171], v[112:115], v[164:167], a[168:171]
    v_mfma_f32_16x16x32_bf16 a[172:175], v[116:119], v[164:167], a[172:175]
    v_lshlrev_b32 v152, 16, v141
    v_mfma_f32_16x16x32_bf16 a[176:179], v[120:123], v[164:167], a[176:179]
    v_and_b32 v153, 0xffff0000, v141
    s_add_u32 m0, s33, 31744
    s_add_u32 s30, s47, s93
    buffer_load_dwordx4 v3, s[8:11], s30 offen lds
    ds_read_b128 v[164:167], v5 offset:2048
    s_waitcnt lgkmcnt(4)
    v_mfma_f32_16x16x32_bf16 a[180:183], v[88:91], v[168:171], a[180:183]
    v_mfma_f32_16x16x32_bf16 a[184:187], v[92:95], v[168:171], a[184:187]
    v_fmac_f32 v144, v128, v152
    v_mfma_f32_16x16x32_bf16 a[188:191], v[96:99], v[168:171], a[188:191]
    v_fmac_f32 v145, v128, v153
    v_mfma_f32_16x16x32_bf16 a[192:195], v[100:103], v[168:171], a[192:195]
    buffer_load_dwordx4 v[84:87], v14, s[12:15], s31 offen offset:0
    v_mfma_f32_16x16x32_bf16 a[196:199], v[104:107], v[168:171], a[196:199]
    v_fmac_f32 v146, v129, v152
    v_mfma_f32_16x16x32_bf16 a[200:203], v[108:111], v[168:171], a[200:203]
    v_fmac_f32 v147, v129, v153
    v_mfma_f32_16x16x32_bf16 a[204:207], v[112:115], v[168:171], a[204:207]
    v_mfma_f32_16x16x32_bf16 a[208:211], v[116:119], v[168:171], a[208:211]
    v_fmac_f32 v148, v130, v152
    v_mfma_f32_16x16x32_bf16 a[212:215], v[120:123], v[168:171], a[212:215]
    s_waitcnt vmcnt(28)
    ds_read_b128 v[168:171], v5 offset:4096
    s_waitcnt lgkmcnt(4)
    v_mfma_f32_16x16x32_bf16 v[172:175], v[16:19], v[160:163], v[172:175]
    v_fmac_f32 v149, v130, v153
    s_lshl_b32 s31, s93, 4
    s_add_u32 s31, s31, s32
    buffer_load_dwordx4 v[88:91], v6, s[12:15], s31 offen offset:1024
    v_mfma_f32_16x16x32_bf16 v[176:179], v[20:23], v[160:163], v[176:179]
    v_fmac_f32 v150, v131, v152
    v_mfma_f32_16x16x32_bf16 v[180:183], v[24:27], v[160:163], v[180:183]
    v_mfma_f32_16x16x32_bf16 v[184:187], v[28:31], v[160:163], v[184:187]
    v_fmac_f32 v151, v131, v153
    v_mfma_f32_16x16x32_bf16 v[188:191], v[32:35], v[160:163], v[188:191]
    ds_read_b128 v[128:131], v250 offset:400
    buffer_load_dwordx4 v[92:95], v7, s[12:15], s31 offen offset:1024
    v_mfma_f32_16x16x32_bf16 v[192:195], v[36:39], v[160:163], v[192:195]
    v_mfma_f32_16x16x32_bf16 v[196:199], v[40:43], v[160:163], v[196:199]
    ds_read_b32 v141, v255 offset:720
    v_mfma_f32_16x16x32_bf16 v[200:203], v[44:47], v[160:163], v[200:203]
    v_mfma_f32_16x16x32_bf16 v[204:207], v[48:51], v[160:163], v[204:207]
    buffer_load_dwordx4 v[96:99], v8, s[12:15], s31 offen offset:1024
    ds_read_b128 v[160:163], v5 offset:6144
    s_waitcnt lgkmcnt(4)
    v_mfma_f32_16x16x32_bf16 v[208:211], v[16:19], v[164:167], v[208:211]
    v_lshlrev_b32 v152, 16, v142
    v_mfma_f32_16x16x32_bf16 v[212:215], v[20:23], v[164:167], v[212:215]
    v_and_b32 v153, 0xffff0000, v142
    v_mfma_f32_16x16x32_bf16 v[216:219], v[24:27], v[164:167], v[216:219]
    v_mfma_f32_16x16x32_bf16 v[220:223], v[28:31], v[164:167], v[220:223]
    v_fmac_f32 v144, v132, v152
    buffer_load_dwordx4 v[100:103], v9, s[12:15], s31 offen offset:1024
    v_mfma_f32_16x16x32_bf16 v[224:227], v[32:35], v[164:167], v[224:227]
    v_fmac_f32 v145, v132, v153
    v_mfma_f32_16x16x32_bf16 v[228:231], v[36:39], v[164:167], v[228:231]
    v_mfma_f32_16x16x32_bf16 v[232:235], v[40:43], v[164:167], v[232:235]
    v_fmac_f32 v146, v133, v152
    v_mfma_f32_16x16x32_bf16 v[236:239], v[44:47], v[164:167], v[236:239]
    v_fmac_f32 v147, v133, v153
    buffer_load_dwordx4 v[104:107], v10, s[12:15], s31 offen offset:1024
    v_mfma_f32_16x16x32_bf16 v[240:243], v[48:51], v[164:167], v[240:243]
    ds_read_b128 v[164:167], v5 offset:8192
    s_waitcnt lgkmcnt(4)
    v_mfma_f32_16x16x32_bf16 a[0:3], v[16:19], v[168:171], a[0:3]
    v_fmac_f32 v148, v134, v152
    v_mfma_f32_16x16x32_bf16 a[4:7], v[20:23], v[168:171], a[4:7]
    v_fmac_f32 v149, v134, v153
    v_mfma_f32_16x16x32_bf16 a[8:11], v[24:27], v[168:171], a[8:11]
    buffer_load_dwordx4 v[108:111], v11, s[12:15], s31 offen offset:1024
    v_mfma_f32_16x16x32_bf16 a[12:15], v[28:31], v[168:171], a[12:15]
    v_fmac_f32 v150, v135, v152
    v_mfma_f32_16x16x32_bf16 a[16:19], v[32:35], v[168:171], a[16:19]
    v_fmac_f32 v151, v135, v153
    v_mfma_f32_16x16x32_bf16 a[20:23], v[36:39], v[168:171], a[20:23]
    v_mfma_f32_16x16x32_bf16 a[24:27], v[40:43], v[168:171], a[24:27]
    ds_read_b128 v[132:135], v250 offset:480
    buffer_load_dwordx4 v[112:115], v12, s[12:15], s31 offen offset:1024
    v_mfma_f32_16x16x32_bf16 a[28:31], v[44:47], v[168:171], a[28:31]
    ds_read_b32 v142, v255 offset:864
    v_mfma_f32_16x16x32_bf16 a[32:35], v[48:51], v[168:171], a[32:35]
    ds_read_b128 v[168:171], v5 offset:10240
    s_waitcnt lgkmcnt(4)
    v_mfma_f32_16x16x32_bf16 a[36:39], v[16:19], v[160:163], a[36:39]
    v_mfma_f32_16x16x32_bf16 a[40:43], v[20:23], v[160:163], a[40:43]
    v_lshlrev_b32 v152, 16, v143
    buffer_load_dwordx4 v[116:119], v13, s[12:15], s31 offen offset:1024
    v_mfma_f32_16x16x32_bf16 a[44:47], v[24:27], v[160:163], a[44:47]
    v_mfma_f32_16x16x32_bf16 a[48:51], v[28:31], v[160:163], a[48:51]
    v_and_b32 v153, 0xffff0000, v143
    v_mfma_f32_16x16x32_bf16 a[52:55], v[32:35], v[160:163], a[52:55]
    v_fmac_f32 v144, v136, v152
    v_mfma_f32_16x16x32_bf16 a[56:59], v[36:39], v[160:163], a[56:59]
    buffer_load_dwordx4 v[120:123], v14, s[12:15], s31 offen offset:1024
    v_mfma_f32_16x16x32_bf16 a[60:63], v[40:43], v[160:163], a[60:63]
    v_fmac_f32 v145, v136, v153
    v_mfma_f32_16x16x32_bf16 a[64:67], v[44:47], v[160:163], a[64:67]
    v_fmac_f32 v146, v137, v152
    v_mfma_f32_16x16x32_bf16 a[68:71], v[48:51], v[160:163], a[68:71]
    ds_read_b128 v[160:163], v5 offset:12288
    s_waitcnt lgkmcnt(4)
    v_mfma_f32_16x16x32_bf16 a[72:75], v[16:19], v[164:167], a[72:75]
    v_fmac_f32 v147, v137, v153
    v_mfma_f32_16x16x32_bf16 a[76:79], v[20:23], v[164:167], a[76:79]
    v_fmac_f32 v148, v138, v152
    v_mfma_f32_16x16x32_bf16 a[80:83], v[24:27], v[164:167], a[80:83]
    s_add_u32 m0, s33, 0
    s_add_u32 s30, s40, s94
    buffer_load_dwordx4 v2, s[8:11], s30 offen lds
    v_mfma_f32_16x16x32_bf16 a[84:87], v[28:31], v[164:167], a[84:87]
    v_fmac_f32 v149, v138, v153
    v_mfma_f32_16x16x32_bf16 a[88:91], v[32:35], v[164:167], a[88:91]
    v_fmac_f32 v150, v139, v152
    v_mfma_f32_16x16x32_bf16 a[92:95], v[36:39], v[164:167], a[92:95]
    v_mfma_f32_16x16x32_bf16 a[96:99], v[40:43], v[164:167], a[96:99]
    v_fmac_f32 v151, v139, v153
    s_add_u32 m0, s33, 1024
    s_add_u32 s30, s40, s94
    buffer_load_dwordx4 v3, s[8:11], s30 offen lds
    v_mfma_f32_16x16x32_bf16 a[100:103], v[44:47], v[164:167], a[100:103]
    ds_read_b128 v[136:139], v250 offset:560
    v_mfma_f32_16x16x32_bf16 a[104:107], v[48:51], v[164:167], a[104:107]
    ds_read_b128 v[164:167], v5 offset:14336
    s_waitcnt lgkmcnt(3)
    v_mfma_f32_16x16x32_bf16 a[108:111], v[16:19], v[168:171], a[108:111]
    ds_read_b32 v143, v255 offset:1008
    v_mfma_f32_16x16x32_bf16 a[112:115], v[20:23], v[168:171], a[112:115]
    s_add_u32 m0, s33, 2048
    s_add_u32 s30, s41, s94
    buffer_load_dwordx4 v2, s[8:11], s30 offen lds
    v_mfma_f32_16x16x32_bf16 a[116:119], v[24:27], v[168:171], a[116:119]
    v_mfma_f32_16x16x32_bf16 a[120:123], v[28:31], v[168:171], a[120:123]
    v_lshlrev_b32 v152, 16, v140
    v_mfma_f32_16x16x32_bf16 a[124:127], v[32:35], v[168:171], a[124:127]
    v_and_b32 v153, 0xffff0000, v140
    v_mfma_f32_16x16x32_bf16 a[128:131], v[36:39], v[168:171], a[128:131]
    s_add_u32 m0, s33, 3072
    s_add_u32 s30, s41, s94
    buffer_load_dwordx4 v3, s[8:11], s30 offen lds
    v_mfma_f32_16x16x32_bf16 a[132:135], v[40:43], v[168:171], a[132:135]
    v_fmac_f32 v144, v124, v152
    v_mfma_f32_16x16x32_bf16 a[136:139], v[44:47], v[168:171], a[136:139]
    v_fmac_f32 v145, v124, v153
    v_mfma_f32_16x16x32_bf16 a[140:143], v[48:51], v[168:171], a[140:143]
    s_waitcnt vmcnt(31)
    ds_read_b128 v[168:171], v4 offset:16384
    s_waitcnt lgkmcnt(4)
    v_mfma_f32_16x16x32_bf16 a[144:147], v[16:19], v[160:163], a[144:147]
    v_fmac_f32 v146, v125, v152
    s_add_u32 m0, s33, 4096
    s_add_u32 s30, s42, s94
    buffer_load_dwordx4 v2, s[8:11], s30 offen lds
    v_mfma_f32_16x16x32_bf16 a[148:151], v[20:23], v[160:163], a[148:151]
    v_fmac_f32 v147, v125, v153
    v_mfma_f32_16x16x32_bf16 a[152:155], v[24:27], v[160:163], a[152:155]
    v_mfma_f32_16x16x32_bf16 a[156:159], v[28:31], v[160:163], a[156:159]
    v_fmac_f32 v148, v126, v152
    v_mfma_f32_16x16x32_bf16 a[160:163], v[32:35], v[160:163], a[160:163]
    v_fmac_f32 v149, v126, v153
    s_add_u32 m0, s33, 5120
    s_add_u32 s30, s42, s94
    buffer_load_dwordx4 v3, s[8:11], s30 offen lds
    v_mfma_f32_16x16x32_bf16 a[164:167], v[36:39], v[160:163], a[164:167]
    v_mfma_f32_16x16x32_bf16 a[168:171], v[40:43], v[160:163], a[168:171]
    v_fmac_f32 v150, v127, v152
    v_mfma_f32_16x16x32_bf16 a[172:175], v[44:47], v[160:163], a[172:175]
    v_fmac_f32 v151, v127, v153
    v_mfma_f32_16x16x32_bf16 a[176:179], v[48:51], v[160:163], a[176:179]
    s_add_u32 m0, s33, 6144
    s_add_u32 s30, s43, s94
    buffer_load_dwordx4 v2, s[8:11], s30 offen lds
    ds_read_b128 v[160:163], v4 offset:18432
    s_waitcnt lgkmcnt(3)
    v_mfma_f32_16x16x32_bf16 a[180:183], v[16:19], v[164:167], a[180:183]
    ds_read_b128 v[124:127], v250 offset:640
    v_mfma_f32_16x16x32_bf16 a[184:187], v[20:23], v[164:167], a[184:187]
    ds_read_b32 v140, v255 offset:1152
    v_mfma_f32_16x16x32_bf16 a[188:191], v[24:27], v[164:167], a[188:191]
    v_mfma_f32_16x16x32_bf16 a[192:195], v[28:31], v[164:167], a[192:195]
    s_add_u32 m0, s33, 7168
    s_add_u32 s30, s43, s94
    buffer_load_dwordx4 v3, s[8:11], s30 offen lds
    v_mfma_f32_16x16x32_bf16 a[196:199], v[32:35], v[164:167], a[196:199]
    v_lshlrev_b32 v152, 16, v141
    v_mfma_f32_16x16x32_bf16 a[200:203], v[36:39], v[164:167], a[200:203]
    v_mfma_f32_16x16x32_bf16 a[204:207], v[40:43], v[164:167], a[204:207]
    v_and_b32 v153, 0xffff0000, v141
    v_mfma_f32_16x16x32_bf16 a[208:211], v[44:47], v[164:167], a[208:211]
    v_fmac_f32 v144, v128, v152
    v_mfma_f32_16x16x32_bf16 a[212:215], v[48:51], v[164:167], a[212:215]
    s_waitcnt vmcnt(17)
    ds_read_b128 v[164:167], v4 offset:20480
    s_waitcnt lgkmcnt(4)
    v_mfma_f32_16x16x32_bf16 v[172:175], v[52:55], v[168:171], v[172:175]
    v_fmac_f32 v145, v128, v153
    s_add_u32 m0, s33, 8192
    s_add_u32 s30, s44, s94
    buffer_load_dwordx4 v2, s[8:11], s30 offen lds
    v_mfma_f32_16x16x32_bf16 v[176:179], v[56:59], v[168:171], v[176:179]
    v_fmac_f32 v146, v129, v152
    v_mfma_f32_16x16x32_bf16 v[180:183], v[60:63], v[168:171], v[180:183]
    v_mfma_f32_16x16x32_bf16 v[184:187], v[64:67], v[168:171], v[184:187]
    v_fmac_f32 v147, v129, v153
    v_mfma_f32_16x16x32_bf16 v[188:191], v[68:71], v[168:171], v[188:191]
    v_fmac_f32 v148, v130, v152
    s_lshl_b32 s31, s94, 4
    s_add_u32 s31, s31, s32
    buffer_load_dwordx4 v[16:19], v6, s[12:15], s31 offen offset:0
    v_mfma_f32_16x16x32_bf16 v[192:195], v[72:75], v[168:171], v[192:195]
    v_mfma_f32_16x16x32_bf16 v[196:199], v[76:79], v[168:171], v[196:199]
    v_fmac_f32 v149, v130, v153
    v_mfma_f32_16x16x32_bf16 v[200:203], v[80:83], v[168:171], v[200:203]
    v_fmac_f32 v150, v131, v152
    v_mfma_f32_16x16x32_bf16 v[204:207], v[84:87], v[168:171], v[204:207]
    buffer_load_dwordx4 v[20:23], v7, s[12:15], s31 offen offset:0
    ds_read_b128 v[168:171], v4 offset:22528
    s_waitcnt lgkmcnt(4)
    v_mfma_f32_16x16x32_bf16 v[208:211], v[52:55], v[160:163], v[208:211]
    v_fmac_f32 v151, v131, v153
    v_mfma_f32_16x16x32_bf16 v[212:215], v[56:59], v[160:163], v[212:215]
    ds_read_b128 v[128:131], v250 offset:720
    v_mfma_f32_16x16x32_bf16 v[216:219], v[60:63], v[160:163], v[216:219]
    v_mfma_f32_16x16x32_bf16 v[220:223], v[64:67], v[160:163], v[220:223]
    ds_read_b32 v141, v255 offset:1296
    s_add_u32 m0, s33, 9216
    s_add_u32 s30, s44, s94
    buffer_load_dwordx4 v3, s[8:11], s30 offen lds
    v_mfma_f32_16x16x32_bf16 v[224:227], v[68:71], v[160:163], v[224:227]
    v_mfma_f32_16x16x32_bf16 v[228:231], v[72:75], v[160:163], v[228:231]
    v_mfma_f32_16x16x32_bf16 v[232:235], v[76:79], v[160:163], v[232:235]
    v_lshlrev_b32 v152, 16, v142
    v_mfma_f32_16x16x32_bf16 v[236:239], v[80:83], v[160:163], v[236:239]
    v_and_b32 v153, 0xffff0000, v142
    buffer_load_dwordx4 v[24:27], v8, s[12:15], s31 offen offset:0
    v_mfma_f32_16x16x32_bf16 v[240:243], v[84:87], v[160:163], v[240:243]
    ds_read_b128 v[160:163], v4 offset:24576
    s_waitcnt lgkmcnt(4)
    v_mfma_f32_16x16x32_bf16 a[0:3], v[52:55], v[164:167], a[0:3]
    v_fmac_f32 v144, v132, v152
    v_mfma_f32_16x16x32_bf16 a[4:7], v[56:59], v[164:167], a[4:7]
    v_fmac_f32 v145, v132, v153
    v_mfma_f32_16x16x32_bf16 a[8:11], v[60:63], v[164:167], a[8:11]
    s_add_u32 m0, s33, 10240
    s_add_u32 s30, s45, s94
    buffer_load_dwordx4 v2, s[8:11], s30 offen lds
    v_mfma_f32_16x16x32_bf16 a[12:15], v[64:67], v[164:167], a[12:15]
    v_fmac_f32 v146, v133, v152
    v_mfma_f32_16x16x32_bf16 a[16:19], v[68:71], v[164:167], a[16:19]
    v_fmac_f32 v147, v133, v153
    v_mfma_f32_16x16x32_bf16 a[20:23], v[72:75], v[164:167], a[20:23]
    v_mfma_f32_16x16x32_bf16 a[24:27], v[76:79], v[164:167], a[24:27]
    v_fmac_f32 v148, v134, v152
    v_mfma_f32_16x16x32_bf16 a[28:31], v[80:83], v[164:167], a[28:31]
    buffer_load_dwordx4 v[28:31], v9, s[12:15], s31 offen offset:0
    v_mfma_f32_16x16x32_bf16 a[32:35], v[84:87], v[164:167], a[32:35]
    v_fmac_f32 v149, v134, v153
    ds_read_b128 v[164:167], v4 offset:26624
    s_waitcnt lgkmcnt(4)
    v_mfma_f32_16x16x32_bf16 a[36:39], v[52:55], v[168:171], a[36:39]
    v_fmac_f32 v150, v135, v152
    v_mfma_f32_16x16x32_bf16 a[40:43], v[56:59], v[168:171], a[40:43]
    v_mfma_f32_16x16x32_bf16 a[44:47], v[60:63], v[168:171], a[44:47]
    v_fmac_f32 v151, v135, v153
    s_add_u32 m0, s33, 11264
    s_add_u32 s30, s45, s94
    buffer_load_dwordx4 v3, s[8:11], s30 offen lds
    v_mfma_f32_16x16x32_bf16 a[48:51], v[64:67], v[168:171], a[48:51]
    ds_read_b128 v[132:135], v250 offset:800
    v_mfma_f32_16x16x32_bf16 a[52:55], v[68:71], v[168:171], a[52:55]
    v_mfma_f32_16x16x32_bf16 a[56:59], v[72:75], v[168:171], a[56:59]
    ds_read_b32 v142, v255 offset:1440
    v_mfma_f32_16x16x32_bf16 a[60:63], v[76:79], v[168:171], a[60:63]
    buffer_load_dwordx4 v[32:35], v10, s[12:15], s31 offen offset:0
    v_mfma_f32_16x16x32_bf16 a[64:67], v[80:83], v[168:171], a[64:67]
    v_mfma_f32_16x16x32_bf16 a[68:71], v[84:87], v[168:171], a[68:71]
    v_lshlrev_b32 v152, 16, v143
    ds_read_b128 v[168:171], v4 offset:28672
    s_waitcnt lgkmcnt(4)
    v_mfma_f32_16x16x32_bf16 a[72:75], v[52:55], v[160:163], a[72:75]
    v_and_b32 v153, 0xffff0000, v143
    v_mfma_f32_16x16x32_bf16 a[76:79], v[56:59], v[160:163], a[76:79]
    s_add_u32 m0, s33, 12288
    s_add_u32 s30, s46, s94
    buffer_load_dwordx4 v2, s[8:11], s30 offen lds
    v_mfma_f32_16x16x32_bf16 a[80:83], v[60:63], v[160:163], a[80:83]
    v_fmac_f32 v144, v136, v152
    v_mfma_f32_16x16x32_bf16 a[84:87], v[64:67], v[160:163], a[84:87]
    v_fmac_f32 v145, v136, v153
    v_mfma_f32_16x16x32_bf16 a[88:91], v[68:71], v[160:163], a[88:91]
    v_mfma_f32_16x16x32_bf16 a[92:95], v[72:75], v[160:163], a[92:95]
    v_fmac_f32 v146, v137, v152
    buffer_load_dwordx4 v[36:39], v11, s[12:15], s31 offen offset:0
    v_mfma_f32_16x16x32_bf16 a[96:99], v[76:79], v[160:163], a[96:99]
    v_fmac_f32 v147, v137, v153
    v_mfma_f32_16x16x32_bf16 a[100:103], v[80:83], v[160:163], a[100:103]
    v_mfma_f32_16x16x32_bf16 a[104:107], v[84:87], v[160:163], a[104:107]
    v_fmac_f32 v148, v138, v152
    ds_read_b128 v[160:163], v4 offset:30720
    s_waitcnt lgkmcnt(4)
    v_mfma_f32_16x16x32_bf16 a[108:111], v[52:55], v[164:167], a[108:111]
    v_fmac_f32 v149, v138, v153
    s_add_u32 m0, s33, 13312
    s_add_u32 s30, s46, s94
    buffer_load_dwordx4 v3, s[8:11], s30 offen lds
    v_mfma_f32_16x16x32_bf16 a[112:115], v[56:59], v[164:167], a[112:115]
    v_mfma_f32_16x16x32_bf16 a[116:119], v[60:63], v[164:167], a[116:119]
    v_fmac_f32 v150, v139, v152
    v_mfma_f32_16x16x32_bf16 a[120:123], v[64:67], v[164:167], a[120:123]
    v_mfma_f32_16x16x32_bf16 a[124:127], v[68:71], v[164:167], a[124:127]
    v_fmac_f32 v151, v139, v153
    v_mfma_f32_16x16x32_bf16 a[128:131], v[72:75], v[164:167], a[128:131]
    ds_read_b128 v[136:139], v250 offset:880
    buffer_load_dwordx4 v[40:43], v12, s[12:15], s31 offen offset:0
    v_mfma_f32_16x16x32_bf16 a[132:135], v[76:79], v[164:167], a[132:135]
    v_mfma_f32_16x16x32_bf16 a[136:139], v[80:83], v[164:167], a[136:139]
    ds_read_b32 v143, v255 offset:1584
    v_mfma_f32_16x16x32_bf16 a[140:143], v[84:87], v[164:167], a[140:143]
    ds_read_b128 v[164:167], v5 offset:16384
    s_waitcnt lgkmcnt(4)
    v_mfma_f32_16x16x32_bf16 a[144:147], v[52:55], v[168:171], a[144:147]
    s_add_u32 m0, s33, 14336
    s_add_u32 s30, s47, s94
    buffer_load_dwordx4 v2, s[8:11], s30 offen lds
    v_mfma_f32_16x16x32_bf16 a[148:151], v[56:59], v[168:171], a[148:151]
    v_lshlrev_b32 v152, 16, v140
    v_mfma_f32_16x16x32_bf16 a[152:155], v[60:63], v[168:171], a[152:155]
    v_and_b32 v153, 0xffff0000, v140
    v_mfma_f32_16x16x32_bf16 a[156:159], v[64:67], v[168:171], a[156:159]
    v_mfma_f32_16x16x32_bf16 a[160:163], v[68:71], v[168:171], a[160:163]
    v_fmac_f32 v144, v124, v152
    buffer_load_dwordx4 v[44:47], v13, s[12:15], s31 offen offset:0
    v_mfma_f32_16x16x32_bf16 a[164:167], v[72:75], v[168:171], a[164:167]
    v_fmac_f32 v145, v124, v153
    v_mfma_f32_16x16x32_bf16 a[168:171], v[76:79], v[168:171], a[168:171]
    v_mfma_f32_16x16x32_bf16 a[172:175], v[80:83], v[168:171], a[172:175]
    v_fmac_f32 v146, v125, v152
    v_mfma_f32_16x16x32_bf16 a[176:179], v[84:87], v[168:171], a[176:179]
    v_fmac_f32 v147, v125, v153
    s_add_u32 m0, s33, 15360
    s_add_u32 s30, s47, s94
    buffer_load_dwordx4 v3, s[8:11], s30 offen lds
    ds_read_b128 v[168:171], v5 offset:18432
    s_waitcnt lgkmcnt(4)
    v_mfma_f32_16x16x32_bf16 a[180:183], v[52:55], v[160:163], a[180:183]
    v_mfma_f32_16x16x32_bf16 a[184:187], v[56:59], v[160:163], a[184:187]
    v_fmac_f32 v148, v126, v152
    v_mfma_f32_16x16x32_bf16 a[188:191], v[60:63], v[160:163], a[188:191]
    v_fmac_f32 v149, v126, v153
    v_mfma_f32_16x16x32_bf16 a[192:195], v[64:67], v[160:163], a[192:195]
    buffer_load_dwordx4 v[48:51], v14, s[12:15], s31 offen offset:0
    v_mfma_f32_16x16x32_bf16 a[196:199], v[68:71], v[160:163], a[196:199]
    v_fmac_f32 v150, v127, v152
    v_mfma_f32_16x16x32_bf16 a[200:203], v[72:75], v[160:163], a[200:203]
    v_fmac_f32 v151, v127, v153
    v_mfma_f32_16x16x32_bf16 a[204:207], v[76:79], v[160:163], a[204:207]
    v_mfma_f32_16x16x32_bf16 a[208:211], v[80:83], v[160:163], a[208:211]
    ds_read_b128 v[124:127], v250 offset:960
    v_mfma_f32_16x16x32_bf16 a[212:215], v[84:87], v[160:163], a[212:215]
    s_waitcnt vmcnt(25)
    ds_read_b128 v[160:163], v5 offset:20480
    s_waitcnt lgkmcnt(3)
    v_mfma_f32_16x16x32_bf16 v[172:175], v[88:91], v[164:167], v[172:175]
    ds_read_b32 v140, v255 offset:1728
    s_lshl_b32 s31, s94, 4
    s_add_u32 s31, s31, s32
    buffer_load_dwordx4 v[52:55], v6, s[12:15], s31 offen offset:1024
    v_mfma_f32_16x16x32_bf16 v[176:179], v[92:95], v[164:167], v[176:179]
    v_mfma_f32_16x16x32_bf16 v[180:183], v[96:99], v[164:167], v[180:183]
    v_mfma_f32_16x16x32_bf16 v[184:187], v[100:103], v[164:167], v[184:187]
    v_lshlrev_b32 v152, 16, v141
    v_mfma_f32_16x16x32_bf16 v[188:191], v[104:107], v[164:167], v[188:191]
    v_and_b32 v153, 0xffff0000, v141
    buffer_load_dwordx4 v[56:59], v7, s[12:15], s31 offen offset:1024
    v_mfma_f32_16x16x32_bf16 v[192:195], v[108:111], v[164:167], v[192:195]
    v_mfma_f32_16x16x32_bf16 v[196:199], v[112:115], v[164:167], v[196:199]
    v_fmac_f32 v144, v128, v152
    v_mfma_f32_16x16x32_bf16 v[200:203], v[116:119], v[164:167], v[200:203]
    v_fmac_f32 v145, v128, v153
    v_mfma_f32_16x16x32_bf16 v[204:207], v[120:123], v[164:167], v[204:207]
    buffer_load_dwordx4 v[60:63], v8, s[12:15], s31 offen offset:1024
    ds_read_b128 v[164:167], v5 offset:22528
    s_waitcnt lgkmcnt(4)
    v_mfma_f32_16x16x32_bf16 v[208:211], v[88:91], v[168:171], v[208:211]
    v_fmac_f32 v146, v129, v152
    v_mfma_f32_16x16x32_bf16 v[212:215], v[92:95], v[168:171], v[212:215]
    v_fmac_f32 v147, v129, v153
    v_mfma_f32_16x16x32_bf16 v[216:219], v[96:99], v[168:171], v[216:219]
    v_mfma_f32_16x16x32_bf16 v[220:223], v[100:103], v[168:171], v[220:223]
    v_fmac_f32 v148, v130, v152
    buffer_load_dwordx4 v[64:67], v9, s[12:15], s31 offen offset:1024
    v_mfma_f32_16x16x32_bf16 v[224:227], v[104:107], v[168:171], v[224:227]
    v_fmac_f32 v149, v130, v153
    v_mfma_f32_16x16x32_bf16 v[228:231], v[108:111], v[168:171], v[228:231]
    v_mfma_f32_16x16x32_bf16 v[232:235], v[112:115], v[168:171], v[232:235]
    v_fmac_f32 v150, v131, v152
    v_mfma_f32_16x16x32_bf16 v[236:239], v[116:119], v[168:171], v[236:239]
    v_fmac_f32 v151, v131, v153
    buffer_load_dwordx4 v[68:71], v10, s[12:15], s31 offen offset:1024
    v_mfma_f32_16x16x32_bf16 v[240:243], v[120:123], v[168:171], v[240:243]
    ds_read_b128 v[168:171], v5 offset:24576
    s_waitcnt lgkmcnt(3)
    v_mfma_f32_16x16x32_bf16 a[0:3], v[88:91], v[160:163], a[0:3]
    ds_read_b128 v[128:131], v250 offset:1040
    v_mfma_f32_16x16x32_bf16 a[4:7], v[92:95], v[160:163], a[4:7]
    ds_read_b32 v141, v255 offset:1872
    v_mfma_f32_16x16x32_bf16 a[8:11], v[96:99], v[160:163], a[8:11]
    buffer_load_dwordx4 v[72:75], v11, s[12:15], s31 offen offset:1024
    v_mfma_f32_16x16x32_bf16 a[12:15], v[100:103], v[160:163], a[12:15]
    v_mfma_f32_16x16x32_bf16 a[16:19], v[104:107], v[160:163], a[16:19]
    v_lshlrev_b32 v152, 16, v142
    v_mfma_f32_16x16x32_bf16 a[20:23], v[108:111], v[160:163], a[20:23]
    v_mfma_f32_16x16x32_bf16 a[24:27], v[112:115], v[160:163], a[24:27]
    v_and_b32 v153, 0xffff0000, v142
    buffer_load_dwordx4 v[76:79], v12, s[12:15], s31 offen offset:1024
    v_mfma_f32_16x16x32_bf16 a[28:31], v[116:119], v[160:163], a[28:31]
    v_fmac_f32 v144, v132, v152
    v_mfma_f32_16x16x32_bf16 a[32:35], v[120:123], v[160:163], a[32:35]
    ds_read_b128 v[160:163], v5 offset:26624
    s_waitcnt lgkmcnt(4)
    v_mfma_f32_16x16x32_bf16 a[36:39], v[88:91], v[164:167], a[36:39]
    v_fmac_f32 v145, v132, v153
    v_mfma_f32_16x16x32_bf16 a[40:43], v[92:95], v[164:167], a[40:43]
    v_fmac_f32 v146, v133, v152
    buffer_load_dwordx4 v[80:83], v13, s[12:15], s31 offen offset:1024
    v_mfma_f32_16x16x32_bf16 a[44:47], v[96:99], v[164:167], a[44:47]
    v_mfma_f32_16x16x32_bf16 a[48:51], v[100:103], v[164:167], a[48:51]
    v_fmac_f32 v147, v133, v153
    v_mfma_f32_16x16x32_bf16 a[52:55], v[104:107], v[164:167], a[52:55]
    v_fmac_f32 v148, v134, v152
    v_mfma_f32_16x16x32_bf16 a[56:59], v[108:111], v[164:167], a[56:59]
    buffer_load_dwordx4 v[84:87], v14, s[12:15], s31 offen offset:1024
    v_mfma_f32_16x16x32_bf16 a[60:63], v[112:115], v[164:167], a[60:63]
    v_fmac_f32 v149, v134, v153
    v_mfma_f32_16x16x32_bf16 a[64:67], v[116:119], v[164:167], a[64:67]
    v_fmac_f32 v150, v135, v152
    v_mfma_f32_16x16x32_bf16 a[68:71], v[120:123], v[164:167], a[68:71]
    ds_read_b128 v[164:167], v5 offset:28672
    s_waitcnt lgkmcnt(4)
    v_mfma_f32_16x16x32_bf16 a[72:75], v[88:91], v[168:171], a[72:75]
    v_fmac_f32 v151, v135, v153
    v_mfma_f32_16x16x32_bf16 a[76:79], v[92:95], v[168:171], a[76:79]
    ds_read_b128 v[132:135], v250 offset:1120
    v_mfma_f32_16x16x32_bf16 a[80:83], v[96:99], v[168:171], a[80:83]
    s_add_u32 m0, s33, 16384
    s_add_u32 s30, s40, s95
    buffer_load_dwordx4 v2, s[8:11], s30 offen lds
    v_mfma_f32_16x16x32_bf16 a[84:87], v[100:103], v[168:171], a[84:87]
    ds_read_b32 v142, v255 offset:2016
    v_mfma_f32_16x16x32_bf16 a[88:91], v[104:107], v[168:171], a[88:91]
    v_mfma_f32_16x16x32_bf16 a[92:95], v[108:111], v[168:171], a[92:95]
    v_mfma_f32_16x16x32_bf16 a[96:99], v[112:115], v[168:171], a[96:99]
    v_lshlrev_b32 v152, 16, v143
    s_add_u32 m0, s33, 17408
    s_add_u32 s30, s40, s95
    buffer_load_dwordx4 v3, s[8:11], s30 offen lds
    v_mfma_f32_16x16x32_bf16 a[100:103], v[116:119], v[168:171], a[100:103]
    v_and_b32 v153, 0xffff0000, v143
    v_mfma_f32_16x16x32_bf16 a[104:107], v[120:123], v[168:171], a[104:107]
    ds_read_b128 v[168:171], v5 offset:30720
    s_waitcnt lgkmcnt(4)
    v_mfma_f32_16x16x32_bf16 a[108:111], v[88:91], v[160:163], a[108:111]
    v_fmac_f32 v144, v136, v152
    v_mfma_f32_16x16x32_bf16 a[112:115], v[92:95], v[160:163], a[112:115]
    v_fmac_f32 v145, v136, v153
    s_add_u32 m0, s33, 18432
    s_add_u32 s30, s41, s95
    buffer_load_dwordx4 v2, s[8:11], s30 offen lds
    v_mfma_f32_16x16x32_bf16 a[116:119], v[96:99], v[160:163], a[116:119]
    v_mfma_f32_16x16x32_bf16 a[120:123], v[100:103], v[160:163], a[120:123]
    v_fmac_f32 v146, v137, v152
    v_mfma_f32_16x16x32_bf16 a[124:127], v[104:107], v[160:163], a[124:127]
    v_fmac_f32 v147, v137, v153
    v_mfma_f32_16x16x32_bf16 a[128:131], v[108:111], v[160:163], a[128:131]
    s_add_u32 m0, s33, 19456
    s_add_u32 s30, s41, s95
    buffer_load_dwordx4 v3, s[8:11], s30 offen lds
    v_mfma_f32_16x16x32_bf16 a[132:135], v[112:115], v[160:163], a[132:135]
    v_fmac_f32 v148, v138, v152
    v_mfma_f32_16x16x32_bf16 a[136:139], v[116:119], v[160:163], a[136:139]
    v_fmac_f32 v149, v138, v153
    v_mfma_f32_16x16x32_bf16 a[140:143], v[120:123], v[160:163], a[140:143]
    s_waitcnt vmcnt(30)
    ds_read_b128 v[160:163], v4 offset:0
    s_waitcnt lgkmcnt(4)
    v_mfma_f32_16x16x32_bf16 a[144:147], v[88:91], v[164:167], a[144:147]
    v_fmac_f32 v150, v139, v152
    s_add_u32 m0, s33, 20480
    s_add_u32 s30, s42, s95
    buffer_load_dwordx4 v2, s[8:11], s30 offen lds
    v_mfma_f32_16x16x32_bf16 a[148:151], v[92:95], v[164:167], a[148:151]
    v_fmac_f32 v151, v139, v153
    v_mfma_f32_16x16x32_bf16 a[152:155], v[96:99], v[164:167], a[152:155]
    v_mfma_f32_16x16x32_bf16 a[156:159], v[100:103], v[164:167], a[156:159]
    ds_read_b128 v[136:139], v250 offset:1200
    v_mfma_f32_16x16x32_bf16 a[160:163], v[104:107], v[164:167], a[160:163]
    ds_read_b32 v143, v255 offset:2160
    s_add_u32 m0, s33, 21504
    s_add_u32 s30, s42, s95
    buffer_load_dwordx4 v3, s[8:11], s30 offen lds
    v_mfma_f32_16x16x32_bf16 a[164:167], v[108:111], v[164:167], a[164:167]
    v_mfma_f32_16x16x32_bf16 a[168:171], v[112:115], v[164:167], a[168:171]
    v_mfma_f32_16x16x32_bf16 a[172:175], v[116:119], v[164:167], a[172:175]
    v_lshlrev_b32 v152, 16, v140
    v_mfma_f32_16x16x32_bf16 a[176:179], v[120:123], v[164:167], a[176:179]
    s_add_u32 m0, s33, 22528
    s_add_u32 s30, s43, s95
    buffer_load_dwordx4 v2, s[8:11], s30 offen lds
    ds_read_b128 v[164:167], v4 offset:2048
    s_waitcnt lgkmcnt(4)
    v_mfma_f32_16x16x32_bf16 a[180:183], v[88:91], v[168:171], a[180:183]
    v_and_b32 v153, 0xffff0000, v140
    v_mfma_f32_16x16x32_bf16 a[184:187], v[92:95], v[168:171], a[184:187]
    v_fmac_f32 v144, v124, v152
    v_mfma_f32_16x16x32_bf16 a[188:191], v[96:99], v[168:171], a[188:191]
    v_mfma_f32_16x16x32_bf16 a[192:195], v[100:103], v[168:171], a[192:195]
    v_fmac_f32 v145, v124, v153
    s_add_u32 m0, s33, 23552
    s_add_u32 s30, s43, s95
    buffer_load_dwordx4 v3, s[8:11], s30 offen lds
    v_mfma_f32_16x16x32_bf16 a[196:199], v[104:107], v[168:171], a[196:199]
    v_fmac_f32 v146, v125, v152
    v_mfma_f32_16x16x32_bf16 a[200:203], v[108:111], v[168:171], a[200:203]
    v_mfma_f32_16x16x32_bf16 a[204:207], v[112:115], v[168:171], a[204:207]
    v_fmac_f32 v147, v125, v153
    v_mfma_f32_16x16x32_bf16 a[208:211], v[116:119], v[168:171], a[208:211]
    v_fmac_f32 v148, v126, v152
    v_mfma_f32_16x16x32_bf16 a[212:215], v[120:123], v[168:171], a[212:215]
    s_waitcnt vmcnt(17)
    ds_read_b128 v[168:171], v4 offset:4096
    s_waitcnt lgkmcnt(4)
    v_mfma_f32_16x16x32_bf16 v[172:175], v[16:19], v[160:163], v[172:175]
    v_fmac_f32 v149, v126, v153
    s_add_u32 m0, s33, 24576
    s_add_u32 s30, s44, s95
    buffer_load_dwordx4 v2, s[8:11], s30 offen lds
    v_mfma_f32_16x16x32_bf16 v[176:179], v[20:23], v[160:163], v[176:179]
    v_fmac_f32 v150, v127, v152
    v_mfma_f32_16x16x32_bf16 v[180:183], v[24:27], v[160:163], v[180:183]
    v_mfma_f32_16x16x32_bf16 v[184:187], v[28:31], v[160:163], v[184:187]
    v_fmac_f32 v151, v127, v153
    v_mfma_f32_16x16x32_bf16 v[188:191], v[32:35], v[160:163], v[188:191]
    ds_read_b128 v[124:127], v250 offset:1280
    s_lshl_b32 s31, s95, 4
    s_add_u32 s31, s31, s32
    buffer_load_dwordx4 v[88:91], v6, s[12:15], s31 offen offset:0
    v_mfma_f32_16x16x32_bf16 v[192:195], v[36:39], v[160:163], v[192:195]
    v_mfma_f32_16x16x32_bf16 v[196:199], v[40:43], v[160:163], v[196:199]
    ds_read_b32 v140, v255 offset:2304
    v_mfma_f32_16x16x32_bf16 v[200:203], v[44:47], v[160:163], v[200:203]
    v_mfma_f32_16x16x32_bf16 v[204:207], v[48:51], v[160:163], v[204:207]
    buffer_load_dwordx4 v[92:95], v7, s[12:15], s31 offen offset:0
    ds_read_b128 v[160:163], v4 offset:6144
    s_waitcnt lgkmcnt(4)
    v_mfma_f32_16x16x32_bf16 v[208:211], v[16:19], v[164:167], v[208:211]
    v_lshlrev_b32 v152, 16, v141
    v_mfma_f32_16x16x32_bf16 v[212:215], v[20:23], v[164:167], v[212:215]
    v_and_b32 v153, 0xffff0000, v141
    v_mfma_f32_16x16x32_bf16 v[216:219], v[24:27], v[164:167], v[216:219]
    v_mfma_f32_16x16x32_bf16 v[220:223], v[28:31], v[164:167], v[220:223]
    v_fmac_f32 v144, v128, v152
    s_add_u32 m0, s33, 25600
    s_add_u32 s30, s44, s95
    buffer_load_dwordx4 v3, s[8:11], s30 offen lds
    v_mfma_f32_16x16x32_bf16 v[224:227], v[32:35], v[164:167], v[224:227]
    v_fmac_f32 v145, v128, v153
    v_mfma_f32_16x16x32_bf16 v[228:231], v[36:39], v[164:167], v[228:231]
    v_mfma_f32_16x16x32_bf16 v[232:235], v[40:43], v[164:167], v[232:235]
    v_fmac_f32 v146, v129, v152
    v_mfma_f32_16x16x32_bf16 v[236:239], v[44:47], v[164:167], v[236:239]
    v_fmac_f32 v147, v129, v153
    buffer_load_dwordx4 v[96:99], v8, s[12:15], s31 offen offset:0
    v_mfma_f32_16x16x32_bf16 v[240:243], v[48:51], v[164:167], v[240:243]
    ds_read_b128 v[164:167], v4 offset:8192
    s_waitcnt lgkmcnt(4)
    v_mfma_f32_16x16x32_bf16 a[0:3], v[16:19], v[168:171], a[0:3]
    v_fmac_f32 v148, v130, v152
    v_mfma_f32_16x16x32_bf16 a[4:7], v[20:23], v[168:171], a[4:7]
    v_fmac_f32 v149, v130, v153
    v_mfma_f32_16x16x32_bf16 a[8:11], v[24:27], v[168:171], a[8:11]
    s_add_u32 m0, s33, 26624
    s_add_u32 s30, s45, s95
    buffer_load_dwordx4 v2, s[8:11], s30 offen lds
    v_mfma_f32_16x16x32_bf16 a[12:15], v[28:31], v[168:171], a[12:15]
    v_fmac_f32 v150, v131, v152
    v_mfma_f32_16x16x32_bf16 a[16:19], v[32:35], v[168:171], a[16:19]
    v_fmac_f32 v151, v131, v153
    v_mfma_f32_16x16x32_bf16 a[20:23], v[36:39], v[168:171], a[20:23]
    v_mfma_f32_16x16x32_bf16 a[24:27], v[40:43], v[168:171], a[24:27]
    ds_read_b128 v[128:131], v250 offset:1360
    v_mfma_f32_16x16x32_bf16 a[28:31], v[44:47], v[168:171], a[28:31]
    buffer_load_dwordx4 v[100:103], v9, s[12:15], s31 offen offset:0
    v_mfma_f32_16x16x32_bf16 a[32:35], v[48:51], v[168:171], a[32:35]
    ds_read_b32 v141, v255 offset:2448
    ds_read_b128 v[168:171], v4 offset:10240
    s_waitcnt lgkmcnt(4)
    v_mfma_f32_16x16x32_bf16 a[36:39], v[16:19], v[160:163], a[36:39]
    v_mfma_f32_16x16x32_bf16 a[40:43], v[20:23], v[160:163], a[40:43]
    v_mfma_f32_16x16x32_bf16 a[44:47], v[24:27], v[160:163], a[44:47]
    v_lshlrev_b32 v152, 16, v142
    s_add_u32 m0, s33, 27648
    s_add_u32 s30, s45, s95
    buffer_load_dwordx4 v3, s[8:11], s30 offen lds
    v_mfma_f32_16x16x32_bf16 a[48:51], v[28:31], v[160:163], a[48:51]
    v_and_b32 v153, 0xffff0000, v142
    v_mfma_f32_16x16x32_bf16 a[52:55], v[32:35], v[160:163], a[52:55]
    v_mfma_f32_16x16x32_bf16 a[56:59], v[36:39], v[160:163], a[56:59]
    v_fmac_f32 v144, v132, v152
    v_mfma_f32_16x16x32_bf16 a[60:63], v[40:43], v[160:163], a[60:63]
    v_fmac_f32 v145, v132, v153
    buffer_load_dwordx4 v[104:107], v10, s[12:15], s31 offen offset:0
    v_mfma_f32_16x16x32_bf16 a[64:67], v[44:47], v[160:163], a[64:67]
    v_mfma_f32_16x16x32_bf16 a[68:71], v[48:51], v[160:163], a[68:71]
    v_fmac_f32 v146, v133, v152
    ds_read_b128 v[160:163], v4 offset:12288
    s_waitcnt lgkmcnt(4)
    v_mfma_f32_16x16x32_bf16 a[72:75], v[16:19], v[164:167], a[72:75]
    v_fmac_f32 v147, v133, v153
    v_mfma_f32_16x16x32_bf16 a[76:79], v[20:23], v[164:167], a[76:79]
    s_add_u32 m0, s33, 28672
    s_add_u32 s30, s46, s95
    buffer_load_dwordx4 v2, s[8:11], s30 offen lds
    v_mfma_f32_16x16x32_bf16 a[80:83], v[24:27], v[164:167], a[80:83]
    v_fmac_f32 v148, v134, v152
    v_mfma_f32_16x16x32_bf16 a[84:87], v[28:31], v[164:167], a[84:87]
    v_fmac_f32 v149, v134, v153
    v_mfma_f32_16x16x32_bf16 a[88:91], v[32:35], v[164:167], a[88:91]
    v_mfma_f32_16x16x32_bf16 a[92:95], v[36:39], v[164:167], a[92:95]
    v_fmac_f32 v150, v135, v152
    buffer_load_dwordx4 v[108:111], v11, s[12:15], s31 offen offset:0
    v_mfma_f32_16x16x32_bf16 a[96:99], v[40:43], v[164:167], a[96:99]
    v_fmac_f32 v151, v135, v153
    v_mfma_f32_16x16x32_bf16 a[100:103], v[44:47], v[164:167], a[100:103]
    v_mfma_f32_16x16x32_bf16 a[104:107], v[48:51], v[164:167], a[104:107]
    ds_read_b128 v[164:167], v4 offset:14336
    s_waitcnt lgkmcnt(2)
    v_mfma_f32_16x16x32_bf16 a[108:111], v[16:19], v[168:171], a[108:111]
    v_lshlrev_b32 v152, 16, v143
    s_add_u32 m0, s33, 29696
    s_add_u32 s30, s46, s95
    buffer_load_dwordx4 v3, s[8:11], s30 offen lds
    v_mfma_f32_16x16x32_bf16 a[112:115], v[20:23], v[168:171], a[112:115]
    v_mfma_f32_16x16x32_bf16 a[116:119], v[24:27], v[168:171], a[116:119]
    v_and_b32 v153, 0xffff0000, v143
    v_mfma_f32_16x16x32_bf16 a[120:123], v[28:31], v[168:171], a[120:123]
    v_mfma_f32_16x16x32_bf16 a[124:127], v[32:35], v[168:171], a[124:127]
    v_fmac_f32 v144, v136, v152
    v_mfma_f32_16x16x32_bf16 a[128:131], v[36:39], v[168:171], a[128:131]
    v_fmac_f32 v145, v136, v153
    buffer_load_dwordx4 v[112:115], v12, s[12:15], s31 offen offset:0
    v_mfma_f32_16x16x32_bf16 a[132:135], v[40:43], v[168:171], a[132:135]
    v_mfma_f32_16x16x32_bf16 a[136:139], v[44:47], v[168:171], a[136:139]
    v_fmac_f32 v146, v137, v152
    v_mfma_f32_16x16x32_bf16 a[140:143], v[48:51], v[168:171], a[140:143]
    v_fmac_f32 v147, v137, v153
    ds_read_b128 v[168:171], v5 offset:0
    s_waitcnt lgkmcnt(2)
    v_mfma_f32_16x16x32_bf16 a[144:147], v[16:19], v[160:163], a[144:147]
    s_add_u32 m0, s33, 30720
    s_add_u32 s30, s47, s95
    buffer_load_dwordx4 v2, s[8:11], s30 offen lds
    v_mfma_f32_16x16x32_bf16 a[148:151], v[20:23], v[160:163], a[148:151]
    v_fmac_f32 v148, v138, v152
    v_mfma_f32_16x16x32_bf16 a[152:155], v[24:27], v[160:163], a[152:155]
    v_fmac_f32 v149, v138, v153
    v_mfma_f32_16x16x32_bf16 a[156:159], v[28:31], v[160:163], a[156:159]
    v_mfma_f32_16x16x32_bf16 a[160:163], v[32:35], v[160:163], a[160:163]
    v_fmac_f32 v150, v139, v152
    buffer_load_dwordx4 v[116:119], v13, s[12:15], s31 offen offset:0
    v_mfma_f32_16x16x32_bf16 a[164:167], v[36:39], v[160:163], a[164:167]
    v_fmac_f32 v151, v139, v153
    v_mfma_f32_16x16x32_bf16 a[168:171], v[40:43], v[160:163], a[168:171]
    v_mfma_f32_16x16x32_bf16 a[172:175], v[44:47], v[160:163], a[172:175]
    v_mfma_f32_16x16x32_bf16 a[176:179], v[48:51], v[160:163], a[176:179]
    v_lshlrev_b32 v152, 16, v140
    s_add_u32 m0, s33, 31744
    s_add_u32 s30, s47, s95
    buffer_load_dwordx4 v3, s[8:11], s30 offen lds
    ds_read_b128 v[160:163], v5 offset:2048
    s_waitcnt lgkmcnt(2)
    v_mfma_f32_16x16x32_bf16 a[180:183], v[16:19], v[164:167], a[180:183]
    v_mfma_f32_16x16x32_bf16 a[184:187], v[20:23], v[164:167], a[184:187]
    v_and_b32 v153, 0xffff0000, v140
    v_mfma_f32_16x16x32_bf16 a[188:191], v[24:27], v[164:167], a[188:191]
    v_fmac_f32 v144, v124, v152
    v_mfma_f32_16x16x32_bf16 a[192:195], v[28:31], v[164:167], a[192:195]
    buffer_load_dwordx4 v[120:123], v14, s[12:15], s31 offen offset:0
    v_mfma_f32_16x16x32_bf16 a[196:199], v[32:35], v[164:167], a[196:199]
    v_fmac_f32 v145, v124, v153
    v_mfma_f32_16x16x32_bf16 a[200:203], v[36:39], v[164:167], a[200:203]
    v_fmac_f32 v146, v125, v152
    v_mfma_f32_16x16x32_bf16 a[204:207], v[40:43], v[164:167], a[204:207]
    v_mfma_f32_16x16x32_bf16 a[208:211], v[44:47], v[164:167], a[208:211]
    v_fmac_f32 v147, v125, v153
    v_mfma_f32_16x16x32_bf16 a[212:215], v[48:51], v[164:167], a[212:215]
    s_waitcnt vmcnt(25)
    ds_read_b128 v[164:167], v5 offset:4096
    s_waitcnt lgkmcnt(2)
    v_mfma_f32_16x16x32_bf16 v[172:175], v[52:55], v[168:171], v[172:175]
    v_fmac_f32 v148, v126, v152
    s_lshl_b32 s31, s95, 4
    s_add_u32 s31, s31, s32
    buffer_load_dwordx4 v[16:19], v6, s[12:15], s31 offen offset:1024
    v_mfma_f32_16x16x32_bf16 v[176:179], v[56:59], v[168:171], v[176:179]
    v_fmac_f32 v149, v126, v153
    v_mfma_f32_16x16x32_bf16 v[180:183], v[60:63], v[168:171], v[180:183]
    v_mfma_f32_16x16x32_bf16 v[184:187], v[64:67], v[168:171], v[184:187]
    v_fmac_f32 v150, v127, v152
    v_mfma_f32_16x16x32_bf16 v[188:191], v[68:71], v[168:171], v[188:191]
    v_fmac_f32 v151, v127, v153
    buffer_load_dwordx4 v[20:23], v7, s[12:15], s31 offen offset:1024
    v_mfma_f32_16x16x32_bf16 v[192:195], v[72:75], v[168:171], v[192:195]
    v_mfma_f32_16x16x32_bf16 v[196:199], v[76:79], v[168:171], v[196:199]
    v_mfma_f32_16x16x32_bf16 v[200:203], v[80:83], v[168:171], v[200:203]
    v_lshlrev_b32 v152, 16, v141
    v_mfma_f32_16x16x32_bf16 v[204:207], v[84:87], v[168:171], v[204:207]
    buffer_load_dwordx4 v[24:27], v8, s[12:15], s31 offen offset:1024
    ds_read_b128 v[168:171], v5 offset:6144
    s_waitcnt lgkmcnt(2)
    v_mfma_f32_16x16x32_bf16 v[208:211], v[52:55], v[160:163], v[208:211]
    v_and_b32 v153, 0xffff0000, v141
    v_mfma_f32_16x16x32_bf16 v[212:215], v[56:59], v[160:163], v[212:215]
    v_fmac_f32 v144, v128, v152
    v_mfma_f32_16x16x32_bf16 v[216:219], v[60:63], v[160:163], v[216:219]
    v_mfma_f32_16x16x32_bf16 v[220:223], v[64:67], v[160:163], v[220:223]
    v_fmac_f32 v145, v128, v153
    buffer_load_dwordx4 v[28:31], v9, s[12:15], s31 offen offset:1024
    v_mfma_f32_16x16x32_bf16 v[224:227], v[68:71], v[160:163], v[224:227]
    v_fmac_f32 v146, v129, v152
    v_mfma_f32_16x16x32_bf16 v[228:231], v[72:75], v[160:163], v[228:231]
    v_mfma_f32_16x16x32_bf16 v[232:235], v[76:79], v[160:163], v[232:235]
    v_fmac_f32 v147, v129, v153
    v_mfma_f32_16x16x32_bf16 v[236:239], v[80:83], v[160:163], v[236:239]
    v_fmac_f32 v148, v130, v152
    buffer_load_dwordx4 v[32:35], v10, s[12:15], s31 offen offset:1024
    v_mfma_f32_16x16x32_bf16 v[240:243], v[84:87], v[160:163], v[240:243]
    ds_read_b128 v[160:163], v5 offset:8192
    s_waitcnt lgkmcnt(2)
    v_mfma_f32_16x16x32_bf16 a[0:3], v[52:55], v[164:167], a[0:3]
    v_fmac_f32 v149, v130, v153
    v_mfma_f32_16x16x32_bf16 a[4:7], v[56:59], v[164:167], a[4:7]
    v_fmac_f32 v150, v131, v152
    v_mfma_f32_16x16x32_bf16 a[8:11], v[60:63], v[164:167], a[8:11]
    buffer_load_dwordx4 v[36:39], v11, s[12:15], s31 offen offset:1024
    v_mfma_f32_16x16x32_bf16 a[12:15], v[64:67], v[164:167], a[12:15]
    v_fmac_f32 v151, v131, v153
    v_mfma_f32_16x16x32_bf16 a[16:19], v[68:71], v[164:167], a[16:19]
    v_cvt_pk_bf16_f32 v144, v144, v145
    v_mfma_f32_16x16x32_bf16 a[20:23], v[72:75], v[164:167], a[20:23]
    v_mfma_f32_16x16x32_bf16 a[24:27], v[76:79], v[164:167], a[24:27]
    v_cvt_pk_bf16_f32 v145, v146, v147
    buffer_load_dwordx4 v[40:43], v12, s[12:15], s31 offen offset:1024
    v_mfma_f32_16x16x32_bf16 a[28:31], v[80:83], v[164:167], a[28:31]
    v_cvt_pk_bf16_f32 v146, v148, v149
    v_mfma_f32_16x16x32_bf16 a[32:35], v[84:87], v[164:167], a[32:35]
    ds_read_b128 v[164:167], v5 offset:10240
    s_waitcnt lgkmcnt(2)
    v_mfma_f32_16x16x32_bf16 a[36:39], v[52:55], v[168:171], a[36:39]
    v_cvt_pk_bf16_f32 v147, v150, v151
    v_mfma_f32_16x16x32_bf16 a[40:43], v[56:59], v[168:171], a[40:43]
    v_lshl_add_u32 v152, v253, 1, s54
    buffer_load_dwordx4 v[44:47], v13, s[12:15], s31 offen offset:1024
    v_mfma_f32_16x16x32_bf16 a[44:47], v[60:63], v[168:171], a[44:47]
    v_mfma_f32_16x16x32_bf16 a[48:51], v[64:67], v[168:171], a[48:51]
    v_mov_b32 v155, 0x40000000
    v_mfma_f32_16x16x32_bf16 a[52:55], v[68:71], v[168:171], a[52:55]
    v_lshrrev_b32 v153, 4, v152
    v_mfma_f32_16x16x32_bf16 a[56:59], v[72:75], v[168:171], a[56:59]
    buffer_load_dwordx4 v[48:51], v14, s[12:15], s31 offen offset:1024
    v_mfma_f32_16x16x32_bf16 a[60:63], v[76:79], v[168:171], a[60:63]
    v_lshlrev_b32 v153, 5, v153
    v_mfma_f32_16x16x32_bf16 a[64:67], v[80:83], v[168:171], a[64:67]
    v_bfe_u32 v154, v152, 2, 2
    v_mfma_f32_16x16x32_bf16 a[68:71], v[84:87], v[168:171], a[68:71]
    ds_read_b128 v[168:171], v5 offset:12288
    s_waitcnt lgkmcnt(2)
    v_mfma_f32_16x16x32_bf16 a[72:75], v[52:55], v[160:163], a[72:75]
    v_lshl_add_u32 v153, v154, 2, v153
    v_mfma_f32_16x16x32_bf16 a[76:79], v[56:59], v[160:163], a[76:79]
    v_and_b32 v154, 1, v152
    v_mfma_f32_16x16x32_bf16 a[80:83], v[60:63], v[160:163], a[80:83]
    v_mfma_f32_16x16x32_bf16 a[84:87], v[64:67], v[160:163], a[84:87]
    v_lshl_add_u32 v153, v154, 1, v153
    v_mfma_f32_16x16x32_bf16 a[88:91], v[68:71], v[160:163], a[88:91]
    v_bfe_u32 v154, v152, 1, 1
    v_mfma_f32_16x16x32_bf16 a[92:95], v[72:75], v[160:163], a[92:95]
    v_mfma_f32_16x16x32_bf16 a[96:99], v[76:79], v[160:163], a[96:99]
    v_lshl_add_u32 v153, v154, 4, v153
    v_mfma_f32_16x16x32_bf16 a[100:103], v[80:83], v[160:163], a[100:103]
    v_mul_u32_u24 v153, 1152, v153
    v_mfma_f32_16x16x32_bf16 a[104:107], v[84:87], v[160:163], a[104:107]
    ds_read_b128 v[160:163], v5 offset:14336
    s_waitcnt lgkmcnt(2)
    v_mfma_f32_16x16x32_bf16 a[108:111], v[52:55], v[164:167], a[108:111]
    v_add_u32 v153, v153, v254
    v_mfma_f32_16x16x32_bf16 a[112:115], v[56:59], v[164:167], a[112:115]
    v_cmp_gt_u32 vcc, 5, v253
    s_nop 1
    v_cndmask_b32 v156, v155, v153, vcc
    v_mfma_f32_16x16x32_bf16 a[116:119], v[60:63], v[164:167], a[116:119]
    v_mfma_f32_16x16x32_bf16 a[120:123], v[64:67], v[164:167], a[120:123]
    buffer_store_dword v144, v156, s[12:15], s55 offen
    v_mfma_f32_16x16x32_bf16 a[124:127], v[68:71], v[164:167], a[124:127]
    buffer_store_dword v145, v156, s[12:15], s55 offen offset:1152
    v_mfma_f32_16x16x32_bf16 a[128:131], v[72:75], v[164:167], a[128:131]
    v_mfma_f32_16x16x32_bf16 a[132:135], v[76:79], v[164:167], a[132:135]
    v_add_u32 v152, 1, v152
    v_mfma_f32_16x16x32_bf16 a[136:139], v[80:83], v[164:167], a[136:139]
    v_lshrrev_b32 v153, 4, v152
    v_mfma_f32_16x16x32_bf16 a[140:143], v[84:87], v[164:167], a[140:143]
    s_waitcnt vmcnt(28)
    ds_read_b128 v[164:167], v4 offset:16384
    s_waitcnt lgkmcnt(2)
    v_mfma_f32_16x16x32_bf16 a[144:147], v[52:55], v[168:171], a[144:147]
    v_lshlrev_b32 v153, 5, v153
    v_mfma_f32_16x16x32_bf16 a[148:151], v[56:59], v[168:171], a[148:151]
    v_bfe_u32 v154, v152, 2, 2
    v_mfma_f32_16x16x32_bf16 a[152:155], v[60:63], v[168:171], a[152:155]
    v_mfma_f32_16x16x32_bf16 a[156:159], v[64:67], v[168:171], a[156:159]
    v_lshl_add_u32 v153, v154, 2, v153
    v_mfma_f32_16x16x32_bf16 a[160:163], v[68:71], v[168:171], a[160:163]
    v_and_b32 v154, 1, v152
    v_mfma_f32_16x16x32_bf16 a[164:167], v[72:75], v[168:171], a[164:167]
    v_mfma_f32_16x16x32_bf16 a[168:171], v[76:79], v[168:171], a[168:171]
    v_lshl_add_u32 v153, v154, 1, v153
    v_mfma_f32_16x16x32_bf16 a[172:175], v[80:83], v[168:171], a[172:175]
    v_bfe_u32 v154, v152, 1, 1
    v_mfma_f32_16x16x32_bf16 a[176:179], v[84:87], v[168:171], a[176:179]
    ds_read_b128 v[168:171], v4 offset:18432
    s_waitcnt lgkmcnt(2)
    v_mfma_f32_16x16x32_bf16 a[180:183], v[52:55], v[160:163], a[180:183]
    v_lshl_add_u32 v153, v154, 4, v153
    v_mfma_f32_16x16x32_bf16 a[184:187], v[56:59], v[160:163], a[184:187]
    v_mul_u32_u24 v153, 1152, v153
    v_mfma_f32_16x16x32_bf16 a[188:191], v[60:63], v[160:163], a[188:191]
    v_mfma_f32_16x16x32_bf16 a[192:195], v[64:67], v[160:163], a[192:195]
    v_add_u32 v153, v153, v254
    v_mfma_f32_16x16x32_bf16 a[196:199], v[68:71], v[160:163], a[196:199]
    v_cmp_gt_u32 vcc, 4, v253
    s_nop 1
    v_cndmask_b32 v157, v155, v153, vcc
    v_mfma_f32_16x16x32_bf16 a[200:203], v[72:75], v[160:163], a[200:203]
    v_mfma_f32_16x16x32_bf16 a[204:207], v[76:79], v[160:163], a[204:207]
    buffer_store_dword v146, v157, s[12:15], s55 offen
    v_mfma_f32_16x16x32_bf16 a[208:211], v[80:83], v[160:163], a[208:211]
    buffer_store_dword v147, v157, s[12:15], s55 offen offset:1152
    v_mfma_f32_16x16x32_bf16 a[212:215], v[84:87], v[160:163], a[212:215]
    s_waitcnt vmcnt(13)
    ds_read_b128 v[160:163], v4 offset:20480
    s_waitcnt lgkmcnt(2)
    v_mfma_f32_16x16x32_bf16 v[172:175], v[88:91], v[164:167], v[172:175]
    buffer_load_dwordx4 v[68:71], v1, s[12:15], s56 offen offset:0
    v_mfma_f32_16x16x32_bf16 v[176:179], v[92:95], v[164:167], v[176:179]
    v_mfma_f32_16x16x32_bf16 v[180:183], v[96:99], v[164:167], v[180:183]
    v_mfma_f32_16x16x32_bf16 v[184:187], v[100:103], v[164:167], v[184:187]
    v_mfma_f32_16x16x32_bf16 v[188:191], v[104:107], v[164:167], v[188:191]
    v_mfma_f32_16x16x32_bf16 v[192:195], v[108:111], v[164:167], v[192:195]
    v_mfma_f32_16x16x32_bf16 v[196:199], v[112:115], v[164:167], v[196:199]
    v_mfma_f32_16x16x32_bf16 v[200:203], v[116:119], v[164:167], v[200:203]
    v_mfma_f32_16x16x32_bf16 v[204:207], v[120:123], v[164:167], v[204:207]
    buffer_load_dwordx4 v[72:75], v1, s[12:15], s56 offen offset:1024
    ds_read_b128 v[164:167], v4 offset:22528
    s_waitcnt lgkmcnt(2)
    v_mfma_f32_16x16x32_bf16 v[208:211], v[88:91], v[168:171], v[208:211]
    v_mfma_f32_16x16x32_bf16 v[212:215], v[92:95], v[168:171], v[212:215]
    v_mfma_f32_16x16x32_bf16 v[216:219], v[96:99], v[168:171], v[216:219]
    v_mfma_f32_16x16x32_bf16 v[220:223], v[100:103], v[168:171], v[220:223]
    v_mfma_f32_16x16x32_bf16 v[224:227], v[104:107], v[168:171], v[224:227]
    v_mfma_f32_16x16x32_bf16 v[228:231], v[108:111], v[168:171], v[228:231]
    v_mfma_f32_16x16x32_bf16 v[232:235], v[112:115], v[168:171], v[232:235]
    v_mfma_f32_16x16x32_bf16 v[236:239], v[116:119], v[168:171], v[236:239]
    buffer_load_dwordx4 v[76:79], v1, s[12:15], s56 offen offset:2048
    v_mfma_f32_16x16x32_bf16 v[240:243], v[120:123], v[168:171], v[240:243]
    ds_read_b128 v[168:171], v4 offset:24576
    s_waitcnt lgkmcnt(2)
    v_mfma_f32_16x16x32_bf16 a[0:3], v[88:91], v[160:163], a[0:3]
    v_mfma_f32_16x16x32_bf16 a[4:7], v[92:95], v[160:163], a[4:7]
    v_mfma_f32_16x16x32_bf16 a[8:11], v[96:99], v[160:163], a[8:11]
    v_mfma_f32_16x16x32_bf16 a[12:15], v[100:103], v[160:163], a[12:15]
    v_mfma_f32_16x16x32_bf16 a[16:19], v[104:107], v[160:163], a[16:19]
    v_mfma_f32_16x16x32_bf16 a[20:23], v[108:111], v[160:163], a[20:23]
    v_mfma_f32_16x16x32_bf16 a[24:27], v[112:115], v[160:163], a[24:27]
    buffer_load_dwordx4 v[80:83], v1, s[12:15], s56 offen offset:3072
    v_mfma_f32_16x16x32_bf16 a[28:31], v[116:119], v[160:163], a[28:31]
    v_mfma_f32_16x16x32_bf16 a[32:35], v[120:123], v[160:163], a[32:35]
    ds_read_b128 v[160:163], v4 offset:26624
    s_waitcnt lgkmcnt(2)
    v_mfma_f32_16x16x32_bf16 a[36:39], v[88:91], v[164:167], a[36:39]
    v_mfma_f32_16x16x32_bf16 a[40:43], v[92:95], v[164:167], a[40:43]
    v_mfma_f32_16x16x32_bf16 a[44:47], v[96:99], v[164:167], a[44:47]
    v_mfma_f32_16x16x32_bf16 a[48:51], v[100:103], v[164:167], a[48:51]
    v_mfma_f32_16x16x32_bf16 a[52:55], v[104:107], v[164:167], a[52:55]
    v_mfma_f32_16x16x32_bf16 a[56:59], v[108:111], v[164:167], a[56:59]
    s_add_u32 s30, s56, 4096
    buffer_load_dwordx4 v[84:87], v1, s[12:15], s30 offen
    v_mfma_f32_16x16x32_bf16 a[60:63], v[112:115], v[164:167], a[60:63]
    v_mfma_f32_16x16x32_bf16 a[64:67], v[116:119], v[164:167], a[64:67]
    v_mfma_f32_16x16x32_bf16 a[68:71], v[120:123], v[164:167], a[68:71]
    ds_read_b128 v[164:167], v4 offset:28672
    s_waitcnt lgkmcnt(2)
    v_mfma_f32_16x16x32_bf16 a[72:75], v[88:91], v[168:171], a[72:75]
    v_mfma_f32_16x16x32_bf16 a[76:79], v[92:95], v[168:171], a[76:79]
    v_mfma_f32_16x16x32_bf16 a[80:83], v[96:99], v[168:171], a[80:83]
    v_mfma_f32_16x16x32_bf16 a[84:87], v[100:103], v[168:171], a[84:87]
    v_mfma_f32_16x16x32_bf16 a[88:91], v[104:107], v[168:171], a[88:91]
    ds_read_b128 v[124:127], v5 offset:16384
    v_mfma_f32_16x16x32_bf16 a[92:95], v[108:111], v[168:171], a[92:95]
    v_mfma_f32_16x16x32_bf16 a[96:99], v[112:115], v[168:171], a[96:99]
    v_mfma_f32_16x16x32_bf16 a[100:103], v[116:119], v[168:171], a[100:103]
    ds_read_b128 v[128:131], v5 offset:18432
    v_mfma_f32_16x16x32_bf16 a[104:107], v[120:123], v[168:171], a[104:107]
    ds_read_b128 v[168:171], v4 offset:30720
    s_waitcnt lgkmcnt(4)
    v_mfma_f32_16x16x32_bf16 a[108:111], v[88:91], v[160:163], a[108:111]
    v_mfma_f32_16x16x32_bf16 a[112:115], v[92:95], v[160:163], a[112:115]
    v_mfma_f32_16x16x32_bf16 a[116:119], v[96:99], v[160:163], a[116:119]
    ds_read_b128 v[132:135], v5 offset:20480
    v_mfma_f32_16x16x32_bf16 a[120:123], v[100:103], v[160:163], a[120:123]
    v_mfma_f32_16x16x32_bf16 a[124:127], v[104:107], v[160:163], a[124:127]
    v_mfma_f32_16x16x32_bf16 a[128:131], v[108:111], v[160:163], a[128:131]
    v_mfma_f32_16x16x32_bf16 a[132:135], v[112:115], v[160:163], a[132:135]
    ds_read_b128 v[136:139], v5 offset:22528
    v_mfma_f32_16x16x32_bf16 a[136:139], v[116:119], v[160:163], a[136:139]
    v_mfma_f32_16x16x32_bf16 a[140:143], v[120:123], v[160:163], a[140:143]
    s_waitcnt lgkmcnt(5)
    v_mfma_f32_16x16x32_bf16 a[144:147], v[88:91], v[164:167], a[144:147]
    v_mfma_f32_16x16x32_bf16 a[148:151], v[92:95], v[164:167], a[148:151]
    ds_read_b128 v[140:143], v5 offset:24576
    v_mfma_f32_16x16x32_bf16 a[152:155], v[96:99], v[164:167], a[152:155]
    v_mfma_f32_16x16x32_bf16 a[156:159], v[100:103], v[164:167], a[156:159]
    v_mfma_f32_16x16x32_bf16 a[160:163], v[104:107], v[164:167], a[160:163]
    v_mfma_f32_16x16x32_bf16 a[164:167], v[108:111], v[164:167], a[164:167]
    ds_read_b128 v[144:147], v5 offset:26624
    v_mfma_f32_16x16x32_bf16 a[168:171], v[112:115], v[164:167], a[168:171]
    s_getpc_b64 s[36:37]
L_gemm2_kernel_pc:
    s_add_u32 s36, s36, gemm3_kernel-L_gemm2_kernel_pc
    s_addc_u32 s37, s37, 0
    s_mov_b32 s38, L_text_end-gemm3_kernel
    s_mov_b32 s39, 0x20000
    s_lshl_b32 s30, s29, 2
    s_add_u32 s30, s30, s26
    s_lshl_b32 s30, s30, 10
    s_mov_b32 m0, 158208
    s_nop 0
    buffer_load_dwordx4 v1, s[36:39], s30 offen lds
    v_mfma_f32_16x16x32_bf16 a[172:175], v[116:119], v[164:167], a[172:175]
    v_mfma_f32_16x16x32_bf16 a[176:179], v[120:123], v[164:167], a[176:179]
    s_waitcnt lgkmcnt(4)
    v_mfma_f32_16x16x32_bf16 a[180:183], v[88:91], v[168:171], a[180:183]
    ds_read_b128 v[148:151], v5 offset:28672
    v_mfma_f32_16x16x32_bf16 a[184:187], v[92:95], v[168:171], a[184:187]
    v_mfma_f32_16x16x32_bf16 a[188:191], v[96:99], v[168:171], a[188:191]
    v_mfma_f32_16x16x32_bf16 a[192:195], v[100:103], v[168:171], a[192:195]
    v_mfma_f32_16x16x32_bf16 a[196:199], v[104:107], v[168:171], a[196:199]
    ds_read_b128 v[152:155], v5 offset:30720
    v_mfma_f32_16x16x32_bf16 a[200:203], v[108:111], v[168:171], a[200:203]
    v_mfma_f32_16x16x32_bf16 a[204:207], v[112:115], v[168:171], a[204:207]
    v_mfma_f32_16x16x32_bf16 a[208:211], v[116:119], v[168:171], a[208:211]
    v_mfma_f32_16x16x32_bf16 a[212:215], v[120:123], v[168:171], a[212:215]
    s_waitcnt vmcnt(10) lgkmcnt(0)
    v_mfma_f32_16x16x32_bf16 a[0:3], v[16:19], v[132:135], a[0:3]
    v_add_u32 v2, s33, v1
    v_mfma_f32_16x16x32_bf16 a[4:7], v[20:23], v[132:135], a[4:7]
    buffer_load_dwordx4 v[88:91], v1, s[12:15], s57 offen offset:0
    v_mfma_f32_16x16x32_bf16 a[8:11], v[24:27], v[132:135], a[8:11]
    v_mfma_f32_16x16x32_bf16 a[12:15], v[28:31], v[132:135], a[12:15]
    buffer_load_dwordx4 v[92:95], v1, s[12:15], s57 offen offset:1024
    v_mfma_f32_16x16x32_bf16 a[16:19], v[32:35], v[132:135], a[16:19]
    v_mfma_f32_16x16x32_bf16 a[20:23], v[36:39], v[132:135], a[20:23]
    buffer_load_dwordx4 v[96:99], v1, s[12:15], s57 offen offset:2048
    v_mfma_f32_16x16x32_bf16 a[24:27], v[40:43], v[132:135], a[24:27]
    buffer_load_dwordx4 v[100:103], v1, s[12:15], s57 offen offset:3072
    v_mfma_f32_16x16x32_bf16 a[28:31], v[44:47], v[132:135], a[28:31]
    v_mfma_f32_16x16x32_bf16 a[32:35], v[48:51], v[132:135], a[32:35]
    s_add_u32 s30, s57, 4096
    buffer_load_dwordx4 v[104:107], v1, s[12:15], s30 offen
    v_mfma_f32_16x16x32_bf16 a[36:39], v[16:19], v[136:139], a[36:39]
    v_mfma_f32_16x16x32_bf16 a[40:43], v[20:23], v[136:139], a[40:43]
    v_mfma_f32_16x16x32_bf16 a[44:47], v[24:27], v[136:139], a[44:47]
    ds_write_b128 v2, a[0:3] offset:0
    v_mfma_f32_16x16x32_bf16 a[48:51], v[28:31], v[136:139], a[48:51]
    ds_write_b128 v2, a[4:7] offset:1024
    v_mfma_f32_16x16x32_bf16 a[52:55], v[32:35], v[136:139], a[52:55]
    ds_write_b128 v2, a[8:11] offset:2048
    v_mfma_f32_16x16x32_bf16 a[56:59], v[36:39], v[136:139], a[56:59]
    ds_write_b128 v2, a[12:15] offset:3072
    v_mfma_f32_16x16x32_bf16 a[60:63], v[40:43], v[136:139], a[60:63]
    ds_write_b128 v2, a[16:19] offset:4096
    v_mfma_f32_16x16x32_bf16 a[64:67], v[44:47], v[136:139], a[64:67]
    v_mfma_f32_16x16x32_bf16 a[68:71], v[48:51], v[136:139], a[68:71]
    ds_write_b128 v2, a[20:23] offset:5120
    v_mfma_f32_16x16x32_bf16 a[72:75], v[16:19], v[140:143], a[72:75]
    ds_write_b128 v2, a[24:27] offset:6144
    v_mfma_f32_16x16x32_bf16 a[76:79], v[20:23], v[140:143], a[76:79]
    ds_write_b128 v2, a[28:31] offset:7168
    v_mfma_f32_16x16x32_bf16 a[80:83], v[24:27], v[140:143], a[80:83]
    ds_write_b128 v2, a[36:39] offset:9216
    ds_write_b128 v2, a[32:35] offset:8192
    v_mfma_f32_16x16x32_bf16 a[84:87], v[28:31], v[140:143], a[84:87]
    ds_write_b128 v2, a[40:43] offset:10240
    v_mfma_f32_16x16x32_bf16 a[88:91], v[32:35], v[140:143], a[88:91]
    v_mfma_f32_16x16x32_bf16 a[92:95], v[36:39], v[140:143], a[92:95]
    ds_write_b128 v2, a[44:47] offset:11264
    v_mfma_f32_16x16x32_bf16 a[96:99], v[40:43], v[140:143], a[96:99]
    ds_write_b128 v2, a[48:51] offset:12288
    v_mfma_f32_16x16x32_bf16 a[100:103], v[44:47], v[140:143], a[100:103]
    v_mfma_f32_16x16x32_bf16 a[104:107], v[48:51], v[140:143], a[104:107]
    ds_write_b128 v2, a[52:55] offset:13312
    v_mfma_f32_16x16x32_bf16 a[108:111], v[16:19], v[144:147], a[108:111]
    ds_write_b128 v2, a[56:59] offset:14336
    v_mfma_f32_16x16x32_bf16 a[112:115], v[20:23], v[144:147], a[112:115]
    v_mfma_f32_16x16x32_bf16 a[116:119], v[24:27], v[144:147], a[116:119]
    ds_write_b128 v2, a[72:75] offset:18432
    ds_write_b128 v2, a[60:63] offset:15360
    v_mfma_f32_16x16x32_bf16 a[120:123], v[28:31], v[144:147], a[120:123]
    ds_write_b128 v2, a[76:79] offset:19456
    ds_write_b128 v2, a[64:67] offset:16384
    v_mfma_f32_16x16x32_bf16 a[124:127], v[32:35], v[144:147], a[124:127]
    v_mfma_f32_16x16x32_bf16 a[128:131], v[36:39], v[144:147], a[128:131]
    ds_write_b128 v2, a[80:83] offset:20480
    ds_write_b128 v2, a[68:71] offset:17408
    v_mfma_f32_16x16x32_bf16 a[132:135], v[40:43], v[144:147], a[132:135]
    v_mfma_f32_16x16x32_bf16 a[136:139], v[44:47], v[144:147], a[136:139]
    ds_write_b128 v2, a[84:87] offset:21504
    v_mfma_f32_16x16x32_bf16 a[140:143], v[48:51], v[144:147], a[140:143]
    v_mfma_f32_16x16x32_bf16 a[144:147], v[16:19], v[148:151], a[144:147]
    ds_write_b128 v2, a[88:91] offset:22528
    v_mfma_f32_16x16x32_bf16 a[148:151], v[20:23], v[148:151], a[148:151]
    v_mfma_f32_16x16x32_bf16 a[152:155], v[24:27], v[148:151], a[152:155]
    ds_write_b128 v2, a[108:111] offset:27648
    ds_write_b128 v2, a[92:95] offset:23552
    v_mfma_f32_16x16x32_bf16 a[156:159], v[28:31], v[148:151], a[156:159]
    v_mfma_f32_16x16x32_bf16 a[160:163], v[32:35], v[148:151], a[160:163]
    ds_write_b128 v2, a[112:115] offset:28672
    ds_write_b128 v2, a[96:99] offset:24576
    v_mfma_f32_16x16x32_bf16 a[164:167], v[36:39], v[148:151], a[164:167]
    v_mfma_f32_16x16x32_bf16 a[168:171], v[40:43], v[148:151], a[168:171]
    ds_write_b128 v2, a[116:119] offset:29696
    ds_write_b128 v2, a[100:103] offset:25600
    v_mfma_f32_16x16x32_bf16 a[172:175], v[44:47], v[148:151], a[172:175]
    v_mfma_f32_16x16x32_bf16 a[176:179], v[48:51], v[148:151], a[176:179]
    ds_write_b128 v2, a[120:123] offset:30720
    ds_write_b128 v2, a[104:107] offset:26624
    v_mfma_f32_16x16x32_bf16 a[180:183], v[16:19], v[152:155], a[180:183]
    v_mfma_f32_16x16x32_bf16 a[184:187], v[20:23], v[152:155], a[184:187]
    ds_write_b128 v2, a[124:127] offset:31744
    v_mfma_f32_16x16x32_bf16 a[188:191], v[24:27], v[152:155], a[188:191]
    v_mfma_f32_16x16x32_bf16 a[192:195], v[28:31], v[152:155], a[192:195]
    v_mfma_f32_16x16x32_bf16 a[196:199], v[32:35], v[152:155], a[196:199]
    ds_write_b128 v2, a[128:131] offset:32768
    v_mfma_f32_16x16x32_bf16 a[200:203], v[36:39], v[152:155], a[200:203]
    v_mfma_f32_16x16x32_bf16 a[204:207], v[40:43], v[152:155], a[204:207]
    ds_write_b128 v2, a[132:135] offset:33792
    v_mfma_f32_16x16x32_bf16 a[208:211], v[44:47], v[152:155], a[208:211]
    v_mfma_f32_16x16x32_bf16 a[212:215], v[48:51], v[152:155], a[212:215]
    ds_write_b128 v2, a[136:139] offset:34816
    v_mfma_f32_16x16x32_bf16 v[172:175], v[16:19], v[124:127], v[172:175]
    v_mfma_f32_16x16x32_bf16 v[176:179], v[20:23], v[124:127], v[176:179]
    ds_write_b128 v2, a[140:143] offset:35840
    v_mfma_f32_16x16x32_bf16 v[180:183], v[24:27], v[124:127], v[180:183]
    v_mfma_f32_16x16x32_bf16 v[184:187], v[28:31], v[124:127], v[184:187]
    v_mfma_f32_16x16x32_bf16 v[188:191], v[32:35], v[124:127], v[188:191]
    s_sub_u32 s31, s26, 1
    v_mfma_f32_16x16x32_bf16 v[192:195], v[36:39], v[124:127], v[192:195]
    s_and_b32 s31, s31, 3
    v_mfma_f32_16x16x32_bf16 v[196:199], v[40:43], v[124:127], v[196:199]
    s_mul_i32 s31, s31, 36864
    v_mfma_f32_16x16x32_bf16 v[200:203], v[44:47], v[124:127], v[200:203]
    v_add_u32 v3, s31, v1
    v_mfma_f32_16x16x32_bf16 v[204:207], v[48:51], v[124:127], v[204:207]
    s_sub_u32 s31, s26, 2
    v_mfma_f32_16x16x32_bf16 v[208:211], v[16:19], v[128:131], v[208:211]
    s_and_b32 s31, s31, 3
    v_mfma_f32_16x16x32_bf16 v[212:215], v[20:23], v[128:131], v[212:215]
    s_mul_i32 s31, s31, 36864
    v_mfma_f32_16x16x32_bf16 v[216:219], v[24:27], v[128:131], v[216:219]
    s_add_u32 s31, s31, 18432
    v_mfma_f32_16x16x32_bf16 v[220:223], v[28:31], v[128:131], v[220:223]
    v_add_u32 v4, s31, v1
    v_mfma_f32_16x16x32_bf16 v[224:227], v[32:35], v[128:131], v[224:227]
    s_add_u32 s31, s26, 1
    v_mfma_f32_16x16x32_bf16 v[228:231], v[36:39], v[128:131], v[228:231]
    s_and_b32 s31, s31, 3
    v_mfma_f32_16x16x32_bf16 v[232:235], v[40:43], v[128:131], v[232:235]
    s_mul_i32 s31, s31, 36864
    v_mfma_f32_16x16x32_bf16 v[236:239], v[44:47], v[128:131], v[236:239]
    v_add_u32 v5, s31, v1
    v_mfma_f32_16x16x32_bf16 v[240:243], v[48:51], v[128:131], v[240:243]
    s_waitcnt lgkmcnt(0)
    s_barrier
    ds_read_b128 v[16:19], v3 offset:0
    ds_read_b128 v[20:23], v3 offset:1024
    ds_read_b128 v[24:27], v3 offset:2048
    ds_read_b128 v[28:31], v3 offset:3072
    ds_read_b128 v[32:35], v3 offset:4096
    ds_read_b128 v[36:39], v3 offset:5120
    ds_read_b128 v[40:43], v3 offset:6144
    ds_read_b128 v[44:47], v3 offset:7168
    ds_read_b128 v[48:51], v3 offset:8192
    ds_read_b128 v[108:111], v3 offset:9216
    ds_read_b128 v[112:115], v3 offset:10240
    ds_read_b128 v[116:119], v3 offset:11264
    ds_read_b128 v[120:123], v3 offset:12288
    ds_read_b128 v[124:127], v3 offset:13312
    ds_read_b128 v[128:131], v3 offset:14336
    ds_read_b128 v[132:135], v3 offset:15360
    ds_read_b128 v[136:139], v3 offset:16384
    ds_read_b128 v[140:143], v3 offset:17408
    s_waitcnt lgkmcnt(9)
    v_add_f32 v172, v172, v16
    v_add_f32 v173, v173, v17
    v_add_f32 v174, v174, v18
    v_add_f32 v175, v175, v19
    v_add_f32 v176, v176, v20
    v_add_f32 v177, v177, v21
    v_add_f32 v178, v178, v22
    v_add_f32 v179, v179, v23
    v_add_f32 v180, v180, v24
    v_add_f32 v181, v181, v25
    v_add_f32 v182, v182, v26
    v_add_f32 v183, v183, v27
    v_add_f32 v184, v184, v28
    v_add_f32 v185, v185, v29
    v_add_f32 v186, v186, v30
    v_add_f32 v187, v187, v31
    v_add_f32 v188, v188, v32
    v_add_f32 v189, v189, v33
    v_add_f32 v190, v190, v34
    v_add_f32 v191, v191, v35
    v_add_f32 v192, v192, v36
    v_add_f32 v193, v193, v37
    v_add_f32 v194, v194, v38
    v_add_f32 v195, v195, v39
    v_add_f32 v196, v196, v40
    v_add_f32 v197, v197, v41
    v_add_f32 v198, v198, v42
    v_add_f32 v199, v199, v43
    v_add_f32 v200, v200, v44
    v_add_f32 v201, v201, v45
    v_add_f32 v202, v202, v46
    v_add_f32 v203, v203, v47
    v_add_f32 v204, v204, v48
    v_add_f32 v205, v205, v49
    v_add_f32 v206, v206, v50
    v_add_f32 v207, v207, v51
    ds_read_b128 v[16:19], v4 offset:0
    ds_read_b128 v[20:23], v4 offset:1024
    ds_read_b128 v[24:27], v4 offset:2048
    ds_read_b128 v[28:31], v4 offset:3072
    ds_read_b128 v[32:35], v4 offset:4096
    ds_read_b128 v[36:39], v4 offset:5120
    ds_read_b128 v[40:43], v4 offset:6144
    ds_read_b128 v[44:47], v4 offset:7168
    ds_read_b128 v[48:51], v4 offset:8192
    s_waitcnt lgkmcnt(9)
    v_add_f32 v208, v208, v108
    v_add_f32 v209, v209, v109
    v_add_f32 v210, v210, v110
    v_add_f32 v211, v211, v111
    v_add_f32 v212, v212, v112
    v_add_f32 v213, v213, v113
    v_add_f32 v214, v214, v114
    v_add_f32 v215, v215, v115
    v_add_f32 v216, v216, v116
    v_add_f32 v217, v217, v117
    v_add_f32 v218, v218, v118
    v_add_f32 v219, v219, v119
    v_add_f32 v220, v220, v120
    v_add_f32 v221, v221, v121
    v_add_f32 v222, v222, v122
    v_add_f32 v223, v223, v123
    v_add_f32 v224, v224, v124
    v_add_f32 v225, v225, v125
    v_add_f32 v226, v226, v126
    v_add_f32 v227, v227, v127
    v_add_f32 v228, v228, v128
    v_add_f32 v229, v229, v129
    v_add_f32 v230, v230, v130
    v_add_f32 v231, v231, v131
    v_add_f32 v232, v232, v132
    v_add_f32 v233, v233, v133
    v_add_f32 v234, v234, v134
    v_add_f32 v235, v235, v135
    v_add_f32 v236, v236, v136
    v_add_f32 v237, v237, v137
    v_add_f32 v238, v238, v138
    v_add_f32 v239, v239, v139
    v_add_f32 v240, v240, v140
    v_add_f32 v241, v241, v141
    v_add_f32 v242, v242, v142
    v_add_f32 v243, v243, v143
    ds_read_b128 v[108:111], v4 offset:9216
    ds_read_b128 v[112:115], v4 offset:10240
    ds_read_b128 v[116:119], v4 offset:11264
    ds_read_b128 v[120:123], v4 offset:12288
    ds_read_b128 v[124:127], v4 offset:13312
    ds_read_b128 v[128:131], v4 offset:14336
    ds_read_b128 v[132:135], v4 offset:15360
    ds_read_b128 v[136:139], v4 offset:16384
    ds_read_b128 v[140:143], v4 offset:17408
    s_waitcnt lgkmcnt(0)
    s_barrier
    ds_write_b128 v2, a[144:147] offset:0
    v_add_f32 v172, v172, v16
    v_add_f32 v173, v173, v17
    v_add_f32 v174, v174, v18
    v_add_f32 v175, v175, v19
    ds_write_b128 v2, a[148:151] offset:1024
    v_add_f32 v176, v176, v20
    v_add_f32 v177, v177, v21
    v_add_f32 v178, v178, v22
    v_add_f32 v179, v179, v23
    ds_write_b128 v2, a[152:155] offset:2048
    v_add_f32 v180, v180, v24
    v_add_f32 v181, v181, v25
    v_add_f32 v182, v182, v26
    v_add_f32 v183, v183, v27
    ds_write_b128 v2, a[156:159] offset:3072
    v_add_f32 v184, v184, v28
    v_add_f32 v185, v185, v29
    v_add_f32 v186, v186, v30
    v_add_f32 v187, v187, v31
    ds_write_b128 v2, a[160:163] offset:4096
    v_add_f32 v188, v188, v32
    v_add_f32 v189, v189, v33
    v_add_f32 v190, v190, v34
    v_add_f32 v191, v191, v35
    ds_write_b128 v2, a[164:167] offset:5120
    v_add_f32 v192, v192, v36
    v_add_f32 v193, v193, v37
    v_add_f32 v194, v194, v38
    v_add_f32 v195, v195, v39
    ds_write_b128 v2, a[168:171] offset:6144
    v_add_f32 v196, v196, v40
    v_add_f32 v197, v197, v41
    v_add_f32 v198, v198, v42
    v_add_f32 v199, v199, v43
    ds_write_b128 v2, a[172:175] offset:7168
    v_add_f32 v200, v200, v44
    v_add_f32 v201, v201, v45
    v_add_f32 v202, v202, v46
    v_add_f32 v203, v203, v47
    ds_write_b128 v2, a[176:179] offset:8192
    v_add_f32 v204, v204, v48
    v_add_f32 v205, v205, v49
    v_add_f32 v206, v206, v50
    v_add_f32 v207, v207, v51
    ds_write_b128 v2, a[180:183] offset:9216
    v_add_f32 v208, v208, v108
    v_add_f32 v209, v209, v109
    v_add_f32 v210, v210, v110
    v_add_f32 v211, v211, v111
    ds_write_b128 v2, a[184:187] offset:10240
    v_add_f32 v212, v212, v112
    v_add_f32 v213, v213, v113
    v_add_f32 v214, v214, v114
    v_add_f32 v215, v215, v115
    ds_write_b128 v2, a[188:191] offset:11264
    v_add_f32 v216, v216, v116
    v_add_f32 v217, v217, v117
    v_add_f32 v218, v218, v118
    v_add_f32 v219, v219, v119
    ds_write_b128 v2, a[192:195] offset:12288
    v_add_f32 v220, v220, v120
    v_add_f32 v221, v221, v121
    v_add_f32 v222, v222, v122
    v_add_f32 v223, v223, v123
    ds_write_b128 v2, a[196:199] offset:13312
    v_add_f32 v224, v224, v124
    v_add_f32 v225, v225, v125
    v_add_f32 v226, v226, v126
    v_add_f32 v227, v227, v127
    ds_write_b128 v2, a[200:203] offset:14336
    v_add_f32 v228, v228, v128
    v_add_f32 v229, v229, v129
    v_add_f32 v230, v230, v130
    v_add_f32 v231, v231, v131
    ds_write_b128 v2, a[204:207] offset:15360
    v_add_f32 v232, v232, v132
    v_add_f32 v233, v233, v133
    v_add_f32 v234, v234, v134
    v_add_f32 v235, v235, v135
    ds_write_b128 v2, a[208:211] offset:16384
    v_add_f32 v236, v236, v136
    v_add_f32 v237, v237, v137
    v_add_f32 v238, v238, v138
    v_add_f32 v239, v239, v139
    ds_write_b128 v2, a[212:215] offset:17408
    v_add_f32 v240, v240, v140
    v_add_f32 v241, v241, v141
    v_add_f32 v242, v242, v142
    v_add_f32 v243, v243, v143
    s_waitcnt lgkmcnt(0)
    s_barrier
    ds_read_b128 v[16:19], v5 offset:0
    ds_read_b128 v[20:23], v5 offset:1024
    ds_read_b128 v[24:27], v5 offset:2048
    ds_read_b128 v[28:31], v5 offset:3072
    ds_read_b128 v[32:35], v5 offset:4096
    ds_read_b128 v[36:39], v5 offset:5120
    ds_read_b128 v[40:43], v5 offset:6144
    ds_read_b128 v[44:47], v5 offset:7168
    ds_read_b128 v[48:51], v5 offset:8192
    ds_read_b128 v[108:111], v5 offset:9216
    ds_read_b128 v[112:115], v5 offset:10240
    ds_read_b128 v[116:119], v5 offset:11264
    ds_read_b128 v[120:123], v5 offset:12288
    ds_read_b128 v[124:127], v5 offset:13312
    ds_read_b128 v[128:131], v5 offset:14336
    ds_read_b128 v[132:135], v5 offset:15360
    ds_read_b128 v[136:139], v5 offset:16384
    ds_read_b128 v[140:143], v5 offset:17408
    s_waitcnt lgkmcnt(9)
    v_add_f32 v172, v172, v16
    v_add_f32 v173, v173, v17
    v_add_f32 v174, v174, v18
    v_add_f32 v175, v175, v19
    v_add_f32 v176, v176, v20
    v_add_f32 v177, v177, v21
    v_add_f32 v178, v178, v22
    v_add_f32 v179, v179, v23
    v_add_f32 v180, v180, v24
    v_add_f32 v181, v181, v25
    v_add_f32 v182, v182, v26
    v_add_f32 v183, v183, v27
    v_add_f32 v184, v184, v28
    v_add_f32 v185, v185, v29
    v_add_f32 v186, v186, v30
    v_add_f32 v187, v187, v31
    v_add_f32 v188, v188, v32
    v_add_f32 v189, v189, v33
    v_add_f32 v190, v190, v34
    v_add_f32 v191, v191, v35
    v_add_f32 v192, v192, v36
    v_add_f32 v193, v193, v37
    v_add_f32 v194, v194, v38
    v_add_f32 v195, v195, v39
    v_add_f32 v196, v196, v40
    v_add_f32 v197, v197, v41
    v_add_f32 v198, v198, v42
    v_add_f32 v199, v199, v43
    v_add_f32 v200, v200, v44
    v_add_f32 v201, v201, v45
    v_add_f32 v202, v202, v46
    v_add_f32 v203, v203, v47
    v_add_f32 v204, v204, v48
    v_add_f32 v205, v205, v49
    v_add_f32 v206, v206, v50
    v_add_f32 v207, v207, v51
    s_waitcnt vmcnt(0) lgkmcnt(0)
    s_bitcmp1_b32 s25, 0
    s_cbranch_scc1 L_gemm2_kernel_odd
    v_lshlrev_b32 v246, 16, v68
    v_add_f32 v208, v208, v108
    v_and_b32 v247, 0xffff0000, v68
    v_mul_f32 v246, v246, v172
    v_add_f32 v209, v209, v109
    v_mul_f32 v247, v247, v173
    v_cvt_pk_bf16_f32 v68, v246, v247
    v_lshlrev_b32 v246, 16, v69
    v_add_f32 v210, v210, v110
    v_and_b32 v247, 0xffff0000, v69
    v_mul_f32 v246, v246, v174
    v_mul_f32 v247, v247, v175
    v_add_f32 v211, v211, v111
    v_cvt_pk_bf16_f32 v69, v246, v247
    v_lshlrev_b32 v246, 16, v70
    v_add_f32 v212, v212, v112
    v_and_b32 v247, 0xffff0000, v70
    v_mul_f32 v246, v246, v176
    v_mul_f32 v247, v247, v177
    v_add_f32 v213, v213, v113
    v_cvt_pk_bf16_f32 v70, v246, v247
    v_lshlrev_b32 v246, 16, v71
    v_and_b32 v247, 0xffff0000, v71
    v_add_f32 v214, v214, v114
    v_mul_f32 v246, v246, v178
    v_mul_f32 v247, v247, v179
    v_add_f32 v215, v215, v115
    v_cvt_pk_bf16_f32 v71, v246, v247
    buffer_store_dwordx4 v[68:71], v1, s[12:15], s58 offen offset:0
    v_lshlrev_b32 v246, 16, v72
    v_add_f32 v216, v216, v116
    v_and_b32 v247, 0xffff0000, v72
    v_mul_f32 v246, v246, v180
    v_mul_f32 v247, v247, v181
    v_add_f32 v217, v217, v117
    v_cvt_pk_bf16_f32 v72, v246, v247
    v_lshlrev_b32 v246, 16, v73
    v_add_f32 v218, v218, v118
    v_and_b32 v247, 0xffff0000, v73
    v_mul_f32 v246, v246, v182
    v_mul_f32 v247, v247, v183
    v_add_f32 v219, v219, v119
    v_cvt_pk_bf16_f32 v73, v246, v247
    v_lshlrev_b32 v246, 16, v74
    v_and_b32 v247, 0xffff0000, v74
    v_add_f32 v220, v220, v120
    v_mul_f32 v246, v246, v184
    v_mul_f32 v247, v247, v185
    v_add_f32 v221, v221, v121
    v_cvt_pk_bf16_f32 v74, v246, v247
    v_lshlrev_b32 v246, 16, v75
    v_and_b32 v247, 0xffff0000, v75
    v_add_f32 v222, v222, v122
    v_mul_f32 v246, v246, v186
    v_mul_f32 v247, v247, v187
    v_cvt_pk_bf16_f32 v75, v246, v247
    v_add_f32 v223, v223, v123
    buffer_store_dwordx4 v[72:75], v1, s[12:15], s58 offen offset:1024
    v_lshlrev_b32 v246, 16, v76
    v_add_f32 v224, v224, v124
    v_and_b32 v247, 0xffff0000, v76
    v_mul_f32 v246, v246, v188
    v_mul_f32 v247, v247, v189
    v_add_f32 v225, v225, v125
    v_cvt_pk_bf16_f32 v76, v246, v247
    v_lshlrev_b32 v246, 16, v77
    v_and_b32 v247, 0xffff0000, v77
    v_add_f32 v226, v226, v126
    v_mul_f32 v246, v246, v190
    v_mul_f32 v247, v247, v191
    v_add_f32 v227, v227, v127
    v_cvt_pk_bf16_f32 v77, v246, v247
    v_lshlrev_b32 v246, 16, v78
    v_and_b32 v247, 0xffff0000, v78
    v_add_f32 v228, v228, v128
    v_mul_f32 v246, v246, v192
    v_mul_f32 v247, v247, v193
    v_cvt_pk_bf16_f32 v78, v246, v247
    v_add_f32 v229, v229, v129
    v_lshlrev_b32 v246, 16, v79
    v_and_b32 v247, 0xffff0000, v79
    v_add_f32 v230, v230, v130
    v_mul_f32 v246, v246, v194
    v_mul_f32 v247, v247, v195
    v_cvt_pk_bf16_f32 v79, v246, v247
    v_add_f32 v231, v231, v131
    buffer_store_dwordx4 v[76:79], v1, s[12:15], s58 offen offset:2048
    v_lshlrev_b32 v246, 16, v80
    v_and_b32 v247, 0xffff0000, v80
    v_add_f32 v232, v232, v132
    v_mul_f32 v246, v246, v196
    v_mul_f32 v247, v247, v197
    v_add_f32 v233, v233, v133
    v_cvt_pk_bf16_f32 v80, v246, v247
    v_lshlrev_b32 v246, 16, v81
    v_and_b32 v247, 0xffff0000, v81
    v_add_f32 v234, v234, v134
    v_mul_f32 v246, v246, v198
    v_mul_f32 v247, v247, v199
    v_cvt_pk_bf16_f32 v81, v246, v247
    v_add_f32 v235, v235, v135
    v_lshlrev_b32 v246, 16, v82
    v_and_b32 v247, 0xffff0000, v82
    v_add_f32 v236, v236, v136
    v_mul_f32 v246, v246, v200
    v_mul_f32 v247, v247, v201
    v_cvt_pk_bf16_f32 v82, v246, v247
    v_add_f32 v237, v237, v137
    v_lshlrev_b32 v246, 16, v83
    v_and_b32 v247, 0xffff0000, v83
    v_mul_f32 v246, v246, v202
    v_add_f32 v238, v238, v138
    v_mul_f32 v247, v247, v203
    v_cvt_pk_bf16_f32 v83, v246, v247
    v_add_f32 v239, v239, v139
    buffer_store_dwordx4 v[80:83], v1, s[12:15], s58 offen offset:3072
    v_lshlrev_b32 v246, 16, v84
    v_and_b32 v247, 0xffff0000, v84
    v_add_f32 v240, v240, v140
    v_mul_f32 v246, v246, v204
    v_mul_f32 v247, v247, v205
    v_cvt_pk_bf16_f32 v84, v246, v247
    v_add_f32 v241, v241, v141
    v_lshlrev_b32 v246, 16, v85
    v_and_b32 v247, 0xffff0000, v85
    v_add_f32 v242, v242, v142
    v_mul_f32 v246, v246, v206
    v_mul_f32 v247, v247, v207
    v_cvt_pk_bf16_f32 v85, v246, v247
    v_add_f32 v243, v243, v143
    s_add_u32 s30, s58, 4096
    buffer_store_dwordx2 v[84:85], v1, s[12:15], s30 offen offset:0
    v_lshlrev_b32 v246, 16, v88
    v_and_b32 v247, 0xffff0000, v88
    v_mul_f32 v246, v246, v208
    v_mul_f32 v247, v247, v209
    v_cvt_pk_bf16_f32 v88, v246, v247
    v_lshlrev_b32 v246, 16, v89
    v_and_b32 v247, 0xffff0000, v89
    v_mul_f32 v246, v246, v210
    v_mul_f32 v247, v247, v211
    v_cvt_pk_bf16_f32 v89, v246, v247
    v_lshlrev_b32 v246, 16, v90
    v_and_b32 v247, 0xffff0000, v90
    v_mul_f32 v246, v246, v212
    v_mul_f32 v247, v247, v213
    v_cvt_pk_bf16_f32 v90, v246, v247
    v_lshlrev_b32 v246, 16, v91
    v_and_b32 v247, 0xffff0000, v91
    v_mul_f32 v246, v246, v214
    v_mul_f32 v247, v247, v215
    v_cvt_pk_bf16_f32 v91, v246, v247
    buffer_store_dwordx4 v[88:91], v1, s[12:15], s59 offen offset:0
    v_lshlrev_b32 v246, 16, v92
    v_and_b32 v247, 0xffff0000, v92
    v_mul_f32 v246, v246, v216
    v_mul_f32 v247, v247, v217
    v_cvt_pk_bf16_f32 v92, v246, v247
    v_lshlrev_b32 v246, 16, v93
    v_and_b32 v247, 0xffff0000, v93
    v_mul_f32 v246, v246, v218
    v_mul_f32 v247, v247, v219
    v_cvt_pk_bf16_f32 v93, v246, v247
    v_lshlrev_b32 v246, 16, v94
    v_and_b32 v247, 0xffff0000, v94
    v_mul_f32 v246, v246, v220
    v_mul_f32 v247, v247, v221
    v_cvt_pk_bf16_f32 v94, v246, v247
    v_lshlrev_b32 v246, 16, v95
    v_and_b32 v247, 0xffff0000, v95
    v_mul_f32 v246, v246, v222
    v_mul_f32 v247, v247, v223
    v_cvt_pk_bf16_f32 v95, v246, v247
    buffer_store_dwordx4 v[92:95], v1, s[12:15], s59 offen offset:1024
    v_lshlrev_b32 v246, 16, v96
    v_and_b32 v247, 0xffff0000, v96
    v_mul_f32 v246, v246, v224
    v_mul_f32 v247, v247, v225
    v_cvt_pk_bf16_f32 v96, v246, v247
    v_lshlrev_b32 v246, 16, v97
    v_and_b32 v247, 0xffff0000, v97
    v_mul_f32 v246, v246, v226
    v_mul_f32 v247, v247, v227
    v_cvt_pk_bf16_f32 v97, v246, v247
    v_lshlrev_b32 v246, 16, v98
    v_and_b32 v247, 0xffff0000, v98
    v_mul_f32 v246, v246, v228
    v_mul_f32 v247, v247, v229
    v_cvt_pk_bf16_f32 v98, v246, v247
    v_lshlrev_b32 v246, 16, v99
    v_and_b32 v247, 0xffff0000, v99
    v_mul_f32 v246, v246, v230
    v_mul_f32 v247, v247, v231
    v_cvt_pk_bf16_f32 v99, v246, v247
    buffer_store_dwordx4 v[96:99], v1, s[12:15], s59 offen offset:2048
    v_lshlrev_b32 v246, 16, v100
    v_and_b32 v247, 0xffff0000, v100
    v_mul_f32 v246, v246, v232
    v_mul_f32 v247, v247, v233
    v_cvt_pk_bf16_f32 v100, v246, v247
    v_lshlrev_b32 v246, 16, v101
    v_and_b32 v247, 0xffff0000, v101
    v_mul_f32 v246, v246, v234
    v_mul_f32 v247, v247, v235
    v_cvt_pk_bf16_f32 v101, v246, v247
    v_lshlrev_b32 v246, 16, v102
    v_and_b32 v247, 0xffff0000, v102
    v_mul_f32 v246, v246, v236
    v_mul_f32 v247, v247, v237
    v_cvt_pk_bf16_f32 v102, v246, v247
    v_lshlrev_b32 v246, 16, v103
    v_and_b32 v247, 0xffff0000, v103
    v_mul_f32 v246, v246, v238
    v_mul_f32 v247, v247, v239
    v_cvt_pk_bf16_f32 v103, v246, v247
    buffer_store_dwordx4 v[100:103], v1, s[12:15], s59 offen offset:3072
    v_lshlrev_b32 v246, 16, v104
    v_and_b32 v247, 0xffff0000, v104
    v_mul_f32 v246, v246, v240
    v_mul_f32 v247, v247, v241
    v_cvt_pk_bf16_f32 v104, v246, v247
    v_lshlrev_b32 v246, 16, v105
    v_and_b32 v247, 0xffff0000, v105
    v_mul_f32 v246, v246, v242
    v_mul_f32 v247, v247, v243
    v_cvt_pk_bf16_f32 v105, v246, v247
    s_add_u32 s30, s59, 4096
    buffer_store_dwordx2 v[104:105], v1, s[12:15], s30 offen offset:0
    s_endpgm
L_gemm2_kernel_odd:
    v_lshlrev_b32 v246, 16, v70
    v_add_f32 v208, v208, v108
    v_and_b32 v247, 0xffff0000, v70
    v_mul_f32 v246, v246, v172
    v_add_f32 v209, v209, v109
    v_mul_f32 v247, v247, v173
    v_cvt_pk_bf16_f32 v70, v246, v247
    v_lshlrev_b32 v246, 16, v71
    v_add_f32 v210, v210, v110
    v_and_b32 v247, 0xffff0000, v71
    v_mul_f32 v246, v246, v174
    v_mul_f32 v247, v247, v175
    v_add_f32 v211, v211, v111
    v_cvt_pk_bf16_f32 v71, v246, v247
    buffer_store_dwordx2 v[70:71], v1, s[12:15], s58 offen offset:8
    v_add_f32 v212, v212, v112
    v_lshlrev_b32 v246, 16, v72
    v_and_b32 v247, 0xffff0000, v72
    v_mul_f32 v246, v246, v176
    v_add_f32 v213, v213, v113
    v_mul_f32 v247, v247, v177
    v_cvt_pk_bf16_f32 v72, v246, v247
    v_lshlrev_b32 v246, 16, v73
    v_add_f32 v214, v214, v114
    v_and_b32 v247, 0xffff0000, v73
    v_mul_f32 v246, v246, v178
    v_add_f32 v215, v215, v115
    v_mul_f32 v247, v247, v179
    v_cvt_pk_bf16_f32 v73, v246, v247
    v_lshlrev_b32 v246, 16, v74
    v_add_f32 v216, v216, v116
    v_and_b32 v247, 0xffff0000, v74
    v_mul_f32 v246, v246, v180
    v_mul_f32 v247, v247, v181
    v_add_f32 v217, v217, v117
    v_cvt_pk_bf16_f32 v74, v246, v247
    v_lshlrev_b32 v246, 16, v75
    v_add_f32 v218, v218, v118
    v_and_b32 v247, 0xffff0000, v75
    v_mul_f32 v246, v246, v182
    v_mul_f32 v247, v247, v183
    v_add_f32 v219, v219, v119
    v_cvt_pk_bf16_f32 v75, v246, v247
    buffer_store_dwordx4 v[72:75], v1, s[12:15], s58 offen offset:1024
    v_lshlrev_b32 v246, 16, v76
    v_add_f32 v220, v220, v120
    v_and_b32 v247, 0xffff0000, v76
    v_mul_f32 v246, v246, v184
    v_add_f32 v221, v221, v121
    v_mul_f32 v247, v247, v185
    v_cvt_pk_bf16_f32 v76, v246, v247
    v_lshlrev_b32 v246, 16, v77
    v_add_f32 v222, v222, v122
    v_and_b32 v247, 0xffff0000, v77
    v_mul_f32 v246, v246, v186
    v_mul_f32 v247, v247, v187
    v_add_f32 v223, v223, v123
    v_cvt_pk_bf16_f32 v77, v246, v247
    v_lshlrev_b32 v246, 16, v78
    v_add_f32 v224, v224, v124
    v_and_b32 v247, 0xffff0000, v78
    v_mul_f32 v246, v246, v188
    v_mul_f32 v247, v247, v189
    v_add_f32 v225, v225, v125
    v_cvt_pk_bf16_f32 v78, v246, v247
    v_lshlrev_b32 v246, 16, v79
    v_and_b32 v247, 0xffff0000, v79
    v_add_f32 v226, v226, v126
    v_mul_f32 v246, v246, v190
    v_mul_f32 v247, v247, v191
    v_add_f32 v227, v227, v127
    v_cvt_pk_bf16_f32 v79, v246, v247
    buffer_store_dwordx4 v[76:79], v1, s[12:15], s58 offen offset:2048
    v_lshlrev_b32 v246, 16, v80
    v_add_f32 v228, v228, v128
    v_and_b32 v247, 0xffff0000, v80
    v_mul_f32 v246, v246, v192
    v_mul_f32 v247, v247, v193
    v_add_f32 v229, v229, v129
    v_cvt_pk_bf16_f32 v80, v246, v247
    v_lshlrev_b32 v246, 16, v81
    v_add_f32 v230, v230, v130
    v_and_b32 v247, 0xffff0000, v81
    v_mul_f32 v246, v246, v194
    v_mul_f32 v247, v247, v195
    v_add_f32 v231, v231, v131
    v_cvt_pk_bf16_f32 v81, v246, v247
    v_lshlrev_b32 v246, 16, v82
    v_and_b32 v247, 0xffff0000, v82
    v_add_f32 v232, v232, v132
    v_mul_f32 v246, v246, v196
    v_mul_f32 v247, v247, v197
    v_add_f32 v233, v233, v133
    v_cvt_pk_bf16_f32 v82, v246, v247
    v_lshlrev_b32 v246, 16, v83
    v_and_b32 v247, 0xffff0000, v83
    v_add_f32 v234, v234, v134
    v_mul_f32 v246, v246, v198
    v_mul_f32 v247, v247, v199
    v_cvt_pk_bf16_f32 v83, v246, v247
    v_add_f32 v235, v235, v135
    buffer_store_dwordx4 v[80:83], v1, s[12:15], s58 offen offset:3072
    v_lshlrev_b32 v246, 16, v84
    v_add_f32 v236, v236, v136
    v_and_b32 v247, 0xffff0000, v84
    v_mul_f32 v246, v246, v200
    v_mul_f32 v247, v247, v201
    v_add_f32 v237, v237, v137
    v_cvt_pk_bf16_f32 v84, v246, v247
    v_lshlrev_b32 v246, 16, v85
    v_and_b32 v247, 0xffff0000, v85
    v_add_f32 v238, v238, v138
    v_mul_f32 v246, v246, v202
    v_mul_f32 v247, v247, v203
    v_add_f32 v239, v239, v139
    v_cvt_pk_bf16_f32 v85, v246, v247
    v_lshlrev_b32 v246, 16, v86
    v_and_b32 v247, 0xffff0000, v86
    v_add_f32 v240, v240, v140
    v_mul_f32 v246, v246, v204
    v_mul_f32 v247, v247, v205
    v_cvt_pk_bf16_f32 v86, v246, v247
    v_add_f32 v241, v241, v141
    v_lshlrev_b32 v246, 16, v87
    v_and_b32 v247, 0xffff0000, v87
    v_add_f32 v242, v242, v142
    v_mul_f32 v246, v246, v206
    v_mul_f32 v247, v247, v207
    v_cvt_pk_bf16_f32 v87, v246, v247
    v_add_f32 v243, v243, v143
    s_add_u32 s30, s58, 4096
    buffer_store_dwordx4 v[84:87], v1, s[12:15], s30 offen offset:0
    v_lshlrev_b32 v246, 16, v90
    v_and_b32 v247, 0xffff0000, v90
    v_mul_f32 v246, v246, v208
    v_mul_f32 v247, v247, v209
    v_cvt_pk_bf16_f32 v90, v246, v247
    v_lshlrev_b32 v246, 16, v91
    v_and_b32 v247, 0xffff0000, v91
    v_mul_f32 v246, v246, v210
    v_mul_f32 v247, v247, v211
    v_cvt_pk_bf16_f32 v91, v246, v247
    buffer_store_dwordx2 v[90:91], v1, s[12:15], s59 offen offset:8
    v_lshlrev_b32 v246, 16, v92
    v_and_b32 v247, 0xffff0000, v92
    v_mul_f32 v246, v246, v212
    v_mul_f32 v247, v247, v213
    v_cvt_pk_bf16_f32 v92, v246, v247
    v_lshlrev_b32 v246, 16, v93
    v_and_b32 v247, 0xffff0000, v93
    v_mul_f32 v246, v246, v214
    v_mul_f32 v247, v247, v215
    v_cvt_pk_bf16_f32 v93, v246, v247
    v_lshlrev_b32 v246, 16, v94
    v_and_b32 v247, 0xffff0000, v94
    v_mul_f32 v246, v246, v216
    v_mul_f32 v247, v247, v217
    v_cvt_pk_bf16_f32 v94, v246, v247
    v_lshlrev_b32 v246, 16, v95
    v_and_b32 v247, 0xffff0000, v95
    v_mul_f32 v246, v246, v218
    v_mul_f32 v247, v247, v219
    v_cvt_pk_bf16_f32 v95, v246, v247
    buffer_store_dwordx4 v[92:95], v1, s[12:15], s59 offen offset:1024
    v_lshlrev_b32 v246, 16, v96
    v_and_b32 v247, 0xffff0000, v96
    v_mul_f32 v246, v246, v220
    v_mul_f32 v247, v247, v221
    v_cvt_pk_bf16_f32 v96, v246, v247
    v_lshlrev_b32 v246, 16, v97
    v_and_b32 v247, 0xffff0000, v97
    v_mul_f32 v246, v246, v222
    v_mul_f32 v247, v247, v223
    v_cvt_pk_bf16_f32 v97, v246, v247
    v_lshlrev_b32 v246, 16, v98
    v_and_b32 v247, 0xffff0000, v98
    v_mul_f32 v246, v246, v224
    v_mul_f32 v247, v247, v225
    v_cvt_pk_bf16_f32 v98, v246, v247
    v_lshlrev_b32 v246, 16, v99
    v_and_b32 v247, 0xffff0000, v99
    v_mul_f32 v246, v246, v226
    v_mul_f32 v247, v247, v227
    v_cvt_pk_bf16_f32 v99, v246, v247
    buffer_store_dwordx4 v[96:99], v1, s[12:15], s59 offen offset:2048
    v_lshlrev_b32 v246, 16, v100
    v_and_b32 v247, 0xffff0000, v100
    v_mul_f32 v246, v246, v228
    v_mul_f32 v247, v247, v229
    v_cvt_pk_bf16_f32 v100, v246, v247
    v_lshlrev_b32 v246, 16, v101
    v_and_b32 v247, 0xffff0000, v101
    v_mul_f32 v246, v246, v230
    v_mul_f32 v247, v247, v231
    v_cvt_pk_bf16_f32 v101, v246, v247
    v_lshlrev_b32 v246, 16, v102
    v_and_b32 v247, 0xffff0000, v102
    v_mul_f32 v246, v246, v232
    v_mul_f32 v247, v247, v233
    v_cvt_pk_bf16_f32 v102, v246, v247
    v_lshlrev_b32 v246, 16, v103
    v_and_b32 v247, 0xffff0000, v103
    v_mul_f32 v246, v246, v234
    v_mul_f32 v247, v247, v235
    v_cvt_pk_bf16_f32 v103, v246, v247
    buffer_store_dwordx4 v[100:103], v1, s[12:15], s59 offen offset:3072
    v_lshlrev_b32 v246, 16, v104
    v_and_b32 v247, 0xffff0000, v104
    v_mul_f32 v246, v246, v236
    v_mul_f32 v247, v247, v237
    v_cvt_pk_bf16_f32 v104, v246, v247
    v_lshlrev_b32 v246, 16, v105
    v_and_b32 v247, 0xffff0000, v105
    v_mul_f32 v246, v246, v238
    v_mul_f32 v247, v247, v239
    v_cvt_pk_bf16_f32 v105, v246, v247
    v_lshlrev_b32 v246, 16, v106
    v_and_b32 v247, 0xffff0000, v106
    v_mul_f32 v246, v246, v240
    v_mul_f32 v247, v247, v241
    v_cvt_pk_bf16_f32 v106, v246, v247
    v_lshlrev_b32 v246, 16, v107
    v_and_b32 v247, 0xffff0000, v107
    v_mul_f32 v246, v246, v242
    v_mul_f32 v247, v247, v243
    v_cvt_pk_bf16_f32 v107, v246, v247
    s_add_u32 s30, s59, 4096
    buffer_store_dwordx4 v[104:107], v1, s[12:15], s30 offen offset:0
    s_endpgm
L_gemm2_kernel_end:
    s_endpgm
.globl gemm3_kernel
.p2align 8
.type gemm3_kernel,@function
gemm3_kernel:
    s_and_b32 s28, s2, 7
    s_lshr_b32 s29, s2, 3
    s_cmp_ge_u32 s29, 30
    s_cbranch_scc1 L_gemm3_kernel_end
    s_mul_i32 s28, s28, 30
    s_add_u32 s28, s28, s29
    s_cmp_ge_u32 s28, 234
    s_cbranch_scc1 L_gemm3_kernel_end
    s_load_dwordx4 s[4:7], s[0:1], 56
    s_load_dwordx2 s[62:63], s[0:1], 80
    s_load_dwordx2 s[64:65], s[0:1], 0
    v_mov_b32 v15, v0
    v_lshrrev_b32 v1, 6, v0
    v_and_b32 v0, 63, v0
    v_readfirstlane_b32 s26, v1
    s_mul_i32 s24, s28, 7282
    s_lshr_b32 s24, s24, 16
    s_mul_i32 s30, s24, 9
    s_sub_u32 s25, s28, s30
    s_mul_i32 s33, s26, 20480
    s_mul_i32 s32, s24, 460800
    s_lshl_b32 s30, s26, 10
    s_add_u32 s32, s32, s30
    s_add_u32 s32, s32, 33554432
    s_mul_i32 s34, s26, 36864
    s_lshl_b32 s30, s25, 7
    s_add_u32 s34, s34, s30
    s_add_u32 s35, s34, 56623104
    s_add_u32 s36, s32, 16384
    s_add_u32 s37, s35, 589824
    s_cmp_ge_u32 s26, 2
    s_cselect_b32 s36, 0x40000000, s36
    s_cselect_b32 s37, 0x40000000, s37
    s_add_u32 s41, s32, 18432
    s_mul_i32 s40, s24, 0
    s_mul_i32 s43, s25, 2
    s_add_u32 s40, s40, s43
    s_and_b32 s43, s2, 7
    s_mul_i32 s43, s43, 2
    s_add_u32 s40, s40, s43
    s_mul_i32 s43, s40, 3641
    s_lshr_b32 s43, s43, 16
    s_mul_i32 s43, s43, 18
    s_sub_u32 s40, s40, s43
    s_mul_i32 s38, s24, 92160
    s_add_u32 s38, s38, s30
    v_lshlrev_b32 v1, 4, v0
    v_lshrrev_b32 v8, 3, v0
    v_mul_u32_u24 v2, 1152, v8
    v_bfe_u32 v8, v0, 1, 2
    v_lshrrev_b32 v9, 4, v0
    v_xor_b32 v8, v8, v9
    v_lshl_add_u32 v2, v8, 5, v2
    v_and_b32 v8, 1, v0
    v_lshl_add_u32 v2, v8, 4, v2
    v_add_u32 v3, s33, v1
    v_lshrrev_b32 v8, 2, v0
    v_lshlrev_b32 v8, 7, v8
    v_and_b32 v9, 3, v0
    v_lshl_add_u32 v8, v9, 3, v8
    v_add_u32 v8, s33, v8
    v_bfe_u32 v9, v0, 3, 2
    v_xor_b32 v10, 0, v9
    v_lshl_add_u32 v4, v10, 5, v8
    v_xor_b32 v10, 1, v9
    v_lshl_add_u32 v5, v10, 5, v8
    v_xor_b32 v10, 2, v9
    v_lshl_add_u32 v6, v10, 5, v8
    v_xor_b32 v10, 3, v9
    v_lshl_add_u32 v7, v10, 5, v8
    v_and_b32 v8, 15, v15
    v_bfe_u32 v9, v15, 4, 3
    v_lshrrev_b32 v10, 7, v15
    v_lshl_add_u32 v13, v10, 4, v8
    v_mul_u32_u24 v13, 1152, v13
    v_lshl_add_u32 v13, v9, 4, v13
    v_lshlrev_b32 v14, 12, v10
    v_lshrrev_b32 v10, 1, v9
    v_lshl_add_u32 v14, v10, 10, v14
    v_and_b32 v10, 1, v9
    v_lshl_add_u32 v14, v10, 9, v14
    v_lshl_add_u32 v14, v8, 4, v14
    v_add_u32 v15, 40960, v14
    v_add_u32 v8, 0, v1
    v_add_u32 v9, 92160, v1
    v_add_u32 v10, 184320, v1
    v_add_u32 v11, 276480, v1
    v_add_u32 v12, 368640, v1
    s_waitcnt lgkmcnt(0)
    s_mov_b32 s8, s4
    s_mov_b32 s9, s5
    s_mov_b32 s10, 2654208
    s_mov_b32 s11, 0x20000
    s_mov_b32 s12, s62
    s_mov_b32 s13, s63
    s_mov_b32 s14, 67108864
    s_mov_b32 s15, 0x20000
    s_mov_b32 s16, s64
    s_mov_b32 s17, s65
    s_mov_b32 s18, 2359296
    s_mov_b32 s19, 0x20000
    s_mov_b32 s20, s6
    s_mov_b32 s21, s7
    s_mov_b32 s22, 2359296
    s_mov_b32 s23, 0x20000
    s_lshl_b32 s31, s40, 12
    s_add_u32 s31, s31, s41
    s_mul_i32 s42, s40, 147456
    s_add_u32 s42, s42, s34
    s_add_u32 s40, s40, 1
    s_cmp_eq_u32 s40, 18
    s_cselect_b32 s40, 0, s40
    buffer_load_dwordx4 v[96:99], v8, s[12:15], s31 offen
    buffer_load_dwordx4 v[100:103], v9, s[12:15], s31 offen
    buffer_load_dwordx4 v[104:107], v10, s[12:15], s31 offen
    buffer_load_dwordx4 v[108:111], v11, s[12:15], s31 offen
    buffer_load_dwordx4 v[112:115], v12, s[12:15], s31 offen
    s_add_u32 m0, s33, 0
    s_add_u32 s30, s42, 0
    buffer_load_dwordx4 v2, s[8:11], s30 offen lds
    s_add_u32 m0, s33, 1024
    s_add_u32 s30, s42, 9216
    buffer_load_dwordx4 v2, s[8:11], s30 offen lds
    s_add_u32 m0, s33, 2048
    s_add_u32 s30, s42, 18432
    buffer_load_dwordx4 v2, s[8:11], s30 offen lds
    s_add_u32 m0, s33, 3072
    s_add_u32 s30, s42, 27648
    buffer_load_dwordx4 v2, s[8:11], s30 offen lds
    s_lshl_b32 s31, s40, 12
    s_add_u32 s31, s31, s41
    s_mul_i32 s42, s40, 147456
    s_add_u32 s42, s42, s34
    s_add_u32 s40, s40, 1
    s_cmp_eq_u32 s40, 18
    s_cselect_b32 s40, 0, s40
    buffer_load_dwordx4 v[116:119], v8, s[12:15], s31 offen
    buffer_load_dwordx4 v[120:123], v9, s[12:15], s31 offen
    buffer_load_dwordx4 v[124:127], v10, s[12:15], s31 offen
    buffer_load_dwordx4 v[128:131], v11, s[12:15], s31 offen
    buffer_load_dwordx4 v[132:135], v12, s[12:15], s31 offen
    s_add_u32 m0, s33, 4096
    s_add_u32 s30, s42, 0
    buffer_load_dwordx4 v2, s[8:11], s30 offen lds
    s_add_u32 m0, s33, 5120
    s_add_u32 s30, s42, 9216
    buffer_load_dwordx4 v2, s[8:11], s30 offen lds
    s_add_u32 m0, s33, 6144
    s_add_u32 s30, s42, 18432
    buffer_load_dwordx4 v2, s[8:11], s30 offen lds
    s_add_u32 m0, s33, 7168
    s_add_u32 s30, s42, 27648
    buffer_load_dwordx4 v2, s[8:11], s30 offen lds
    s_lshl_b32 s31, s40, 12
    s_add_u32 s31, s31, s41
    s_mul_i32 s42, s40, 147456
    s_add_u32 s42, s42, s34
    s_add_u32 s40, s40, 1
    s_cmp_eq_u32 s40, 18
    s_cselect_b32 s40, 0, s40
    buffer_load_dwordx4 v[136:139], v8, s[12:15], s31 offen
    buffer_load_dwordx4 v[140:143], v9, s[12:15], s31 offen
    buffer_load_dwordx4 v[144:147], v10, s[12:15], s31 offen
    buffer_load_dwordx4 v[148:151], v11, s[12:15], s31 offen
    buffer_load_dwordx4 v[152:155], v12, s[12:15], s31 offen
    s_add_u32 m0, s33, 8192
    s_add_u32 s30, s42, 0
    buffer_load_dwordx4 v2, s[8:11], s30 offen lds
    s_add_u32 m0, s33, 9216
    s_add_u32 s30, s42, 9216
    buffer_load_dwordx4 v2, s[8:11], s30 offen lds
    s_add_u32 m0, s33, 10240
    s_add_u32 s30, s42, 18432
    buffer_load_dwordx4 v2, s[8:11], s30 offen lds
    s_add_u32 m0, s33, 11264
    s_add_u32 s30, s42, 27648
    buffer_load_dwordx4 v2, s[8:11], s30 offen lds
    s_waitcnt vmcnt(18)
    ds_read_b64_tr_b16 v[176:177], v4 offset:0
    ds_read_b64_tr_b16 v[178:179], v4 offset:2048
    ds_read_b64_tr_b16 v[180:181], v5 offset:0
    ds_read_b64_tr_b16 v[182:183], v5 offset:2048
    ds_read_b64_tr_b16 v[184:185], v6 offset:0
    ds_read_b64_tr_b16 v[186:187], v6 offset:2048
    ds_read_b64_tr_b16 v[188:189], v7 offset:0
    ds_read_b64_tr_b16 v[190:191], v7 offset:2048
    s_waitcnt lgkmcnt(6)
    v_mfma_f32_16x16x32_bf16 v[16:19], v[176:179], v[96:99], 0
    s_lshl_b32 s31, s40, 12
    s_add_u32 s31, s31, s41
    s_mul_i32 s42, s40, 147456
    s_add_u32 s42, s42, s34
    s_add_u32 s40, s40, 1
    s_cmp_eq_u32 s40, 18
    s_cselect_b32 s40, 0, s40
    buffer_load_dwordx4 v[156:159], v8, s[12:15], s31 offen
    v_mfma_f32_16x16x32_bf16 v[32:35], v[176:179], v[100:103], 0
    buffer_load_dwordx4 v[160:163], v9, s[12:15], s31 offen
    v_mfma_f32_16x16x32_bf16 v[48:51], v[176:179], v[104:107], 0
    buffer_load_dwordx4 v[164:167], v10, s[12:15], s31 offen
    v_mfma_f32_16x16x32_bf16 v[64:67], v[176:179], v[108:111], 0
    buffer_load_dwordx4 v[168:171], v11, s[12:15], s31 offen
    v_mfma_f32_16x16x32_bf16 v[80:83], v[176:179], v[112:115], 0
    buffer_load_dwordx4 v[172:175], v12, s[12:15], s31 offen
    s_waitcnt lgkmcnt(4)
    v_mfma_f32_16x16x32_bf16 v[20:23], v[180:183], v[96:99], 0
    s_add_u32 m0, s33, 12288
    s_add_u32 s30, s42, 0
    buffer_load_dwordx4 v2, s[8:11], s30 offen lds
    v_mfma_f32_16x16x32_bf16 v[36:39], v[180:183], v[100:103], 0
    s_add_u32 m0, s33, 13312
    s_add_u32 s30, s42, 9216
    buffer_load_dwordx4 v2, s[8:11], s30 offen lds
    v_mfma_f32_16x16x32_bf16 v[52:55], v[180:183], v[104:107], 0
    s_add_u32 m0, s33, 14336
    s_add_u32 s30, s42, 18432
    buffer_load_dwordx4 v2, s[8:11], s30 offen lds
    v_mfma_f32_16x16x32_bf16 v[68:71], v[180:183], v[108:111], 0
    s_add_u32 m0, s33, 15360
    s_add_u32 s30, s42, 27648
    buffer_load_dwordx4 v2, s[8:11], s30 offen lds
    v_mfma_f32_16x16x32_bf16 v[84:87], v[180:183], v[112:115], 0
    s_waitcnt vmcnt(18) lgkmcnt(2)
    v_mfma_f32_16x16x32_bf16 v[24:27], v[184:187], v[96:99], 0
    ds_read_b64_tr_b16 v[192:193], v4 offset:4096
    v_mfma_f32_16x16x32_bf16 v[40:43], v[184:187], v[100:103], 0
    ds_read_b64_tr_b16 v[194:195], v4 offset:6144
    v_mfma_f32_16x16x32_bf16 v[56:59], v[184:187], v[104:107], 0
    ds_read_b64_tr_b16 v[196:197], v5 offset:4096
    v_mfma_f32_16x16x32_bf16 v[72:75], v[184:187], v[108:111], 0
    ds_read_b64_tr_b16 v[198:199], v5 offset:6144
    v_mfma_f32_16x16x32_bf16 v[88:91], v[184:187], v[112:115], 0
    ds_read_b64_tr_b16 v[200:201], v6 offset:4096
    s_waitcnt lgkmcnt(5)
    v_mfma_f32_16x16x32_bf16 v[28:31], v[188:191], v[96:99], 0
    ds_read_b64_tr_b16 v[202:203], v6 offset:6144
    v_mfma_f32_16x16x32_bf16 v[44:47], v[188:191], v[100:103], 0
    ds_read_b64_tr_b16 v[204:205], v7 offset:4096
    v_mfma_f32_16x16x32_bf16 v[60:63], v[188:191], v[104:107], 0
    ds_read_b64_tr_b16 v[206:207], v7 offset:6144
    v_mfma_f32_16x16x32_bf16 v[76:79], v[188:191], v[108:111], 0
    v_mfma_f32_16x16x32_bf16 v[92:95], v[188:191], v[112:115], 0
    s_waitcnt lgkmcnt(6)
    v_mfma_f32_16x16x32_bf16 v[16:19], v[192:195], v[116:119], v[16:19]
    s_lshl_b32 s31, s40, 12
    s_add_u32 s31, s31, s41
    s_mul_i32 s42, s40, 147456
    s_add_u32 s42, s42, s34
    s_add_u32 s40, s40, 1
    s_cmp_eq_u32 s40, 18
    s_cselect_b32 s40, 0, s40
    buffer_load_dwordx4 v[96:99], v8, s[12:15], s31 offen
    v_mfma_f32_16x16x32_bf16 v[32:35], v[192:195], v[120:123], v[32:35]
    buffer_load_dwordx4 v[100:103], v9, s[12:15], s31 offen
    v_mfma_f32_16x16x32_bf16 v[48:51], v[192:195], v[124:127], v[48:51]
    buffer_load_dwordx4 v[104:107], v10, s[12:15], s31 offen
    v_mfma_f32_16x16x32_bf16 v[64:67], v[192:195], v[128:131], v[64:67]
    buffer_load_dwordx4 v[108:111], v11, s[12:15], s31 offen
    v_mfma_f32_16x16x32_bf16 v[80:83], v[192:195], v[132:135], v[80:83]
    buffer_load_dwordx4 v[112:115], v12, s[12:15], s31 offen
    s_waitcnt lgkmcnt(4)
    v_mfma_f32_16x16x32_bf16 v[20:23], v[196:199], v[116:119], v[20:23]
    s_add_u32 m0, s33, 0
    s_add_u32 s30, s42, 0
    buffer_load_dwordx4 v2, s[8:11], s30 offen lds
    v_mfma_f32_16x16x32_bf16 v[36:39], v[196:199], v[120:123], v[36:39]
    s_add_u32 m0, s33, 1024
    s_add_u32 s30, s42, 9216
    buffer_load_dwordx4 v2, s[8:11], s30 offen lds
    v_mfma_f32_16x16x32_bf16 v[52:55], v[196:199], v[124:127], v[52:55]
    s_add_u32 m0, s33, 2048
    s_add_u32 s30, s42, 18432
    buffer_load_dwordx4 v2, s[8:11], s30 offen lds
    v_mfma_f32_16x16x32_bf16 v[68:71], v[196:199], v[128:131], v[68:71]
    s_add_u32 m0, s33, 3072
    s_add_u32 s30, s42, 27648
    buffer_load_dwordx4 v2, s[8:11], s30 offen lds
    v_mfma_f32_16x16x32_bf16 v[84:87], v[196:199], v[132:135], v[84:87]
    s_waitcnt vmcnt(18) lgkmcnt(2)
    v_mfma_f32_16x16x32_bf16 v[24:27], v[200:203], v[116:119], v[24:27]
    ds_read_b64_tr_b16 v[176:177], v4 offset:8192
    v_mfma_f32_16x16x32_bf16 v[40:43], v[200:203], v[120:123], v[40:43]
    ds_read_b64_tr_b16 v[178:179], v4 offset:10240
    v_mfma_f32_16x16x32_bf16 v[56:59], v[200:203], v[124:127], v[56:59]
    ds_read_b64_tr_b16 v[180:181], v5 offset:8192
    v_mfma_f32_16x16x32_bf16 v[72:75], v[200:203], v[128:131], v[72:75]
    ds_read_b64_tr_b16 v[182:183], v5 offset:10240
    v_mfma_f32_16x16x32_bf16 v[88:91], v[200:203], v[132:135], v[88:91]
    ds_read_b64_tr_b16 v[184:185], v6 offset:8192
    s_waitcnt lgkmcnt(5)
    v_mfma_f32_16x16x32_bf16 v[28:31], v[204:207], v[116:119], v[28:31]
    ds_read_b64_tr_b16 v[186:187], v6 offset:10240
    v_mfma_f32_16x16x32_bf16 v[44:47], v[204:207], v[120:123], v[44:47]
    ds_read_b64_tr_b16 v[188:189], v7 offset:8192
    v_mfma_f32_16x16x32_bf16 v[60:63], v[204:207], v[124:127], v[60:63]
    ds_read_b64_tr_b16 v[190:191], v7 offset:10240
    v_mfma_f32_16x16x32_bf16 v[76:79], v[204:207], v[128:131], v[76:79]
    v_mfma_f32_16x16x32_bf16 v[92:95], v[204:207], v[132:135], v[92:95]
    s_waitcnt lgkmcnt(6)
    v_mfma_f32_16x16x32_bf16 v[16:19], v[176:179], v[136:139], v[16:19]
    s_lshl_b32 s31, s40, 12
    s_add_u32 s31, s31, s41
    s_mul_i32 s42, s40, 147456
    s_add_u32 s42, s42, s34
    s_add_u32 s40, s40, 1
    s_cmp_eq_u32 s40, 18
    s_cselect_b32 s40, 0, s40
    buffer_load_dwordx4 v[116:119], v8, s[12:15], s31 offen
    v_mfma_f32_16x16x32_bf16 v[32:35], v[176:179], v[140:143], v[32:35]
    buffer_load_dwordx4 v[120:123], v9, s[12:15], s31 offen
    v_mfma_f32_16x16x32_bf16 v[48:51], v[176:179], v[144:147], v[48:51]
    buffer_load_dwordx4 v[124:127], v10, s[12:15], s31 offen
    v_mfma_f32_16x16x32_bf16 v[64:67], v[176:179], v[148:151], v[64:67]
    buffer_load_dwordx4 v[128:131], v11, s[12:15], s31 offen
    v_mfma_f32_16x16x32_bf16 v[80:83], v[176:179], v[152:155], v[80:83]
    buffer_load_dwordx4 v[132:135], v12, s[12:15], s31 offen
    s_waitcnt lgkmcnt(4)
    v_mfma_f32_16x16x32_bf16 v[20:23], v[180:183], v[136:139], v[20:23]
    s_add_u32 m0, s33, 4096
    s_add_u32 s30, s42, 0
    buffer_load_dwordx4 v2, s[8:11], s30 offen lds
    v_mfma_f32_16x16x32_bf16 v[36:39], v[180:183], v[140:143], v[36:39]
    s_add_u32 m0, s33, 5120
    s_add_u32 s30, s42, 9216
    buffer_load_dwordx4 v2, s[8:11], s30 offen lds
    v_mfma_f32_16x16x32_bf16 v[52:55], v[180:183], v[144:147], v[52:55]
    s_add_u32 m0, s33, 6144
    s_add_u32 s30, s42, 18432
    buffer_load_dwordx4 v2, s[8:11], s30 offen lds
    v_mfma_f32_16x16x32_bf16 v[68:71], v[180:183], v[148:151], v[68:71]
    s_add_u32 m0, s33, 7168
    s_add_u32 s30, s42, 27648
    buffer_load_dwordx4 v2, s[8:11], s30 offen lds
    v_mfma_f32_16x16x32_bf16 v[84:87], v[180:183], v[152:155], v[84:87]
    s_waitcnt vmcnt(18) lgkmcnt(2)
    v_mfma_f32_16x16x32_bf16 v[24:27], v[184:187], v[136:139], v[24:27]
    ds_read_b64_tr_b16 v[192:193], v4 offset:12288
    v_mfma_f32_16x16x32_bf16 v[40:43], v[184:187], v[140:143], v[40:43]
    ds_read_b64_tr_b16 v[194:195], v4 offset:14336
    v_mfma_f32_16x16x32_bf16 v[56:59], v[184:187], v[144:147], v[56:59]
    ds_read_b64_tr_b16 v[196:197], v5 offset:12288
    v_mfma_f32_16x16x32_bf16 v[72:75], v[184:187], v[148:151], v[72:75]
    ds_read_b64_tr_b16 v[198:199], v5 offset:14336
    v_mfma_f32_16x16x32_bf16 v[88:91], v[184:187], v[152:155], v[88:91]
    ds_read_b64_tr_b16 v[200:201], v6 offset:12288
    s_waitcnt lgkmcnt(5)
    v_mfma_f32_16x16x32_bf16 v[28:31], v[188:191], v[136:139], v[28:31]
    ds_read_b64_tr_b16 v[202:203], v6 offset:14336
    v_mfma_f32_16x16x32_bf16 v[44:47], v[188:191], v[140:143], v[44:47]
    ds_read_b64_tr_b16 v[204:205], v7 offset:12288
    v_mfma_f32_16x16x32_bf16 v[60:63], v[188:191], v[144:147], v[60:63]
    ds_read_b64_tr_b16 v[206:207], v7 offset:14336
    v_mfma_f32_16x16x32_bf16 v[76:79], v[188:191], v[148:151], v[76:79]
    v_mfma_f32_16x16x32_bf16 v[92:95], v[188:191], v[152:155], v[92:95]
    s_waitcnt lgkmcnt(6)
    v_mfma_f32_16x16x32_bf16 v[16:19], v[192:195], v[156:159], v[16:19]
    s_lshl_b32 s31, s40, 12
    s_add_u32 s31, s31, s41
    s_mul_i32 s42, s40, 147456
    s_add_u32 s42, s42, s34
    s_add_u32 s40, s40, 1
    s_cmp_eq_u32 s40, 18
    s_cselect_b32 s40, 0, s40
    buffer_load_dwordx4 v[136:139], v8, s[12:15], s31 offen
    v_mfma_f32_16x16x32_bf16 v[32:35], v[192:195], v[160:163], v[32:35]
    buffer_load_dwordx4 v[140:143], v9, s[12:15], s31 offen
    v_mfma_f32_16x16x32_bf16 v[48:51], v[192:195], v[164:167], v[48:51]
    buffer_load_dwordx4 v[144:147], v10, s[12:15], s31 offen
    v_mfma_f32_16x16x32_bf16 v[64:67], v[192:195], v[168:171], v[64:67]
    buffer_load_dwordx4 v[148:151], v11, s[12:15], s31 offen
    v_mfma_f32_16x16x32_bf16 v[80:83], v[192:195], v[172:175], v[80:83]
    buffer_load_dwordx4 v[152:155], v12, s[12:15], s31 offen
    s_waitcnt lgkmcnt(4)
    v_mfma_f32_16x16x32_bf16 v[20:23], v[196:199], v[156:159], v[20:23]
    s_add_u32 m0, s33, 8192
    s_add_u32 s30, s42, 0
    buffer_load_dwordx4 v2, s[8:11], s30 offen lds
    v_mfma_f32_16x16x32_bf16 v[36:39], v[196:199], v[160:163], v[36:39]
    s_add_u32 m0, s33, 9216
    s_add_u32 s30, s42, 9216
    buffer_load_dwordx4 v2, s[8:11], s30 offen lds
    v_mfma_f32_16x16x32_bf16 v[52:55], v[196:199], v[164:167], v[52:55]
    s_add_u32 m0, s33, 10240
    s_add_u32 s30, s42, 18432
    buffer_load_dwordx4 v2, s[8:11], s30 offen lds
    v_mfma_f32_16x16x32_bf16 v[68:71], v[196:199], v[168:171], v[68:71]
    s_add_u32 m0, s33, 11264
    s_add_u32 s30, s42, 27648
    buffer_load_dwordx4 v2, s[8:11], s30 offen lds
    v_mfma_f32_16x16x32_bf16 v[84:87], v[196:199], v[172:175], v[84:87]
    s_waitcnt vmcnt(18) lgkmcnt(2)
    v_mfma_f32_16x16x32_bf16 v[24:27], v[200:203], v[156:159], v[24:27]
    ds_read_b64_tr_b16 v[176:177], v4 offset:0
    v_mfma_f32_16x16x32_bf16 v[40:43], v[200:203], v[160:163], v[40:43]
    ds_read_b64_tr_b16 v[178:179], v4 offset:2048
    v_mfma_f32_16x16x32_bf16 v[56:59], v[200:203], v[164:167], v[56:59]
    ds_read_b64_tr_b16 v[180:181], v5 offset:0
    v_mfma_f32_16x16x32_bf16 v[72:75], v[200:203], v[168:171], v[72:75]
    ds_read_b64_tr_b16 v[182:183], v5 offset:2048
    v_mfma_f32_16x16x32_bf16 v[88:91], v[200:203], v[172:175], v[88:91]
    ds_read_b64_tr_b16 v[184:185], v6 offset:0
    s_waitcnt lgkmcnt(5)
    v_mfma_f32_16x16x32_bf16 v[28:31], v[204:207], v[156:159], v[28:31]
    ds_read_b64_tr_b16 v[186:187], v6 offset:2048
    v_mfma_f32_16x16x32_bf16 v[44:47], v[204:207], v[160:163], v[44:47]
    ds_read_b64_tr_b16 v[188:189], v7 offset:0
    v_mfma_f32_16x16x32_bf16 v[60:63], v[204:207], v[164:167], v[60:63]
    ds_read_b64_tr_b16 v[190:191], v7 offset:2048
    v_mfma_f32_16x16x32_bf16 v[76:79], v[204:207], v[168:171], v[76:79]
    v_mfma_f32_16x16x32_bf16 v[92:95], v[204:207], v[172:175], v[92:95]
    s_waitcnt lgkmcnt(6)
    v_mfma_f32_16x16x32_bf16 v[16:19], v[176:179], v[96:99], v[16:19]
    s_lshl_b32 s31, s40, 12
    s_add_u32 s31, s31, s41
    s_mul_i32 s42, s40, 147456
    s_add_u32 s42, s42, s34
    s_add_u32 s40, s40, 1
    s_cmp_eq_u32 s40, 18
    s_cselect_b32 s40, 0, s40
    buffer_load_dwordx4 v[156:159], v8, s[12:15], s31 offen
    v_mfma_f32_16x16x32_bf16 v[32:35], v[176:179], v[100:103], v[32:35]
    buffer_load_dwordx4 v[160:163], v9, s[12:15], s31 offen
    v_mfma_f32_16x16x32_bf16 v[48:51], v[176:179], v[104:107], v[48:51]
    buffer_load_dwordx4 v[164:167], v10, s[12:15], s31 offen
    v_mfma_f32_16x16x32_bf16 v[64:67], v[176:179], v[108:111], v[64:67]
    buffer_load_dwordx4 v[168:171], v11, s[12:15], s31 offen
    v_mfma_f32_16x16x32_bf16 v[80:83], v[176:179], v[112:115], v[80:83]
    buffer_load_dwordx4 v[172:175], v12, s[12:15], s31 offen
    s_waitcnt lgkmcnt(4)
    v_mfma_f32_16x16x32_bf16 v[20:23], v[180:183], v[96:99], v[20:23]
    s_add_u32 m0, s33, 12288
    s_add_u32 s30, s42, 0
    buffer_load_dwordx4 v2, s[8:11], s30 offen lds
    v_mfma_f32_16x16x32_bf16 v[36:39], v[180:183], v[100:103], v[36:39]
    s_add_u32 m0, s33, 13312
    s_add_u32 s30, s42, 9216
    buffer_load_dwordx4 v2, s[8:11], s30 offen lds
    v_mfma_f32_16x16x32_bf16 v[52:55], v[180:183], v[104:107], v[52:55]
    s_add_u32 m0, s33, 14336
    s_add_u32 s30, s42, 18432
    buffer_load_dwordx4 v2, s[8:11], s30 offen lds
    v_mfma_f32_16x16x32_bf16 v[68:71], v[180:183], v[108:111], v[68:71]
    s_add_u32 m0, s33, 15360
    s_add_u32 s30, s42, 27648
    buffer_load_dwordx4 v2, s[8:11], s30 offen lds
    v_mfma_f32_16x16x32_bf16 v[84:87], v[180:183], v[112:115], v[84:87]
    s_waitcnt vmcnt(18) lgkmcnt(2)
    v_mfma_f32_16x16x32_bf16 v[24:27], v[184:187], v[96:99], v[24:27]
    ds_read_b64_tr_b16 v[192:193], v4 offset:4096
    v_mfma_f32_16x16x32_bf16 v[40:43], v[184:187], v[100:103], v[40:43]
    ds_read_b64_tr_b16 v[194:195], v4 offset:6144
    v_mfma_f32_16x16x32_bf16 v[56:59], v[184:187], v[104:107], v[56:59]
    ds_read_b64_tr_b16 v[196:197], v5 offset:4096
    v_mfma_f32_16x16x32_bf16 v[72:75], v[184:187], v[108:111], v[72:75]
    ds_read_b64_tr_b16 v[198:199], v5 offset:6144
    v_mfma_f32_16x16x32_bf16 v[88:91], v[184:187], v[112:115], v[88:91]
    ds_read_b64_tr_b16 v[200:201], v6 offset:4096
    s_waitcnt lgkmcnt(5)
    v_mfma_f32_16x16x32_bf16 v[28:31], v[188:191], v[96:99], v[28:31]
    ds_read_b64_tr_b16 v[202:203], v6 offset:6144
    v_mfma_f32_16x16x32_bf16 v[44:47], v[188:191], v[100:103], v[44:47]
    ds_read_b64_tr_b16 v[204:205], v7 offset:4096
    v_mfma_f32_16x16x32_bf16 v[60:63], v[188:191], v[104:107], v[60:63]
    ds_read_b64_tr_b16 v[206:207], v7 offset:6144
    v_mfma_f32_16x16x32_bf16 v[76:79], v[188:191], v[108:111], v[76:79]
    v_mfma_f32_16x16x32_bf16 v[92:95], v[188:191], v[112:115], v[92:95]
    s_waitcnt lgkmcnt(6)
    v_mfma_f32_16x16x32_bf16 v[16:19], v[192:195], v[116:119], v[16:19]
    s_lshl_b32 s31, s40, 12
    s_add_u32 s31, s31, s41
    s_mul_i32 s42, s40, 147456
    s_add_u32 s42, s42, s34
    s_add_u32 s40, s40, 1
    s_cmp_eq_u32 s40, 18
    s_cselect_b32 s40, 0, s40
    buffer_load_dwordx4 v[96:99], v8, s[12:15], s31 offen
    v_mfma_f32_16x16x32_bf16 v[32:35], v[192:195], v[120:123], v[32:35]
    buffer_load_dwordx4 v[100:103], v9, s[12:15], s31 offen
    v_mfma_f32_16x16x32_bf16 v[48:51], v[192:195], v[124:127], v[48:51]
    buffer_load_dwordx4 v[104:107], v10, s[12:15], s31 offen
    v_mfma_f32_16x16x32_bf16 v[64:67], v[192:195], v[128:131], v[64:67]
    buffer_load_dwordx4 v[108:111], v11, s[12:15], s31 offen
    v_mfma_f32_16x16x32_bf16 v[80:83], v[192:195], v[132:135], v[80:83]
    buffer_load_dwordx4 v[112:115], v12, s[12:15], s31 offen
    s_waitcnt lgkmcnt(4)
    v_mfma_f32_16x16x32_bf16 v[20:23], v[196:199], v[116:119], v[20:23]
    s_add_u32 m0, s33, 0
    s_add_u32 s30, s42, 0
    buffer_load_dwordx4 v2, s[8:11], s30 offen lds
    v_mfma_f32_16x16x32_bf16 v[36:39], v[196:199], v[120:123], v[36:39]
    s_add_u32 m0, s33, 1024
    s_add_u32 s30, s42, 9216
    buffer_load_dwordx4 v2, s[8:11], s30 offen lds
    v_mfma_f32_16x16x32_bf16 v[52:55], v[196:199], v[124:127], v[52:55]
    s_add_u32 m0, s33, 2048
    s_add_u32 s30, s42, 18432
    buffer_load_dwordx4 v2, s[8:11], s30 offen lds
    v_mfma_f32_16x16x32_bf16 v[68:71], v[196:199], v[128:131], v[68:71]
    s_add_u32 m0, s33, 3072
    s_add_u32 s30, s42, 27648
    buffer_load_dwordx4 v2, s[8:11], s30 offen lds
    v_mfma_f32_16x16x32_bf16 v[84:87], v[196:199], v[132:135], v[84:87]
    s_waitcnt vmcnt(18) lgkmcnt(2)
    v_mfma_f32_16x16x32_bf16 v[24:27], v[200:203], v[116:119], v[24:27]
    ds_read_b64_tr_b16 v[176:177], v4 offset:8192
    v_mfma_f32_16x16x32_bf16 v[40:43], v[200:203], v[120:123], v[40:43]
    ds_read_b64_tr_b16 v[178:179], v4 offset:10240
    v_mfma_f32_16x16x32_bf16 v[56:59], v[200:203], v[124:127], v[56:59]
    ds_read_b64_tr_b16 v[180:181], v5 offset:8192
    v_mfma_f32_16x16x32_bf16 v[72:75], v[200:203], v[128:131], v[72:75]
    ds_read_b64_tr_b16 v[182:183], v5 offset:10240
    v_mfma_f32_16x16x32_bf16 v[88:91], v[200:203], v[132:135], v[88:91]
    ds_read_b64_tr_b16 v[184:185], v6 offset:8192
    s_waitcnt lgkmcnt(5)
    v_mfma_f32_16x16x32_bf16 v[28:31], v[204:207], v[116:119], v[28:31]
    ds_read_b64_tr_b16 v[186:187], v6 offset:10240
    v_mfma_f32_16x16x32_bf16 v[44:47], v[204:207], v[120:123], v[44:47]
    ds_read_b64_tr_b16 v[188:189], v7 offset:8192
    v_mfma_f32_16x16x32_bf16 v[60:63], v[204:207], v[124:127], v[60:63]
    ds_read_b64_tr_b16 v[190:191], v7 offset:10240
    v_mfma_f32_16x16x32_bf16 v[76:79], v[204:207], v[128:131], v[76:79]
    v_mfma_f32_16x16x32_bf16 v[92:95], v[204:207], v[132:135], v[92:95]
    s_waitcnt lgkmcnt(6)
    v_mfma_f32_16x16x32_bf16 v[16:19], v[176:179], v[136:139], v[16:19]
    s_lshl_b32 s31, s40, 12
    s_add_u32 s31, s31, s41
    s_mul_i32 s42, s40, 147456
    s_add_u32 s42, s42, s34
    s_add_u32 s40, s40, 1
    s_cmp_eq_u32 s40, 18
    s_cselect_b32 s40, 0, s40
    buffer_load_dwordx4 v[116:119], v8, s[12:15], s31 offen
    v_mfma_f32_16x16x32_bf16 v[32:35], v[176:179], v[140:143], v[32:35]
    buffer_load_dwordx4 v[120:123], v9, s[12:15], s31 offen
    v_mfma_f32_16x16x32_bf16 v[48:51], v[176:179], v[144:147], v[48:51]
    buffer_load_dwordx4 v[124:127], v10, s[12:15], s31 offen
    v_mfma_f32_16x16x32_bf16 v[64:67], v[176:179], v[148:151], v[64:67]
    buffer_load_dwordx4 v[128:131], v11, s[12:15], s31 offen
    v_mfma_f32_16x16x32_bf16 v[80:83], v[176:179], v[152:155], v[80:83]
    buffer_load_dwordx4 v[132:135], v12, s[12:15], s31 offen
    s_waitcnt lgkmcnt(4)
    v_mfma_f32_16x16x32_bf16 v[20:23], v[180:183], v[136:139], v[20:23]
    s_add_u32 m0, s33, 4096
    s_add_u32 s30, s42, 0
    buffer_load_dwordx4 v2, s[8:11], s30 offen lds
    v_mfma_f32_16x16x32_bf16 v[36:39], v[180:183], v[140:143], v[36:39]
    s_add_u32 m0, s33, 5120
    s_add_u32 s30, s42, 9216
    buffer_load_dwordx4 v2, s[8:11], s30 offen lds
    v_mfma_f32_16x16x32_bf16 v[52:55], v[180:183], v[144:147], v[52:55]
    s_add_u32 m0, s33, 6144
    s_add_u32 s30, s42, 18432
    buffer_load_dwordx4 v2, s[8:11], s30 offen lds
    v_mfma_f32_16x16x32_bf16 v[68:71], v[180:183], v[148:151], v[68:71]
    s_add_u32 m0, s33, 7168
    s_add_u32 s30, s42, 27648
    buffer_load_dwordx4 v2, s[8:11], s30 offen lds
    v_mfma_f32_16x16x32_bf16 v[84:87], v[180:183], v[152:155], v[84:87]
    s_waitcnt vmcnt(18) lgkmcnt(2)
    v_mfma_f32_16x16x32_bf16 v[24:27], v[184:187], v[136:139], v[24:27]
    ds_read_b64_tr_b16 v[192:193], v4 offset:12288
    v_mfma_f32_16x16x32_bf16 v[40:43], v[184:187], v[140:143], v[40:43]
    ds_read_b64_tr_b16 v[194:195], v4 offset:14336
    v_mfma_f32_16x16x32_bf16 v[56:59], v[184:187], v[144:147], v[56:59]
    ds_read_b64_tr_b16 v[196:197], v5 offset:12288
    v_mfma_f32_16x16x32_bf16 v[72:75], v[184:187], v[148:151], v[72:75]
    ds_read_b64_tr_b16 v[198:199], v5 offset:14336
    v_mfma_f32_16x16x32_bf16 v[88:91], v[184:187], v[152:155], v[88:91]
    ds_read_b64_tr_b16 v[200:201], v6 offset:12288
    s_waitcnt lgkmcnt(5)
    v_mfma_f32_16x16x32_bf16 v[28:31], v[188:191], v[136:139], v[28:31]
    ds_read_b64_tr_b16 v[202:203], v6 offset:14336
    v_mfma_f32_16x16x32_bf16 v[44:47], v[188:191], v[140:143], v[44:47]
    ds_read_b64_tr_b16 v[204:205], v7 offset:12288
    v_mfma_f32_16x16x32_bf16 v[60:63], v[188:191], v[144:147], v[60:63]
    ds_read_b64_tr_b16 v[206:207], v7 offset:14336
    v_mfma_f32_16x16x32_bf16 v[76:79], v[188:191], v[148:151], v[76:79]
    v_mfma_f32_16x16x32_bf16 v[92:95], v[188:191], v[152:155], v[92:95]
    s_waitcnt lgkmcnt(6)
    v_mfma_f32_16x16x32_bf16 v[16:19], v[192:195], v[156:159], v[16:19]
    s_lshl_b32 s31, s40, 12
    s_add_u32 s31, s31, s41
    s_mul_i32 s42, s40, 147456
    s_add_u32 s42, s42, s34
    s_add_u32 s40, s40, 1
    s_cmp_eq_u32 s40, 18
    s_cselect_b32 s40, 0, s40
    buffer_load_dwordx4 v[136:139], v8, s[12:15], s31 offen
    v_mfma_f32_16x16x32_bf16 v[32:35], v[192:195], v[160:163], v[32:35]
    buffer_load_dwordx4 v[140:143], v9, s[12:15], s31 offen
    v_mfma_f32_16x16x32_bf16 v[48:51], v[192:195], v[164:167], v[48:51]
    buffer_load_dwordx4 v[144:147], v10, s[12:15], s31 offen
    v_mfma_f32_16x16x32_bf16 v[64:67], v[192:195], v[168:171], v[64:67]
    buffer_load_dwordx4 v[148:151], v11, s[12:15], s31 offen
    v_mfma_f32_16x16x32_bf16 v[80:83], v[192:195], v[172:175], v[80:83]
    buffer_load_dwordx4 v[152:155], v12, s[12:15], s31 offen
    s_waitcnt lgkmcnt(4)
    v_mfma_f32_16x16x32_bf16 v[20:23], v[196:199], v[156:159], v[20:23]
    s_add_u32 m0, s33, 8192
    s_add_u32 s30, s42, 0
    buffer_load_dwordx4 v2, s[8:11], s30 offen lds
    v_mfma_f32_16x16x32_bf16 v[36:39], v[196:199], v[160:163], v[36:39]
    s_add_u32 m0, s33, 9216
    s_add_u32 s30, s42, 9216
    buffer_load_dwordx4 v2, s[8:11], s30 offen lds
    v_mfma_f32_16x16x32_bf16 v[52:55], v[196:199], v[164:167], v[52:55]
    s_add_u32 m0, s33, 10240
    s_add_u32 s30, s42, 18432
    buffer_load_dwordx4 v2, s[8:11], s30 offen lds
    v_mfma_f32_16x16x32_bf16 v[68:71], v[196:199], v[168:171], v[68:71]
    s_add_u32 m0, s33, 11264
    s_add_u32 s30, s42, 27648
    buffer_load_dwordx4 v2, s[8:11], s30 offen lds
    v_mfma_f32_16x16x32_bf16 v[84:87], v[196:199], v[172:175], v[84:87]
    s_waitcnt vmcnt(18) lgkmcnt(2)
    v_mfma_f32_16x16x32_bf16 v[24:27], v[200:203], v[156:159], v[24:27]
    ds_read_b64_tr_b16 v[176:177], v4 offset:0
    v_mfma_f32_16x16x32_bf16 v[40:43], v[200:203], v[160:163], v[40:43]
    ds_read_b64_tr_b16 v[178:179], v4 offset:2048
    v_mfma_f32_16x16x32_bf16 v[56:59], v[200:203], v[164:167], v[56:59]
    ds_read_b64_tr_b16 v[180:181], v5 offset:0
    v_mfma_f32_16x16x32_bf16 v[72:75], v[200:203], v[168:171], v[72:75]
    ds_read_b64_tr_b16 v[182:183], v5 offset:2048
    v_mfma_f32_16x16x32_bf16 v[88:91], v[200:203], v[172:175], v[88:91]
    ds_read_b64_tr_b16 v[184:185], v6 offset:0
    s_waitcnt lgkmcnt(5)
    v_mfma_f32_16x16x32_bf16 v[28:31], v[204:207], v[156:159], v[28:31]
    ds_read_b64_tr_b16 v[186:187], v6 offset:2048
    v_mfma_f32_16x16x32_bf16 v[44:47], v[204:207], v[160:163], v[44:47]
    ds_read_b64_tr_b16 v[188:189], v7 offset:0
    v_mfma_f32_16x16x32_bf16 v[60:63], v[204:207], v[164:167], v[60:63]
    ds_read_b64_tr_b16 v[190:191], v7 offset:2048
    v_mfma_f32_16x16x32_bf16 v[76:79], v[204:207], v[168:171], v[76:79]
    v_mfma_f32_16x16x32_bf16 v[92:95], v[204:207], v[172:175], v[92:95]
    s_waitcnt lgkmcnt(6)
    v_mfma_f32_16x16x32_bf16 v[16:19], v[176:179], v[96:99], v[16:19]
    s_lshl_b32 s31, s40, 12
    s_add_u32 s31, s31, s41
    s_mul_i32 s42, s40, 147456
    s_add_u32 s42, s42, s34
    s_add_u32 s40, s40, 1
    s_cmp_eq_u32 s40, 18
    s_cselect_b32 s40, 0, s40
    buffer_load_dwordx4 v[156:159], v8, s[12:15], s31 offen
    v_mfma_f32_16x16x32_bf16 v[32:35], v[176:179], v[100:103], v[32:35]
    buffer_load_dwordx4 v[160:163], v9, s[12:15], s31 offen
    v_mfma_f32_16x16x32_bf16 v[48:51], v[176:179], v[104:107], v[48:51]
    buffer_load_dwordx4 v[164:167], v10, s[12:15], s31 offen
    v_mfma_f32_16x16x32_bf16 v[64:67], v[176:179], v[108:111], v[64:67]
    buffer_load_dwordx4 v[168:171], v11, s[12:15], s31 offen
    v_mfma_f32_16x16x32_bf16 v[80:83], v[176:179], v[112:115], v[80:83]
    buffer_load_dwordx4 v[172:175], v12, s[12:15], s31 offen
    s_waitcnt lgkmcnt(4)
    v_mfma_f32_16x16x32_bf16 v[20:23], v[180:183], v[96:99], v[20:23]
    s_add_u32 m0, s33, 12288
    s_add_u32 s30, s42, 0
    buffer_load_dwordx4 v2, s[8:11], s30 offen lds
    v_mfma_f32_16x16x32_bf16 v[36:39], v[180:183], v[100:103], v[36:39]
    s_add_u32 m0, s33, 13312
    s_add_u32 s30, s42, 9216
    buffer_load_dwordx4 v2, s[8:11], s30 offen lds
    v_mfma_f32_16x16x32_bf16 v[52:55], v[180:183], v[104:107], v[52:55]
    s_add_u32 m0, s33, 14336
    s_add_u32 s30, s42, 18432
    buffer_load_dwordx4 v2, s[8:11], s30 offen lds
    v_mfma_f32_16x16x32_bf16 v[68:71], v[180:183], v[108:111], v[68:71]
    s_add_u32 m0, s33, 15360
    s_add_u32 s30, s42, 27648
    buffer_load_dwordx4 v2, s[8:11], s30 offen lds
    v_mfma_f32_16x16x32_bf16 v[84:87], v[180:183], v[112:115], v[84:87]
    s_waitcnt vmcnt(18) lgkmcnt(2)
    v_mfma_f32_16x16x32_bf16 v[24:27], v[184:187], v[96:99], v[24:27]
    ds_read_b64_tr_b16 v[192:193], v4 offset:4096
    v_mfma_f32_16x16x32_bf16 v[40:43], v[184:187], v[100:103], v[40:43]
    ds_read_b64_tr_b16 v[194:195], v4 offset:6144
    v_mfma_f32_16x16x32_bf16 v[56:59], v[184:187], v[104:107], v[56:59]
    ds_read_b64_tr_b16 v[196:197], v5 offset:4096
    v_mfma_f32_16x16x32_bf16 v[72:75], v[184:187], v[108:111], v[72:75]
    ds_read_b64_tr_b16 v[198:199], v5 offset:6144
    v_mfma_f32_16x16x32_bf16 v[88:91], v[184:187], v[112:115], v[88:91]
    ds_read_b64_tr_b16 v[200:201], v6 offset:4096
    s_waitcnt lgkmcnt(5)
    v_mfma_f32_16x16x32_bf16 v[28:31], v[188:191], v[96:99], v[28:31]
    ds_read_b64_tr_b16 v[202:203], v6 offset:6144
    v_mfma_f32_16x16x32_bf16 v[44:47], v[188:191], v[100:103], v[44:47]
    ds_read_b64_tr_b16 v[204:205], v7 offset:4096
    v_mfma_f32_16x16x32_bf16 v[60:63], v[188:191], v[104:107], v[60:63]
    ds_read_b64_tr_b16 v[206:207], v7 offset:6144
    v_mfma_f32_16x16x32_bf16 v[76:79], v[188:191], v[108:111], v[76:79]
    v_mfma_f32_16x16x32_bf16 v[92:95], v[188:191], v[112:115], v[92:95]
    s_waitcnt lgkmcnt(6)
    v_mfma_f32_16x16x32_bf16 v[16:19], v[192:195], v[116:119], v[16:19]
    s_lshl_b32 s31, s40, 12
    s_add_u32 s31, s31, s41
    s_mul_i32 s42, s40, 147456
    s_add_u32 s42, s42, s34
    s_add_u32 s40, s40, 1
    s_cmp_eq_u32 s40, 18
    s_cselect_b32 s40, 0, s40
    buffer_load_dwordx4 v[96:99], v8, s[12:15], s31 offen
    v_mfma_f32_16x16x32_bf16 v[32:35], v[192:195], v[120:123], v[32:35]
    buffer_load_dwordx4 v[100:103], v9, s[12:15], s31 offen
    v_mfma_f32_16x16x32_bf16 v[48:51], v[192:195], v[124:127], v[48:51]
    buffer_load_dwordx4 v[104:107], v10, s[12:15], s31 offen
    v_mfma_f32_16x16x32_bf16 v[64:67], v[192:195], v[128:131], v[64:67]
    buffer_load_dwordx4 v[108:111], v11, s[12:15], s31 offen
    v_mfma_f32_16x16x32_bf16 v[80:83], v[192:195], v[132:135], v[80:83]
    buffer_load_dwordx4 v[112:115], v12, s[12:15], s31 offen
    s_waitcnt lgkmcnt(4)
    v_mfma_f32_16x16x32_bf16 v[20:23], v[196:199], v[116:119], v[20:23]
    s_add_u32 m0, s33, 0
    s_add_u32 s30, s42, 0
    buffer_load_dwordx4 v2, s[8:11], s30 offen lds
    v_mfma_f32_16x16x32_bf16 v[36:39], v[196:199], v[120:123], v[36:39]
    s_add_u32 m0, s33, 1024
    s_add_u32 s30, s42, 9216
    buffer_load_dwordx4 v2, s[8:11], s30 offen lds
    v_mfma_f32_16x16x32_bf16 v[52:55], v[196:199], v[124:127], v[52:55]
    s_add_u32 m0, s33, 2048
    s_add_u32 s30, s42, 18432
    buffer_load_dwordx4 v2, s[8:11], s30 offen lds
    v_mfma_f32_16x16x32_bf16 v[68:71], v[196:199], v[128:131], v[68:71]
    s_add_u32 m0, s33, 3072
    s_add_u32 s30, s42, 27648
    buffer_load_dwordx4 v2, s[8:11], s30 offen lds
    v_mfma_f32_16x16x32_bf16 v[84:87], v[196:199], v[132:135], v[84:87]
    s_waitcnt vmcnt(18) lgkmcnt(2)
    v_mfma_f32_16x16x32_bf16 v[24:27], v[200:203], v[116:119], v[24:27]
    ds_read_b64_tr_b16 v[176:177], v4 offset:8192
    v_mfma_f32_16x16x32_bf16 v[40:43], v[200:203], v[120:123], v[40:43]
    ds_read_b64_tr_b16 v[178:179], v4 offset:10240
    v_mfma_f32_16x16x32_bf16 v[56:59], v[200:203], v[124:127], v[56:59]
    ds_read_b64_tr_b16 v[180:181], v5 offset:8192
    v_mfma_f32_16x16x32_bf16 v[72:75], v[200:203], v[128:131], v[72:75]
    ds_read_b64_tr_b16 v[182:183], v5 offset:10240
    v_mfma_f32_16x16x32_bf16 v[88:91], v[200:203], v[132:135], v[88:91]
    ds_read_b64_tr_b16 v[184:185], v6 offset:8192
    s_waitcnt lgkmcnt(5)
    v_mfma_f32_16x16x32_bf16 v[28:31], v[204:207], v[116:119], v[28:31]
    ds_read_b64_tr_b16 v[186:187], v6 offset:10240
    v_mfma_f32_16x16x32_bf16 v[44:47], v[204:207], v[120:123], v[44:47]
    ds_read_b64_tr_b16 v[188:189], v7 offset:8192
    v_mfma_f32_16x16x32_bf16 v[60:63], v[204:207], v[124:127], v[60:63]
    ds_read_b64_tr_b16 v[190:191], v7 offset:10240
    v_mfma_f32_16x16x32_bf16 v[76:79], v[204:207], v[128:131], v[76:79]
    v_mfma_f32_16x16x32_bf16 v[92:95], v[204:207], v[132:135], v[92:95]
    s_waitcnt lgkmcnt(6)
    v_mfma_f32_16x16x32_bf16 v[16:19], v[176:179], v[136:139], v[16:19]
    s_lshl_b32 s31, s40, 12
    s_add_u32 s31, s31, s41
    s_mul_i32 s42, s40, 147456
    s_add_u32 s42, s42, s34
    s_add_u32 s40, s40, 1
    s_cmp_eq_u32 s40, 18
    s_cselect_b32 s40, 0, s40
    buffer_load_dwordx4 v[116:119], v8, s[12:15], s31 offen
    v_mfma_f32_16x16x32_bf16 v[32:35], v[176:179], v[140:143], v[32:35]
    buffer_load_dwordx4 v[120:123], v9, s[12:15], s31 offen
    v_mfma_f32_16x16x32_bf16 v[48:51], v[176:179], v[144:147], v[48:51]
    buffer_load_dwordx4 v[124:127], v10, s[12:15], s31 offen
    v_mfma_f32_16x16x32_bf16 v[64:67], v[176:179], v[148:151], v[64:67]
    buffer_load_dwordx4 v[128:131], v11, s[12:15], s31 offen
    v_mfma_f32_16x16x32_bf16 v[80:83], v[176:179], v[152:155], v[80:83]
    buffer_load_dwordx4 v[132:135], v12, s[12:15], s31 offen
    s_waitcnt lgkmcnt(4)
    v_mfma_f32_16x16x32_bf16 v[20:23], v[180:183], v[136:139], v[20:23]
    s_add_u32 m0, s33, 4096
    s_add_u32 s30, s42, 0
    buffer_load_dwordx4 v2, s[8:11], s30 offen lds
    v_mfma_f32_16x16x32_bf16 v[36:39], v[180:183], v[140:143], v[36:39]
    s_add_u32 m0, s33, 5120
    s_add_u32 s30, s42, 9216
    buffer_load_dwordx4 v2, s[8:11], s30 offen lds
    v_mfma_f32_16x16x32_bf16 v[52:55], v[180:183], v[144:147], v[52:55]
    s_add_u32 m0, s33, 6144
    s_add_u32 s30, s42, 18432
    buffer_load_dwordx4 v2, s[8:11], s30 offen lds
    v_mfma_f32_16x16x32_bf16 v[68:71], v[180:183], v[148:151], v[68:71]
    s_add_u32 m0, s33, 7168
    s_add_u32 s30, s42, 27648
    buffer_load_dwordx4 v2, s[8:11], s30 offen lds
    v_mfma_f32_16x16x32_bf16 v[84:87], v[180:183], v[152:155], v[84:87]
    s_waitcnt vmcnt(18) lgkmcnt(2)
    v_mfma_f32_16x16x32_bf16 v[24:27], v[184:187], v[136:139], v[24:27]
    ds_read_b64_tr_b16 v[192:193], v4 offset:12288
    v_mfma_f32_16x16x32_bf16 v[40:43], v[184:187], v[140:143], v[40:43]
    ds_read_b64_tr_b16 v[194:195], v4 offset:14336
    v_mfma_f32_16x16x32_bf16 v[56:59], v[184:187], v[144:147], v[56:59]
    ds_read_b64_tr_b16 v[196:197], v5 offset:12288
    v_mfma_f32_16x16x32_bf16 v[72:75], v[184:187], v[148:151], v[72:75]
    ds_read_b64_tr_b16 v[198:199], v5 offset:14336
    v_mfma_f32_16x16x32_bf16 v[88:91], v[184:187], v[152:155], v[88:91]
    ds_read_b64_tr_b16 v[200:201], v6 offset:12288
    s_waitcnt lgkmcnt(5)
    v_mfma_f32_16x16x32_bf16 v[28:31], v[188:191], v[136:139], v[28:31]
    ds_read_b64_tr_b16 v[202:203], v6 offset:14336
    v_mfma_f32_16x16x32_bf16 v[44:47], v[188:191], v[140:143], v[44:47]
    ds_read_b64_tr_b16 v[204:205], v7 offset:12288
    v_mfma_f32_16x16x32_bf16 v[60:63], v[188:191], v[144:147], v[60:63]
    ds_read_b64_tr_b16 v[206:207], v7 offset:14336
    v_mfma_f32_16x16x32_bf16 v[76:79], v[188:191], v[148:151], v[76:79]
    v_mfma_f32_16x16x32_bf16 v[92:95], v[188:191], v[152:155], v[92:95]
    s_waitcnt lgkmcnt(6)
    v_mfma_f32_16x16x32_bf16 v[16:19], v[192:195], v[156:159], v[16:19]
    s_lshl_b32 s31, s40, 12
    s_add_u32 s31, s31, s41
    s_mul_i32 s42, s40, 147456
    s_add_u32 s42, s42, s34
    s_add_u32 s40, s40, 1
    s_cmp_eq_u32 s40, 18
    s_cselect_b32 s40, 0, s40
    buffer_load_dwordx4 v[136:139], v8, s[12:15], s31 offen
    v_mfma_f32_16x16x32_bf16 v[32:35], v[192:195], v[160:163], v[32:35]
    buffer_load_dwordx4 v[140:143], v9, s[12:15], s31 offen
    v_mfma_f32_16x16x32_bf16 v[48:51], v[192:195], v[164:167], v[48:51]
    buffer_load_dwordx4 v[144:147], v10, s[12:15], s31 offen
    v_mfma_f32_16x16x32_bf16 v[64:67], v[192:195], v[168:171], v[64:67]
    buffer_load_dwordx4 v[148:151], v11, s[12:15], s31 offen
    v_mfma_f32_16x16x32_bf16 v[80:83], v[192:195], v[172:175], v[80:83]
    buffer_load_dwordx4 v[152:155], v12, s[12:15], s31 offen
    s_waitcnt lgkmcnt(4)
    v_mfma_f32_16x16x32_bf16 v[20:23], v[196:199], v[156:159], v[20:23]
    s_add_u32 m0, s33, 8192
    s_add_u32 s30, s42, 0
    buffer_load_dwordx4 v2, s[8:11], s30 offen lds
    v_mfma_f32_16x16x32_bf16 v[36:39], v[196:199], v[160:163], v[36:39]
    s_add_u32 m0, s33, 9216
    s_add_u32 s30, s42, 9216
    buffer_load_dwordx4 v2, s[8:11], s30 offen lds
    v_mfma_f32_16x16x32_bf16 v[52:55], v[196:199], v[164:167], v[52:55]
    s_add_u32 m0, s33, 10240
    s_add_u32 s30, s42, 18432
    buffer_load_dwordx4 v2, s[8:11], s30 offen lds
    v_mfma_f32_16x16x32_bf16 v[68:71], v[196:199], v[168:171], v[68:71]
    s_add_u32 m0, s33, 11264
    s_add_u32 s30, s42, 27648
    buffer_load_dwordx4 v2, s[8:11], s30 offen lds
    v_mfma_f32_16x16x32_bf16 v[84:87], v[196:199], v[172:175], v[84:87]
    s_waitcnt vmcnt(18) lgkmcnt(2)
    v_mfma_f32_16x16x32_bf16 v[24:27], v[200:203], v[156:159], v[24:27]
    ds_read_b64_tr_b16 v[176:177], v4 offset:0
    v_mfma_f32_16x16x32_bf16 v[40:43], v[200:203], v[160:163], v[40:43]
    ds_read_b64_tr_b16 v[178:179], v4 offset:2048
    v_mfma_f32_16x16x32_bf16 v[56:59], v[200:203], v[164:167], v[56:59]
    ds_read_b64_tr_b16 v[180:181], v5 offset:0
    v_mfma_f32_16x16x32_bf16 v[72:75], v[200:203], v[168:171], v[72:75]
    ds_read_b64_tr_b16 v[182:183], v5 offset:2048
    v_mfma_f32_16x16x32_bf16 v[88:91], v[200:203], v[172:175], v[88:91]
    ds_read_b64_tr_b16 v[184:185], v6 offset:0
    s_waitcnt lgkmcnt(5)
    v_mfma_f32_16x16x32_bf16 v[28:31], v[204:207], v[156:159], v[28:31]
    ds_read_b64_tr_b16 v[186:187], v6 offset:2048
    v_mfma_f32_16x16x32_bf16 v[44:47], v[204:207], v[160:163], v[44:47]
    ds_read_b64_tr_b16 v[188:189], v7 offset:0
    v_mfma_f32_16x16x32_bf16 v[60:63], v[204:207], v[164:167], v[60:63]
    ds_read_b64_tr_b16 v[190:191], v7 offset:2048
    v_mfma_f32_16x16x32_bf16 v[76:79], v[204:207], v[168:171], v[76:79]
    v_mfma_f32_16x16x32_bf16 v[92:95], v[204:207], v[172:175], v[92:95]
    s_waitcnt lgkmcnt(6)
    v_mfma_f32_16x16x32_bf16 v[16:19], v[176:179], v[96:99], v[16:19]
    s_lshl_b32 s31, s40, 12
    s_add_u32 s31, s31, s41
    s_mul_i32 s42, s40, 147456
    s_add_u32 s42, s42, s34
    s_add_u32 s40, s40, 1
    s_cmp_eq_u32 s40, 18
    s_cselect_b32 s40, 0, s40
    buffer_load_dwordx4 v[156:159], v8, s[12:15], s31 offen
    v_mfma_f32_16x16x32_bf16 v[32:35], v[176:179], v[100:103], v[32:35]
    buffer_load_dwordx4 v[160:163], v9, s[12:15], s31 offen
    v_mfma_f32_16x16x32_bf16 v[48:51], v[176:179], v[104:107], v[48:51]
    buffer_load_dwordx4 v[164:167], v10, s[12:15], s31 offen
    v_mfma_f32_16x16x32_bf16 v[64:67], v[176:179], v[108:111], v[64:67]
    buffer_load_dwordx4 v[168:171], v11, s[12:15], s31 offen
    v_mfma_f32_16x16x32_bf16 v[80:83], v[176:179], v[112:115], v[80:83]
    buffer_load_dwordx4 v[172:175], v12, s[12:15], s31 offen
    s_waitcnt lgkmcnt(4)
    v_mfma_f32_16x16x32_bf16 v[20:23], v[180:183], v[96:99], v[20:23]
    s_add_u32 m0, s33, 12288
    s_add_u32 s30, s42, 0
    buffer_load_dwordx4 v2, s[8:11], s30 offen lds
    v_mfma_f32_16x16x32_bf16 v[36:39], v[180:183], v[100:103], v[36:39]
    s_add_u32 m0, s33, 13312
    s_add_u32 s30, s42, 9216
    buffer_load_dwordx4 v2, s[8:11], s30 offen lds
    v_mfma_f32_16x16x32_bf16 v[52:55], v[180:183], v[104:107], v[52:55]
    s_add_u32 m0, s33, 14336
    s_add_u32 s30, s42, 18432
    buffer_load_dwordx4 v2, s[8:11], s30 offen lds
    v_mfma_f32_16x16x32_bf16 v[68:71], v[180:183], v[108:111], v[68:71]
    s_add_u32 m0, s33, 15360
    s_add_u32 s30, s42, 27648
    buffer_load_dwordx4 v2, s[8:11], s30 offen lds
    v_mfma_f32_16x16x32_bf16 v[84:87], v[180:183], v[112:115], v[84:87]
    s_waitcnt vmcnt(18) lgkmcnt(2)
    v_mfma_f32_16x16x32_bf16 v[24:27], v[184:187], v[96:99], v[24:27]
    ds_read_b64_tr_b16 v[192:193], v4 offset:4096
    v_mfma_f32_16x16x32_bf16 v[40:43], v[184:187], v[100:103], v[40:43]
    ds_read_b64_tr_b16 v[194:195], v4 offset:6144
    v_mfma_f32_16x16x32_bf16 v[56:59], v[184:187], v[104:107], v[56:59]
    ds_read_b64_tr_b16 v[196:197], v5 offset:4096
    v_mfma_f32_16x16x32_bf16 v[72:75], v[184:187], v[108:111], v[72:75]
    ds_read_b64_tr_b16 v[198:199], v5 offset:6144
    v_mfma_f32_16x16x32_bf16 v[88:91], v[184:187], v[112:115], v[88:91]
    ds_read_b64_tr_b16 v[200:201], v6 offset:4096
    s_waitcnt lgkmcnt(5)
    v_mfma_f32_16x16x32_bf16 v[28:31], v[188:191], v[96:99], v[28:31]
    ds_read_b64_tr_b16 v[202:203], v6 offset:6144
    v_mfma_f32_16x16x32_bf16 v[44:47], v[188:191], v[100:103], v[44:47]
    ds_read_b64_tr_b16 v[204:205], v7 offset:4096
    v_mfma_f32_16x16x32_bf16 v[60:63], v[188:191], v[104:107], v[60:63]
    ds_read_b64_tr_b16 v[206:207], v7 offset:6144
    v_mfma_f32_16x16x32_bf16 v[76:79], v[188:191], v[108:111], v[76:79]
    v_mfma_f32_16x16x32_bf16 v[92:95], v[188:191], v[112:115], v[92:95]
    s_waitcnt lgkmcnt(6)
    v_mfma_f32_16x16x32_bf16 v[16:19], v[192:195], v[116:119], v[16:19]
    s_lshl_b32 s31, s40, 12
    s_add_u32 s31, s31, s41
    s_mul_i32 s42, s40, 147456
    s_add_u32 s42, s42, s34
    s_add_u32 s40, s40, 1
    s_cmp_eq_u32 s40, 18
    s_cselect_b32 s40, 0, s40
    buffer_load_dwordx4 v[96:99], v8, s[12:15], s31 offen
    v_mfma_f32_16x16x32_bf16 v[32:35], v[192:195], v[120:123], v[32:35]
    buffer_load_dwordx4 v[100:103], v9, s[12:15], s31 offen
    v_mfma_f32_16x16x32_bf16 v[48:51], v[192:195], v[124:127], v[48:51]
    buffer_load_dwordx4 v[104:107], v10, s[12:15], s31 offen
    v_mfma_f32_16x16x32_bf16 v[64:67], v[192:195], v[128:131], v[64:67]
    buffer_load_dwordx4 v[108:111], v11, s[12:15], s31 offen
    v_mfma_f32_16x16x32_bf16 v[80:83], v[192:195], v[132:135], v[80:83]
    buffer_load_dwordx4 v[112:115], v12, s[12:15], s31 offen
    s_waitcnt lgkmcnt(4)
    v_mfma_f32_16x16x32_bf16 v[20:23], v[196:199], v[116:119], v[20:23]
    s_add_u32 m0, s33, 0
    s_add_u32 s30, s42, 0
    buffer_load_dwordx4 v2, s[8:11], s30 offen lds
    v_mfma_f32_16x16x32_bf16 v[36:39], v[196:199], v[120:123], v[36:39]
    s_add_u32 m0, s33, 1024
    s_add_u32 s30, s42, 9216
    buffer_load_dwordx4 v2, s[8:11], s30 offen lds
    v_mfma_f32_16x16x32_bf16 v[52:55], v[196:199], v[124:127], v[52:55]
    s_add_u32 m0, s33, 2048
    s_add_u32 s30, s42, 18432
    buffer_load_dwordx4 v2, s[8:11], s30 offen lds
    v_mfma_f32_16x16x32_bf16 v[68:71], v[196:199], v[128:131], v[68:71]
    s_add_u32 m0, s33, 3072
    s_add_u32 s30, s42, 27648
    buffer_load_dwordx4 v2, s[8:11], s30 offen lds
    v_mfma_f32_16x16x32_bf16 v[84:87], v[196:199], v[132:135], v[84:87]
    s_waitcnt vmcnt(18) lgkmcnt(2)
    v_mfma_f32_16x16x32_bf16 v[24:27], v[200:203], v[116:119], v[24:27]
    ds_read_b64_tr_b16 v[176:177], v4 offset:8192
    v_mfma_f32_16x16x32_bf16 v[40:43], v[200:203], v[120:123], v[40:43]
    ds_read_b64_tr_b16 v[178:179], v4 offset:10240
    v_mfma_f32_16x16x32_bf16 v[56:59], v[200:203], v[124:127], v[56:59]
    ds_read_b64_tr_b16 v[180:181], v5 offset:8192
    v_mfma_f32_16x16x32_bf16 v[72:75], v[200:203], v[128:131], v[72:75]
    ds_read_b64_tr_b16 v[182:183], v5 offset:10240
    v_mfma_f32_16x16x32_bf16 v[88:91], v[200:203], v[132:135], v[88:91]
    ds_read_b64_tr_b16 v[184:185], v6 offset:8192
    s_waitcnt lgkmcnt(5)
    v_mfma_f32_16x16x32_bf16 v[28:31], v[204:207], v[116:119], v[28:31]
    ds_read_b64_tr_b16 v[186:187], v6 offset:10240
    v_mfma_f32_16x16x32_bf16 v[44:47], v[204:207], v[120:123], v[44:47]
    ds_read_b64_tr_b16 v[188:189], v7 offset:8192
    v_mfma_f32_16x16x32_bf16 v[60:63], v[204:207], v[124:127], v[60:63]
    ds_read_b64_tr_b16 v[190:191], v7 offset:10240
    v_mfma_f32_16x16x32_bf16 v[76:79], v[204:207], v[128:131], v[76:79]
    v_mfma_f32_16x16x32_bf16 v[92:95], v[204:207], v[132:135], v[92:95]
    s_waitcnt lgkmcnt(6)
    v_mfma_f32_16x16x32_bf16 v[16:19], v[176:179], v[136:139], v[16:19]
    s_lshl_b32 s31, s40, 12
    s_add_u32 s31, s31, s41
    s_mul_i32 s42, s40, 147456
    s_add_u32 s42, s42, s34
    s_add_u32 s40, s40, 1
    s_cmp_eq_u32 s40, 18
    s_cselect_b32 s40, 0, s40
    buffer_load_dwordx4 v[116:119], v8, s[12:15], s31 offen
    v_mfma_f32_16x16x32_bf16 v[32:35], v[176:179], v[140:143], v[32:35]
    buffer_load_dwordx4 v[120:123], v9, s[12:15], s31 offen
    v_mfma_f32_16x16x32_bf16 v[48:51], v[176:179], v[144:147], v[48:51]
    buffer_load_dwordx4 v[124:127], v10, s[12:15], s31 offen
    v_mfma_f32_16x16x32_bf16 v[64:67], v[176:179], v[148:151], v[64:67]
    buffer_load_dwordx4 v[128:131], v11, s[12:15], s31 offen
    v_mfma_f32_16x16x32_bf16 v[80:83], v[176:179], v[152:155], v[80:83]
    buffer_load_dwordx4 v[132:135], v12, s[12:15], s31 offen
    s_waitcnt lgkmcnt(4)
    v_mfma_f32_16x16x32_bf16 v[20:23], v[180:183], v[136:139], v[20:23]
    s_add_u32 m0, s33, 4096
    s_add_u32 s30, s42, 0
    buffer_load_dwordx4 v2, s[8:11], s30 offen lds
    v_mfma_f32_16x16x32_bf16 v[36:39], v[180:183], v[140:143], v[36:39]
    s_add_u32 m0, s33, 5120
    s_add_u32 s30, s42, 9216
    buffer_load_dwordx4 v2, s[8:11], s30 offen lds
    v_mfma_f32_16x16x32_bf16 v[52:55], v[180:183], v[144:147], v[52:55]
    s_add_u32 m0, s33, 6144
    s_add_u32 s30, s42, 18432
    buffer_load_dwordx4 v2, s[8:11], s30 offen lds
    v_mfma_f32_16x16x32_bf16 v[68:71], v[180:183], v[148:151], v[68:71]
    s_add_u32 m0, s33, 7168
    s_add_u32 s30, s42, 27648
    buffer_load_dwordx4 v2, s[8:11], s30 offen lds
    v_mfma_f32_16x16x32_bf16 v[84:87], v[180:183], v[152:155], v[84:87]
    s_waitcnt vmcnt(18) lgkmcnt(2)
    v_mfma_f32_16x16x32_bf16 v[24:27], v[184:187], v[136:139], v[24:27]
    ds_read_b64_tr_b16 v[192:193], v4 offset:12288
    v_mfma_f32_16x16x32_bf16 v[40:43], v[184:187], v[140:143], v[40:43]
    ds_read_b64_tr_b16 v[194:195], v4 offset:14336
    v_mfma_f32_16x16x32_bf16 v[56:59], v[184:187], v[144:147], v[56:59]
    ds_read_b64_tr_b16 v[196:197], v5 offset:12288
    v_mfma_f32_16x16x32_bf16 v[72:75], v[184:187], v[148:151], v[72:75]
    ds_read_b64_tr_b16 v[198:199], v5 offset:14336
    v_mfma_f32_16x16x32_bf16 v[88:91], v[184:187], v[152:155], v[88:91]
    ds_read_b64_tr_b16 v[200:201], v6 offset:12288
    s_waitcnt lgkmcnt(5)
    v_mfma_f32_16x16x32_bf16 v[28:31], v[188:191], v[136:139], v[28:31]
    ds_read_b64_tr_b16 v[202:203], v6 offset:14336
    v_mfma_f32_16x16x32_bf16 v[44:47], v[188:191], v[140:143], v[44:47]
    ds_read_b64_tr_b16 v[204:205], v7 offset:12288
    v_mfma_f32_16x16x32_bf16 v[60:63], v[188:191], v[144:147], v[60:63]
    ds_read_b64_tr_b16 v[206:207], v7 offset:14336
    v_mfma_f32_16x16x32_bf16 v[76:79], v[188:191], v[148:151], v[76:79]
    v_mfma_f32_16x16x32_bf16 v[92:95], v[188:191], v[152:155], v[92:95]
    s_waitcnt lgkmcnt(6)
    v_mfma_f32_16x16x32_bf16 v[16:19], v[192:195], v[156:159], v[16:19]
    s_add_u32 s31, s32, 0
    buffer_load_dwordx4 v[136:139], v8, s[12:15], s31 offen
    v_mfma_f32_16x16x32_bf16 v[32:35], v[192:195], v[160:163], v[32:35]
    buffer_load_dwordx4 v[140:143], v9, s[12:15], s31 offen
    v_mfma_f32_16x16x32_bf16 v[48:51], v[192:195], v[164:167], v[48:51]
    buffer_load_dwordx4 v[144:147], v10, s[12:15], s31 offen
    v_mfma_f32_16x16x32_bf16 v[64:67], v[192:195], v[168:171], v[64:67]
    buffer_load_dwordx4 v[148:151], v11, s[12:15], s31 offen
    v_mfma_f32_16x16x32_bf16 v[80:83], v[192:195], v[172:175], v[80:83]
    buffer_load_dwordx4 v[152:155], v12, s[12:15], s31 offen
    s_waitcnt lgkmcnt(4)
    v_mfma_f32_16x16x32_bf16 v[20:23], v[196:199], v[156:159], v[20:23]
    s_add_u32 m0, s33, 8192
    s_add_u32 s30, s35, 0
    buffer_load_dwordx4 v2, s[12:15], s30 offen lds
    v_mfma_f32_16x16x32_bf16 v[36:39], v[196:199], v[160:163], v[36:39]
    s_add_u32 m0, s33, 9216
    s_add_u32 s30, s35, 9216
    buffer_load_dwordx4 v2, s[12:15], s30 offen lds
    v_mfma_f32_16x16x32_bf16 v[52:55], v[196:199], v[164:167], v[52:55]
    s_add_u32 m0, s33, 10240
    s_add_u32 s30, s35, 18432
    buffer_load_dwordx4 v2, s[12:15], s30 offen lds
    v_mfma_f32_16x16x32_bf16 v[68:71], v[196:199], v[168:171], v[68:71]
    s_add_u32 m0, s33, 11264
    s_add_u32 s30, s35, 27648
    buffer_load_dwordx4 v2, s[12:15], s30 offen lds
    v_mfma_f32_16x16x32_bf16 v[84:87], v[196:199], v[172:175], v[84:87]
    s_waitcnt vmcnt(18) lgkmcnt(2)
    v_mfma_f32_16x16x32_bf16 v[24:27], v[200:203], v[156:159], v[24:27]
    ds_read_b64_tr_b16 v[176:177], v4 offset:0
    v_mfma_f32_16x16x32_bf16 v[40:43], v[200:203], v[160:163], v[40:43]
    ds_read_b64_tr_b16 v[178:179], v4 offset:2048
    v_mfma_f32_16x16x32_bf16 v[56:59], v[200:203], v[164:167], v[56:59]
    ds_read_b64_tr_b16 v[180:181], v5 offset:0
    v_mfma_f32_16x16x32_bf16 v[72:75], v[200:203], v[168:171], v[72:75]
    ds_read_b64_tr_b16 v[182:183], v5 offset:2048
    v_mfma_f32_16x16x32_bf16 v[88:91], v[200:203], v[172:175], v[88:91]
    ds_read_b64_tr_b16 v[184:185], v6 offset:0
    s_waitcnt lgkmcnt(5)
    v_mfma_f32_16x16x32_bf16 v[28:31], v[204:207], v[156:159], v[28:31]
    ds_read_b64_tr_b16 v[186:187], v6 offset:2048
    v_mfma_f32_16x16x32_bf16 v[44:47], v[204:207], v[160:163], v[44:47]
    ds_read_b64_tr_b16 v[188:189], v7 offset:0
    v_mfma_f32_16x16x32_bf16 v[60:63], v[204:207], v[164:167], v[60:63]
    ds_read_b64_tr_b16 v[190:191], v7 offset:2048
    v_mfma_f32_16x16x32_bf16 v[76:79], v[204:207], v[168:171], v[76:79]
    v_mfma_f32_16x16x32_bf16 v[92:95], v[204:207], v[172:175], v[92:95]
    s_waitcnt lgkmcnt(6)
    v_mfma_f32_16x16x32_bf16 v[16:19], v[176:179], v[96:99], v[16:19]
    s_add_u32 s31, s32, 4096
    buffer_load_dwordx4 v[156:159], v8, s[12:15], s31 offen
    v_mfma_f32_16x16x32_bf16 v[32:35], v[176:179], v[100:103], v[32:35]
    buffer_load_dwordx4 v[160:163], v9, s[12:15], s31 offen
    v_mfma_f32_16x16x32_bf16 v[48:51], v[176:179], v[104:107], v[48:51]
    buffer_load_dwordx4 v[164:167], v10, s[12:15], s31 offen
    v_mfma_f32_16x16x32_bf16 v[64:67], v[176:179], v[108:111], v[64:67]
    buffer_load_dwordx4 v[168:171], v11, s[12:15], s31 offen
    v_mfma_f32_16x16x32_bf16 v[80:83], v[176:179], v[112:115], v[80:83]
    buffer_load_dwordx4 v[172:175], v12, s[12:15], s31 offen
    s_waitcnt lgkmcnt(4)
    v_mfma_f32_16x16x32_bf16 v[20:23], v[180:183], v[96:99], v[20:23]
    s_add_u32 m0, s33, 12288
    s_add_u32 s30, s35, 147456
    buffer_load_dwordx4 v2, s[12:15], s30 offen lds
    v_mfma_f32_16x16x32_bf16 v[36:39], v[180:183], v[100:103], v[36:39]
    s_add_u32 m0, s33, 13312
    s_add_u32 s30, s35, 156672
    buffer_load_dwordx4 v2, s[12:15], s30 offen lds
    v_mfma_f32_16x16x32_bf16 v[52:55], v[180:183], v[104:107], v[52:55]
    s_add_u32 m0, s33, 14336
    s_add_u32 s30, s35, 165888
    buffer_load_dwordx4 v2, s[12:15], s30 offen lds
    v_mfma_f32_16x16x32_bf16 v[68:71], v[180:183], v[108:111], v[68:71]
    s_add_u32 m0, s33, 15360
    s_add_u32 s30, s35, 175104
    buffer_load_dwordx4 v2, s[12:15], s30 offen lds
    v_mfma_f32_16x16x32_bf16 v[84:87], v[180:183], v[112:115], v[84:87]
    s_waitcnt vmcnt(18) lgkmcnt(2)
    v_mfma_f32_16x16x32_bf16 v[24:27], v[184:187], v[96:99], v[24:27]
    ds_read_b64_tr_b16 v[192:193], v4 offset:4096
    v_mfma_f32_16x16x32_bf16 v[40:43], v[184:187], v[100:103], v[40:43]
    ds_read_b64_tr_b16 v[194:195], v4 offset:6144
    v_mfma_f32_16x16x32_bf16 v[56:59], v[184:187], v[104:107], v[56:59]
    ds_read_b64_tr_b16 v[196:197], v5 offset:4096
    v_mfma_f32_16x16x32_bf16 v[72:75], v[184:187], v[108:111], v[72:75]
    ds_read_b64_tr_b16 v[198:199], v5 offset:6144
    v_mfma_f32_16x16x32_bf16 v[88:91], v[184:187], v[112:115], v[88:91]
    ds_read_b64_tr_b16 v[200:201], v6 offset:4096
    s_waitcnt lgkmcnt(5)
    v_mfma_f32_16x16x32_bf16 v[28:31], v[188:191], v[96:99], v[28:31]
    ds_read_b64_tr_b16 v[202:203], v6 offset:6144
    v_mfma_f32_16x16x32_bf16 v[44:47], v[188:191], v[100:103], v[44:47]
    ds_read_b64_tr_b16 v[204:205], v7 offset:4096
    v_mfma_f32_16x16x32_bf16 v[60:63], v[188:191], v[104:107], v[60:63]
    ds_read_b64_tr_b16 v[206:207], v7 offset:6144
    v_mfma_f32_16x16x32_bf16 v[76:79], v[188:191], v[108:111], v[76:79]
    v_mfma_f32_16x16x32_bf16 v[92:95], v[188:191], v[112:115], v[92:95]
    s_waitcnt lgkmcnt(6)
    v_mfma_f32_16x16x32_bf16 v[16:19], v[192:195], v[116:119], v[16:19]
    s_add_u32 s31, s32, 8192
    buffer_load_dwordx4 v[96:99], v8, s[12:15], s31 offen
    v_mfma_f32_16x16x32_bf16 v[32:35], v[192:195], v[120:123], v[32:35]
    buffer_load_dwordx4 v[100:103], v9, s[12:15], s31 offen
    v_mfma_f32_16x16x32_bf16 v[48:51], v[192:195], v[124:127], v[48:51]
    buffer_load_dwordx4 v[104:107], v10, s[12:15], s31 offen
    v_mfma_f32_16x16x32_bf16 v[64:67], v[192:195], v[128:131], v[64:67]
    buffer_load_dwordx4 v[108:111], v11, s[12:15], s31 offen
    v_mfma_f32_16x16x32_bf16 v[80:83], v[192:195], v[132:135], v[80:83]
    buffer_load_dwordx4 v[112:115], v12, s[12:15], s31 offen
    s_waitcnt lgkmcnt(4)
    v_mfma_f32_16x16x32_bf16 v[20:23], v[196:199], v[116:119], v[20:23]
    s_add_u32 m0, s33, 0
    s_add_u32 s30, s35, 294912
    buffer_load_dwordx4 v2, s[12:15], s30 offen lds
    v_mfma_f32_16x16x32_bf16 v[36:39], v[196:199], v[120:123], v[36:39]
    s_add_u32 m0, s33, 1024
    s_add_u32 s30, s35, 304128
    buffer_load_dwordx4 v2, s[12:15], s30 offen lds
    v_mfma_f32_16x16x32_bf16 v[52:55], v[196:199], v[124:127], v[52:55]
    s_add_u32 m0, s33, 2048
    s_add_u32 s30, s35, 313344
    buffer_load_dwordx4 v2, s[12:15], s30 offen lds
    v_mfma_f32_16x16x32_bf16 v[68:71], v[196:199], v[128:131], v[68:71]
    s_add_u32 m0, s33, 3072
    s_add_u32 s30, s35, 322560
    buffer_load_dwordx4 v2, s[12:15], s30 offen lds
    v_mfma_f32_16x16x32_bf16 v[84:87], v[196:199], v[132:135], v[84:87]
    s_waitcnt vmcnt(18) lgkmcnt(2)
    v_mfma_f32_16x16x32_bf16 v[24:27], v[200:203], v[116:119], v[24:27]
    ds_read_b64_tr_b16 v[176:177], v4 offset:8192
    v_mfma_f32_16x16x32_bf16 v[40:43], v[200:203], v[120:123], v[40:43]
    ds_read_b64_tr_b16 v[178:179], v4 offset:10240
    v_mfma_f32_16x16x32_bf16 v[56:59], v[200:203], v[124:127], v[56:59]
    ds_read_b64_tr_b16 v[180:181], v5 offset:8192
    v_mfma_f32_16x16x32_bf16 v[72:75], v[200:203], v[128:131], v[72:75]
    ds_read_b64_tr_b16 v[182:183], v5 offset:10240
    v_mfma_f32_16x16x32_bf16 v[88:91], v[200:203], v[132:135], v[88:91]
    ds_read_b64_tr_b16 v[184:185], v6 offset:8192
    s_waitcnt lgkmcnt(5)
    v_mfma_f32_16x16x32_bf16 v[28:31], v[204:207], v[116:119], v[28:31]
    ds_read_b64_tr_b16 v[186:187], v6 offset:10240
    v_mfma_f32_16x16x32_bf16 v[44:47], v[204:207], v[120:123], v[44:47]
    ds_read_b64_tr_b16 v[188:189], v7 offset:8192
    v_mfma_f32_16x16x32_bf16 v[60:63], v[204:207], v[124:127], v[60:63]
    ds_read_b64_tr_b16 v[190:191], v7 offset:10240
    v_mfma_f32_16x16x32_bf16 v[76:79], v[204:207], v[128:131], v[76:79]
    v_mfma_f32_16x16x32_bf16 v[92:95], v[204:207], v[132:135], v[92:95]
    s_waitcnt lgkmcnt(6)
    v_mfma_f32_16x16x32_bf16 v[16:19], v[176:179], v[136:139], v[16:19]
    s_add_u32 s31, s32, 12288
    buffer_load_dwordx4 v[116:119], v8, s[12:15], s31 offen
    v_mfma_f32_16x16x32_bf16 v[32:35], v[176:179], v[140:143], v[32:35]
    buffer_load_dwordx4 v[120:123], v9, s[12:15], s31 offen
    v_mfma_f32_16x16x32_bf16 v[48:51], v[176:179], v[144:147], v[48:51]
    buffer_load_dwordx4 v[124:127], v10, s[12:15], s31 offen
    v_mfma_f32_16x16x32_bf16 v[64:67], v[176:179], v[148:151], v[64:67]
    buffer_load_dwordx4 v[128:131], v11, s[12:15], s31 offen
    v_mfma_f32_16x16x32_bf16 v[80:83], v[176:179], v[152:155], v[80:83]
    buffer_load_dwordx4 v[132:135], v12, s[12:15], s31 offen
    s_waitcnt lgkmcnt(4)
    v_mfma_f32_16x16x32_bf16 v[20:23], v[180:183], v[136:139], v[20:23]
    s_add_u32 m0, s33, 4096
    s_add_u32 s30, s35, 442368
    buffer_load_dwordx4 v2, s[12:15], s30 offen lds
    v_mfma_f32_16x16x32_bf16 v[36:39], v[180:183], v[140:143], v[36:39]
    s_add_u32 m0, s33, 5120
    s_add_u32 s30, s35, 451584
    buffer_load_dwordx4 v2, s[12:15], s30 offen lds
    v_mfma_f32_16x16x32_bf16 v[52:55], v[180:183], v[144:147], v[52:55]
    s_add_u32 m0, s33, 6144
    s_add_u32 s30, s35, 460800
    buffer_load_dwordx4 v2, s[12:15], s30 offen lds
    v_mfma_f32_16x16x32_bf16 v[68:71], v[180:183], v[148:151], v[68:71]
    s_add_u32 m0, s33, 7168
    s_add_u32 s30, s35, 470016
    buffer_load_dwordx4 v2, s[12:15], s30 offen lds
    v_mfma_f32_16x16x32_bf16 v[84:87], v[180:183], v[152:155], v[84:87]
    s_waitcnt vmcnt(18) lgkmcnt(2)
    v_mfma_f32_16x16x32_bf16 v[24:27], v[184:187], v[136:139], v[24:27]
    ds_read_b64_tr_b16 v[192:193], v4 offset:12288
    v_mfma_f32_16x16x32_bf16 v[40:43], v[184:187], v[140:143], v[40:43]
    ds_read_b64_tr_b16 v[194:195], v4 offset:14336
    v_mfma_f32_16x16x32_bf16 v[56:59], v[184:187], v[144:147], v[56:59]
    ds_read_b64_tr_b16 v[196:197], v5 offset:12288
    v_mfma_f32_16x16x32_bf16 v[72:75], v[184:187], v[148:151], v[72:75]
    ds_read_b64_tr_b16 v[198:199], v5 offset:14336
    v_mfma_f32_16x16x32_bf16 v[88:91], v[184:187], v[152:155], v[88:91]
    ds_read_b64_tr_b16 v[200:201], v6 offset:12288
    s_waitcnt lgkmcnt(5)
    v_mfma_f32_16x16x32_bf16 v[28:31], v[188:191], v[136:139], v[28:31]
    ds_read_b64_tr_b16 v[202:203], v6 offset:14336
    v_mfma_f32_16x16x32_bf16 v[44:47], v[188:191], v[140:143], v[44:47]
    ds_read_b64_tr_b16 v[204:205], v7 offset:12288
    v_mfma_f32_16x16x32_bf16 v[60:63], v[188:191], v[144:147], v[60:63]
    ds_read_b64_tr_b16 v[206:207], v7 offset:14336
    v_mfma_f32_16x16x32_bf16 v[76:79], v[188:191], v[148:151], v[76:79]
    v_mfma_f32_16x16x32_bf16 v[92:95], v[188:191], v[152:155], v[92:95]
    s_waitcnt lgkmcnt(6)
    v_mfma_f32_16x16x32_bf16 v[16:19], v[192:195], v[156:159], v[16:19]
    s_mov_b32 s31, s36
    buffer_load_dwordx4 v[136:139], v8, s[12:15], s31 offen
    v_mfma_f32_16x16x32_bf16 v[32:35], v[192:195], v[160:163], v[32:35]
    buffer_load_dwordx4 v[140:143], v9, s[12:15], s31 offen
    v_mfma_f32_16x16x32_bf16 v[48:51], v[192:195], v[164:167], v[48:51]
    buffer_load_dwordx4 v[144:147], v10, s[12:15], s31 offen
    v_mfma_f32_16x16x32_bf16 v[64:67], v[192:195], v[168:171], v[64:67]
    buffer_load_dwordx4 v[148:151], v11, s[12:15], s31 offen
    v_mfma_f32_16x16x32_bf16 v[80:83], v[192:195], v[172:175], v[80:83]
    buffer_load_dwordx4 v[152:155], v12, s[12:15], s31 offen
    s_waitcnt lgkmcnt(4)
    v_mfma_f32_16x16x32_bf16 v[20:23], v[196:199], v[156:159], v[20:23]
    s_add_u32 m0, s33, 8192
    s_add_u32 s30, s37, 0
    buffer_load_dwordx4 v2, s[12:15], s30 offen lds
    v_mfma_f32_16x16x32_bf16 v[36:39], v[196:199], v[160:163], v[36:39]
    s_add_u32 m0, s33, 9216
    s_add_u32 s30, s37, 9216
    buffer_load_dwordx4 v2, s[12:15], s30 offen lds
    v_mfma_f32_16x16x32_bf16 v[52:55], v[196:199], v[164:167], v[52:55]
    s_add_u32 m0, s33, 10240
    s_add_u32 s30, s37, 18432
    buffer_load_dwordx4 v2, s[12:15], s30 offen lds
    v_mfma_f32_16x16x32_bf16 v[68:71], v[196:199], v[168:171], v[68:71]
    s_add_u32 m0, s33, 11264
    s_add_u32 s30, s37, 27648
    buffer_load_dwordx4 v2, s[12:15], s30 offen lds
    v_mfma_f32_16x16x32_bf16 v[84:87], v[196:199], v[172:175], v[84:87]
    s_waitcnt vmcnt(18) lgkmcnt(2)
    v_mfma_f32_16x16x32_bf16 v[24:27], v[200:203], v[156:159], v[24:27]
    ds_read_b64_tr_b16 v[176:177], v4 offset:0
    v_mfma_f32_16x16x32_bf16 v[40:43], v[200:203], v[160:163], v[40:43]
    ds_read_b64_tr_b16 v[178:179], v4 offset:2048
    v_mfma_f32_16x16x32_bf16 v[56:59], v[200:203], v[164:167], v[56:59]
    ds_read_b64_tr_b16 v[180:181], v5 offset:0
    v_mfma_f32_16x16x32_bf16 v[72:75], v[200:203], v[168:171], v[72:75]
    ds_read_b64_tr_b16 v[182:183], v5 offset:2048
    v_mfma_f32_16x16x32_bf16 v[88:91], v[200:203], v[172:175], v[88:91]
    ds_read_b64_tr_b16 v[184:185], v6 offset:0
    s_waitcnt lgkmcnt(5)
    v_mfma_f32_16x16x32_bf16 v[28:31], v[204:207], v[156:159], v[28:31]
    ds_read_b64_tr_b16 v[186:187], v6 offset:2048
    v_mfma_f32_16x16x32_bf16 v[44:47], v[204:207], v[160:163], v[44:47]
    ds_read_b64_tr_b16 v[188:189], v7 offset:0
    v_mfma_f32_16x16x32_bf16 v[60:63], v[204:207], v[164:167], v[60:63]
    ds_read_b64_tr_b16 v[190:191], v7 offset:2048
    v_mfma_f32_16x16x32_bf16 v[76:79], v[204:207], v[168:171], v[76:79]
    v_mfma_f32_16x16x32_bf16 v[92:95], v[204:207], v[172:175], v[92:95]
    s_waitcnt lgkmcnt(6)
    v_mfma_f32_16x16x32_bf16 v[16:19], v[176:179], v[96:99], v[16:19]
    s_add_u32 s30, s38, 0
    buffer_load_dwordx4 v[208:211], v13, s[16:19], s30 offen
    v_mfma_f32_16x16x32_bf16 v[32:35], v[176:179], v[100:103], v[32:35]
    s_add_u32 s30, s38, 36864
    buffer_load_dwordx4 v[212:215], v13, s[16:19], s30 offen
    v_mfma_f32_16x16x32_bf16 v[48:51], v[176:179], v[104:107], v[48:51]
    v_mfma_f32_16x16x32_bf16 v[64:67], v[176:179], v[108:111], v[64:67]
    s_add_u32 s30, s38, 73728
    buffer_load_dwordx4 v[216:219], v13, s[16:19], s30 offen
    v_mfma_f32_16x16x32_bf16 v[80:83], v[176:179], v[112:115], v[80:83]
    s_waitcnt vmcnt(12) lgkmcnt(4)
    v_mfma_f32_16x16x32_bf16 v[20:23], v[180:183], v[96:99], v[20:23]
    v_mfma_f32_16x16x32_bf16 v[36:39], v[180:183], v[100:103], v[36:39]
    ds_read_b64_tr_b16 v[192:193], v4 offset:4096
    v_mfma_f32_16x16x32_bf16 v[52:55], v[180:183], v[104:107], v[52:55]
    ds_read_b64_tr_b16 v[194:195], v4 offset:6144
    v_mfma_f32_16x16x32_bf16 v[68:71], v[180:183], v[108:111], v[68:71]
    v_mfma_f32_16x16x32_bf16 v[84:87], v[180:183], v[112:115], v[84:87]
    ds_read_b64_tr_b16 v[196:197], v5 offset:4096
    s_waitcnt lgkmcnt(5)
    v_mfma_f32_16x16x32_bf16 v[24:27], v[184:187], v[96:99], v[24:27]
    ds_read_b64_tr_b16 v[198:199], v5 offset:6144
    v_mfma_f32_16x16x32_bf16 v[40:43], v[184:187], v[100:103], v[40:43]
    v_mfma_f32_16x16x32_bf16 v[56:59], v[184:187], v[104:107], v[56:59]
    ds_read_b64_tr_b16 v[200:201], v6 offset:4096
    v_mfma_f32_16x16x32_bf16 v[72:75], v[184:187], v[108:111], v[72:75]
    ds_read_b64_tr_b16 v[202:203], v6 offset:6144
    v_mfma_f32_16x16x32_bf16 v[88:91], v[184:187], v[112:115], v[88:91]
    s_waitcnt lgkmcnt(6)
    v_mfma_f32_16x16x32_bf16 v[28:31], v[188:191], v[96:99], v[28:31]
    ds_read_b64_tr_b16 v[204:205], v7 offset:4096
    v_mfma_f32_16x16x32_bf16 v[44:47], v[188:191], v[100:103], v[44:47]
    ds_read_b64_tr_b16 v[206:207], v7 offset:6144
    v_mfma_f32_16x16x32_bf16 v[60:63], v[188:191], v[104:107], v[60:63]
    v_mfma_f32_16x16x32_bf16 v[76:79], v[188:191], v[108:111], v[76:79]
    v_mfma_f32_16x16x32_bf16 v[92:95], v[188:191], v[112:115], v[92:95]
    s_waitcnt lgkmcnt(6)
    v_mfma_f32_16x16x32_bf16 v[16:19], v[192:195], v[116:119], v[16:19]
    s_waitcnt vmcnt(3)
    v_mfma_f32_16x16x32_bf16 v[32:35], v[192:195], v[120:123], v[32:35]
    v_mfma_f32_16x16x32_bf16 v[48:51], v[192:195], v[124:127], v[48:51]
    ds_read_b64_tr_b16 v[176:177], v4 offset:8192
    v_mfma_f32_16x16x32_bf16 v[64:67], v[192:195], v[128:131], v[64:67]
    v_mfma_f32_16x16x32_bf16 v[80:83], v[192:195], v[132:135], v[80:83]
    ds_read_b64_tr_b16 v[178:179], v4 offset:10240
    s_waitcnt lgkmcnt(6)
    v_mfma_f32_16x16x32_bf16 v[20:23], v[196:199], v[116:119], v[20:23]
    v_mfma_f32_16x16x32_bf16 v[36:39], v[196:199], v[120:123], v[36:39]
    ds_read_b64_tr_b16 v[180:181], v5 offset:8192
    v_mfma_f32_16x16x32_bf16 v[52:55], v[196:199], v[124:127], v[52:55]
    v_mfma_f32_16x16x32_bf16 v[68:71], v[196:199], v[128:131], v[68:71]
    ds_read_b64_tr_b16 v[182:183], v5 offset:10240
    v_mfma_f32_16x16x32_bf16 v[84:87], v[196:199], v[132:135], v[84:87]
    s_waitcnt lgkmcnt(6)
    v_mfma_f32_16x16x32_bf16 v[24:27], v[200:203], v[116:119], v[24:27]
    ds_read_b64_tr_b16 v[184:185], v6 offset:8192
    v_mfma_f32_16x16x32_bf16 v[40:43], v[200:203], v[120:123], v[40:43]
    v_mfma_f32_16x16x32_bf16 v[56:59], v[200:203], v[124:127], v[56:59]
    ds_read_b64_tr_b16 v[186:187], v6 offset:10240
    v_mfma_f32_16x16x32_bf16 v[72:75], v[200:203], v[128:131], v[72:75]
    v_mfma_f32_16x16x32_bf16 v[88:91], v[200:203], v[132:135], v[88:91]
    ds_read_b64_tr_b16 v[188:189], v7 offset:8192
    s_waitcnt lgkmcnt(7)
    v_mfma_f32_16x16x32_bf16 v[28:31], v[204:207], v[116:119], v[28:31]
    v_mfma_f32_16x16x32_bf16 v[44:47], v[204:207], v[120:123], v[44:47]
    ds_read_b64_tr_b16 v[190:191], v7 offset:10240
    v_mfma_f32_16x16x32_bf16 v[60:63], v[204:207], v[124:127], v[60:63]
    v_mfma_f32_16x16x32_bf16 v[76:79], v[204:207], v[128:131], v[76:79]
    v_mfma_f32_16x16x32_bf16 v[92:95], v[204:207], v[132:135], v[92:95]
    s_waitcnt lgkmcnt(0)
    v_mfma_f32_16x16x32_bf16 v[16:19], v[176:179], v[136:139], v[16:19]
    v_mfma_f32_16x16x32_bf16 v[32:35], v[176:179], v[140:143], v[32:35]
    v_mfma_f32_16x16x32_bf16 v[48:51], v[176:179], v[144:147], v[48:51]
    v_mfma_f32_16x16x32_bf16 v[64:67], v[176:179], v[148:151], v[64:67]
    v_mfma_f32_16x16x32_bf16 v[80:83], v[176:179], v[152:155], v[80:83]
    v_mfma_f32_16x16x32_bf16 v[20:23], v[180:183], v[136:139], v[20:23]
    v_mfma_f32_16x16x32_bf16 v[36:39], v[180:183], v[140:143], v[36:39]
    s_nop 1
    ds_write_b128 v3, v[16:19] offset:0
    v_mfma_f32_16x16x32_bf16 v[52:55], v[180:183], v[144:147], v[52:55]
    ds_write_b128 v3, v[32:35] offset:4096
    v_mfma_f32_16x16x32_bf16 v[68:71], v[180:183], v[148:151], v[68:71]
    ds_write_b128 v3, v[48:51] offset:8192
    v_mfma_f32_16x16x32_bf16 v[84:87], v[180:183], v[152:155], v[84:87]
    v_mfma_f32_16x16x32_bf16 v[24:27], v[184:187], v[136:139], v[24:27]
    ds_write_b128 v3, v[64:67] offset:12288
    v_mfma_f32_16x16x32_bf16 v[40:43], v[184:187], v[140:143], v[40:43]
    ds_write_b128 v3, v[20:23] offset:1024
    ds_write_b128 v3, v[80:83] offset:16384
    v_mfma_f32_16x16x32_bf16 v[56:59], v[184:187], v[144:147], v[56:59]
    ds_write_b128 v3, v[36:39] offset:5120
    v_mfma_f32_16x16x32_bf16 v[72:75], v[184:187], v[148:151], v[72:75]
    ds_write_b128 v3, v[52:55] offset:9216
    v_mfma_f32_16x16x32_bf16 v[88:91], v[184:187], v[152:155], v[88:91]
    v_mfma_f32_16x16x32_bf16 v[28:31], v[188:191], v[136:139], v[28:31]
    ds_write_b128 v3, v[68:71] offset:13312
    v_mfma_f32_16x16x32_bf16 v[44:47], v[188:191], v[140:143], v[44:47]
    ds_write_b128 v3, v[24:27] offset:2048
    ds_write_b128 v3, v[40:43] offset:6144
    ds_write_b128 v3, v[84:87] offset:17408
    v_mfma_f32_16x16x32_bf16 v[60:63], v[188:191], v[144:147], v[60:63]
    ds_write_b128 v3, v[56:59] offset:10240
    v_mfma_f32_16x16x32_bf16 v[76:79], v[188:191], v[148:151], v[76:79]
    ds_write_b128 v3, v[72:75] offset:14336
    v_mfma_f32_16x16x32_bf16 v[92:95], v[188:191], v[152:155], v[92:95]
    ds_write_b128 v3, v[88:91] offset:18432
    ds_write_b128 v3, v[28:31] offset:3072
    ds_write_b128 v3, v[44:47] offset:7168
    s_nop 0
    ds_write_b128 v3, v[60:63] offset:11264
    s_nop 0
    ds_write_b128 v3, v[76:79] offset:15360
    s_nop 0
    ds_write_b128 v3, v[92:95] offset:19456
    s_waitcnt lgkmcnt(0)
    s_barrier
    ds_read_b128 v[16:19], v14 offset:0
    ds_read_b128 v[20:23], v14 offset:256
    ds_read_b128 v[24:27], v14 offset:20480
    ds_read_b128 v[28:31], v14 offset:20736
    ds_read_b128 v[32:35], v14 offset:40960
    ds_read_b128 v[36:39], v14 offset:41216
    ds_read_b128 v[40:43], v14 offset:61440
    ds_read_b128 v[44:47], v14 offset:61696
    ds_read_b128 v[48:51], v14 offset:8192
    ds_read_b128 v[52:55], v14 offset:8448
    ds_read_b128 v[56:59], v14 offset:28672
    ds_read_b128 v[60:63], v14 offset:28928
    ds_read_b128 v[64:67], v14 offset:49152
    ds_read_b128 v[68:71], v14 offset:49408
    ds_read_b128 v[72:75], v15 offset:28672
    ds_read_b128 v[76:79], v15 offset:28928
    s_waitcnt vmcnt(0) lgkmcnt(8)
    v_add_f32 v16, v16, v24
    v_add_f32 v32, v32, v40
    v_add_f32 v17, v17, v25
    v_add_f32 v33, v33, v41
    v_add_f32 v18, v18, v26
    v_add_f32 v34, v34, v42
    v_add_f32 v19, v19, v27
    v_add_f32 v35, v35, v43
    v_add_f32 v20, v20, v28
    v_add_f32 v36, v36, v44
    v_add_f32 v21, v21, v29
    v_add_f32 v37, v37, v45
    v_add_f32 v22, v22, v30
    v_add_f32 v38, v38, v46
    v_add_f32 v23, v23, v31
    v_add_f32 v39, v39, v47
    v_add_f32 v16, v16, v32
    v_add_f32 v17, v17, v33
    v_add_f32 v18, v18, v34
    v_add_f32 v19, v19, v35
    v_add_f32 v20, v20, v36
    v_add_f32 v21, v21, v37
    v_add_f32 v22, v22, v38
    v_add_f32 v23, v23, v39
    v_lshlrev_b32 v80, 16, v208
    v_and_b32 v81, 0xffff0000, v208
    v_add_f32 v80, v80, v16
    v_add_f32 v81, v81, v17
    v_cvt_pk_bf16_f32 v208, v80, v81
    v_lshlrev_b32 v80, 16, v209
    v_and_b32 v81, 0xffff0000, v209
    v_add_f32 v80, v80, v18
    v_add_f32 v81, v81, v19
    v_cvt_pk_bf16_f32 v209, v80, v81
    v_lshlrev_b32 v80, 16, v210
    v_and_b32 v81, 0xffff0000, v210
    v_add_f32 v80, v80, v20
    v_add_f32 v81, v81, v21
    v_cvt_pk_bf16_f32 v210, v80, v81
    v_lshlrev_b32 v80, 16, v211
    v_and_b32 v81, 0xffff0000, v211
    v_add_f32 v80, v80, v22
    v_add_f32 v81, v81, v23
    v_cvt_pk_bf16_f32 v211, v80, v81
    s_add_u32 s30, s38, 0
    buffer_store_dwordx4 v[208:211], v13, s[20:23], s30 offen
    s_waitcnt lgkmcnt(0)
    v_add_f32 v48, v48, v56
    v_add_f32 v64, v64, v72
    v_add_f32 v49, v49, v57
    v_add_f32 v65, v65, v73
    v_add_f32 v50, v50, v58
    v_add_f32 v66, v66, v74
    v_add_f32 v51, v51, v59
    v_add_f32 v67, v67, v75
    v_add_f32 v52, v52, v60
    v_add_f32 v68, v68, v76
    v_add_f32 v53, v53, v61
    v_add_f32 v69, v69, v77
    v_add_f32 v54, v54, v62
    v_add_f32 v70, v70, v78
    v_add_f32 v55, v55, v63
    v_add_f32 v71, v71, v79
    v_add_f32 v48, v48, v64
    v_add_f32 v49, v49, v65
    v_add_f32 v50, v50, v66
    v_add_f32 v51, v51, v67
    v_add_f32 v52, v52, v68
    v_add_f32 v53, v53, v69
    v_add_f32 v54, v54, v70
    v_add_f32 v55, v55, v71
    v_lshlrev_b32 v80, 16, v212
    v_and_b32 v81, 0xffff0000, v212
    v_add_f32 v80, v80, v48
    v_add_f32 v81, v81, v49
    v_cvt_pk_bf16_f32 v212, v80, v81
    v_lshlrev_b32 v80, 16, v213
    v_and_b32 v81, 0xffff0000, v213
    v_add_f32 v80, v80, v50
    v_add_f32 v81, v81, v51
    v_cvt_pk_bf16_f32 v213, v80, v81
    v_lshlrev_b32 v80, 16, v214
    v_and_b32 v81, 0xffff0000, v214
    v_add_f32 v80, v80, v52
    v_add_f32 v81, v81, v53
    v_cvt_pk_bf16_f32 v214, v80, v81
    v_lshlrev_b32 v80, 16, v215
    v_and_b32 v81, 0xffff0000, v215
    v_add_f32 v80, v80, v54
    v_add_f32 v81, v81, v55
    v_cvt_pk_bf16_f32 v215, v80, v81
    s_add_u32 s30, s38, 36864
    buffer_store_dwordx4 v[212:215], v13, s[20:23], s30 offen
    s_waitcnt lgkmcnt(0)
    s_cmp_ge_u32 s26, 2
    s_cbranch_scc1 L_gemm3_kernel_fin
    ds_read_b128 v[16:19], v14 offset:16384
    ds_read_b128 v[20:23], v14 offset:16640
    ds_read_b128 v[24:27], v14 offset:36864
    ds_read_b128 v[28:31], v14 offset:37120
    ds_read_b128 v[32:35], v14 offset:57344
    ds_read_b128 v[36:39], v14 offset:57600
    ds_read_b128 v[40:43], v15 offset:36864
    ds_read_b128 v[44:47], v15 offset:37120
    s_waitcnt lgkmcnt(0)
    v_add_f32 v16, v16, v24
    v_add_f32 v32, v32, v40
    v_add_f32 v17, v17, v25
    v_add_f32 v33, v33, v41
    v_add_f32 v18, v18, v26
    v_add_f32 v34, v34, v42
    v_add_f32 v19, v19, v27
    v_add_f32 v35, v35, v43
    v_add_f32 v20, v20, v28
    v_add_f32 v36, v36, v44
    v_add_f32 v21, v21, v29
    v_add_f32 v37, v37, v45
    v_add_f32 v22, v22, v30
    v_add_f32 v38, v38, v46
    v_add_f32 v23, v23, v31
    v_add_f32 v39, v39, v47
    v_add_f32 v16, v16, v32
    v_add_f32 v17, v17, v33
    v_add_f32 v18, v18, v34
    v_add_f32 v19, v19, v35
    v_add_f32 v20, v20, v36
    v_add_f32 v21, v21, v37
    v_add_f32 v22, v22, v38
    v_add_f32 v23, v23, v39
    v_lshlrev_b32 v80, 16, v216
    v_and_b32 v81, 0xffff0000, v216
    v_add_f32 v80, v80, v16
    v_add_f32 v81, v81, v17
    v_cvt_pk_bf16_f32 v216, v80, v81
    v_lshlrev_b32 v80, 16, v217
    v_and_b32 v81, 0xffff0000, v217
    v_add_f32 v80, v80, v18
    v_add_f32 v81, v81, v19
    v_cvt_pk_bf16_f32 v217, v80, v81
    v_lshlrev_b32 v80, 16, v218
    v_and_b32 v81, 0xffff0000, v218
    v_add_f32 v80, v80, v20
    v_add_f32 v81, v81, v21
    v_cvt_pk_bf16_f32 v218, v80, v81
    v_lshlrev_b32 v80, 16, v219
    v_and_b32 v81, 0xffff0000, v219
    v_add_f32 v80, v80, v22
    v_add_f32 v81, v81, v23
    v_cvt_pk_bf16_f32 v219, v80, v81
    s_add_u32 s30, s38, 73728
    buffer_store_dwordx4 v[216:219], v13, s[20:23], s30 offen
L_gemm3_kernel_fin:
    s_endpgm
L_gemm3_kernel_end:
    s_endpgm
L_text_end:
.section .rodata,"a"
.p2align 6
.amdhsa_kernel ln_kernel
  .amdhsa_next_free_vgpr 72
  .amdhsa_next_free_sgpr 48
  .amdhsa_accum_offset 72
  .amdhsa_group_segment_fixed_size 0
  .amdhsa_kernarg_size 88
  .amdhsa_user_sgpr_count 2
  .amdhsa_user_sgpr_kernarg_segment_ptr 1
  .amdhsa_system_sgpr_workgroup_id_x 1
  .amdhsa_float_denorm_mode_32 3
.end_amdhsa_kernel
.p2align 6
.amdhsa_kernel gemm1_kernel
  .amdhsa_next_free_vgpr 256
  .amdhsa_next_free_sgpr 100
  .amdhsa_accum_offset 112
  .amdhsa_group_segment_fixed_size 0
  .amdhsa_kernarg_size 88
  .amdhsa_user_sgpr_count 2
  .amdhsa_user_sgpr_kernarg_segment_ptr 1
  .amdhsa_system_sgpr_workgroup_id_x 1
  .amdhsa_float_denorm_mode_32 3
.end_amdhsa_kernel
.p2align 6
.amdhsa_kernel gemm2_kernel
  .amdhsa_next_free_vgpr 512
  .amdhsa_next_free_sgpr 100
  .amdhsa_accum_offset 256
  .amdhsa_group_segment_fixed_size 0
  .amdhsa_kernarg_size 88
  .amdhsa_user_sgpr_count 2
  .amdhsa_user_sgpr_kernarg_segment_ptr 1
  .amdhsa_system_sgpr_workgroup_id_x 1
  .amdhsa_float_denorm_mode_32 3
.end_amdhsa_kernel
.p2align 6
.amdhsa_kernel gemm3_kernel
  .amdhsa_next_free_vgpr 220
  .amdhsa_next_free_sgpr 100
  .amdhsa_accum_offset 220
  .amdhsa_group_segment_fixed_size 0
  .amdhsa_kernarg_size 88
  .amdhsa_user_sgpr_count 2
  .amdhsa_user_sgpr_kernarg_segment_ptr 1
  .amdhsa_system_sgpr_workgroup_id_x 1
  .amdhsa_float_denorm_mode_32 3
.end_amdhsa_kernel
```
